```python
import torch

def _softmax(x, axis=-1):
    return torch.softmax(x, dim=axis)
def _gelu(x):
    return torch.nn.functional.gelu(x, approximate="tanh")
def _silu(x):
    return torch.nn.functional.silu(x)
def _sigmoid(x):
    return torch.sigmoid(x)
def _layernorm(x, axis=-1, eps=1e-5):
    m = x.mean(dim=axis, keepdim=True)
    v = x.var(dim=axis, keepdim=True, unbiased=False)
    return (x - m) / torch.sqrt(v + eps)
def _scatter_add(tgt, idx, src, axis=0):
    return tgt.clone().index_add_(axis, idx, src)
def _segment_sum(src, seg, n):
    out = torch.zeros((n,) + src.shape[1:], dtype=src.dtype)
    return out.index_add_(0, seg, src)
def _pad(x, pw):
    flat = tuple(v for pair in reversed(pw) for v in pair)
    return torch.nn.functional.pad(x, flat)

kernel_name = 'interleave_layers__softmax_full_mha__mixer_token_mlp__prompt'

def setup_inputs():

    _w = (lambda a: (lambda t: t.to(torch.bfloat16) if t.is_floating_point() else t)(torch.as_tensor(a)))
    def _A_setup():
        B, S, D = 1, 2048, 512
        return {
            "x": _w((lambda *s: torch.randn(*s, dtype=torch.bfloat16) * 0.05)(B, S, D)),
            "wqkv": _w((lambda *s: torch.randn(*s, dtype=torch.bfloat16) * 0.05)(D, 3 * D)),
            "wo": _w((lambda *s: torch.randn(*s, dtype=torch.bfloat16) * 0.05)(D, D)),
        }
    _A_in = _A_setup()

    def _B_setup():
        B, S, D, F = 1, 2048, 512, 1792
        return {
            "x": _w((lambda *s: torch.randn(*s, dtype=torch.bfloat16) * 0.05)(B, S, D)),
            "w1": _w((lambda *s: torch.randn(*s, dtype=torch.bfloat16) * 0.8)(S, F) * (S ** -0.5)),
            "b1": _w((lambda *s: torch.randn(*s, dtype=torch.bfloat16) * 12.8)(F) * 0.02),
            "w2": _w((lambda *s: torch.randn(*s, dtype=torch.bfloat16) * 0.2)(F, S) * (F ** -0.5)),
            "b2": _w((lambda *s: torch.randn(*s, dtype=torch.bfloat16) * 3.2)(S) * 0.02),
        }
    _B_in = _B_setup()

    return {
        "A_x": _A_in["x"],
        "A_wqkv": _A_in["wqkv"],
        "A_wo": _A_in["wo"],
        "B_x": _B_in["x"],
        "B_w1": _B_in["w1"],
        "B_b1": _B_in["b1"],
        "B_w2": _B_in["w2"],
        "B_b2": _B_in["b2"],
    }

def reference(A_x, A_wqkv, A_wo, B_x, B_w1, B_b1, B_w2, B_b2):
    def _A_ref(x, wqkv, wo):
        B, S, D = x.shape
        H = 32; Dh = D // H
        qkv = (lambda x, *d: x.permute(*d))((x @ wqkv).reshape(B, S, 3, H, Dh), 2, 0, 3, 1, 4)
        q, k, v = qkv[0], qkv[1], qkv[2]
        scale = Dh ** -0.5
        scores = torch.einsum("bhqd,bhkd->bhqk", q, k) * scale
        p = _softmax(scores, axis=-1)
        o = torch.einsum("bhqk,bhkd->bhqd", p, v)
        return (lambda x, *d: x.permute(*d))(o, 0, 2, 1, 3).reshape(B, S, D) @ wo

    def _B_ref(x, w1, b1, w2, b2):
        B, S, D = x.shape
        h = _layernorm(x, axis=-1)
        u = torch.einsum("bsd,sf->bdf", h, w1) + b1
        u = _gelu(u)
        y = torch.einsum("bdf,fs->bds", u, w2) + b2
        return (lambda x, *d: x.permute(*d))(y, 0, 2, 1)

    x = A_x
    x = x + _A_ref(_layernorm(x, axis=-1), A_wqkv, A_wo)
    x = x + _B_ref(_layernorm(x, axis=-1), B_w1, B_b1, B_w2, B_b2)
    x = x + _A_ref(_layernorm(x, axis=-1), A_wqkv, A_wo)
    x = x + _B_ref(_layernorm(x, axis=-1), B_w1, B_b1, B_w2, B_b2)
    return x
```

```asm
; @launch grid=(256,1,1) block=(256,1,1) lds=163840
.amdgcn_target "amdgcn-amd-amdhsa--gfx950"
.text
.p2align 12
.globl interleave_layers__softmax_full_mha__mixer_token_mlp__prompt_kernel
.p2align 8
.type interleave_layers__softmax_full_mha__mixer_token_mlp__prompt_kernel,@function
interleave_layers__softmax_full_mha__mixer_token_mlp__prompt_kernel:
    s_load_dwordx2 s[64:65], s[0:1], 0
    s_load_dwordx2 s[4:5], s[0:1], 8
    s_load_dwordx2 s[12:13], s[0:1], 80
    s_load_dwordx2 s[8:9], s[0:1], 16
    s_load_dwordx2 s[48:49], s[0:1], 32
    s_load_dwordx2 s[56:57], s[0:1], 40
    s_load_dwordx2 s[52:53], s[0:1], 48
    s_load_dwordx2 s[60:61], s[0:1], 56
    s_load_dwordx2 s[68:69], s[0:1], 64
    s_load_dwordx2 s[80:81], s[0:1], 72
    s_cmp_ge_u32 s2, 256
    s_cbranch_scc1 L_kb_end
    v_lshrrev_b32 v11, 6, v0
    v_and_b32 v1, 63, v0
    s_and_b32 s17, s2, 7
    v_readfirstlane_b32 s16, v11
    s_lshr_b32 s18, s2, 3
    v_lshlrev_b32 v2, 4, v1
    s_lshl_b32 s20, s17, 2
    s_and_b32 s24, s18, 3
    s_add_u32 s20, s20, s24
    s_lshr_b32 s21, s18, 2
    s_getpc_b64 s[86:87]
L_pc:
    s_lshl_b32 s24, s18, 2
    s_add_u32 s24, s24, s16
    s_lshl_b32 s24, s24, 7
    v_lshlrev_b32 v11, 14, v1
    v_add_u32 v11, s24, v11
    v_min_u32 v11, L_kb_end-L_pc, v11
    global_load_dword v136, v11, s[86:87]
    s_mov_b32 s66, 0x200000
    s_mov_b32 s67, 0x20000
    s_mov_b32 s6, 0x180000
    s_mov_b32 s7, 0x20000
    v_lshrrev_b32 v3, 3, v1
    v_and_b32 v13, 7, v1
    v_lshlrev_b32 v14, 4, v13
    v_lshl_add_u32 v144, v3, 10, v14
    v_add_u32 v145, 8192, v144
    s_lshl_b32 s26, s20, 16
    s_lshl_b32 s25, s16, 14
    s_add_u32 s26, s26, s25
    s_mul_i32 s27, s2, 6144
    s_lshl_b32 s25, s16, 11
    s_add_u32 s27, s27, s25
    s_add_u32 s24, s21, 0
    s_and_b32 s24, s24, 7
    s_lshl_b32 s24, s24, 7
    s_add_u32 s72, s24, s26
    s_add_u32 s24, s21, 1
    s_and_b32 s24, s24, 7
    s_lshl_b32 s24, s24, 7
    s_add_u32 s73, s24, s26
    s_add_u32 s24, s21, 2
    s_and_b32 s24, s24, 7
    s_lshl_b32 s24, s24, 7
    s_add_u32 s74, s24, s26
    s_add_u32 s24, s21, 3
    s_and_b32 s24, s24, 7
    s_lshl_b32 s24, s24, 7
    s_add_u32 s75, s24, s26
    s_add_u32 s24, s21, 4
    s_and_b32 s24, s24, 7
    s_lshl_b32 s24, s24, 7
    s_add_u32 s76, s24, s26
    s_add_u32 s24, s21, 5
    s_and_b32 s24, s24, 7
    s_lshl_b32 s24, s24, 7
    s_add_u32 s77, s24, s26
    s_add_u32 s24, s21, 6
    s_and_b32 s24, s24, 7
    s_lshl_b32 s24, s24, 7
    s_add_u32 s78, s24, s26
    s_add_u32 s24, s21, 7
    s_and_b32 s24, s24, 7
    s_lshl_b32 s24, s24, 7
    s_add_u32 s79, s24, s26
    s_waitcnt lgkmcnt(0)
    buffer_load_dwordx4 v[40:43], v144, s[64:67], s72 offen
    buffer_load_dwordx4 v[72:75], v145, s[64:67], s72 offen
    buffer_load_dwordx4 v[136:139], v2, s[4:7], s27 offen
    buffer_load_dwordx4 v[136:139], v2, s[4:7], s27 offen offset:1024
    buffer_load_dwordx4 v[44:47], v144, s[64:67], s73 offen
    buffer_load_dwordx4 v[76:79], v145, s[64:67], s73 offen
    buffer_load_dwordx4 v[48:51], v144, s[64:67], s74 offen
    buffer_load_dwordx4 v[80:83], v145, s[64:67], s74 offen
    s_mov_b32 s14, 0x2000000
    s_mov_b32 s15, 0x20000
    s_mov_b32 s10, 0x80000
    s_mov_b32 s11, 0x20000
    s_mov_b32 s50, 0x700000
    s_mov_b32 s51, 0x20000
    s_mov_b32 s58, 0xe00
    s_mov_b32 s59, 0x20000
    s_mov_b32 s54, 0x700000
    s_mov_b32 s55, 0x20000
    s_mov_b32 s62, 0x1000
    s_mov_b32 s63, 0x20000
    s_mov_b32 s70, 0x200000
    s_mov_b32 s71, 0x20000
    s_mov_b32 s82, 0x100
    s_mov_b32 s83, 0x20000
    s_cmp_lg_u32 s16, 0
    s_cbranch_scc1 L_nozero
    v_and_b32 v11, 3, v1
    v_lshlrev_b32 v11, 7, v11
    v_bfe_u32 v12, v1, 2, 1
    v_lshl_add_u32 v11, v12, 24, v11
    v_lshlrev_b32 v12, 7, v13
    v_mov_b32 v146, 0
    s_lshl_b32 s24, s2, 9
    s_add_u32 s24, s24, 14680064
    s_lshl_b32 s25, s2, 10
    s_add_u32 s25, s25, 14811136
    s_mov_b64 exec, 0xff
    buffer_store_dword v146, v11, s[12:15], s24 offen sc1
    buffer_store_dword v146, v12, s[12:15], s25 offen sc1
    s_mov_b64 exec, -1
L_nozero:
    s_and_b32 s24, s18, 3
    s_and_b32 s25, s17, 1
    s_lshl_b32 s25, s25, 2
    s_add_u32 s36, s25, s24
    s_lshr_b32 s25, s17, 1
    s_mul_i32 s25, s25, 7
    s_min_u32 s26, s21, 6
    s_add_u32 s37, s25, s26
    s_lshr_b32 s22, s16, 1
    s_and_b32 s23, s16, 1
    s_mov_b32 s35, 0
    s_mov_b32 s19, 0
    v_bfe_u32 v12, v1, 4, 1
    v_lshlrev_b32 v12, 2, v12
    v_xor_b32 v12, v12, v1
    v_and_b32 v12, 7, v12
    v_lshlrev_b32 v8, 4, v12
    v_bfe_u32 v12, v1, 2, 2
    v_lshlrev_b32 v11, 7, v12
    v_and_b32 v12, 3, v1
    v_lshl_add_u32 v11, v12, 3, v11
    v_bfe_u32 v12, v1, 4, 1
    v_lshl_add_u32 v11, v12, 5, v11
    v_bfe_u32 v12, v1, 3, 1
    v_lshl_add_u32 v11, v12, 6, v11
    v_lshrrev_b32 v12, 5, v1
    v_lshl_add_u32 v9, v12, 9, v11
    s_lshl_b32 s34, s16, 15
    s_mul_i32 s91, s16, 262144
    s_lshl_b32 s24, s20, 7
    s_add_u32 s91, s91, s24
    s_lshl_b32 s24, s23, 8
    v_xor_b32 v19, s24, v2
    s_mul_i32 s24, s16, 6144
    s_add_u32 s24, s24, 131072
    v_add_u32 v18, s24, v2
    s_xor_b32 s24, s16, 1
    s_mul_i32 s24, s24, 6144
    s_add_u32 s24, s24, 131072
    v_add_u32 v15, s24, v2
    s_xor_b32 s24, s16, 2
    s_mul_i32 s24, s24, 6144
    s_add_u32 s24, s24, 133120
    v_add_u32 v16, s24, v2
    s_xor_b32 s24, s16, 3
    s_mul_i32 s24, s24, 6144
    s_add_u32 s24, s24, 135168
    v_add_u32 v17, s24, v2
    v_mul_u32_u24 v4, 3072, v3
    v_add_u32 v4, v4, v8
    v_add_u32 v5, 23552, v4
    s_mul_i32 s96, s16, 24576
    s_lshl_b32 s24, s21, 7
    s_add_u32 s95, s96, s24
    s_mul_i32 s96, s22, 196608
    s_mul_i32 s25, s23, 49152
    s_add_u32 s96, s96, s25
    s_add_u32 s96, s96, s24
    s_mul_i32 s24, s20, 0
    s_add_u32 s95, s95, s24
    s_add_u32 s96, s96, s24
    s_lshl_b32 s97, s16, 11
    s_add_u32 s97, s97, 67584
    s_lshl_b32 s24, s21, 2
    s_lshl_b32 s25, s23, 1
    s_add_u32 s24, s24, s25
    s_lshl_b32 s24, s24, 6
    s_lshl_b32 s25, s20, 1
    s_add_u32 s25, s25, s22
    s_add_u32 s24, s24, s25
    s_lshl_b32 s98, s24, 10
    s_add_u32 s98, s98, 0
    s_add_u32 s99, s98, 65536
    s_lshl_b32 s100, s24, 11
    s_add_u32 s100, s100, 2097152
    s_add_u32 s101, s100, 131072
    s_lshl_b32 s24, s23, 6
    v_and_b32 v11, 0x1ff, v9
    v_xor_b32 v11, s24, v11
    v_add_u32 v11, 67584, v11
    v_lshrrev_b32 v12, 5, v1
    v_lshl_add_u32 v153, v12, 11, v11
    v_add_u32 v154, 65536, v153
    v_lshl_add_u32 v157, v12, 10, v11
    v_add_u32 v158, 65536, v157
    s_mul_i32 s24, s22, 33792
    v_add_u32 v152, s24, v2
    v_lshl_add_u32 v152, v12, 4, v152
    v_and_b32 v156, 15, v1
    v_lshlrev_b32 v156, 4, v156
    v_lshrrev_b32 v12, 5, v1
    v_lshl_add_u32 v156, v12, 8, v156
    v_bfe_u32 v12, v1, 4, 1
    v_lshl_add_u32 v156, v12, 17, v156
    v_and_b32 v155, 0x33, v1
    v_bfe_u32 v12, v1, 2, 1
    v_lshl_add_u32 v155, v12, 3, v155
    v_bfe_u32 v12, v1, 3, 1
    v_lshl_add_u32 v155, v12, 2, v155
    v_lshlrev_b32 v155, 4, v155
    v_and_b32 v11, 1, v1
    v_lshlrev_b32 v11, 7, v11
    v_bfe_u32 v12, v1, 1, 2
    v_lshl_add_u32 v20, v12, 2, v11
    v_and_b32 v151, 7, v1
    v_lshlrev_b32 v151, 7, v151
    s_min_u32 s24, s16, 2
    s_lshl_b32 s24, s24, 10
    s_mul_i32 s31, s20, 49152
    s_add_u32 s31, s31, s24
    s_lshl_b32 s25, s21, 7
    s_add_u32 s31, s31, s25
    v_lshrrev_b32 v11, 5, v1
    v_mul_u32_u24 v148, 24576, v11
    v_and_b32 v12, 31, v1
    v_lshl_add_u32 v148, v12, 2, v148
    v_lshlrev_b32 v12, 10, v12
    v_lshl_add_u32 v149, v11, 3, v12
    s_lshl_b32 s29, s20, 16
    s_lshl_b32 s24, s22, 15
    s_add_u32 s29, s29, s24
    s_add_u32 s29, s29, s25
    s_lshl_b32 s24, s23, 5
    s_add_u32 s29, s29, s24
    s_lshl_b32 s24, s21, 12
    s_lshl_b32 s25, s17, 9
    s_add_u32 s24, s24, s25
    s_add_u32 s28, s24, 14712832
    v_lshrrev_b32 v11, 1, v13
    v_mul_u32_u24 v12, 1056, v11
    v_and_b32 v11, 1, v13
    v_mul_u32_u24 v11, 528, v11
    v_add_u32 v12, v11, v12
    v_lshl_add_u32 v12, v3, 4, v12
    s_mul_i32 s24, s22, 33792
    s_lshl_b32 s25, s23, 8
    s_add_u32 s24, s24, s25
    v_add_u32 v12, s24, v12
    v_mov_b32 v146, 0x3f803f80
    s_bfe_u32 s24, s72, 0x30007
    s_mul_i32 s24, s24, 4224
    v_add_u32 v24, s24, v12
    s_bfe_u32 s24, s73, 0x30007
    s_mul_i32 s24, s24, 4224
    v_add_u32 v25, s24, v12
    s_bfe_u32 s24, s74, 0x30007
    s_mul_i32 s24, s24, 4224
    v_add_u32 v26, s24, v12
    s_bfe_u32 s24, s75, 0x30007
    s_mul_i32 s24, s24, 4224
    v_add_u32 v27, s24, v12
    s_bfe_u32 s24, s76, 0x30007
    s_mul_i32 s24, s24, 4224
    v_add_u32 v28, s24, v12
    s_bfe_u32 s24, s77, 0x30007
    s_mul_i32 s24, s24, 4224
    v_add_u32 v29, s24, v12
    s_bfe_u32 s24, s78, 0x30007
    s_mul_i32 s24, s24, 4224
    v_add_u32 v30, s24, v12
    s_bfe_u32 s24, s79, 0x30007
    s_mul_i32 s24, s24, 4224
    v_add_u32 v31, s24, v12
    v_mov_b32 v140, 0
    v_mov_b32 v141, 0
    v_mov_b32 v142, 0
    v_mov_b32 v143, 0
    s_cmp_lg_u32 s16, 0
    s_cbranch_scc1 L_ts_E_0
    s_mov_b64 exec, 0
    s_branch L_pad_E_0
L_ret_E_0:
    s_mov_b64 exec, -1
L_ts_E_0:
    s_cmp_lg_u32 s16, 1
    s_cbranch_scc1 L_ts_E_1
    s_mov_b64 exec, 0
    s_branch L_pad_E_1
L_ret_E_1:
    s_mov_b64 exec, -1
L_ts_E_1:
    s_cmp_lg_u32 s16, 2
    s_cbranch_scc1 L_ts_E_2
    s_mov_b64 exec, 0
    s_branch L_pad_E_2
L_ret_E_2:
    s_mov_b64 exec, -1
L_ts_E_2:
    s_cmp_lg_u32 s16, 3
    s_cbranch_scc1 L_ts_E_3
    s_mov_b64 exec, 0
    s_branch L_ret_E_3
L_ret_E_3:
    s_mov_b64 exec, -1
L_ts_E_3:
    s_waitcnt vmcnt(6)
    buffer_load_dwordx4 v[52:55], v144, s[64:67], s75 offen
    buffer_load_dwordx4 v[84:87], v145, s[64:67], s75 offen
    buffer_load_dwordx4 v[56:59], v144, s[64:67], s76 offen
    buffer_load_dwordx4 v[88:91], v145, s[64:67], s76 offen
    v_dot2_f32_bf16 v140, v40, v146, v140
    v_dot2_f32_bf16 v141, v40, v40, v141
    v_lshlrev_b32 v104, 16, v40
    v_and_b32 v105, 0xffff0000, v40
    v_dot2_f32_bf16 v140, v41, v146, v140
    v_dot2_f32_bf16 v141, v41, v41, v141
    v_lshlrev_b32 v106, 16, v41
    v_and_b32 v107, 0xffff0000, v41
    v_dot2_f32_bf16 v140, v42, v146, v140
    v_dot2_f32_bf16 v141, v42, v42, v141
    v_lshlrev_b32 v108, 16, v42
    v_and_b32 v109, 0xffff0000, v42
    v_dot2_f32_bf16 v140, v43, v146, v140
    v_dot2_f32_bf16 v141, v43, v43, v141
    v_lshlrev_b32 v110, 16, v43
    v_and_b32 v111, 0xffff0000, v43
    v_dot2_f32_bf16 v142, v72, v146, v142
    v_dot2_f32_bf16 v143, v72, v72, v143
    v_lshlrev_b32 v192, 16, v72
    v_and_b32 v193, 0xffff0000, v72
    v_dot2_f32_bf16 v142, v73, v146, v142
    v_dot2_f32_bf16 v143, v73, v73, v143
    v_lshlrev_b32 v194, 16, v73
    v_and_b32 v195, 0xffff0000, v73
    v_dot2_f32_bf16 v142, v74, v146, v142
    v_dot2_f32_bf16 v143, v74, v74, v143
    v_lshlrev_b32 v196, 16, v74
    v_and_b32 v197, 0xffff0000, v74
    v_dot2_f32_bf16 v142, v75, v146, v142
    v_dot2_f32_bf16 v143, v75, v75, v143
    v_lshlrev_b32 v198, 16, v75
    v_and_b32 v199, 0xffff0000, v75
    s_waitcnt vmcnt(6)
    buffer_load_dwordx4 v[60:63], v144, s[64:67], s77 offen
    buffer_load_dwordx4 v[92:95], v145, s[64:67], s77 offen
    buffer_load_dwordx4 v[64:67], v144, s[64:67], s78 offen
    buffer_load_dwordx4 v[96:99], v145, s[64:67], s78 offen
    v_dot2_f32_bf16 v140, v44, v146, v140
    v_dot2_f32_bf16 v141, v44, v44, v141
    v_lshlrev_b32 v112, 16, v44
    v_and_b32 v113, 0xffff0000, v44
    v_dot2_f32_bf16 v140, v45, v146, v140
    v_dot2_f32_bf16 v141, v45, v45, v141
    v_lshlrev_b32 v114, 16, v45
    v_and_b32 v115, 0xffff0000, v45
    v_dot2_f32_bf16 v140, v46, v146, v140
    v_dot2_f32_bf16 v141, v46, v46, v141
    v_lshlrev_b32 v116, 16, v46
    v_and_b32 v117, 0xffff0000, v46
    v_dot2_f32_bf16 v140, v47, v146, v140
    v_dot2_f32_bf16 v141, v47, v47, v141
    v_lshlrev_b32 v118, 16, v47
    v_and_b32 v119, 0xffff0000, v47
    v_dot2_f32_bf16 v142, v76, v146, v142
    v_dot2_f32_bf16 v143, v76, v76, v143
    v_lshlrev_b32 v200, 16, v76
    v_and_b32 v201, 0xffff0000, v76
    v_dot2_f32_bf16 v142, v77, v146, v142
    v_dot2_f32_bf16 v143, v77, v77, v143
    v_lshlrev_b32 v202, 16, v77
    v_and_b32 v203, 0xffff0000, v77
    v_dot2_f32_bf16 v142, v78, v146, v142
    v_dot2_f32_bf16 v143, v78, v78, v143
    v_lshlrev_b32 v204, 16, v78
    v_and_b32 v205, 0xffff0000, v78
    v_dot2_f32_bf16 v142, v79, v146, v142
    v_dot2_f32_bf16 v143, v79, v79, v143
    v_lshlrev_b32 v206, 16, v79
    v_and_b32 v207, 0xffff0000, v79
    s_waitcnt vmcnt(8)
    buffer_load_dwordx4 v[68:71], v144, s[64:67], s79 offen
    buffer_load_dwordx4 v[100:103], v145, s[64:67], s79 offen
    s_add_u32 m0, s97, 0
    s_add_u32 s84, s95, 1024
    buffer_load_dwordx4 v4, s[4:7], s84 offen lds
    buffer_load_dwordx4 v4, s[4:7], s84 offen offset:1024 lds
    v_dot2_f32_bf16 v140, v48, v146, v140
    v_dot2_f32_bf16 v141, v48, v48, v141
    v_lshlrev_b32 v120, 16, v48
    v_and_b32 v121, 0xffff0000, v48
    v_dot2_f32_bf16 v140, v49, v146, v140
    v_dot2_f32_bf16 v141, v49, v49, v141
    v_lshlrev_b32 v122, 16, v49
    v_and_b32 v123, 0xffff0000, v49
    v_dot2_f32_bf16 v140, v50, v146, v140
    v_dot2_f32_bf16 v141, v50, v50, v141
    v_lshlrev_b32 v124, 16, v50
    v_and_b32 v125, 0xffff0000, v50
    v_dot2_f32_bf16 v140, v51, v146, v140
    v_dot2_f32_bf16 v141, v51, v51, v141
    v_lshlrev_b32 v126, 16, v51
    v_and_b32 v127, 0xffff0000, v51
    v_dot2_f32_bf16 v142, v80, v146, v142
    v_dot2_f32_bf16 v143, v80, v80, v143
    v_lshlrev_b32 v208, 16, v80
    v_and_b32 v209, 0xffff0000, v80
    v_dot2_f32_bf16 v142, v81, v146, v142
    v_dot2_f32_bf16 v143, v81, v81, v143
    v_lshlrev_b32 v210, 16, v81
    v_and_b32 v211, 0xffff0000, v81
    v_dot2_f32_bf16 v142, v82, v146, v142
    v_dot2_f32_bf16 v143, v82, v82, v143
    v_lshlrev_b32 v212, 16, v82
    v_and_b32 v213, 0xffff0000, v82
    v_dot2_f32_bf16 v142, v83, v146, v142
    v_dot2_f32_bf16 v143, v83, v83, v143
    v_lshlrev_b32 v214, 16, v83
    v_and_b32 v215, 0xffff0000, v83
    s_waitcnt vmcnt(10)
    s_cmp_lg_u32 s16, 0
    s_cbranch_scc1 L_ia_1
    s_getreg_b32 s24, hwreg(HW_REG_XCC_ID, 0, 4)
    s_mul_i32 s25, s24, s24
    s_lshl_b32 s25, s25, 18
    s_lshl_b32 s24, s24, 8
    s_add_u32 s24, s24, s25
    s_add_u32 s24, s24, 1
    v_mov_b32 v11, s24
    s_and_b32 s24, s17, 1
    s_lshl_b32 s24, s24, 7
    s_lshr_b32 s25, s17, 1
    s_lshl_b32 s25, s25, 2
    s_add_u32 s24, s24, s25
    v_mov_b32 v12, 0
    s_mov_b64 exec, 1
    buffer_atomic_add v11, v12, s[80:83], s24 offen sc1
    s_mov_b64 exec, -1
L_ia_1:
    s_add_u32 m0, s97, 8192
    s_add_u32 s84, s95, 197632
    buffer_load_dwordx4 v4, s[4:7], s84 offen lds
    buffer_load_dwordx4 v4, s[4:7], s84 offen offset:1024 lds
    v_dot2_f32_bf16 v140, v52, v146, v140
    v_dot2_f32_bf16 v141, v52, v52, v141
    v_lshlrev_b32 v128, 16, v52
    v_and_b32 v129, 0xffff0000, v52
    v_dot2_f32_bf16 v140, v53, v146, v140
    v_dot2_f32_bf16 v141, v53, v53, v141
    v_lshlrev_b32 v130, 16, v53
    v_and_b32 v131, 0xffff0000, v53
    v_dot2_f32_bf16 v140, v54, v146, v140
    v_dot2_f32_bf16 v141, v54, v54, v141
    v_lshlrev_b32 v132, 16, v54
    v_and_b32 v133, 0xffff0000, v54
    v_dot2_f32_bf16 v140, v55, v146, v140
    v_dot2_f32_bf16 v141, v55, v55, v141
    v_lshlrev_b32 v134, 16, v55
    v_and_b32 v135, 0xffff0000, v55
    v_dot2_f32_bf16 v142, v84, v146, v142
    v_dot2_f32_bf16 v143, v84, v84, v143
    v_lshlrev_b32 v216, 16, v84
    v_and_b32 v217, 0xffff0000, v84
    v_dot2_f32_bf16 v142, v85, v146, v142
    v_dot2_f32_bf16 v143, v85, v85, v143
    v_lshlrev_b32 v218, 16, v85
    v_and_b32 v219, 0xffff0000, v85
    v_dot2_f32_bf16 v142, v86, v146, v142
    v_dot2_f32_bf16 v143, v86, v86, v143
    v_lshlrev_b32 v220, 16, v86
    v_and_b32 v221, 0xffff0000, v86
    v_dot2_f32_bf16 v142, v87, v146, v142
    v_dot2_f32_bf16 v143, v87, v87, v143
    v_lshlrev_b32 v222, 16, v87
    v_and_b32 v223, 0xffff0000, v87
    s_waitcnt vmcnt(10)
    s_add_u32 m0, s97, 16384
    s_add_u32 s84, s96, 0
    buffer_load_dwordx4 v4, s[4:7], s84 offen lds
    buffer_load_dwordx4 v5, s[4:7], s84 offen offset:1024 lds
    v_dot2_f32_bf16 v140, v56, v146, v140
    v_dot2_f32_bf16 v141, v56, v56, v141
    v_lshlrev_b32 v160, 16, v56
    v_and_b32 v161, 0xffff0000, v56
    v_dot2_f32_bf16 v140, v57, v146, v140
    v_dot2_f32_bf16 v141, v57, v57, v141
    v_lshlrev_b32 v162, 16, v57
    v_and_b32 v163, 0xffff0000, v57
    v_dot2_f32_bf16 v140, v58, v146, v140
    v_dot2_f32_bf16 v141, v58, v58, v141
    v_lshlrev_b32 v164, 16, v58
    v_and_b32 v165, 0xffff0000, v58
    v_dot2_f32_bf16 v140, v59, v146, v140
    v_dot2_f32_bf16 v141, v59, v59, v141
    v_lshlrev_b32 v166, 16, v59
    v_and_b32 v167, 0xffff0000, v59
    v_dot2_f32_bf16 v142, v88, v146, v142
    v_dot2_f32_bf16 v143, v88, v88, v143
    v_lshlrev_b32 v224, 16, v88
    v_and_b32 v225, 0xffff0000, v88
    v_dot2_f32_bf16 v142, v89, v146, v142
    v_dot2_f32_bf16 v143, v89, v89, v143
    v_lshlrev_b32 v226, 16, v89
    v_and_b32 v227, 0xffff0000, v89
    v_dot2_f32_bf16 v142, v90, v146, v142
    v_dot2_f32_bf16 v143, v90, v90, v143
    v_lshlrev_b32 v228, 16, v90
    v_and_b32 v229, 0xffff0000, v90
    v_dot2_f32_bf16 v142, v91, v146, v142
    v_dot2_f32_bf16 v143, v91, v91, v143
    v_lshlrev_b32 v230, 16, v91
    v_and_b32 v231, 0xffff0000, v91
    s_waitcnt vmcnt(10)
    s_add_u32 m0, s97, 24576
    s_add_u32 s84, s95, 394240
    buffer_load_dwordx4 v4, s[4:7], s84 offen lds
    buffer_load_dwordx4 v4, s[4:7], s84 offen offset:1024 lds
    v_dot2_f32_bf16 v140, v60, v146, v140
    v_dot2_f32_bf16 v141, v60, v60, v141
    v_lshlrev_b32 v168, 16, v60
    v_and_b32 v169, 0xffff0000, v60
    v_dot2_f32_bf16 v140, v61, v146, v140
    v_dot2_f32_bf16 v141, v61, v61, v141
    v_lshlrev_b32 v170, 16, v61
    v_and_b32 v171, 0xffff0000, v61
    v_dot2_f32_bf16 v140, v62, v146, v140
    v_dot2_f32_bf16 v141, v62, v62, v141
    v_lshlrev_b32 v172, 16, v62
    v_and_b32 v173, 0xffff0000, v62
    v_dot2_f32_bf16 v140, v63, v146, v140
    v_dot2_f32_bf16 v141, v63, v63, v141
    v_lshlrev_b32 v174, 16, v63
    v_and_b32 v175, 0xffff0000, v63
    v_dot2_f32_bf16 v142, v92, v146, v142
    v_dot2_f32_bf16 v143, v92, v92, v143
    v_lshlrev_b32 v232, 16, v92
    v_and_b32 v233, 0xffff0000, v92
    v_dot2_f32_bf16 v142, v93, v146, v142
    v_dot2_f32_bf16 v143, v93, v93, v143
    v_lshlrev_b32 v234, 16, v93
    v_and_b32 v235, 0xffff0000, v93
    v_dot2_f32_bf16 v142, v94, v146, v142
    v_dot2_f32_bf16 v143, v94, v94, v143
    v_lshlrev_b32 v236, 16, v94
    v_and_b32 v237, 0xffff0000, v94
    v_dot2_f32_bf16 v142, v95, v146, v142
    v_dot2_f32_bf16 v143, v95, v95, v143
L_pad_E_0:
    s_cbranch_execz L_ret_E_0
    v_lshlrev_b32 v238, 16, v95
    v_and_b32 v239, 0xffff0000, v95
    s_waitcnt vmcnt(10)
    s_add_u32 m0, s97, 32768
    s_add_u32 s84, s95, 590848
    buffer_load_dwordx4 v4, s[4:7], s84 offen lds
    buffer_load_dwordx4 v4, s[4:7], s84 offen offset:1024 lds
    v_dot2_f32_bf16 v140, v64, v146, v140
    v_dot2_f32_bf16 v141, v64, v64, v141
    v_lshlrev_b32 v176, 16, v64
    v_and_b32 v177, 0xffff0000, v64
    v_dot2_f32_bf16 v140, v65, v146, v140
    v_dot2_f32_bf16 v141, v65, v65, v141
    v_lshlrev_b32 v178, 16, v65
    v_and_b32 v179, 0xffff0000, v65
    v_dot2_f32_bf16 v140, v66, v146, v140
    v_dot2_f32_bf16 v141, v66, v66, v141
    v_lshlrev_b32 v180, 16, v66
    v_and_b32 v181, 0xffff0000, v66
    v_dot2_f32_bf16 v140, v67, v146, v140
    v_dot2_f32_bf16 v141, v67, v67, v141
    v_lshlrev_b32 v182, 16, v67
    v_and_b32 v183, 0xffff0000, v67
    v_dot2_f32_bf16 v142, v96, v146, v142
    v_dot2_f32_bf16 v143, v96, v96, v143
    v_lshlrev_b32 v240, 16, v96
    v_and_b32 v241, 0xffff0000, v96
    v_dot2_f32_bf16 v142, v97, v146, v142
    v_dot2_f32_bf16 v143, v97, v97, v143
    v_lshlrev_b32 v242, 16, v97
    v_and_b32 v243, 0xffff0000, v97
    v_dot2_f32_bf16 v142, v98, v146, v142
    v_dot2_f32_bf16 v143, v98, v98, v143
    v_lshlrev_b32 v244, 16, v98
    v_and_b32 v245, 0xffff0000, v98
    v_dot2_f32_bf16 v142, v99, v146, v142
    v_dot2_f32_bf16 v143, v99, v99, v143
    v_lshlrev_b32 v246, 16, v99
    v_and_b32 v247, 0xffff0000, v99
    s_waitcnt vmcnt(10)
    s_add_u32 m0, s97, 40960
    s_add_u32 s84, s96, 393216
    buffer_load_dwordx4 v4, s[4:7], s84 offen lds
    buffer_load_dwordx4 v5, s[4:7], s84 offen offset:1024 lds
    v_dot2_f32_bf16 v140, v68, v146, v140
    v_dot2_f32_bf16 v141, v68, v68, v141
    v_dot2_f32_bf16 v140, v69, v146, v140
    v_dot2_f32_bf16 v141, v69, v69, v141
    v_dot2_f32_bf16 v140, v70, v146, v140
    v_dot2_f32_bf16 v141, v70, v70, v141
    v_dot2_f32_bf16 v140, v71, v146, v140
    v_dot2_f32_bf16 v141, v71, v71, v141
    v_dot2_f32_bf16 v142, v100, v146, v142
    v_dot2_f32_bf16 v143, v100, v100, v143
    v_dot2_f32_bf16 v142, v101, v146, v142
    v_dot2_f32_bf16 v143, v101, v101, v143
    v_dot2_f32_bf16 v142, v102, v146, v142
    v_dot2_f32_bf16 v143, v102, v102, v143
    v_dot2_f32_bf16 v142, v103, v146, v142
    v_dot2_f32_bf16 v143, v103, v103, v143
    v_lshlrev_b32 v254, 16, v103
    v_and_b32 v255, 0xffff0000, v103
    v_lshlrev_b32 v252, 16, v102
    v_and_b32 v253, 0xffff0000, v102
    v_add_f32_dpp v140, v140, v140 quad_perm:[1,0,3,2] row_mask:0xf bank_mask:0xf
    v_add_f32_dpp v141, v141, v141 quad_perm:[1,0,3,2] row_mask:0xf bank_mask:0xf
    v_add_f32_dpp v142, v142, v142 quad_perm:[1,0,3,2] row_mask:0xf bank_mask:0xf
    v_add_f32_dpp v143, v143, v143 quad_perm:[1,0,3,2] row_mask:0xf bank_mask:0xf
    v_add_f32_dpp v140, v140, v140 quad_perm:[2,3,0,1] row_mask:0xf bank_mask:0xf
    v_add_f32_dpp v141, v141, v141 quad_perm:[2,3,0,1] row_mask:0xf bank_mask:0xf
    v_add_f32_dpp v142, v142, v142 quad_perm:[2,3,0,1] row_mask:0xf bank_mask:0xf
    v_add_f32_dpp v143, v143, v143 quad_perm:[2,3,0,1] row_mask:0xf bank_mask:0xf
    v_add_f32_dpp v140, v140, v140 row_half_mirror row_mask:0xf bank_mask:0xf
    v_add_f32_dpp v141, v141, v141 row_half_mirror row_mask:0xf bank_mask:0xf
    v_add_f32_dpp v142, v142, v142 row_half_mirror row_mask:0xf bank_mask:0xf
    v_add_f32_dpp v143, v143, v143 row_half_mirror row_mask:0xf bank_mask:0xf
    v_mul_f32 v140, 0x3b000000, v140
    v_mul_f32 v141, 0x3b000000, v141
    v_fma_f32 v141, -v140, v140, v141
    v_max_f32 v141, 0, v141
    v_add_f32 v141, 0x3727c5ac, v141
    v_rsq_f32 v141, v141
    v_lshlrev_b32 v250, 16, v101
    v_and_b32 v251, 0xffff0000, v101
    v_mul_f32 v140, v140, v141
    v_mul_f32 v142, 0x3b000000, v142
    v_mul_f32 v143, 0x3b000000, v143
    v_fma_f32 v143, -v142, v142, v143
    v_max_f32 v143, 0, v143
    v_add_f32 v143, 0x3727c5ac, v143
    v_rsq_f32 v143, v143
    v_lshlrev_b32 v248, 16, v100
    v_and_b32 v249, 0xffff0000, v100
    v_mul_f32 v142, v142, v143
    v_lshlrev_b32 v184, 16, v68
    v_and_b32 v185, 0xffff0000, v68
    v_lshlrev_b32 v186, 16, v69
    v_and_b32 v187, 0xffff0000, v69
    v_lshlrev_b32 v188, 16, v70
    v_and_b32 v189, 0xffff0000, v70
    v_lshlrev_b32 v190, 16, v71
    v_and_b32 v191, 0xffff0000, v71
    v_pk_fma_f32 v[104:105], v[104:105], v[140:141], v[140:141] op_sel:[0,1,0] op_sel_hi:[1,1,0] neg_lo:[0,0,1] neg_hi:[0,0,1]
    v_pk_fma_f32 v[106:107], v[106:107], v[140:141], v[140:141] op_sel:[0,1,0] op_sel_hi:[1,1,0] neg_lo:[0,0,1] neg_hi:[0,0,1]
    v_pk_fma_f32 v[108:109], v[108:109], v[140:141], v[140:141] op_sel:[0,1,0] op_sel_hi:[1,1,0] neg_lo:[0,0,1] neg_hi:[0,0,1]
    v_pk_fma_f32 v[110:111], v[110:111], v[140:141], v[140:141] op_sel:[0,1,0] op_sel_hi:[1,1,0] neg_lo:[0,0,1] neg_hi:[0,0,1]
    v_cvt_pk_bf16_f32 v40, v104, v105
    v_cvt_pk_bf16_f32 v41, v106, v107
    v_cvt_pk_bf16_f32 v42, v108, v109
    v_cvt_pk_bf16_f32 v43, v110, v111
    ds_write_b128 v24, v[40:43] offset:0
    v_pk_fma_f32 v[192:193], v[192:193], v[142:143], v[142:143] op_sel:[0,1,0] op_sel_hi:[1,1,0] neg_lo:[0,0,1] neg_hi:[0,0,1]
    v_pk_fma_f32 v[194:195], v[194:195], v[142:143], v[142:143] op_sel:[0,1,0] op_sel_hi:[1,1,0] neg_lo:[0,0,1] neg_hi:[0,0,1]
    v_pk_fma_f32 v[196:197], v[196:197], v[142:143], v[142:143] op_sel:[0,1,0] op_sel_hi:[1,1,0] neg_lo:[0,0,1] neg_hi:[0,0,1]
    v_pk_fma_f32 v[198:199], v[198:199], v[142:143], v[142:143] op_sel:[0,1,0] op_sel_hi:[1,1,0] neg_lo:[0,0,1] neg_hi:[0,0,1]
    v_cvt_pk_bf16_f32 v72, v192, v193
    v_cvt_pk_bf16_f32 v73, v194, v195
    v_cvt_pk_bf16_f32 v74, v196, v197
    v_cvt_pk_bf16_f32 v75, v198, v199
    ds_write_b128 v24, v[72:75] offset:128
    v_pk_fma_f32 v[112:113], v[112:113], v[140:141], v[140:141] op_sel:[0,1,0] op_sel_hi:[1,1,0] neg_lo:[0,0,1] neg_hi:[0,0,1]
    v_pk_fma_f32 v[114:115], v[114:115], v[140:141], v[140:141] op_sel:[0,1,0] op_sel_hi:[1,1,0] neg_lo:[0,0,1] neg_hi:[0,0,1]
    v_pk_fma_f32 v[116:117], v[116:117], v[140:141], v[140:141] op_sel:[0,1,0] op_sel_hi:[1,1,0] neg_lo:[0,0,1] neg_hi:[0,0,1]
    v_pk_fma_f32 v[118:119], v[118:119], v[140:141], v[140:141] op_sel:[0,1,0] op_sel_hi:[1,1,0] neg_lo:[0,0,1] neg_hi:[0,0,1]
    v_cvt_pk_bf16_f32 v44, v112, v113
    v_cvt_pk_bf16_f32 v45, v114, v115
    v_cvt_pk_bf16_f32 v46, v116, v117
    v_cvt_pk_bf16_f32 v47, v118, v119
    ds_write_b128 v25, v[44:47] offset:0
    v_pk_fma_f32 v[200:201], v[200:201], v[142:143], v[142:143] op_sel:[0,1,0] op_sel_hi:[1,1,0] neg_lo:[0,0,1] neg_hi:[0,0,1]
    v_pk_fma_f32 v[202:203], v[202:203], v[142:143], v[142:143] op_sel:[0,1,0] op_sel_hi:[1,1,0] neg_lo:[0,0,1] neg_hi:[0,0,1]
    v_pk_fma_f32 v[204:205], v[204:205], v[142:143], v[142:143] op_sel:[0,1,0] op_sel_hi:[1,1,0] neg_lo:[0,0,1] neg_hi:[0,0,1]
    v_pk_fma_f32 v[206:207], v[206:207], v[142:143], v[142:143] op_sel:[0,1,0] op_sel_hi:[1,1,0] neg_lo:[0,0,1] neg_hi:[0,0,1]
    v_cvt_pk_bf16_f32 v76, v200, v201
    v_cvt_pk_bf16_f32 v77, v202, v203
    v_cvt_pk_bf16_f32 v78, v204, v205
    v_cvt_pk_bf16_f32 v79, v206, v207
    ds_write_b128 v25, v[76:79] offset:128
    s_add_u32 m0, s97, 49152
    s_add_u32 s84, s95, 787456
    buffer_load_dwordx4 v4, s[4:7], s84 offen lds
    buffer_load_dwordx4 v4, s[4:7], s84 offen offset:1024 lds
    v_pk_fma_f32 v[120:121], v[120:121], v[140:141], v[140:141] op_sel:[0,1,0] op_sel_hi:[1,1,0] neg_lo:[0,0,1] neg_hi:[0,0,1]
    v_pk_fma_f32 v[122:123], v[122:123], v[140:141], v[140:141] op_sel:[0,1,0] op_sel_hi:[1,1,0] neg_lo:[0,0,1] neg_hi:[0,0,1]
    v_pk_fma_f32 v[124:125], v[124:125], v[140:141], v[140:141] op_sel:[0,1,0] op_sel_hi:[1,1,0] neg_lo:[0,0,1] neg_hi:[0,0,1]
    v_pk_fma_f32 v[126:127], v[126:127], v[140:141], v[140:141] op_sel:[0,1,0] op_sel_hi:[1,1,0] neg_lo:[0,0,1] neg_hi:[0,0,1]
    v_cvt_pk_bf16_f32 v48, v120, v121
    v_cvt_pk_bf16_f32 v49, v122, v123
    v_cvt_pk_bf16_f32 v50, v124, v125
    v_cvt_pk_bf16_f32 v51, v126, v127
    ds_write_b128 v26, v[48:51] offset:0
    v_pk_fma_f32 v[208:209], v[208:209], v[142:143], v[142:143] op_sel:[0,1,0] op_sel_hi:[1,1,0] neg_lo:[0,0,1] neg_hi:[0,0,1]
    v_pk_fma_f32 v[210:211], v[210:211], v[142:143], v[142:143] op_sel:[0,1,0] op_sel_hi:[1,1,0] neg_lo:[0,0,1] neg_hi:[0,0,1]
    v_pk_fma_f32 v[212:213], v[212:213], v[142:143], v[142:143] op_sel:[0,1,0] op_sel_hi:[1,1,0] neg_lo:[0,0,1] neg_hi:[0,0,1]
    v_pk_fma_f32 v[214:215], v[214:215], v[142:143], v[142:143] op_sel:[0,1,0] op_sel_hi:[1,1,0] neg_lo:[0,0,1] neg_hi:[0,0,1]
    v_cvt_pk_bf16_f32 v80, v208, v209
    v_cvt_pk_bf16_f32 v81, v210, v211
    v_cvt_pk_bf16_f32 v82, v212, v213
    v_cvt_pk_bf16_f32 v83, v214, v215
    ds_write_b128 v26, v[80:83] offset:128
    v_pk_fma_f32 v[128:129], v[128:129], v[140:141], v[140:141] op_sel:[0,1,0] op_sel_hi:[1,1,0] neg_lo:[0,0,1] neg_hi:[0,0,1]
    v_pk_fma_f32 v[130:131], v[130:131], v[140:141], v[140:141] op_sel:[0,1,0] op_sel_hi:[1,1,0] neg_lo:[0,0,1] neg_hi:[0,0,1]
    v_pk_fma_f32 v[132:133], v[132:133], v[140:141], v[140:141] op_sel:[0,1,0] op_sel_hi:[1,1,0] neg_lo:[0,0,1] neg_hi:[0,0,1]
    v_pk_fma_f32 v[134:135], v[134:135], v[140:141], v[140:141] op_sel:[0,1,0] op_sel_hi:[1,1,0] neg_lo:[0,0,1] neg_hi:[0,0,1]
    v_cvt_pk_bf16_f32 v52, v128, v129
    v_cvt_pk_bf16_f32 v53, v130, v131
    v_cvt_pk_bf16_f32 v54, v132, v133
    v_cvt_pk_bf16_f32 v55, v134, v135
    ds_write_b128 v27, v[52:55] offset:0
    v_pk_fma_f32 v[216:217], v[216:217], v[142:143], v[142:143] op_sel:[0,1,0] op_sel_hi:[1,1,0] neg_lo:[0,0,1] neg_hi:[0,0,1]
    v_pk_fma_f32 v[218:219], v[218:219], v[142:143], v[142:143] op_sel:[0,1,0] op_sel_hi:[1,1,0] neg_lo:[0,0,1] neg_hi:[0,0,1]
    v_pk_fma_f32 v[220:221], v[220:221], v[142:143], v[142:143] op_sel:[0,1,0] op_sel_hi:[1,1,0] neg_lo:[0,0,1] neg_hi:[0,0,1]
    v_pk_fma_f32 v[222:223], v[222:223], v[142:143], v[142:143] op_sel:[0,1,0] op_sel_hi:[1,1,0] neg_lo:[0,0,1] neg_hi:[0,0,1]
    v_cvt_pk_bf16_f32 v84, v216, v217
    v_cvt_pk_bf16_f32 v85, v218, v219
    v_cvt_pk_bf16_f32 v86, v220, v221
    v_cvt_pk_bf16_f32 v87, v222, v223
    ds_write_b128 v27, v[84:87] offset:128
    s_add_u32 m0, s97, 57344
    s_add_u32 s84, s95, 984064
    buffer_load_dwordx4 v4, s[4:7], s84 offen lds
    buffer_load_dwordx4 v4, s[4:7], s84 offen offset:1024 lds
    v_pk_fma_f32 v[160:161], v[160:161], v[140:141], v[140:141] op_sel:[0,1,0] op_sel_hi:[1,1,0] neg_lo:[0,0,1] neg_hi:[0,0,1]
    v_pk_fma_f32 v[162:163], v[162:163], v[140:141], v[140:141] op_sel:[0,1,0] op_sel_hi:[1,1,0] neg_lo:[0,0,1] neg_hi:[0,0,1]
    v_pk_fma_f32 v[164:165], v[164:165], v[140:141], v[140:141] op_sel:[0,1,0] op_sel_hi:[1,1,0] neg_lo:[0,0,1] neg_hi:[0,0,1]
    v_pk_fma_f32 v[166:167], v[166:167], v[140:141], v[140:141] op_sel:[0,1,0] op_sel_hi:[1,1,0] neg_lo:[0,0,1] neg_hi:[0,0,1]
    v_cvt_pk_bf16_f32 v56, v160, v161
    v_cvt_pk_bf16_f32 v57, v162, v163
    v_cvt_pk_bf16_f32 v58, v164, v165
    v_cvt_pk_bf16_f32 v59, v166, v167
    ds_write_b128 v28, v[56:59] offset:0
    v_pk_fma_f32 v[224:225], v[224:225], v[142:143], v[142:143] op_sel:[0,1,0] op_sel_hi:[1,1,0] neg_lo:[0,0,1] neg_hi:[0,0,1]
    v_pk_fma_f32 v[226:227], v[226:227], v[142:143], v[142:143] op_sel:[0,1,0] op_sel_hi:[1,1,0] neg_lo:[0,0,1] neg_hi:[0,0,1]
    v_pk_fma_f32 v[228:229], v[228:229], v[142:143], v[142:143] op_sel:[0,1,0] op_sel_hi:[1,1,0] neg_lo:[0,0,1] neg_hi:[0,0,1]
    v_pk_fma_f32 v[230:231], v[230:231], v[142:143], v[142:143] op_sel:[0,1,0] op_sel_hi:[1,1,0] neg_lo:[0,0,1] neg_hi:[0,0,1]
    v_cvt_pk_bf16_f32 v88, v224, v225
    v_cvt_pk_bf16_f32 v89, v226, v227
    v_cvt_pk_bf16_f32 v90, v228, v229
    v_cvt_pk_bf16_f32 v91, v230, v231
    ds_write_b128 v28, v[88:91] offset:128
    v_pk_fma_f32 v[168:169], v[168:169], v[140:141], v[140:141] op_sel:[0,1,0] op_sel_hi:[1,1,0] neg_lo:[0,0,1] neg_hi:[0,0,1]
    v_pk_fma_f32 v[170:171], v[170:171], v[140:141], v[140:141] op_sel:[0,1,0] op_sel_hi:[1,1,0] neg_lo:[0,0,1] neg_hi:[0,0,1]
    v_pk_fma_f32 v[172:173], v[172:173], v[140:141], v[140:141] op_sel:[0,1,0] op_sel_hi:[1,1,0] neg_lo:[0,0,1] neg_hi:[0,0,1]
    v_pk_fma_f32 v[174:175], v[174:175], v[140:141], v[140:141] op_sel:[0,1,0] op_sel_hi:[1,1,0] neg_lo:[0,0,1] neg_hi:[0,0,1]
    v_cvt_pk_bf16_f32 v60, v168, v169
    v_cvt_pk_bf16_f32 v61, v170, v171
    v_cvt_pk_bf16_f32 v62, v172, v173
    v_cvt_pk_bf16_f32 v63, v174, v175
    ds_write_b128 v29, v[60:63] offset:0
    v_pk_fma_f32 v[232:233], v[232:233], v[142:143], v[142:143] op_sel:[0,1,0] op_sel_hi:[1,1,0] neg_lo:[0,0,1] neg_hi:[0,0,1]
    v_pk_fma_f32 v[234:235], v[234:235], v[142:143], v[142:143] op_sel:[0,1,0] op_sel_hi:[1,1,0] neg_lo:[0,0,1] neg_hi:[0,0,1]
    v_pk_fma_f32 v[236:237], v[236:237], v[142:143], v[142:143] op_sel:[0,1,0] op_sel_hi:[1,1,0] neg_lo:[0,0,1] neg_hi:[0,0,1]
    v_pk_fma_f32 v[238:239], v[238:239], v[142:143], v[142:143] op_sel:[0,1,0] op_sel_hi:[1,1,0] neg_lo:[0,0,1] neg_hi:[0,0,1]
    v_cvt_pk_bf16_f32 v92, v232, v233
    v_cvt_pk_bf16_f32 v93, v234, v235
    v_cvt_pk_bf16_f32 v94, v236, v237
    v_cvt_pk_bf16_f32 v95, v238, v239
    ds_write_b128 v29, v[92:95] offset:128
    s_add_u32 m0, s97, 65536
    s_add_u32 s84, s96, 786432
    buffer_load_dwordx4 v4, s[4:7], s84 offen lds
    buffer_load_dwordx4 v5, s[4:7], s84 offen offset:1024 lds
    v_pk_fma_f32 v[176:177], v[176:177], v[140:141], v[140:141] op_sel:[0,1,0] op_sel_hi:[1,1,0] neg_lo:[0,0,1] neg_hi:[0,0,1]
    v_pk_fma_f32 v[178:179], v[178:179], v[140:141], v[140:141] op_sel:[0,1,0] op_sel_hi:[1,1,0] neg_lo:[0,0,1] neg_hi:[0,0,1]
    v_pk_fma_f32 v[180:181], v[180:181], v[140:141], v[140:141] op_sel:[0,1,0] op_sel_hi:[1,1,0] neg_lo:[0,0,1] neg_hi:[0,0,1]
    v_pk_fma_f32 v[182:183], v[182:183], v[140:141], v[140:141] op_sel:[0,1,0] op_sel_hi:[1,1,0] neg_lo:[0,0,1] neg_hi:[0,0,1]
    v_cvt_pk_bf16_f32 v64, v176, v177
    v_cvt_pk_bf16_f32 v65, v178, v179
    v_cvt_pk_bf16_f32 v66, v180, v181
    v_cvt_pk_bf16_f32 v67, v182, v183
    ds_write_b128 v30, v[64:67] offset:0
    v_pk_fma_f32 v[240:241], v[240:241], v[142:143], v[142:143] op_sel:[0,1,0] op_sel_hi:[1,1,0] neg_lo:[0,0,1] neg_hi:[0,0,1]
    v_pk_fma_f32 v[242:243], v[242:243], v[142:143], v[142:143] op_sel:[0,1,0] op_sel_hi:[1,1,0] neg_lo:[0,0,1] neg_hi:[0,0,1]
    v_pk_fma_f32 v[244:245], v[244:245], v[142:143], v[142:143] op_sel:[0,1,0] op_sel_hi:[1,1,0] neg_lo:[0,0,1] neg_hi:[0,0,1]
    v_pk_fma_f32 v[246:247], v[246:247], v[142:143], v[142:143] op_sel:[0,1,0] op_sel_hi:[1,1,0] neg_lo:[0,0,1] neg_hi:[0,0,1]
    v_cvt_pk_bf16_f32 v96, v240, v241
    v_cvt_pk_bf16_f32 v97, v242, v243
    v_cvt_pk_bf16_f32 v98, v244, v245
    v_cvt_pk_bf16_f32 v99, v246, v247
    ds_write_b128 v30, v[96:99] offset:128
    v_pk_fma_f32 v[184:185], v[184:185], v[140:141], v[140:141] op_sel:[0,1,0] op_sel_hi:[1,1,0] neg_lo:[0,0,1] neg_hi:[0,0,1]
    v_pk_fma_f32 v[186:187], v[186:187], v[140:141], v[140:141] op_sel:[0,1,0] op_sel_hi:[1,1,0] neg_lo:[0,0,1] neg_hi:[0,0,1]
    v_pk_fma_f32 v[188:189], v[188:189], v[140:141], v[140:141] op_sel:[0,1,0] op_sel_hi:[1,1,0] neg_lo:[0,0,1] neg_hi:[0,0,1]
    v_pk_fma_f32 v[190:191], v[190:191], v[140:141], v[140:141] op_sel:[0,1,0] op_sel_hi:[1,1,0] neg_lo:[0,0,1] neg_hi:[0,0,1]
    v_cvt_pk_bf16_f32 v68, v184, v185
    v_cvt_pk_bf16_f32 v69, v186, v187
    v_cvt_pk_bf16_f32 v70, v188, v189
    v_cvt_pk_bf16_f32 v71, v190, v191
    ds_write_b128 v31, v[68:71] offset:0
    v_pk_fma_f32 v[248:249], v[248:249], v[142:143], v[142:143] op_sel:[0,1,0] op_sel_hi:[1,1,0] neg_lo:[0,0,1] neg_hi:[0,0,1]
    v_pk_fma_f32 v[250:251], v[250:251], v[142:143], v[142:143] op_sel:[0,1,0] op_sel_hi:[1,1,0] neg_lo:[0,0,1] neg_hi:[0,0,1]
    v_pk_fma_f32 v[252:253], v[252:253], v[142:143], v[142:143] op_sel:[0,1,0] op_sel_hi:[1,1,0] neg_lo:[0,0,1] neg_hi:[0,0,1]
    v_pk_fma_f32 v[254:255], v[254:255], v[142:143], v[142:143] op_sel:[0,1,0] op_sel_hi:[1,1,0] neg_lo:[0,0,1] neg_hi:[0,0,1]
    v_cvt_pk_bf16_f32 v100, v248, v249
    v_cvt_pk_bf16_f32 v101, v250, v251
    v_cvt_pk_bf16_f32 v102, v252, v253
    v_cvt_pk_bf16_f32 v103, v254, v255
    ds_write_b128 v31, v[100:103] offset:128
    s_add_u32 m0, s97, 73728
    s_add_u32 s84, s95, 1180672
    buffer_load_dwordx4 v4, s[4:7], s84 offen lds
    buffer_load_dwordx4 v4, s[4:7], s84 offen offset:1024 lds
    s_waitcnt lgkmcnt(0)
    s_waitcnt vmcnt(14)
    s_barrier
    ds_read_b128 v[88:91], v152 offset:0
    ds_read_b64_tr_b16 v[104:105], v153 offset:0
    ds_read_b64_tr_b16 v[106:107], v153 offset:512
    ds_read_b64_tr_b16 v[108:109], v153 offset:1024
    ds_read_b64_tr_b16 v[110:111], v153 offset:1536
    ds_read_b64_tr_b16 v[92:93], v157 offset:16384
    ds_read_b64_tr_b16 v[94:95], v157 offset:16896
    ds_read_b128 v[96:99], v152 offset:1056
    ds_read_b64_tr_b16 v[112:113], v153 offset:4096
    ds_read_b64_tr_b16 v[114:115], v153 offset:4608
    ds_read_b64_tr_b16 v[116:117], v153 offset:5120
    ds_read_b64_tr_b16 v[118:119], v153 offset:5632
    ds_read_b64_tr_b16 v[100:101], v157 offset:18432
    ds_read_b64_tr_b16 v[102:103], v157 offset:18944
    s_waitcnt lgkmcnt(7)
    v_mfma_f32_32x32x16_bf16 v[40:55], v[104:107], v[88:91], 0
    ds_read_b64_tr_b16 v[104:105], v153 offset:8192
    ds_read_b64_tr_b16 v[106:107], v153 offset:8704
    s_add_u32 m0, s97, 81920
    s_add_u32 s84, s95, 1377280
    buffer_load_dwordx4 v4, s[4:7], s84 offen lds
    v_mfma_f32_32x32x16_bf16 v[56:71], v[88:91], v[108:111], 0
    ds_read_b64_tr_b16 v[108:109], v153 offset:9216
    ds_read_b64_tr_b16 v[110:111], v153 offset:9728
    buffer_load_dwordx4 v4, s[4:7], s84 offen offset:1024 lds
    v_mfma_f32_32x32x16_bf16 v[72:87], v[92:95], v[88:91], 0
    ds_read_b128 v[88:91], v152 offset:4224
    ds_read_b64_tr_b16 v[92:93], v157 offset:20480
    ds_read_b64_tr_b16 v[94:95], v157 offset:20992
    s_waitcnt lgkmcnt(7)
    v_mfma_f32_32x32x16_bf16 v[40:55], v[112:115], v[96:99], v[40:55]
    ds_read_b64_tr_b16 v[112:113], v153 offset:12288
    ds_read_b64_tr_b16 v[114:115], v153 offset:12800
    v_mfma_f32_32x32x16_bf16 v[56:71], v[96:99], v[116:119], v[56:71]
    ds_read_b64_tr_b16 v[116:117], v153 offset:13312
    ds_read_b64_tr_b16 v[118:119], v153 offset:13824
    v_mfma_f32_32x32x16_bf16 v[72:87], v[100:103], v[96:99], v[72:87]
    ds_read_b128 v[96:99], v152 offset:5280
    ds_read_b64_tr_b16 v[100:101], v157 offset:22528
    ds_read_b64_tr_b16 v[102:103], v157 offset:23040
    s_waitcnt lgkmcnt(7)
    v_mfma_f32_32x32x16_bf16 v[40:55], v[104:107], v[88:91], v[40:55]
    s_waitcnt vmcnt(10)
    s_barrier
    ds_read_b64_tr_b16 v[104:105], v153 offset:24576
    ds_read_b64_tr_b16 v[106:107], v153 offset:25088
    s_add_u32 m0, s97, 0
    s_add_u32 s84, s96, 1179648
    buffer_load_dwordx4 v4, s[4:7], s84 offen lds
    v_mfma_f32_32x32x16_bf16 v[56:71], v[88:91], v[108:111], v[56:71]
    ds_read_b64_tr_b16 v[108:109], v153 offset:25600
    ds_read_b64_tr_b16 v[110:111], v153 offset:26112
    buffer_load_dwordx4 v5, s[4:7], s84 offen offset:1024 lds
    v_mfma_f32_32x32x16_bf16 v[72:87], v[92:95], v[88:91], v[72:87]
    ds_read_b128 v[88:91], v152 offset:8448
    ds_read_b64_tr_b16 v[92:93], v157 offset:40960
    ds_read_b64_tr_b16 v[94:95], v157 offset:41472
    s_waitcnt lgkmcnt(7)
    v_mfma_f32_32x32x16_bf16 v[40:55], v[112:115], v[96:99], v[40:55]
    ds_read_b64_tr_b16 v[112:113], v153 offset:28672
    ds_read_b64_tr_b16 v[114:115], v153 offset:29184
    v_mfma_f32_32x32x16_bf16 v[56:71], v[96:99], v[116:119], v[56:71]
    ds_read_b64_tr_b16 v[116:117], v153 offset:29696
    ds_read_b64_tr_b16 v[118:119], v153 offset:30208
    v_mfma_f32_32x32x16_bf16 v[72:87], v[100:103], v[96:99], v[72:87]
    ds_read_b128 v[96:99], v152 offset:9504
    ds_read_b64_tr_b16 v[100:101], v157 offset:43008
    ds_read_b64_tr_b16 v[102:103], v157 offset:43520
    s_waitcnt lgkmcnt(7)
    v_mfma_f32_32x32x16_bf16 v[40:55], v[104:107], v[88:91], v[40:55]
    ds_read_b64_tr_b16 v[104:105], v153 offset:32768
    ds_read_b64_tr_b16 v[106:107], v153 offset:33280
    v_mfma_f32_32x32x16_bf16 v[56:71], v[88:91], v[108:111], v[56:71]
    ds_read_b64_tr_b16 v[108:109], v153 offset:33792
    ds_read_b64_tr_b16 v[110:111], v153 offset:34304
    v_mfma_f32_32x32x16_bf16 v[72:87], v[92:95], v[88:91], v[72:87]
    ds_read_b128 v[88:91], v152 offset:12672
    ds_read_b64_tr_b16 v[92:93], v157 offset:45056
    ds_read_b64_tr_b16 v[94:95], v157 offset:45568
    s_waitcnt lgkmcnt(7)
    v_mfma_f32_32x32x16_bf16 v[40:55], v[112:115], v[96:99], v[40:55]
    ds_read_b64_tr_b16 v[112:113], v153 offset:36864
    ds_read_b64_tr_b16 v[114:115], v153 offset:37376
    v_mfma_f32_32x32x16_bf16 v[56:71], v[96:99], v[116:119], v[56:71]
    ds_read_b64_tr_b16 v[116:117], v153 offset:37888
    ds_read_b64_tr_b16 v[118:119], v153 offset:38400
    v_mfma_f32_32x32x16_bf16 v[72:87], v[100:103], v[96:99], v[72:87]
    ds_read_b128 v[96:99], v152 offset:13728
    ds_read_b64_tr_b16 v[100:101], v157 offset:47104
    ds_read_b64_tr_b16 v[102:103], v157 offset:47616
    s_waitcnt lgkmcnt(7)
    v_mfma_f32_32x32x16_bf16 v[40:55], v[104:107], v[88:91], v[40:55]
    s_waitcnt vmcnt(6)
    s_barrier
    ds_read_b64_tr_b16 v[104:105], v153 offset:49152
    ds_read_b64_tr_b16 v[106:107], v153 offset:49664
    s_add_u32 m0, s97, 8192
    s_add_u32 s84, s95, 99328
    buffer_load_dwordx4 v4, s[4:7], s84 offen lds
    v_mfma_f32_32x32x16_bf16 v[56:71], v[88:91], v[108:111], v[56:71]
    ds_read_b64_tr_b16 v[108:109], v153 offset:50176
    ds_read_b64_tr_b16 v[110:111], v153 offset:50688
    buffer_load_dwordx4 v4, s[4:7], s84 offen offset:1024 lds
    s_add_u32 m0, s97, 16384
    s_add_u32 s84, s95, 295936
    v_mfma_f32_32x32x16_bf16 v[72:87], v[92:95], v[88:91], v[72:87]
    ds_read_b128 v[88:91], v152 offset:16896
    ds_read_b64_tr_b16 v[92:93], v158 offset:0
    ds_read_b64_tr_b16 v[94:95], v158 offset:512
    buffer_load_dwordx4 v4, s[4:7], s84 offen lds
    s_waitcnt lgkmcnt(7)
    v_mfma_f32_32x32x16_bf16 v[40:55], v[112:115], v[96:99], v[40:55]
    ds_read_b64_tr_b16 v[112:113], v153 offset:53248
    ds_read_b64_tr_b16 v[114:115], v153 offset:53760
    buffer_load_dwordx4 v4, s[4:7], s84 offen offset:1024 lds
    s_add_u32 m0, s97, 24576
    s_add_u32 s84, s95, 492544
    v_mfma_f32_32x32x16_bf16 v[56:71], v[96:99], v[116:119], v[56:71]
    ds_read_b64_tr_b16 v[116:117], v153 offset:54272
    ds_read_b64_tr_b16 v[118:119], v153 offset:54784
    buffer_load_dwordx4 v4, s[4:7], s84 offen lds
    buffer_load_dwordx4 v4, s[4:7], s84 offen offset:1024 lds
    v_mfma_f32_32x32x16_bf16 v[72:87], v[100:103], v[96:99], v[72:87]
    ds_read_b128 v[96:99], v152 offset:17952
    ds_read_b64_tr_b16 v[100:101], v158 offset:2048
    ds_read_b64_tr_b16 v[102:103], v158 offset:2560
    s_waitcnt lgkmcnt(7)
    v_mfma_f32_32x32x16_bf16 v[40:55], v[104:107], v[88:91], v[40:55]
    ds_read_b64_tr_b16 v[104:105], v153 offset:57344
    ds_read_b64_tr_b16 v[106:107], v153 offset:57856
    v_mfma_f32_32x32x16_bf16 v[56:71], v[88:91], v[108:111], v[56:71]
    ds_read_b64_tr_b16 v[108:109], v153 offset:58368
    ds_read_b64_tr_b16 v[110:111], v153 offset:58880
    v_mfma_f32_32x32x16_bf16 v[72:87], v[92:95], v[88:91], v[72:87]
    ds_read_b128 v[88:91], v152 offset:21120
    ds_read_b64_tr_b16 v[92:93], v158 offset:4096
    ds_read_b64_tr_b16 v[94:95], v158 offset:4608
    s_waitcnt lgkmcnt(7)
    v_mfma_f32_32x32x16_bf16 v[40:55], v[112:115], v[96:99], v[40:55]
    ds_read_b64_tr_b16 v[112:113], v153 offset:61440
    ds_read_b64_tr_b16 v[114:115], v153 offset:61952
    v_mfma_f32_32x32x16_bf16 v[56:71], v[96:99], v[116:119], v[56:71]
    ds_read_b64_tr_b16 v[116:117], v153 offset:62464
    ds_read_b64_tr_b16 v[118:119], v153 offset:62976
    v_mfma_f32_32x32x16_bf16 v[72:87], v[100:103], v[96:99], v[72:87]
    ds_read_b128 v[96:99], v152 offset:22176
    ds_read_b64_tr_b16 v[100:101], v158 offset:6144
    ds_read_b64_tr_b16 v[102:103], v158 offset:6656
    s_waitcnt lgkmcnt(7)
    v_mfma_f32_32x32x16_bf16 v[40:55], v[104:107], v[88:91], v[40:55]
    s_waitcnt vmcnt(6)
    s_barrier
    ds_read_b64_tr_b16 v[104:105], v154 offset:8192
    ds_read_b64_tr_b16 v[106:107], v154 offset:8704
    s_add_u32 m0, s97, 32768
    s_add_u32 s84, s95, 689152
    buffer_load_dwordx4 v4, s[4:7], s84 offen lds
    v_mfma_f32_32x32x16_bf16 v[56:71], v[88:91], v[108:111], v[56:71]
    ds_read_b64_tr_b16 v[108:109], v154 offset:9216
    ds_read_b64_tr_b16 v[110:111], v154 offset:9728
    buffer_load_dwordx4 v4, s[4:7], s84 offen offset:1024 lds
    s_add_u32 m0, s97, 40960
    s_add_u32 s84, s95, 885760
    v_mfma_f32_32x32x16_bf16 v[72:87], v[92:95], v[88:91], v[72:87]
    ds_read_b128 v[88:91], v152 offset:25344
    ds_read_b64_tr_b16 v[92:93], v157 offset:0
    ds_read_b64_tr_b16 v[94:95], v157 offset:512
    buffer_load_dwordx4 v4, s[4:7], s84 offen lds
    s_waitcnt lgkmcnt(7)
    v_mfma_f32_32x32x16_bf16 v[40:55], v[112:115], v[96:99], v[40:55]
    ds_read_b64_tr_b16 v[112:113], v154 offset:12288
    ds_read_b64_tr_b16 v[114:115], v154 offset:12800
    buffer_load_dwordx4 v4, s[4:7], s84 offen offset:1024 lds
    s_add_u32 m0, s97, 49152
    s_add_u32 s84, s95, 1082368
    v_mfma_f32_32x32x16_bf16 v[56:71], v[96:99], v[116:119], v[56:71]
    ds_read_b64_tr_b16 v[116:117], v154 offset:13312
    ds_read_b64_tr_b16 v[118:119], v154 offset:13824
    buffer_load_dwordx4 v4, s[4:7], s84 offen lds
    buffer_load_dwordx4 v4, s[4:7], s84 offen offset:1024 lds
    v_mfma_f32_32x32x16_bf16 v[72:87], v[100:103], v[96:99], v[72:87]
    ds_read_b128 v[96:99], v152 offset:26400
    ds_read_b64_tr_b16 v[100:101], v157 offset:2048
    ds_read_b64_tr_b16 v[102:103], v157 offset:2560
    s_waitcnt lgkmcnt(7)
    v_mfma_f32_32x32x16_bf16 v[40:55], v[104:107], v[88:91], v[40:55]
    ds_read_b64_tr_b16 v[104:105], v154 offset:16384
    ds_read_b64_tr_b16 v[106:107], v154 offset:16896
    v_mfma_f32_32x32x16_bf16 v[56:71], v[88:91], v[108:111], v[56:71]
    ds_read_b64_tr_b16 v[108:109], v154 offset:17408
    ds_read_b64_tr_b16 v[110:111], v154 offset:17920
    v_mfma_f32_32x32x16_bf16 v[72:87], v[92:95], v[88:91], v[72:87]
    ds_read_b128 v[88:91], v152 offset:29568
    ds_read_b64_tr_b16 v[92:93], v157 offset:4096
    ds_read_b64_tr_b16 v[94:95], v157 offset:4608
    s_waitcnt lgkmcnt(7)
    v_mfma_f32_32x32x16_bf16 v[40:55], v[112:115], v[96:99], v[40:55]
    ds_read_b64_tr_b16 v[112:113], v154 offset:20480
    ds_read_b64_tr_b16 v[114:115], v154 offset:20992
    buffer_load_dword v14, v20, s[80:83], 0 offen sc1
    v_mfma_f32_32x32x16_bf16 v[56:71], v[96:99], v[116:119], v[56:71]
    ds_read_b64_tr_b16 v[116:117], v154 offset:21504
    ds_read_b64_tr_b16 v[118:119], v154 offset:22016
    v_mfma_f32_32x32x16_bf16 v[72:87], v[100:103], v[96:99], v[72:87]
    ds_read_b128 v[96:99], v152 offset:30624
    ds_read_b64_tr_b16 v[100:101], v157 offset:6144
    ds_read_b64_tr_b16 v[102:103], v157 offset:6656
    s_waitcnt lgkmcnt(7)
    v_mfma_f32_32x32x16_bf16 v[40:55], v[104:107], v[88:91], v[40:55]
    s_waitcnt vmcnt(9)
    s_barrier
    ds_read_b64_tr_b16 v[104:105], v153 offset:8192
    ds_read_b64_tr_b16 v[106:107], v153 offset:8704
    s_add_u32 m0, s97, 57344
    s_add_u32 s84, s95, 1278976
    buffer_load_dwordx4 v4, s[4:7], s84 offen lds
    v_mfma_f32_32x32x16_bf16 v[56:71], v[88:91], v[108:111], v[56:71]
    ds_read_b64_tr_b16 v[108:109], v153 offset:9216
    ds_read_b64_tr_b16 v[110:111], v153 offset:9728
    buffer_load_dwordx4 v4, s[4:7], s84 offen offset:1024 lds
    s_add_u32 m0, s97, 65536
    s_add_u32 s84, s95, 1475584
    v_mfma_f32_32x32x16_bf16 v[72:87], v[92:95], v[88:91], v[72:87]
    ds_read_b128 v[88:91], v152 offset:2112
    buffer_load_dwordx4 v4, s[4:7], s84 offen lds
    buffer_load_dwordx4 v4, s[4:7], s84 offen offset:1024 lds
    s_waitcnt lgkmcnt(5)
    v_mfma_f32_32x32x16_bf16 v[40:55], v[112:115], v[96:99], v[40:55]
    ds_read_b64_tr_b16 v[112:113], v153 offset:12288
    ds_read_b64_tr_b16 v[114:115], v153 offset:12800
    s_add_u32 m0, s97, 73728
    s_add_u32 s84, s96, 98304
    buffer_load_dwordx4 v4, s[4:7], s84 offen lds
    v_mfma_f32_32x32x16_bf16 v[56:71], v[96:99], v[116:119], v[56:71]
    ds_read_b64_tr_b16 v[116:117], v153 offset:13312
    ds_read_b64_tr_b16 v[118:119], v153 offset:13824
    buffer_load_dwordx4 v5, s[4:7], s84 offen offset:1024 lds
    v_mfma_f32_32x32x16_bf16 v[72:87], v[100:103], v[96:99], v[72:87]
    ds_read_b128 v[96:99], v152 offset:3168
    s_waitcnt lgkmcnt(5)
    v_mfma_f32_32x32x16_bf16 v[40:55], v[104:107], v[88:91], v[40:55]
    ds_read_b64_tr_b16 v[104:105], v153 offset:16384
    ds_read_b64_tr_b16 v[106:107], v153 offset:16896
    v_mfma_f32_32x32x16_bf16 v[56:71], v[88:91], v[108:111], v[56:71]
    ds_read_b128 v[88:91], v152 offset:6336
    ds_read_b64_tr_b16 v[108:109], v153 offset:17408
    ds_read_b64_tr_b16 v[110:111], v153 offset:17920
    s_waitcnt lgkmcnt(5)
    v_mfma_f32_32x32x16_bf16 v[40:55], v[112:115], v[96:99], v[40:55]
    ds_read_b64_tr_b16 v[112:113], v153 offset:20480
    ds_read_b64_tr_b16 v[114:115], v153 offset:20992
    v_mfma_f32_32x32x16_bf16 v[56:71], v[96:99], v[116:119], v[56:71]
    ds_read_b128 v[96:99], v152 offset:7392
    ds_read_b64_tr_b16 v[116:117], v153 offset:21504
    ds_read_b64_tr_b16 v[118:119], v153 offset:22016
    s_waitcnt lgkmcnt(5)
    v_mfma_f32_32x32x16_bf16 v[40:55], v[104:107], v[88:91], v[40:55]
    s_waitcnt vmcnt(11)
    s_barrier
    ds_read_b64_tr_b16 v[104:105], v153 offset:24576
    ds_read_b64_tr_b16 v[106:107], v153 offset:25088
    s_add_u32 m0, s97, 81920
    s_add_u32 s84, s96, 491520
    buffer_load_dwordx4 v4, s[4:7], s84 offen lds
    v_mfma_f32_32x32x16_bf16 v[56:71], v[88:91], v[108:111], v[56:71]
    ds_read_b128 v[88:91], v152 offset:10560
    ds_read_b64_tr_b16 v[108:109], v153 offset:25600
    ds_read_b64_tr_b16 v[110:111], v153 offset:26112
    buffer_load_dwordx4 v5, s[4:7], s84 offen offset:1024 lds
    s_waitcnt lgkmcnt(5)
    v_mfma_f32_32x32x16_bf16 v[40:55], v[112:115], v[96:99], v[40:55]
    ds_read_b64_tr_b16 v[112:113], v153 offset:28672
    ds_read_b64_tr_b16 v[114:115], v153 offset:29184
    s_add_u32 m0, s97, 0
    s_add_u32 s84, s96, 884736
    buffer_load_dwordx4 v4, s[4:7], s84 offen lds
L_pad_E_1:
    s_cbranch_execz L_ret_E_1
    v_mfma_f32_32x32x16_bf16 v[56:71], v[96:99], v[116:119], v[56:71]
    ds_read_b128 v[96:99], v152 offset:11616
    ds_read_b64_tr_b16 v[116:117], v153 offset:29696
    ds_read_b64_tr_b16 v[118:119], v153 offset:30208
    buffer_load_dwordx4 v5, s[4:7], s84 offen offset:1024 lds
    s_waitcnt lgkmcnt(5)
    v_mfma_f32_32x32x16_bf16 v[40:55], v[104:107], v[88:91], v[40:55]
    ds_read_b64_tr_b16 v[104:105], v153 offset:32768
    ds_read_b64_tr_b16 v[106:107], v153 offset:33280
    s_add_u32 m0, s97, 8192
    s_add_u32 s84, s96, 1277952
    buffer_load_dwordx4 v4, s[4:7], s84 offen lds
    v_mfma_f32_32x32x16_bf16 v[56:71], v[88:91], v[108:111], v[56:71]
    ds_read_b128 v[88:91], v152 offset:14784
    ds_read_b64_tr_b16 v[108:109], v153 offset:33792
    ds_read_b64_tr_b16 v[110:111], v153 offset:34304
    buffer_load_dwordx4 v5, s[4:7], s84 offen offset:1024 lds
    s_waitcnt lgkmcnt(5)
    v_mfma_f32_32x32x16_bf16 v[40:55], v[112:115], v[96:99], v[40:55]
    ds_read_b64_tr_b16 v[112:113], v153 offset:36864
    ds_read_b64_tr_b16 v[114:115], v153 offset:37376
    v_mfma_f32_32x32x16_bf16 v[56:71], v[96:99], v[116:119], v[56:71]
    ds_read_b128 v[96:99], v152 offset:15840
    ds_read_b64_tr_b16 v[116:117], v153 offset:37888
    ds_read_b64_tr_b16 v[118:119], v153 offset:38400
    s_waitcnt lgkmcnt(5)
    v_mfma_f32_32x32x16_bf16 v[40:55], v[104:107], v[88:91], v[40:55]
    s_waitcnt vmcnt(13)
    s_barrier
    ds_read_b64_tr_b16 v[104:105], v153 offset:40960
    ds_read_b64_tr_b16 v[106:107], v153 offset:41472
    v_mfma_f32_32x32x16_bf16 v[56:71], v[88:91], v[108:111], v[56:71]
    ds_read_b128 v[88:91], v152 offset:19008
    ds_read_b64_tr_b16 v[108:109], v153 offset:41984
    ds_read_b64_tr_b16 v[110:111], v153 offset:42496
    s_waitcnt lgkmcnt(5)
    v_mfma_f32_32x32x16_bf16 v[40:55], v[112:115], v[96:99], v[40:55]
    ds_read_b64_tr_b16 v[112:113], v153 offset:45056
    ds_read_b64_tr_b16 v[114:115], v153 offset:45568
    v_mfma_f32_32x32x16_bf16 v[56:71], v[96:99], v[116:119], v[56:71]
    ds_read_b128 v[96:99], v152 offset:20064
    ds_read_b64_tr_b16 v[116:117], v153 offset:46080
    ds_read_b64_tr_b16 v[118:119], v153 offset:46592
    s_waitcnt lgkmcnt(5)
    v_mfma_f32_32x32x16_bf16 v[40:55], v[104:107], v[88:91], v[40:55]
    ds_read_b64_tr_b16 v[104:105], v153 offset:49152
    ds_read_b64_tr_b16 v[106:107], v153 offset:49664
    v_mfma_f32_32x32x16_bf16 v[56:71], v[88:91], v[108:111], v[56:71]
    ds_read_b128 v[88:91], v152 offset:23232
    ds_read_b64_tr_b16 v[108:109], v153 offset:50176
    ds_read_b64_tr_b16 v[110:111], v153 offset:50688
    s_waitcnt lgkmcnt(5)
    v_mfma_f32_32x32x16_bf16 v[40:55], v[112:115], v[96:99], v[40:55]
    ds_read_b64_tr_b16 v[112:113], v153 offset:53248
    ds_read_b64_tr_b16 v[114:115], v153 offset:53760
    v_mfma_f32_32x32x16_bf16 v[56:71], v[96:99], v[116:119], v[56:71]
    ds_read_b128 v[96:99], v152 offset:24288
    ds_read_b64_tr_b16 v[116:117], v153 offset:54272
    ds_read_b64_tr_b16 v[118:119], v153 offset:54784
    s_waitcnt lgkmcnt(5)
    v_mfma_f32_32x32x16_bf16 v[40:55], v[104:107], v[88:91], v[40:55]
    s_waitcnt vmcnt(8)
    s_barrier
    ds_read_b64_tr_b16 v[104:105], v153 offset:57344
    ds_read_b64_tr_b16 v[106:107], v153 offset:57856
    v_mfma_f32_32x32x16_bf16 v[56:71], v[88:91], v[108:111], v[56:71]
    ds_read_b128 v[88:91], v152 offset:27456
    ds_read_b64_tr_b16 v[108:109], v153 offset:58368
    ds_read_b64_tr_b16 v[110:111], v153 offset:58880
    s_waitcnt lgkmcnt(5)
    v_mfma_f32_32x32x16_bf16 v[40:55], v[112:115], v[96:99], v[40:55]
    ds_read_b64_tr_b16 v[112:113], v153 offset:61440
    ds_read_b64_tr_b16 v[114:115], v153 offset:61952
    v_mfma_f32_32x32x16_bf16 v[56:71], v[96:99], v[116:119], v[56:71]
    ds_read_b128 v[96:99], v152 offset:28512
    ds_read_b64_tr_b16 v[116:117], v153 offset:62464
    ds_read_b64_tr_b16 v[118:119], v153 offset:62976
    s_waitcnt lgkmcnt(5)
    v_mfma_f32_32x32x16_bf16 v[40:55], v[104:107], v[88:91], v[40:55]
    ds_read_b64_tr_b16 v[104:105], v154 offset:0
    ds_read_b64_tr_b16 v[106:107], v154 offset:512
    v_mfma_f32_32x32x16_bf16 v[56:71], v[88:91], v[108:111], v[56:71]
    ds_read_b128 v[88:91], v152 offset:31680
    ds_read_b64_tr_b16 v[108:109], v154 offset:1024
    ds_read_b64_tr_b16 v[110:111], v154 offset:1536
    s_waitcnt lgkmcnt(5)
    v_mfma_f32_32x32x16_bf16 v[40:55], v[112:115], v[96:99], v[40:55]
    ds_read_b64_tr_b16 v[112:113], v154 offset:4096
    ds_read_b64_tr_b16 v[114:115], v154 offset:4608
    v_mfma_f32_32x32x16_bf16 v[56:71], v[96:99], v[116:119], v[56:71]
    ds_read_b128 v[96:99], v152 offset:32736
    ds_read_b64_tr_b16 v[116:117], v154 offset:5120
    ds_read_b64_tr_b16 v[118:119], v154 offset:5632
    s_waitcnt lgkmcnt(5)
    v_mfma_f32_32x32x16_bf16 v[40:55], v[104:107], v[88:91], v[40:55]
    s_waitcnt vmcnt(4)
    s_barrier
    ds_read_b64_tr_b16 v[92:93], v158 offset:8192
    ds_read_b64_tr_b16 v[94:95], v158 offset:8704
    v_mfma_f32_32x32x16_bf16 v[56:71], v[88:91], v[108:111], v[56:71]
    ds_read_b128 v[88:91], v152 offset:2112
    s_waitcnt lgkmcnt(3)
    v_mfma_f32_32x32x16_bf16 v[40:55], v[112:115], v[96:99], v[40:55]
    ds_read_b64_tr_b16 v[100:101], v158 offset:10240
    ds_read_b64_tr_b16 v[102:103], v158 offset:10752
    v_mfma_f32_32x32x16_bf16 v[56:71], v[96:99], v[116:119], v[56:71]
    ds_read_b128 v[96:99], v152 offset:3168
    s_waitcnt lgkmcnt(3)
    v_mfma_f32_32x32x16_bf16 v[72:87], v[92:95], v[88:91], v[72:87]
    ds_read_b128 v[88:91], v152 offset:6336
    ds_read_b64_tr_b16 v[92:93], v158 offset:12288
    ds_read_b64_tr_b16 v[94:95], v158 offset:12800
    s_waitcnt lgkmcnt(3)
    v_mfma_f32_32x32x16_bf16 v[72:87], v[100:103], v[96:99], v[72:87]
    ds_read_b128 v[96:99], v152 offset:7392
    ds_read_b64_tr_b16 v[100:101], v158 offset:14336
    ds_read_b64_tr_b16 v[102:103], v158 offset:14848
    s_waitcnt lgkmcnt(3)
    v_mfma_f32_32x32x16_bf16 v[72:87], v[92:95], v[88:91], v[72:87]
    ds_read_b128 v[88:91], v152 offset:10560
    ds_read_b64_tr_b16 v[92:93], v158 offset:16384
    ds_read_b64_tr_b16 v[94:95], v158 offset:16896
    v_cvt_pk_bf16_f32 v40, v40, v41
    v_cvt_pk_bf16_f32 v41, v42, v43
    v_cvt_pk_bf16_f32 v42, v44, v45
    v_cvt_pk_bf16_f32 v43, v46, v47
    v_cvt_pk_bf16_f32 v44, v48, v49
    v_cvt_pk_bf16_f32 v45, v50, v51
    v_cvt_pk_bf16_f32 v46, v52, v53
    v_cvt_pk_bf16_f32 v47, v54, v55
    buffer_store_dwordx4 v[40:43], v155, s[12:15], s100 offen sc1
    buffer_store_dwordx4 v[44:47], v155, s[12:15], s101 offen sc1
    v_cvt_pk_bf16_f32 v56, v56, v57
    v_cvt_pk_bf16_f32 v57, v58, v59
    v_cvt_pk_bf16_f32 v58, v60, v61
    v_cvt_pk_bf16_f32 v59, v62, v63
    v_cvt_pk_bf16_f32 v60, v64, v65
    v_cvt_pk_bf16_f32 v61, v66, v67
    v_cvt_pk_bf16_f32 v62, v68, v69
    v_cvt_pk_bf16_f32 v63, v70, v71
    buffer_store_dwordx4 v[56:59], v156, s[12:15], s100 offen offset:1024 sc1
    buffer_store_dwordx4 v[60:63], v156, s[12:15], s100 offen offset:1536 sc1
    s_waitcnt lgkmcnt(3)
    v_mfma_f32_32x32x16_bf16 v[72:87], v[100:103], v[96:99], v[72:87]
    ds_read_b128 v[96:99], v152 offset:11616
    ds_read_b64_tr_b16 v[100:101], v158 offset:18432
    ds_read_b64_tr_b16 v[102:103], v158 offset:18944
    buffer_load_dword v150, v151, s[12:15], s98 offen
    buffer_load_dword v150, v151, s[12:15], s99 offen
    buffer_load_dword v150, v151, s[12:15], s28 offen sc1
    s_waitcnt lgkmcnt(3)
    v_mfma_f32_32x32x16_bf16 v[72:87], v[92:95], v[88:91], v[72:87]
    ds_read_b128 v[88:91], v152 offset:14784
    ds_read_b64_tr_b16 v[92:93], v158 offset:20480
    ds_read_b64_tr_b16 v[94:95], v158 offset:20992
    s_waitcnt vmcnt(19)
    s_mov_b32 s24, 0
    v_mov_b32 v12, 32
L_iw_2:
    v_and_b32 v11, 255, v14
    v_cmp_lt_u32 vcc, v11, v12
    s_add_u32 s24, s24, 1
    s_cmp_ge_u32 s24, 65536
    s_cbranch_vccz L_iw_2_go
    s_cbranch_scc1 L_iw_2_go
    buffer_load_dword v14, v20, s[80:83], 0 offen sc1
    s_waitcnt vmcnt(0)
    s_branch L_iw_2
L_iw_2_go:
    v_readlane_b32 s24, v14, s17
    s_nop 0
    s_bfe_u32 s25, s24, 0xa0008
    s_mul_i32 s25, s25, s25
    s_lshr_b32 s30, s24, 18
    s_lshl_b32 s30, s30, 5
    s_cmp_eq_u32 s25, s30
    s_cselect_b32 s35, 1, 0
    s_and_b32 s24, s24, 255
    s_cmp_eq_u32 s24, 32
    s_cselect_b32 s35, s35, 0
    v_mov_b32 v132, -1
    v_mov_b32 v133, -1
    v_mov_b32 v134, -1
    v_mov_b32 v135, -1
    s_cmp_eq_u32 s35, 0
    s_cbranch_scc1 L_ls_3_g
    buffer_store_dwordx4 v[132:135], v2, s[12:15], s98 offen
    buffer_store_dwordx4 v[132:135], v2, s[12:15], s99 offen
L_ls_3_d:
    s_waitcnt lgkmcnt(3)
    v_mfma_f32_32x32x16_bf16 v[72:87], v[100:103], v[96:99], v[72:87]
    ds_read_b128 v[96:99], v152 offset:15840
    ds_read_b64_tr_b16 v[100:101], v158 offset:22528
    ds_read_b64_tr_b16 v[102:103], v158 offset:23040
    buffer_load_dword v124, v148, s[4:7], s31 offen offset:0
    buffer_load_dword v125, v148, s[4:7], s31 offen offset:3072
    s_add_u32 s31, s31, 6144
    buffer_load_dword v126, v148, s[4:7], s31 offen offset:0
    buffer_load_dword v127, v148, s[4:7], s31 offen offset:3072
    s_add_u32 s31, s31, 6144
    s_waitcnt lgkmcnt(3)
    v_mfma_f32_32x32x16_bf16 v[72:87], v[92:95], v[88:91], v[72:87]
    s_waitcnt vmcnt(13)
    s_barrier
    ds_read_b128 v[88:91], v152 offset:19008
    ds_read_b64_tr_b16 v[92:93], v157 offset:0
    ds_read_b64_tr_b16 v[94:95], v157 offset:512
    buffer_load_dword v128, v148, s[4:7], s31 offen offset:0
    buffer_load_dword v129, v148, s[4:7], s31 offen offset:3072
    s_add_u32 s31, s31, 6144
    buffer_load_dword v130, v148, s[4:7], s31 offen offset:0
    buffer_load_dword v131, v148, s[4:7], s31 offen offset:3072
    buffer_load_dwordx2 v[24:25], v149, s[64:67], s29 offen offset:0
    s_waitcnt lgkmcnt(3)
    v_mfma_f32_32x32x16_bf16 v[72:87], v[100:103], v[96:99], v[72:87]
    ds_read_b128 v[96:99], v152 offset:20064
    ds_read_b64_tr_b16 v[100:101], v157 offset:2048
    ds_read_b64_tr_b16 v[102:103], v157 offset:2560
    buffer_load_dwordx2 v[26:27], v149, s[64:67], s29 offen offset:16
    buffer_load_dwordx2 v[28:29], v149, s[64:67], s29 offen offset:64
    buffer_load_dwordx2 v[30:31], v149, s[64:67], s29 offen offset:80
    s_waitcnt lgkmcnt(3)
    v_mfma_f32_32x32x16_bf16 v[72:87], v[92:95], v[88:91], v[72:87]
    ds_read_b128 v[88:91], v152 offset:23232
    ds_read_b64_tr_b16 v[92:93], v157 offset:4096
    ds_read_b64_tr_b16 v[94:95], v157 offset:4608
    s_waitcnt lgkmcnt(3)
    v_mfma_f32_32x32x16_bf16 v[72:87], v[100:103], v[96:99], v[72:87]
    ds_read_b128 v[96:99], v152 offset:24288
    ds_read_b64_tr_b16 v[100:101], v157 offset:6144
    ds_read_b64_tr_b16 v[102:103], v157 offset:6656
    s_waitcnt lgkmcnt(3)
    v_mfma_f32_32x32x16_bf16 v[72:87], v[92:95], v[88:91], v[72:87]
    ds_read_b128 v[88:91], v152 offset:27456
    ds_read_b64_tr_b16 v[92:93], v157 offset:8192
    ds_read_b64_tr_b16 v[94:95], v157 offset:8704
    s_waitcnt lgkmcnt(3)
    v_mfma_f32_32x32x16_bf16 v[72:87], v[100:103], v[96:99], v[72:87]
    ds_read_b128 v[96:99], v152 offset:28512
    ds_read_b64_tr_b16 v[100:101], v157 offset:10240
    ds_read_b64_tr_b16 v[102:103], v157 offset:10752
    s_waitcnt lgkmcnt(3)
    v_mfma_f32_32x32x16_bf16 v[72:87], v[92:95], v[88:91], v[72:87]
    ds_read_b128 v[88:91], v152 offset:31680
    ds_read_b64_tr_b16 v[92:93], v157 offset:12288
    ds_read_b64_tr_b16 v[94:95], v157 offset:12800
    s_waitcnt lgkmcnt(3)
    v_mfma_f32_32x32x16_bf16 v[72:87], v[100:103], v[96:99], v[72:87]
    ds_read_b128 v[96:99], v152 offset:32736
    ds_read_b64_tr_b16 v[100:101], v157 offset:14336
    ds_read_b64_tr_b16 v[102:103], v157 offset:14848
    s_waitcnt lgkmcnt(3)
    v_mfma_f32_32x32x16_bf16 v[72:87], v[92:95], v[88:91], v[72:87]
    s_waitcnt lgkmcnt(0)
    v_mfma_f32_32x32x16_bf16 v[72:87], v[100:103], v[96:99], v[72:87]
    s_lshl_b32 s24, s21, 5
    s_add_u32 s24, s24, s20
    s_lshl_b32 s24, s24, 7
    s_add_u32 s72, s24, 14680064
    s_add_u32 s73, s72, 32768
    s_waitcnt vmcnt(12)
    s_barrier
    s_cmp_lg_u32 s16, 0
    s_cbranch_scc1 L_f1_4
    v_mov_b32 v11, 1
    v_mov_b32 v12, 0
    s_mov_b64 exec, 1
    s_cmp_eq_u32 s35, 0
    s_cbranch_scc1 L_ls_5_g
    buffer_store_dword v11, v12, s[12:15], s73 offen
L_ls_5_d:
    s_mov_b64 exec, -1
L_f1_4:
    s_cmp_lg_u32 s16, 1
    s_cbranch_scc1 L_f1_6
    v_mov_b32 v11, 1
    v_mov_b32 v12, 0
    s_mov_b64 exec, 1
    buffer_store_dword v11, v12, s[12:15], s72 offen sc1
    s_mov_b64 exec, -1
L_f1_6:
    v_mov_b32 v148, 0x3eb8aa3b
    v_pk_mul_f32 v[72:73], v[72:73], v[148:149] op_sel_hi:[1,0]
    v_pk_mul_f32 v[74:75], v[74:75], v[148:149] op_sel_hi:[1,0]
    v_pk_mul_f32 v[76:77], v[76:77], v[148:149] op_sel_hi:[1,0]
    v_pk_mul_f32 v[78:79], v[78:79], v[148:149] op_sel_hi:[1,0]
    v_pk_mul_f32 v[80:81], v[80:81], v[148:149] op_sel_hi:[1,0]
    v_pk_mul_f32 v[82:83], v[82:83], v[148:149] op_sel_hi:[1,0]
    v_pk_mul_f32 v[84:85], v[84:85], v[148:149] op_sel_hi:[1,0]
    v_pk_mul_f32 v[86:87], v[86:87], v[148:149] op_sel_hi:[1,0]
    v_cvt_pk_bf16_f32 v72, v72, v73
    v_cvt_pk_bf16_f32 v73, v74, v75
    v_cvt_pk_bf16_f32 v74, v76, v77
    v_cvt_pk_bf16_f32 v75, v78, v79
    v_cvt_pk_bf16_f32 v76, v80, v81
    v_cvt_pk_bf16_f32 v77, v82, v83
    v_cvt_pk_bf16_f32 v78, v84, v85
    v_cvt_pk_bf16_f32 v79, v86, v87
    v_min_u32 v72, -2, v72
    v_min_u32 v73, -2, v73
    v_min_u32 v74, -2, v74
    v_min_u32 v75, -2, v75
    v_min_u32 v76, -2, v76
    v_min_u32 v77, -2, v77
    v_min_u32 v78, -2, v78
    v_min_u32 v79, -2, v79
    s_cmp_eq_u32 s35, 0
    s_cbranch_scc1 L_ls_7_g
    buffer_store_dwordx4 v[72:75], v2, s[12:15], s98 offen
    buffer_store_dwordx4 v[76:79], v2, s[12:15], s99 offen
L_ls_7_d:
    s_lshl_b32 s28, s18, 17
    s_add_u32 s28, s28, 2097152
    s_lshl_b32 s30, s16, 11
    s_add_u32 s24, s28, s30
    v_add_u32 v148, s24, v2
    s_lshl_b32 s29, s17, 14
    s_lshl_b32 s27, s17, 2
    s_add_u32 s27, s27, s16
    s_lshl_b32 s26, s18, 5
    s_add_u32 s26, s26, s27
    s_lshl_b32 s26, s26, 11
    s_add_u32 s26, s26, 0
    s_lshl_b32 s24, s21, 12
    s_lshl_b32 s25, s22, 7
    s_add_u32 s25, s25, s24
    s_add_u32 s76, s25, 14680064
    s_lshl_b32 s25, s17, 9
    s_add_u32 s25, s25, s24
    s_add_u32 s25, s25, 14712832
    s_lshl_b32 s75, s27, 6
    s_add_u32 s75, s75, s18
    s_lshl_b32 s75, s75, 10
    s_add_u32 s75, s75, 6291456
    s_add_u32 s77, s75, 32768
    v_min_u32 v20, 3, v1
    v_lshlrev_b32 v20, 7, v20
    v_and_b32 v11, 1, v1
    v_bfe_u32 v12, v1, 1, 1
    v_lshlrev_b32 v13, 4, v11
    v_lshl_add_u32 v13, v12, 6, v13
    v_bfe_u32 v12, v1, 2, 1
    v_lshl_add_u32 v13, v12, 9, v13
    v_bfe_u32 v12, v1, 3, 2
    v_lshl_add_u32 v13, v12, 11, v13
    v_add_u32 v13, 155648, v13
    v_cmp_eq_u32 vcc, 0, v11
    v_mov_b32 v12, 0x3f803f80
    v_mov_b32 v136, 0xdddd
    v_cndmask_b32 v48, 0, v12, vcc
    v_cndmask_b32 v49, 0, v12, vcc
    v_cndmask_b32 v50, 0, v12, vcc
    v_cndmask_b32 v51, 0, v12, vcc
    ds_write_b128 v13, v[48:51]
    v_add_u32 v146, 24576, v2
    v_add_u32 v147, 90112, v2
    v_and_b32 v11, 15, v1
    v_lshlrev_b32 v12, 4, v11
    v_lshrrev_b32 v13, 5, v1
    v_lshl_add_u32 v12, v13, 8, v12
    v_add_u32 v13, 4, v11
    v_bfe_u32 v13, v13, 3, 1
    v_lshlrev_b32 v13, 6, v13
    v_and_b32 v11, 11, v11
    v_cmp_ne_u32 vcc, 0, v11
    v_add_u32 v13, 155648, v13
    v_add_u32 v14, 16, v13
    v_cndmask_b32 v13, v13, v14, vcc
    v_and_b32 v11, 16, v1
    v_cmp_ne_u32 vcc, 0, v11
    v_add_u32 v140, 25600, v12
    v_add_u32 v141, 58368, v12
    v_add_u32 v142, 91136, v12
    v_add_u32 v143, 123904, v12
    v_add_u32 v144, 132096, v12
    v_add_u32 v145, 140288, v12
    v_cndmask_b32 v140, v140, v13, vcc
    v_cndmask_b32 v141, v141, v13, vcc
    v_cndmask_b32 v142, v142, v13, vcc
    v_cndmask_b32 v143, v143, v13, vcc
    v_cndmask_b32 v144, v144, v13, vcc
    v_cndmask_b32 v145, v145, v13, vcc
    v_pk_mov_b32 v[72:73], 0, 0
    v_pk_mov_b32 v[74:75], 0, 0
    v_pk_mov_b32 v[76:77], 0, 0
    v_pk_mov_b32 v[78:79], 0, 0
    v_pk_mov_b32 v[80:81], 0, 0
    v_pk_mov_b32 v[82:83], 0, 0
    v_pk_mov_b32 v[84:85], 0, 0
    v_pk_mov_b32 v[86:87], 0, 0
    v_pk_mov_b32 v[88:89], 0, 0
    v_pk_mov_b32 v[90:91], 0, 0
    v_pk_mov_b32 v[92:93], 0, 0
    v_pk_mov_b32 v[94:95], 0, 0
    v_pk_mov_b32 v[96:97], 0, 0
    v_pk_mov_b32 v[98:99], 0, 0
    v_pk_mov_b32 v[100:101], 0, 0
    v_pk_mov_b32 v[102:103], 0, 0
    s_cmp_lg_u32 s16, 2
    s_cbranch_scc1 L_qp_8
    s_mov_b32 s24, 0
L_pl_9:
    buffer_load_dword v14, v20, s[12:15], s25 offen sc1
    s_add_u32 s24, s24, 1
    s_waitcnt vmcnt(0)
    v_cmp_eq_u32 vcc, 0, v14
    s_cmp_ge_u32 s24, 65536
    s_cbranch_scc1 L_pl_9_x
    s_cbranch_vccz L_pl_9_x
    s_mov_b64 exec, vcc
    s_branch L_pl_9
L_pl_9_x:
    s_mov_b64 exec, -1
L_pl_9_go:
L_qp_8:
    s_barrier
    s_add_u32 m0, s30, 90112
    s_and_b32 s29, s29, 0x1ffff
    buffer_load_dwordx4 v148, s[12:15], s29 offen sc1 lds
    buffer_load_dwordx4 v148, s[12:15], s29 offen offset:1024 sc1 lds
    buffer_load_dwordx4 v[40:43], v2, s[12:15], s26 offen offset:0 sc1
    buffer_load_dwordx4 v[44:47], v2, s[12:15], s26 offen offset:1024 sc1
    s_add_u32 s29, s29, 8192
    s_add_u32 m0, s30, 122880
    s_and_b32 s29, s29, 0x1ffff
    buffer_load_dwordx4 v148, s[12:15], s29 offen sc1 lds
    buffer_load_dwordx4 v148, s[12:15], s29 offen offset:1024 sc1 lds
    v_min_u32 v20, 15, v1
    v_lshlrev_b32 v20, 8, v20
    v_mul_u32_u24 v4, 3584, v3
    v_add_u32 v4, v4, v8
    v_add_u32 v5, 27648, v4
    v_add_u32 v6, 55296, v4
    v_add_u32 v7, 82944, v4
    s_mul_i32 s33, s16, 229376
    s_lshl_b32 s24, s37, 7
    s_add_u32 s33, s33, s24
    s_sub_u32 s33, s33, 802816
    s_lshl_b32 s24, s16, 5
    v_xor_b32 v21, s24, v9
    v_add_u32 v21, s34, v21
    v_xor_b32 v22, 64, v21
    s_waitcnt vmcnt(6)
    v_and_b32 v39, 0xffff0000, v31
    v_lshlrev_b32 v38, 16, v31
    v_and_b32 v37, 0xffff0000, v30
    v_lshlrev_b32 v36, 16, v30
    v_and_b32 v35, 0xffff0000, v29
    v_lshlrev_b32 v34, 16, v29
    v_and_b32 v33, 0xffff0000, v28
    v_lshlrev_b32 v32, 16, v28
    v_and_b32 v31, 0xffff0000, v27
    v_lshlrev_b32 v30, 16, v27
    v_and_b32 v29, 0xffff0000, v26
    v_lshlrev_b32 v28, 16, v26
    v_and_b32 v27, 0xffff0000, v25
    v_lshlrev_b32 v26, 16, v25
    v_and_b32 v25, 0xffff0000, v24
    v_lshlrev_b32 v24, 16, v24
    v_lshlrev_b32 v132, 16, v124
    v_and_b32 v133, 0xffff0000, v124
    v_lshlrev_b32 v11, 16, v125
    v_and_b32 v12, 0xffff0000, v125
    v_add_f32 v132, v132, v11
    v_add_f32 v133, v133, v12
    v_lshlrev_b32 v11, 16, v126
    v_and_b32 v12, 0xffff0000, v126
    v_add_f32 v132, v132, v11
    v_add_f32 v133, v133, v12
    v_lshlrev_b32 v11, 16, v127
    v_and_b32 v12, 0xffff0000, v127
    v_add_f32 v132, v132, v11
    v_add_f32 v133, v133, v12
    v_lshlrev_b32 v11, 16, v128
    v_and_b32 v12, 0xffff0000, v128
    v_add_f32 v132, v132, v11
    v_add_f32 v133, v133, v12
    v_lshlrev_b32 v11, 16, v129
    v_and_b32 v12, 0xffff0000, v129
    v_add_f32 v132, v132, v11
    v_add_f32 v133, v133, v12
    v_lshlrev_b32 v11, 16, v130
    v_and_b32 v12, 0xffff0000, v130
    v_add_f32 v132, v132, v11
    v_add_f32 v133, v133, v12
    v_lshlrev_b32 v11, 16, v131
    v_and_b32 v12, 0xffff0000, v131
    v_add_f32 v132, v132, v11
    v_add_f32 v133, v133, v12
    v_mov_b32 v11, v132
    v_mov_b32 v12, v133
    s_nop 0
    v_permlane32_swap_b32 v132, v11
    v_permlane32_swap_b32 v133, v12
    v_add_f32 v132, v132, v11
    v_add_f32 v133, v133, v12
    s_mul_i32 s31, s20, 6144
    s_min_u32 s24, s16, 2
    s_lshl_b32 s24, s24, 11
    s_add_u32 s31, s31, s24
    s_lshl_b32 s24, s21, 8
    s_add_u32 s31, s31, s24
    s_add_u32 s31, s31, 15990784
    v_and_b32 v12, 31, v1
    v_lshlrev_b32 v12, 3, v12
    buffer_store_dwordx2 v[132:133], v12, s[12:15], s31 offen sc1
    s_cmp_lg_u32 s16, 0
    s_cbranch_scc1 L_ts_Q_0
    s_mov_b64 exec, 0
    s_branch L_pad_Q_0
L_ret_Q_0:
    s_branch L_pad_Q_4
L_ret_Q_4:
    s_mov_b64 exec, -1
L_ts_Q_0:
    s_cmp_lg_u32 s16, 1
    s_cbranch_scc1 L_ts_Q_1
    s_mov_b64 exec, 0
    s_branch L_pad_Q_1
L_ret_Q_1:
    s_branch L_pad_Q_5
L_ret_Q_5:
    s_mov_b64 exec, -1
L_ts_Q_1:
    s_cmp_lg_u32 s16, 2
    s_cbranch_scc1 L_ts_Q_2
    s_mov_b64 exec, 0
    s_branch L_pad_Q_2
L_ret_Q_2:
    s_branch L_pad_Q_6
L_ret_Q_6:
    s_mov_b64 exec, -1
L_ts_Q_2:
    s_cmp_lg_u32 s16, 3
    s_cbranch_scc1 L_ts_Q_3
    s_mov_b64 exec, 0
    s_branch L_pad_Q_3
L_ret_Q_3:
    s_branch L_pad_Q_7
L_ret_Q_7:
    s_mov_b64 exec, -1
L_ts_Q_3:
L_reg_Q:
    s_waitcnt vmcnt(3)
    v_max3_u32 v14, v40, v41, v42
    v_max3_u32 v13, v44, v45, v46
    v_max3_u32 v14, v14, v43, v47
    v_max_u32 v14, v14, v13
    v_cmp_eq_u32 vcc, -1, v14
    s_waitcnt lgkmcnt(0)
    s_barrier
    ds_read_b128 v[48:51], v147 offset:0
    ds_read_b128 v[52:55], v147 offset:2048
    ds_read_b128 v[56:59], v142 offset:0
    ds_read_b128 v[60:63], v142 offset:512
    s_cbranch_vccnz L_qt_10
L_qt_10_d:
    s_waitcnt lgkmcnt(3)
    v_mfma_f32_32x32x16_bf16 v[104:119], v[48:51], v[40:43], 0
    s_nop 11
    v_exp_f32 v104, v104
    v_exp_f32 v105, v105
    v_exp_f32 v106, v106
    s_waitcnt lgkmcnt(0)
    v_exp_f32 v107, v107
    v_exp_f32 v108, v108
    v_exp_f32 v109, v109
    v_mfma_f32_32x32x16_bf16 v[120:135], v[48:51], v[44:47], 0
    ds_read_b128 v[48:51], v147 offset:4096
    v_exp_f32 v110, v110
    v_exp_f32 v111, v111
    v_exp_f32 v112, v112
    v_exp_f32 v113, v113
    v_exp_f32 v114, v114
    v_smfmac_f32_32x32x32_bf16 v[72:87], v[56:59], v[104:111], v136
    ds_read_b128 v[68:71], v142 offset:2560
    v_exp_f32 v115, v115
    v_exp_f32 v116, v116
    v_exp_f32 v117, v117
    v_exp_f32 v118, v118
    v_exp_f32 v119, v119
    v_exp_f32 v120, v120
    v_exp_f32 v121, v121
    v_exp_f32 v122, v122
    v_smfmac_f32_32x32x32_bf16 v[72:87], v[60:63], v[112:119], v136
    v_exp_f32 v123, v123
    v_exp_f32 v124, v124
    v_exp_f32 v125, v125
    v_mfma_f32_32x32x16_bf16 v[104:119], v[52:55], v[40:43], 0
    ds_read_b128 v[64:67], v142 offset:2048
    v_exp_f32 v126, v126
    v_exp_f32 v127, v127
    v_exp_f32 v128, v128
    v_exp_f32 v129, v129
    v_exp_f32 v130, v130
    v_smfmac_f32_32x32x32_bf16 v[88:103], v[56:59], v[120:127], v136
    v_exp_f32 v131, v131
    v_exp_f32 v132, v132
    v_exp_f32 v133, v133
    v_exp_f32 v134, v134
    v_exp_f32 v135, v135
    v_exp_f32 v104, v104
    v_exp_f32 v105, v105
    v_exp_f32 v106, v106
    v_smfmac_f32_32x32x32_bf16 v[88:103], v[60:63], v[128:135], v136
    s_waitcnt lgkmcnt(0)
    v_exp_f32 v107, v107
    v_exp_f32 v108, v108
    v_exp_f32 v109, v109
    v_mfma_f32_32x32x16_bf16 v[120:135], v[52:55], v[44:47], 0
    ds_read_b128 v[52:55], v147 offset:6144
    v_exp_f32 v110, v110
    v_exp_f32 v111, v111
    v_exp_f32 v112, v112
    v_exp_f32 v113, v113
    v_exp_f32 v114, v114
    v_smfmac_f32_32x32x32_bf16 v[72:87], v[64:67], v[104:111], v136
    ds_read_b128 v[60:63], v142 offset:4608
    v_exp_f32 v115, v115
    v_exp_f32 v116, v116
    v_exp_f32 v117, v117
    v_exp_f32 v118, v118
    v_exp_f32 v119, v119
    v_exp_f32 v120, v120
    v_exp_f32 v121, v121
    v_exp_f32 v122, v122
    v_smfmac_f32_32x32x32_bf16 v[72:87], v[68:71], v[112:119], v136
    buffer_load_dword v14, v20, s[12:15], s76 offen sc1
    v_exp_f32 v123, v123
    v_exp_f32 v124, v124
    v_exp_f32 v125, v125
    v_mfma_f32_32x32x16_bf16 v[104:119], v[48:51], v[40:43], 0
    ds_read_b128 v[56:59], v142 offset:4096
    v_exp_f32 v126, v126
    v_exp_f32 v127, v127
    v_exp_f32 v128, v128
    v_exp_f32 v129, v129
    v_exp_f32 v130, v130
    v_smfmac_f32_32x32x32_bf16 v[88:103], v[64:67], v[120:127], v136
    v_exp_f32 v131, v131
    v_exp_f32 v132, v132
    v_exp_f32 v133, v133
    v_exp_f32 v134, v134
    v_exp_f32 v135, v135
    v_exp_f32 v104, v104
    v_exp_f32 v105, v105
    v_exp_f32 v106, v106
    v_smfmac_f32_32x32x32_bf16 v[88:103], v[68:71], v[128:135], v136
    s_waitcnt vmcnt(2) lgkmcnt(0)
    s_barrier
    v_exp_f32 v107, v107
    v_exp_f32 v108, v108
    v_exp_f32 v109, v109
    v_mfma_f32_32x32x16_bf16 v[120:135], v[48:51], v[44:47], 0
    ds_read_b128 v[48:51], v147 offset:32768
    v_exp_f32 v110, v110
    v_exp_f32 v111, v111
    v_exp_f32 v112, v112
    v_exp_f32 v113, v113
    v_exp_f32 v114, v114
    v_smfmac_f32_32x32x32_bf16 v[72:87], v[56:59], v[104:111], v136
    ds_read_b128 v[68:71], v142 offset:6656
    v_exp_f32 v115, v115
    v_exp_f32 v116, v116
    v_exp_f32 v117, v117
    v_exp_f32 v118, v118
    v_exp_f32 v119, v119
    v_exp_f32 v120, v120
    v_exp_f32 v121, v121
    v_exp_f32 v122, v122
    v_smfmac_f32_32x32x32_bf16 v[72:87], v[60:63], v[112:119], v136
    v_exp_f32 v123, v123
    v_exp_f32 v124, v124
    v_exp_f32 v125, v125
    v_mfma_f32_32x32x16_bf16 v[104:119], v[52:55], v[40:43], 0
    ds_read_b128 v[64:67], v142 offset:6144
    v_exp_f32 v126, v126
    v_exp_f32 v127, v127
    v_exp_f32 v128, v128
    v_exp_f32 v129, v129
    v_exp_f32 v130, v130
    v_smfmac_f32_32x32x32_bf16 v[88:103], v[56:59], v[120:127], v136
    v_exp_f32 v131, v131
    v_exp_f32 v132, v132
    v_exp_f32 v133, v133
    v_exp_f32 v134, v134
    v_exp_f32 v135, v135
    v_exp_f32 v104, v104
    v_exp_f32 v105, v105
    v_exp_f32 v106, v106
    v_smfmac_f32_32x32x32_bf16 v[88:103], v[60:63], v[128:135], v136
    s_waitcnt vmcnt(0) lgkmcnt(0)
    v_cmp_eq_u32 vcc, 0, v14
    v_exp_f32 v107, v107
    v_exp_f32 v108, v108
    v_exp_f32 v109, v109
    v_mfma_f32_32x32x16_bf16 v[120:135], v[52:55], v[44:47], 0
    ds_read_b128 v[52:55], v147 offset:34816
    v_exp_f32 v110, v110
    v_exp_f32 v111, v111
    v_exp_f32 v112, v112
    v_exp_f32 v113, v113
    v_exp_f32 v114, v114
    v_smfmac_f32_32x32x32_bf16 v[72:87], v[64:67], v[104:111], v136
    s_cbranch_vccnz L_gq_12
L_gq_12_d:
    s_add_u32 s29, s29, 8192
    s_add_u32 m0, s30, 131072
    s_and_b32 s29, s29, 0x1ffff
    buffer_load_dwordx4 v148, s[12:15], s29 offen sc1 lds
L_pad_Q_0:
    s_cbranch_execz L_ret_Q_0
    buffer_load_dwordx4 v148, s[12:15], s29 offen offset:1024 sc1 lds
    s_add_u32 s29, s29, 8192
    s_add_u32 m0, s30, 139264
    s_and_b32 s29, s29, 0x1ffff
    buffer_load_dwordx4 v148, s[12:15], s29 offen sc1 lds
    buffer_load_dwordx4 v148, s[12:15], s29 offen offset:1024 sc1 lds
    ds_read_b128 v[60:63], v143 offset:512
    v_exp_f32 v115, v115
    v_exp_f32 v116, v116
    v_exp_f32 v117, v117
    v_exp_f32 v118, v118
    v_exp_f32 v119, v119
    v_exp_f32 v120, v120
    v_exp_f32 v121, v121
    v_exp_f32 v122, v122
    v_smfmac_f32_32x32x32_bf16 v[72:87], v[68:71], v[112:119], v136
    v_exp_f32 v123, v123
    v_exp_f32 v124, v124
    v_exp_f32 v125, v125
    v_mfma_f32_32x32x16_bf16 v[104:119], v[48:51], v[40:43], 0
    ds_read_b128 v[56:59], v143 offset:0
    v_exp_f32 v126, v126
    v_exp_f32 v127, v127
    v_exp_f32 v128, v128
    v_exp_f32 v129, v129
    v_exp_f32 v130, v130
    v_smfmac_f32_32x32x32_bf16 v[88:103], v[64:67], v[120:127], v136
    v_exp_f32 v131, v131
    v_exp_f32 v132, v132
    v_exp_f32 v133, v133
    v_exp_f32 v134, v134
    v_exp_f32 v135, v135
    v_exp_f32 v104, v104
    v_exp_f32 v105, v105
    v_exp_f32 v106, v106
    v_smfmac_f32_32x32x32_bf16 v[88:103], v[68:71], v[128:135], v136
    s_waitcnt lgkmcnt(0)
    v_exp_f32 v107, v107
    v_exp_f32 v108, v108
    v_exp_f32 v109, v109
    v_mfma_f32_32x32x16_bf16 v[120:135], v[48:51], v[44:47], 0
    ds_read_b128 v[48:51], v147 offset:36864
    v_exp_f32 v110, v110
    v_exp_f32 v111, v111
    v_exp_f32 v112, v112
    v_exp_f32 v113, v113
    v_exp_f32 v114, v114
    v_smfmac_f32_32x32x32_bf16 v[72:87], v[56:59], v[104:111], v136
    s_add_u32 s29, s29, 8192
    s_add_u32 m0, s30, 24576
    s_and_b32 s29, s29, 0x1ffff
    buffer_load_dwordx4 v148, s[12:15], s29 offen sc1 lds
    buffer_load_dwordx4 v148, s[12:15], s29 offen offset:1024 sc1 lds
    s_add_u32 s29, s29, 8192
    ds_read_b128 v[68:71], v143 offset:2560
    v_exp_f32 v115, v115
    v_exp_f32 v116, v116
    v_exp_f32 v117, v117
    v_exp_f32 v118, v118
    v_exp_f32 v119, v119
    v_exp_f32 v120, v120
    v_exp_f32 v121, v121
    v_exp_f32 v122, v122
    v_smfmac_f32_32x32x32_bf16 v[72:87], v[60:63], v[112:119], v136
    v_exp_f32 v123, v123
    v_exp_f32 v124, v124
    v_exp_f32 v125, v125
    v_mfma_f32_32x32x16_bf16 v[104:119], v[52:55], v[40:43], 0
    ds_read_b128 v[64:67], v143 offset:2048
    v_exp_f32 v126, v126
    v_exp_f32 v127, v127
    v_exp_f32 v128, v128
    v_exp_f32 v129, v129
    v_exp_f32 v130, v130
    v_smfmac_f32_32x32x32_bf16 v[88:103], v[56:59], v[120:127], v136
    v_exp_f32 v131, v131
    v_exp_f32 v132, v132
    v_exp_f32 v133, v133
    v_exp_f32 v134, v134
    v_exp_f32 v135, v135
    v_exp_f32 v104, v104
    v_exp_f32 v105, v105
    v_exp_f32 v106, v106
    v_smfmac_f32_32x32x32_bf16 v[88:103], v[60:63], v[128:135], v136
    s_waitcnt lgkmcnt(0)
    v_exp_f32 v107, v107
    v_exp_f32 v108, v108
    v_exp_f32 v109, v109
    v_mfma_f32_32x32x16_bf16 v[120:135], v[52:55], v[44:47], 0
    ds_read_b128 v[52:55], v147 offset:38912
    v_exp_f32 v110, v110
    v_exp_f32 v111, v111
    v_exp_f32 v112, v112
    v_exp_f32 v113, v113
    v_exp_f32 v114, v114
    v_smfmac_f32_32x32x32_bf16 v[72:87], v[64:67], v[104:111], v136
    ds_read_b128 v[60:63], v143 offset:4608
    v_exp_f32 v115, v115
    v_exp_f32 v116, v116
    v_exp_f32 v117, v117
    v_exp_f32 v118, v118
    v_exp_f32 v119, v119
    v_exp_f32 v120, v120
    v_exp_f32 v121, v121
    v_exp_f32 v122, v122
    v_smfmac_f32_32x32x32_bf16 v[72:87], v[68:71], v[112:119], v136
    v_exp_f32 v123, v123
    v_exp_f32 v124, v124
    v_exp_f32 v125, v125
    v_mfma_f32_32x32x16_bf16 v[104:119], v[48:51], v[40:43], 0
    ds_read_b128 v[56:59], v143 offset:4096
    v_exp_f32 v126, v126
    v_exp_f32 v127, v127
    v_exp_f32 v128, v128
    v_exp_f32 v129, v129
    v_exp_f32 v130, v130
    v_smfmac_f32_32x32x32_bf16 v[88:103], v[64:67], v[120:127], v136
    s_add_u32 m0, s30, 57344
    s_and_b32 s29, s29, 0x1ffff
    v_exp_f32 v131, v131
    v_exp_f32 v132, v132
    v_exp_f32 v133, v133
    v_exp_f32 v134, v134
    v_exp_f32 v135, v135
    v_exp_f32 v104, v104
    v_exp_f32 v105, v105
    v_exp_f32 v106, v106
    v_smfmac_f32_32x32x32_bf16 v[88:103], v[68:71], v[128:135], v136
    s_waitcnt vmcnt(4) lgkmcnt(0)
    s_barrier
    v_exp_f32 v107, v107
    v_exp_f32 v108, v108
    v_exp_f32 v109, v109
    v_mfma_f32_32x32x16_bf16 v[120:135], v[48:51], v[44:47], 0
    ds_read_b128 v[48:51], v147 offset:40960
    v_exp_f32 v110, v110
    v_exp_f32 v111, v111
    v_exp_f32 v112, v112
    v_exp_f32 v113, v113
    v_exp_f32 v114, v114
    v_smfmac_f32_32x32x32_bf16 v[72:87], v[56:59], v[104:111], v136
    ds_read_b128 v[68:71], v143 offset:6656
    v_exp_f32 v115, v115
    v_exp_f32 v116, v116
    v_exp_f32 v117, v117
    v_exp_f32 v118, v118
    v_exp_f32 v119, v119
    v_exp_f32 v120, v120
    v_exp_f32 v121, v121
    v_exp_f32 v122, v122
    v_smfmac_f32_32x32x32_bf16 v[72:87], v[60:63], v[112:119], v136
    buffer_load_dwordx4 v148, s[12:15], s29 offen sc1 lds
    buffer_load_dwordx4 v148, s[12:15], s29 offen offset:1024 sc1 lds
    v_exp_f32 v123, v123
    v_exp_f32 v124, v124
    v_exp_f32 v125, v125
    v_mfma_f32_32x32x16_bf16 v[104:119], v[52:55], v[40:43], 0
    ds_read_b128 v[64:67], v143 offset:6144
    v_exp_f32 v126, v126
    v_exp_f32 v127, v127
    v_exp_f32 v128, v128
    v_exp_f32 v129, v129
    v_exp_f32 v130, v130
    v_smfmac_f32_32x32x32_bf16 v[88:103], v[56:59], v[120:127], v136
    s_add_u32 m0, s34, 8192
    s_add_u32 s33, s33, 802816
    v_exp_f32 v131, v131
    v_exp_f32 v132, v132
    v_exp_f32 v133, v133
    v_exp_f32 v134, v134
    v_exp_f32 v135, v135
    v_exp_f32 v104, v104
    v_exp_f32 v105, v105
    v_exp_f32 v106, v106
    v_smfmac_f32_32x32x32_bf16 v[88:103], v[60:63], v[128:135], v136
    s_waitcnt lgkmcnt(0)
    v_exp_f32 v107, v107
    v_exp_f32 v108, v108
    v_exp_f32 v109, v109
    v_mfma_f32_32x32x16_bf16 v[120:135], v[52:55], v[44:47], 0
    ds_read_b128 v[52:55], v147 offset:43008
    v_exp_f32 v110, v110
    v_exp_f32 v111, v111
    v_exp_f32 v112, v112
    v_exp_f32 v113, v113
    v_exp_f32 v114, v114
    v_smfmac_f32_32x32x32_bf16 v[72:87], v[64:67], v[104:111], v136
    ds_read_b128 v[60:63], v144 offset:512
    v_exp_f32 v115, v115
    v_exp_f32 v116, v116
    v_exp_f32 v117, v117
    v_exp_f32 v118, v118
    v_exp_f32 v119, v119
    v_exp_f32 v120, v120
    v_exp_f32 v121, v121
    v_exp_f32 v122, v122
    v_smfmac_f32_32x32x32_bf16 v[72:87], v[68:71], v[112:119], v136
    buffer_load_dwordx4 v4, s[48:51], s33 offen offset:0 lds
    buffer_load_dwordx4 v5, s[48:51], s33 offen offset:1024 lds
    v_exp_f32 v123, v123
    v_exp_f32 v124, v124
    v_exp_f32 v125, v125
    v_mfma_f32_32x32x16_bf16 v[104:119], v[48:51], v[40:43], 0
    ds_read_b128 v[56:59], v144 offset:0
    v_exp_f32 v126, v126
    v_exp_f32 v127, v127
    v_exp_f32 v128, v128
    v_exp_f32 v129, v129
    v_exp_f32 v130, v130
    v_smfmac_f32_32x32x32_bf16 v[88:103], v[64:67], v[120:127], v136
    buffer_load_dwordx4 v6, s[48:51], s33 offen offset:2048 lds
    buffer_load_dwordx4 v7, s[48:51], s33 offen offset:3072 lds
    v_exp_f32 v131, v131
    v_exp_f32 v132, v132
    v_exp_f32 v133, v133
    v_exp_f32 v134, v134
    v_exp_f32 v135, v135
    v_exp_f32 v104, v104
    v_exp_f32 v105, v105
    v_exp_f32 v106, v106
    v_smfmac_f32_32x32x32_bf16 v[88:103], v[68:71], v[128:135], v136
    s_waitcnt lgkmcnt(0)
    s_add_u32 s29, s29, 8192
    v_exp_f32 v107, v107
    v_exp_f32 v108, v108
    v_exp_f32 v109, v109
    v_mfma_f32_32x32x16_bf16 v[120:135], v[48:51], v[44:47], 0
    ds_read_b128 v[48:51], v147 offset:45056
    v_exp_f32 v110, v110
    v_exp_f32 v111, v111
    v_exp_f32 v112, v112
    v_exp_f32 v113, v113
    v_exp_f32 v114, v114
    v_smfmac_f32_32x32x32_bf16 v[72:87], v[56:59], v[104:111], v136
    ds_read_b128 v[68:71], v144 offset:2560
    v_exp_f32 v115, v115
    v_exp_f32 v116, v116
    v_exp_f32 v117, v117
    v_exp_f32 v118, v118
    v_exp_f32 v119, v119
    v_exp_f32 v120, v120
    v_exp_f32 v121, v121
    v_exp_f32 v122, v122
    v_smfmac_f32_32x32x32_bf16 v[72:87], v[60:63], v[112:119], v136
    s_add_u32 m0, s34, 12288
    s_add_u32 s33, s33, 114688
    v_exp_f32 v123, v123
    v_exp_f32 v124, v124
    v_exp_f32 v125, v125
    v_mfma_f32_32x32x16_bf16 v[104:119], v[52:55], v[40:43], 0
    ds_read_b128 v[64:67], v144 offset:2048
    v_exp_f32 v126, v126
    v_exp_f32 v127, v127
    v_exp_f32 v128, v128
    v_exp_f32 v129, v129
    v_exp_f32 v130, v130
    v_smfmac_f32_32x32x32_bf16 v[88:103], v[56:59], v[120:127], v136
    buffer_load_dwordx4 v4, s[48:51], s33 offen offset:0 lds
    buffer_load_dwordx4 v5, s[48:51], s33 offen offset:1024 lds
    v_exp_f32 v131, v131
    v_exp_f32 v132, v132
    v_exp_f32 v133, v133
    v_exp_f32 v134, v134
    v_exp_f32 v135, v135
    v_exp_f32 v104, v104
    v_exp_f32 v105, v105
    v_exp_f32 v106, v106
    v_smfmac_f32_32x32x32_bf16 v[88:103], v[60:63], v[128:135], v136
    s_waitcnt lgkmcnt(0)
    s_lshl_b32 s72, s21, 1
    s_add_u32 s72, s72, s22
    s_lshl_b32 s72, s72, 6
    s_lshl_b32 s73, s20, 1
    s_add_u32 s72, s72, s73
    s_add_u32 s72, s72, s23
    s_lshl_b32 s72, s72, 11
    s_add_u32 s72, s72, 10485760
    s_mul_i32 s73, s36, 224
    s_lshl_b32 s74, s37, 2
    s_add_u32 s73, s73, s74
    s_add_u32 s73, s73, s16
    s_lshl_b32 s73, s73, 10
    s_add_u32 s73, s73, 12582912
    s_add_u32 s74, s73, 114688
    v_mov_b32 v150, -1
    v_mov_b32 v151, -1
    v_mov_b32 v152, -1
    v_mov_b32 v153, -1
    v_exp_f32 v107, v107
    v_exp_f32 v108, v108
    v_exp_f32 v109, v109
    v_mfma_f32_32x32x16_bf16 v[120:135], v[52:55], v[44:47], 0
    ds_read_b128 v[52:55], v147 offset:47104
    v_exp_f32 v110, v110
    v_exp_f32 v111, v111
    v_exp_f32 v112, v112
    v_exp_f32 v113, v113
    v_exp_f32 v114, v114
    v_smfmac_f32_32x32x32_bf16 v[72:87], v[64:67], v[104:111], v136
    ds_read_b128 v[60:63], v144 offset:4608
    v_exp_f32 v115, v115
    v_exp_f32 v116, v116
    v_exp_f32 v117, v117
    v_exp_f32 v118, v118
    v_exp_f32 v119, v119
    v_exp_f32 v120, v120
    v_exp_f32 v121, v121
    v_exp_f32 v122, v122
    v_smfmac_f32_32x32x32_bf16 v[72:87], v[68:71], v[112:119], v136
    buffer_load_dwordx4 v6, s[48:51], s33 offen offset:2048 lds
    buffer_load_dwordx4 v7, s[48:51], s33 offen offset:3072 lds
    v_exp_f32 v123, v123
    v_exp_f32 v124, v124
    v_exp_f32 v125, v125
    v_mfma_f32_32x32x16_bf16 v[104:119], v[48:51], v[40:43], 0
    ds_read_b128 v[56:59], v144 offset:4096
    v_exp_f32 v126, v126
    v_exp_f32 v127, v127
    v_exp_f32 v128, v128
    v_exp_f32 v129, v129
    v_exp_f32 v130, v130
    v_smfmac_f32_32x32x32_bf16 v[88:103], v[64:67], v[120:127], v136
    s_add_u32 m0, s30, 90112
    s_and_b32 s29, s29, 0x1ffff
    v_exp_f32 v131, v131
    v_exp_f32 v132, v132
    v_exp_f32 v133, v133
    v_exp_f32 v134, v134
    v_exp_f32 v135, v135
    v_exp_f32 v104, v104
    v_exp_f32 v105, v105
    v_exp_f32 v106, v106
    v_smfmac_f32_32x32x32_bf16 v[88:103], v[68:71], v[128:135], v136
    s_waitcnt vmcnt(10) lgkmcnt(0)
    s_barrier
    buffer_store_dwordx4 v[150:153], v2, s[12:15], s72 offen offset:0 sc1
    buffer_store_dwordx4 v[150:153], v2, s[12:15], s72 offen offset:1024 sc1
    v_exp_f32 v107, v107
    v_exp_f32 v108, v108
    v_exp_f32 v109, v109
    v_mfma_f32_32x32x16_bf16 v[120:135], v[48:51], v[44:47], 0
    ds_read_b128 v[48:51], v147 offset:49152
    v_exp_f32 v110, v110
    v_exp_f32 v111, v111
    v_exp_f32 v112, v112
    v_exp_f32 v113, v113
    v_exp_f32 v114, v114
    v_smfmac_f32_32x32x32_bf16 v[72:87], v[56:59], v[104:111], v136
    ds_read_b128 v[68:71], v144 offset:6656
    v_exp_f32 v115, v115
    v_exp_f32 v116, v116
    v_exp_f32 v117, v117
    v_exp_f32 v118, v118
    v_exp_f32 v119, v119
    v_exp_f32 v120, v120
    v_exp_f32 v121, v121
    v_exp_f32 v122, v122
    v_smfmac_f32_32x32x32_bf16 v[72:87], v[60:63], v[112:119], v136
    buffer_load_dwordx4 v148, s[12:15], s29 offen sc1 lds
    buffer_load_dwordx4 v148, s[12:15], s29 offen offset:1024 sc1 lds
    v_exp_f32 v123, v123
    v_exp_f32 v124, v124
    v_exp_f32 v125, v125
    v_mfma_f32_32x32x16_bf16 v[104:119], v[52:55], v[40:43], 0
    ds_read_b128 v[64:67], v144 offset:6144
    v_exp_f32 v126, v126
    v_exp_f32 v127, v127
    v_exp_f32 v128, v128
    v_exp_f32 v129, v129
    v_exp_f32 v130, v130
    v_smfmac_f32_32x32x32_bf16 v[88:103], v[56:59], v[120:127], v136
    s_add_u32 m0, s34, 16384
    s_add_u32 s33, s33, 802816
    v_exp_f32 v131, v131
    v_exp_f32 v132, v132
    v_exp_f32 v133, v133
    v_exp_f32 v134, v134
    v_exp_f32 v135, v135
    v_exp_f32 v104, v104
    v_exp_f32 v105, v105
    v_exp_f32 v106, v106
    v_smfmac_f32_32x32x32_bf16 v[88:103], v[60:63], v[128:135], v136
    s_waitcnt lgkmcnt(0)
    buffer_store_dwordx4 v[150:153], v2, s[12:15], s73 offen offset:0 sc1
    buffer_store_dwordx4 v[150:153], v2, s[12:15], s74 offen offset:0 sc1
    v_exp_f32 v107, v107
    v_exp_f32 v108, v108
    v_exp_f32 v109, v109
    v_mfma_f32_32x32x16_bf16 v[120:135], v[52:55], v[44:47], 0
    ds_read_b128 v[52:55], v147 offset:51200
    v_exp_f32 v110, v110
    v_exp_f32 v111, v111
    v_exp_f32 v112, v112
    v_exp_f32 v113, v113
    v_exp_f32 v114, v114
    v_smfmac_f32_32x32x32_bf16 v[72:87], v[64:67], v[104:111], v136
    ds_read_b128 v[60:63], v145 offset:512
    v_exp_f32 v115, v115
    v_exp_f32 v116, v116
    v_exp_f32 v117, v117
    v_exp_f32 v118, v118
    v_exp_f32 v119, v119
    v_exp_f32 v120, v120
    v_exp_f32 v121, v121
    v_exp_f32 v122, v122
    v_smfmac_f32_32x32x32_bf16 v[72:87], v[68:71], v[112:119], v136
    buffer_load_dwordx4 v4, s[48:51], s33 offen offset:0 lds
    buffer_load_dwordx4 v5, s[48:51], s33 offen offset:1024 lds
    v_exp_f32 v123, v123
    v_exp_f32 v124, v124
    v_exp_f32 v125, v125
    v_mfma_f32_32x32x16_bf16 v[104:119], v[48:51], v[40:43], 0
    ds_read_b128 v[56:59], v145 offset:0
    v_exp_f32 v126, v126
    v_exp_f32 v127, v127
    v_exp_f32 v128, v128
    v_exp_f32 v129, v129
    v_exp_f32 v130, v130
    v_smfmac_f32_32x32x32_bf16 v[88:103], v[64:67], v[120:127], v136
    buffer_load_dwordx4 v6, s[48:51], s33 offen offset:2048 lds
    buffer_load_dwordx4 v7, s[48:51], s33 offen offset:3072 lds
    v_exp_f32 v131, v131
    v_exp_f32 v132, v132
    v_exp_f32 v133, v133
    v_exp_f32 v134, v134
    v_exp_f32 v135, v135
    v_exp_f32 v104, v104
    v_exp_f32 v105, v105
    v_exp_f32 v106, v106
    v_smfmac_f32_32x32x32_bf16 v[88:103], v[68:71], v[128:135], v136
    s_waitcnt lgkmcnt(0)
    s_add_u32 s29, s29, 8192
    s_cmp_eq_u32 s35, 0
    s_cbranch_scc1 L_ls_13_g
    buffer_store_dwordx4 v[150:153], v2, s[12:15], s75 offen
    buffer_store_dwordx4 v[150:153], v2, s[12:15], s77 offen
L_ls_13_d:
    v_exp_f32 v107, v107
    v_exp_f32 v108, v108
    v_exp_f32 v109, v109
    v_mfma_f32_32x32x16_bf16 v[120:135], v[48:51], v[44:47], 0
    ds_read_b128 v[48:51], v147 offset:53248
    v_exp_f32 v110, v110
    v_exp_f32 v111, v111
    v_exp_f32 v112, v112
    v_exp_f32 v113, v113
    v_exp_f32 v114, v114
    v_smfmac_f32_32x32x32_bf16 v[72:87], v[56:59], v[104:111], v136
    ds_read_b128 v[68:71], v145 offset:2560
    v_exp_f32 v115, v115
    v_exp_f32 v116, v116
    v_exp_f32 v117, v117
    v_exp_f32 v118, v118
    v_exp_f32 v119, v119
    v_exp_f32 v120, v120
    v_exp_f32 v121, v121
    v_exp_f32 v122, v122
    v_smfmac_f32_32x32x32_bf16 v[72:87], v[60:63], v[112:119], v136
    s_add_u32 m0, s34, 20480
    s_add_u32 s33, s33, 114688
    v_exp_f32 v123, v123
    v_exp_f32 v124, v124
    v_exp_f32 v125, v125
    v_mfma_f32_32x32x16_bf16 v[104:119], v[52:55], v[40:43], 0
    ds_read_b128 v[64:67], v145 offset:2048
    v_exp_f32 v126, v126
    v_exp_f32 v127, v127
    v_exp_f32 v128, v128
    v_exp_f32 v129, v129
    v_exp_f32 v130, v130
    v_smfmac_f32_32x32x32_bf16 v[88:103], v[56:59], v[120:127], v136
    buffer_load_dwordx4 v4, s[48:51], s33 offen offset:0 lds
    buffer_load_dwordx4 v5, s[48:51], s33 offen offset:1024 lds
    v_exp_f32 v131, v131
    v_exp_f32 v132, v132
    v_exp_f32 v133, v133
    v_exp_f32 v134, v134
    v_exp_f32 v135, v135
    v_exp_f32 v104, v104
    v_exp_f32 v105, v105
    v_exp_f32 v106, v106
    v_smfmac_f32_32x32x32_bf16 v[88:103], v[60:63], v[128:135], v136
    s_waitcnt vmcnt(18) lgkmcnt(0)
    ds_read_b64_tr_b16 a[0:1], v21 offset:8192
    ds_read_b64_tr_b16 a[2:3], v21 offset:9216
    ds_read_b64_tr_b16 a[4:5], v22 offset:8192
    ds_read_b64_tr_b16 a[6:7], v22 offset:9216
    ds_read_b64_tr_b16 a[8:9], v21 offset:10240
    ds_read_b64_tr_b16 a[10:11], v21 offset:11264
    ds_read_b64_tr_b16 a[12:13], v22 offset:10240
    ds_read_b64_tr_b16 a[14:15], v22 offset:11264
    v_lshlrev_b32 v138, 2, v1
    s_lshl_b32 s24, s20, 1
    s_add_u32 s24, s24, s22
    s_lshl_b32 s24, s24, 3
    s_add_u32 s24, s24, s21
    s_lshl_b32 s24, s24, 1
    s_add_u32 s24, s24, s23
    s_lshl_b32 s24, s24, 8
    s_add_u32 s72, s24, 14417920
    s_cmp_eq_u32 s35, 0
    s_cbranch_scc1 L_ls_14_g
    buffer_store_dword v150, v138, s[12:15], s72 offen
L_ls_14_d:
    v_exp_f32 v107, v107
    v_exp_f32 v108, v108
    v_exp_f32 v109, v109
    v_mfma_f32_32x32x16_bf16 v[120:135], v[52:55], v[44:47], 0
    ds_read_b128 v[52:55], v147 offset:55296
    v_exp_f32 v110, v110
    v_exp_f32 v111, v111
    v_exp_f32 v112, v112
    v_exp_f32 v113, v113
    v_exp_f32 v114, v114
    v_smfmac_f32_32x32x32_bf16 v[72:87], v[64:67], v[104:111], v136
    ds_read_b128 v[60:63], v145 offset:4608
    v_exp_f32 v115, v115
    v_exp_f32 v116, v116
    v_exp_f32 v117, v117
    v_exp_f32 v118, v118
    v_exp_f32 v119, v119
    v_exp_f32 v120, v120
    v_exp_f32 v121, v121
    v_exp_f32 v122, v122
    v_smfmac_f32_32x32x32_bf16 v[72:87], v[68:71], v[112:119], v136
    buffer_load_dwordx4 v6, s[48:51], s33 offen offset:2048 lds
    buffer_load_dwordx4 v7, s[48:51], s33 offen offset:3072 lds
    v_exp_f32 v123, v123
    v_exp_f32 v124, v124
    v_exp_f32 v125, v125
    v_mfma_f32_32x32x16_bf16 v[104:119], v[48:51], v[40:43], 0
    ds_read_b128 v[56:59], v145 offset:4096
    v_exp_f32 v126, v126
    v_exp_f32 v127, v127
    v_exp_f32 v128, v128
    v_exp_f32 v129, v129
    v_exp_f32 v130, v130
    v_smfmac_f32_32x32x32_bf16 v[88:103], v[64:67], v[120:127], v136
    s_add_u32 m0, s30, 122880
    s_and_b32 s29, s29, 0x1ffff
    v_exp_f32 v131, v131
    v_exp_f32 v132, v132
    v_exp_f32 v133, v133
    v_exp_f32 v134, v134
    v_exp_f32 v135, v135
    v_exp_f32 v104, v104
    v_exp_f32 v105, v105
    v_exp_f32 v106, v106
    v_smfmac_f32_32x32x32_bf16 v[88:103], v[68:71], v[128:135], v136
    s_waitcnt lgkmcnt(0)
    v_exp_f32 v107, v107
    v_exp_f32 v108, v108
    v_exp_f32 v109, v109
    v_mfma_f32_32x32x16_bf16 v[120:135], v[48:51], v[44:47], 0
    ds_read_b128 v[48:51], v146 offset:0
    v_exp_f32 v110, v110
    v_exp_f32 v111, v111
    v_exp_f32 v112, v112
    v_exp_f32 v113, v113
    v_exp_f32 v114, v114
    v_smfmac_f32_32x32x32_bf16 v[72:87], v[56:59], v[104:111], v136
    ds_read_b128 v[68:71], v145 offset:6656
    v_exp_f32 v115, v115
    v_exp_f32 v116, v116
    v_exp_f32 v117, v117
    v_exp_f32 v118, v118
    v_exp_f32 v119, v119
    v_exp_f32 v120, v120
    v_exp_f32 v121, v121
    v_exp_f32 v122, v122
    v_smfmac_f32_32x32x32_bf16 v[72:87], v[60:63], v[112:119], v136
    buffer_load_dwordx4 v148, s[12:15], s29 offen sc1 lds
    buffer_load_dwordx4 v148, s[12:15], s29 offen offset:1024 sc1 lds
    v_exp_f32 v123, v123
    v_exp_f32 v124, v124
    v_exp_f32 v125, v125
    v_mfma_f32_32x32x16_bf16 v[104:119], v[52:55], v[40:43], 0
    ds_read_b128 v[64:67], v145 offset:6144
    v_exp_f32 v126, v126
    v_exp_f32 v127, v127
    v_exp_f32 v128, v128
    v_exp_f32 v129, v129
    v_exp_f32 v130, v130
    v_smfmac_f32_32x32x32_bf16 v[88:103], v[56:59], v[120:127], v136
    s_add_u32 m0, s34, 0
    s_add_u32 s33, s33, 802816
    v_exp_f32 v131, v131
    v_exp_f32 v132, v132
    v_exp_f32 v133, v133
    v_exp_f32 v134, v134
    v_exp_f32 v135, v135
    v_exp_f32 v104, v104
    v_exp_f32 v105, v105
    v_exp_f32 v106, v106
    v_smfmac_f32_32x32x32_bf16 v[88:103], v[60:63], v[128:135], v136
    s_waitcnt vmcnt(19) lgkmcnt(0)
    ds_read_b64_tr_b16 a[16:17], v21 offset:12288
    ds_read_b64_tr_b16 a[18:19], v21 offset:13312
    ds_read_b64_tr_b16 a[20:21], v22 offset:12288
    ds_read_b64_tr_b16 a[22:23], v22 offset:13312
    ds_read_b64_tr_b16 a[24:25], v21 offset:14336
    ds_read_b64_tr_b16 a[26:27], v21 offset:15360
    ds_read_b64_tr_b16 a[28:29], v22 offset:14336
    ds_read_b64_tr_b16 a[30:31], v22 offset:15360
    v_exp_f32 v107, v107
    v_exp_f32 v108, v108
    v_exp_f32 v109, v109
    v_mfma_f32_32x32x16_bf16 v[120:135], v[52:55], v[44:47], 0
    ds_read_b128 v[52:55], v146 offset:2048
    v_exp_f32 v110, v110
    v_exp_f32 v111, v111
    v_exp_f32 v112, v112
    v_exp_f32 v113, v113
    v_exp_f32 v114, v114
    v_smfmac_f32_32x32x32_bf16 v[72:87], v[64:67], v[104:111], v136
    ds_read_b128 v[60:63], v140 offset:512
    v_exp_f32 v115, v115
    v_exp_f32 v116, v116
    v_exp_f32 v117, v117
    v_exp_f32 v118, v118
    v_exp_f32 v119, v119
    v_exp_f32 v120, v120
    v_exp_f32 v121, v121
    v_exp_f32 v122, v122
    v_smfmac_f32_32x32x32_bf16 v[72:87], v[68:71], v[112:119], v136
    buffer_load_dwordx4 v4, s[48:51], s33 offen offset:0 lds
    buffer_load_dwordx4 v5, s[48:51], s33 offen offset:1024 lds
    v_exp_f32 v123, v123
    v_exp_f32 v124, v124
    v_exp_f32 v125, v125
    v_mfma_f32_32x32x16_bf16 v[104:119], v[48:51], v[40:43], 0
    ds_read_b128 v[56:59], v140 offset:0
    v_exp_f32 v126, v126
    v_exp_f32 v127, v127
    v_exp_f32 v128, v128
    v_exp_f32 v129, v129
    v_exp_f32 v130, v130
    v_smfmac_f32_32x32x32_bf16 v[88:103], v[64:67], v[120:127], v136
    buffer_load_dwordx4 v6, s[48:51], s33 offen offset:2048 lds
    buffer_load_dwordx4 v7, s[48:51], s33 offen offset:3072 lds
    v_exp_f32 v131, v131
    v_exp_f32 v132, v132
    v_exp_f32 v133, v133
    v_exp_f32 v134, v134
    v_exp_f32 v135, v135
    v_exp_f32 v104, v104
    v_exp_f32 v105, v105
    v_exp_f32 v106, v106
    v_smfmac_f32_32x32x32_bf16 v[88:103], v[68:71], v[128:135], v136
    s_waitcnt lgkmcnt(0)
    s_add_u32 s29, s29, 8192
    v_exp_f32 v107, v107
    v_exp_f32 v108, v108
    v_exp_f32 v109, v109
    v_mfma_f32_32x32x16_bf16 v[120:135], v[48:51], v[44:47], 0
    ds_read_b128 v[48:51], v146 offset:4096
    v_exp_f32 v110, v110
    v_exp_f32 v111, v111
    v_exp_f32 v112, v112
    v_exp_f32 v113, v113
    v_exp_f32 v114, v114
    v_smfmac_f32_32x32x32_bf16 v[72:87], v[56:59], v[104:111], v136
    ds_read_b128 v[68:71], v140 offset:2560
    v_exp_f32 v115, v115
    v_exp_f32 v116, v116
    v_exp_f32 v117, v117
    v_exp_f32 v118, v118
    v_exp_f32 v119, v119
    v_exp_f32 v120, v120
    v_exp_f32 v121, v121
    v_exp_f32 v122, v122
    v_smfmac_f32_32x32x32_bf16 v[72:87], v[60:63], v[112:119], v136
    s_add_u32 m0, s34, 4096
    s_add_u32 s33, s33, 114688
    v_exp_f32 v123, v123
    v_exp_f32 v124, v124
    v_exp_f32 v125, v125
    v_mfma_f32_32x32x16_bf16 v[104:119], v[52:55], v[40:43], 0
    ds_read_b128 v[64:67], v140 offset:2048
    v_exp_f32 v126, v126
    v_exp_f32 v127, v127
    v_exp_f32 v128, v128
    v_exp_f32 v129, v129
    v_exp_f32 v130, v130
    v_smfmac_f32_32x32x32_bf16 v[88:103], v[56:59], v[120:127], v136
    buffer_load_dwordx4 v4, s[48:51], s33 offen offset:0 lds
    buffer_load_dwordx4 v5, s[48:51], s33 offen offset:1024 lds
    v_exp_f32 v131, v131
    v_exp_f32 v132, v132
    v_exp_f32 v133, v133
    v_exp_f32 v134, v134
    v_exp_f32 v135, v135
    v_exp_f32 v104, v104
    v_exp_f32 v105, v105
    v_exp_f32 v106, v106
    v_smfmac_f32_32x32x32_bf16 v[88:103], v[60:63], v[128:135], v136
    s_waitcnt vmcnt(15) lgkmcnt(0)
    ds_read_b64_tr_b16 a[32:33], v21 offset:16384
    ds_read_b64_tr_b16 a[34:35], v21 offset:17408
    ds_read_b64_tr_b16 a[36:37], v22 offset:16384
    ds_read_b64_tr_b16 a[38:39], v22 offset:17408
    ds_read_b64_tr_b16 a[40:41], v21 offset:18432
    ds_read_b64_tr_b16 a[42:43], v21 offset:19456
    ds_read_b64_tr_b16 a[44:45], v22 offset:18432
    ds_read_b64_tr_b16 a[46:47], v22 offset:19456
    v_exp_f32 v107, v107
    v_exp_f32 v108, v108
    v_exp_f32 v109, v109
    v_mfma_f32_32x32x16_bf16 v[120:135], v[52:55], v[44:47], 0
    ds_read_b128 v[52:55], v146 offset:6144
    v_exp_f32 v110, v110
    v_exp_f32 v111, v111
    v_exp_f32 v112, v112
    v_exp_f32 v113, v113
    v_exp_f32 v114, v114
    v_smfmac_f32_32x32x32_bf16 v[72:87], v[64:67], v[104:111], v136
    ds_read_b128 v[60:63], v140 offset:4608
    v_exp_f32 v115, v115
    v_exp_f32 v116, v116
    v_exp_f32 v117, v117
    v_exp_f32 v118, v118
    v_exp_f32 v119, v119
    v_exp_f32 v120, v120
    v_exp_f32 v121, v121
    v_exp_f32 v122, v122
    v_smfmac_f32_32x32x32_bf16 v[72:87], v[68:71], v[112:119], v136
    buffer_load_dwordx4 v6, s[48:51], s33 offen offset:2048 lds
    buffer_load_dwordx4 v7, s[48:51], s33 offen offset:3072 lds
    v_exp_f32 v123, v123
    v_exp_f32 v124, v124
    v_exp_f32 v125, v125
    v_mfma_f32_32x32x16_bf16 v[104:119], v[48:51], v[40:43], 0
    ds_read_b128 v[56:59], v140 offset:4096
    v_exp_f32 v126, v126
    v_exp_f32 v127, v127
    v_exp_f32 v128, v128
    v_exp_f32 v129, v129
    v_exp_f32 v130, v130
    v_smfmac_f32_32x32x32_bf16 v[88:103], v[64:67], v[120:127], v136
    s_add_u32 m0, s30, 131072
    s_and_b32 s29, s29, 0x1ffff
    v_exp_f32 v131, v131
    v_exp_f32 v132, v132
    v_exp_f32 v133, v133
    v_exp_f32 v134, v134
    v_exp_f32 v135, v135
    v_exp_f32 v104, v104
    v_exp_f32 v105, v105
    v_exp_f32 v106, v106
    v_smfmac_f32_32x32x32_bf16 v[88:103], v[68:71], v[128:135], v136
    s_waitcnt vmcnt(12) lgkmcnt(0)
    s_barrier
    s_cmp_lg_u32 s16, 3
    s_cbranch_scc1 L_a2_15
    s_lshl_b32 s24, s17, 7
    s_add_u32 s24, s24, 14745600
    v_mov_b32 v138, 1
    v_mov_b32 v139, 0
    s_mov_b64 exec, 1
    buffer_atomic_add v138, v139, s[12:15], s24 offen sc1
    s_mov_b64 exec, -1
L_a2_15:
    v_exp_f32 v107, v107
    v_exp_f32 v108, v108
    v_exp_f32 v109, v109
    v_mfma_f32_32x32x16_bf16 v[120:135], v[48:51], v[44:47], 0
    ds_read_b128 v[48:51], v146 offset:32768
    v_exp_f32 v110, v110
    v_exp_f32 v111, v111
    v_exp_f32 v112, v112
    v_exp_f32 v113, v113
    v_exp_f32 v114, v114
    v_smfmac_f32_32x32x32_bf16 v[72:87], v[56:59], v[104:111], v136
    ds_read_b128 v[68:71], v140 offset:6656
    v_exp_f32 v115, v115
    v_exp_f32 v116, v116
    v_exp_f32 v117, v117
    v_exp_f32 v118, v118
    v_exp_f32 v119, v119
    v_exp_f32 v120, v120
    v_exp_f32 v121, v121
    v_exp_f32 v122, v122
    v_smfmac_f32_32x32x32_bf16 v[72:87], v[60:63], v[112:119], v136
    buffer_load_dwordx4 v148, s[12:15], s29 offen sc1 lds
    buffer_load_dwordx4 v148, s[12:15], s29 offen offset:1024 sc1 lds
L_pad_Q_1:
    s_cbranch_execz L_ret_Q_1
    v_exp_f32 v123, v123
    v_exp_f32 v124, v124
    v_exp_f32 v125, v125
    v_mfma_f32_32x32x16_bf16 v[104:119], v[52:55], v[40:43], 0
    ds_read_b128 v[64:67], v140 offset:6144
    v_exp_f32 v126, v126
    v_exp_f32 v127, v127
    v_exp_f32 v128, v128
    v_exp_f32 v129, v129
    v_exp_f32 v130, v130
    v_smfmac_f32_32x32x32_bf16 v[88:103], v[56:59], v[120:127], v136
    s_add_u32 m0, s34, 8192
    s_add_u32 s33, s33, 802816
    v_exp_f32 v131, v131
    v_exp_f32 v132, v132
    v_exp_f32 v133, v133
    v_exp_f32 v134, v134
    v_exp_f32 v135, v135
    v_exp_f32 v104, v104
    v_exp_f32 v105, v105
    v_exp_f32 v106, v106
    v_smfmac_f32_32x32x32_bf16 v[88:103], v[60:63], v[128:135], v136
    s_waitcnt vmcnt(12) lgkmcnt(0)
    ds_read_b64_tr_b16 a[48:49], v21 offset:20480
    ds_read_b64_tr_b16 a[50:51], v21 offset:21504
    ds_read_b64_tr_b16 a[52:53], v22 offset:20480
    ds_read_b64_tr_b16 a[54:55], v22 offset:21504
    ds_read_b64_tr_b16 a[56:57], v21 offset:22528
    ds_read_b64_tr_b16 a[58:59], v21 offset:23552
    ds_read_b64_tr_b16 a[60:61], v22 offset:22528
    ds_read_b64_tr_b16 a[62:63], v22 offset:23552
    v_exp_f32 v107, v107
    v_exp_f32 v108, v108
    v_exp_f32 v109, v109
    v_mfma_f32_32x32x16_bf16 v[120:135], v[52:55], v[44:47], 0
    ds_read_b128 v[52:55], v146 offset:34816
    v_exp_f32 v110, v110
    v_exp_f32 v111, v111
    v_exp_f32 v112, v112
    v_exp_f32 v113, v113
    v_exp_f32 v114, v114
    v_smfmac_f32_32x32x32_bf16 v[72:87], v[64:67], v[104:111], v136
    ds_read_b128 v[60:63], v141 offset:512
    v_exp_f32 v115, v115
    v_exp_f32 v116, v116
    v_exp_f32 v117, v117
    v_exp_f32 v118, v118
    v_exp_f32 v119, v119
    v_exp_f32 v120, v120
    v_exp_f32 v121, v121
    v_exp_f32 v122, v122
    v_smfmac_f32_32x32x32_bf16 v[72:87], v[68:71], v[112:119], v136
    buffer_load_dwordx4 v4, s[48:51], s33 offen offset:0 lds
    buffer_load_dwordx4 v5, s[48:51], s33 offen offset:1024 lds
    v_exp_f32 v123, v123
    v_exp_f32 v124, v124
    v_exp_f32 v125, v125
    v_mfma_f32_32x32x16_bf16 v[104:119], v[48:51], v[40:43], 0
    ds_read_b128 v[56:59], v141 offset:0
    v_exp_f32 v126, v126
    v_exp_f32 v127, v127
    v_exp_f32 v128, v128
    v_exp_f32 v129, v129
    v_exp_f32 v130, v130
    v_smfmac_f32_32x32x32_bf16 v[88:103], v[64:67], v[120:127], v136
    buffer_load_dwordx4 v6, s[48:51], s33 offen offset:2048 lds
    buffer_load_dwordx4 v7, s[48:51], s33 offen offset:3072 lds
    v_exp_f32 v131, v131
    v_exp_f32 v132, v132
    v_exp_f32 v133, v133
    v_exp_f32 v134, v134
    v_exp_f32 v135, v135
    v_exp_f32 v104, v104
    v_exp_f32 v105, v105
    v_exp_f32 v106, v106
    v_smfmac_f32_32x32x32_bf16 v[88:103], v[68:71], v[128:135], v136
    s_waitcnt lgkmcnt(0)
    s_add_u32 s29, s29, 8192
    v_exp_f32 v107, v107
    v_exp_f32 v108, v108
    v_exp_f32 v109, v109
    v_mfma_f32_32x32x16_bf16 v[120:135], v[48:51], v[44:47], 0
    ds_read_b128 v[48:51], v146 offset:36864
    v_exp_f32 v110, v110
    v_exp_f32 v111, v111
    v_exp_f32 v112, v112
    v_exp_f32 v113, v113
    v_exp_f32 v114, v114
    v_smfmac_f32_32x32x32_bf16 v[72:87], v[56:59], v[104:111], v136
    ds_read_b128 v[68:71], v141 offset:2560
    v_exp_f32 v115, v115
    v_exp_f32 v116, v116
    v_exp_f32 v117, v117
    v_exp_f32 v118, v118
    v_exp_f32 v119, v119
    v_exp_f32 v120, v120
    v_exp_f32 v121, v121
    v_exp_f32 v122, v122
    v_smfmac_f32_32x32x32_bf16 v[72:87], v[60:63], v[112:119], v136
    s_add_u32 m0, s34, 12288
    s_add_u32 s33, s33, 114688
    v_exp_f32 v123, v123
    v_exp_f32 v124, v124
    v_exp_f32 v125, v125
    v_mfma_f32_32x32x16_bf16 v[104:119], v[52:55], v[40:43], 0
    ds_read_b128 v[64:67], v141 offset:2048
    v_exp_f32 v126, v126
    v_exp_f32 v127, v127
    v_exp_f32 v128, v128
    v_exp_f32 v129, v129
    v_exp_f32 v130, v130
    v_smfmac_f32_32x32x32_bf16 v[88:103], v[56:59], v[120:127], v136
    buffer_load_dwordx4 v4, s[48:51], s33 offen offset:0 lds
    buffer_load_dwordx4 v5, s[48:51], s33 offen offset:1024 lds
    v_exp_f32 v131, v131
    v_exp_f32 v132, v132
    v_exp_f32 v133, v133
    v_exp_f32 v134, v134
    v_exp_f32 v135, v135
    v_exp_f32 v104, v104
    v_exp_f32 v105, v105
    v_exp_f32 v106, v106
    v_smfmac_f32_32x32x32_bf16 v[88:103], v[60:63], v[128:135], v136
    s_waitcnt vmcnt(12) lgkmcnt(0)
    ds_read_b64_tr_b16 a[64:65], v21 offset:0
    ds_read_b64_tr_b16 a[66:67], v21 offset:1024
    ds_read_b64_tr_b16 a[68:69], v22 offset:0
    ds_read_b64_tr_b16 a[70:71], v22 offset:1024
    ds_read_b64_tr_b16 a[72:73], v21 offset:2048
    ds_read_b64_tr_b16 a[74:75], v21 offset:3072
    ds_read_b64_tr_b16 a[76:77], v22 offset:2048
    ds_read_b64_tr_b16 a[78:79], v22 offset:3072
    v_exp_f32 v107, v107
    v_exp_f32 v108, v108
    v_exp_f32 v109, v109
    v_mfma_f32_32x32x16_bf16 v[120:135], v[52:55], v[44:47], 0
    ds_read_b128 v[52:55], v146 offset:38912
    v_exp_f32 v110, v110
    v_exp_f32 v111, v111
    v_exp_f32 v112, v112
    v_exp_f32 v113, v113
    v_exp_f32 v114, v114
    v_smfmac_f32_32x32x32_bf16 v[72:87], v[64:67], v[104:111], v136
    ds_read_b128 v[60:63], v141 offset:4608
    v_exp_f32 v115, v115
    v_exp_f32 v116, v116
    v_exp_f32 v117, v117
    v_exp_f32 v118, v118
    v_exp_f32 v119, v119
    v_exp_f32 v120, v120
    v_exp_f32 v121, v121
    v_exp_f32 v122, v122
    v_smfmac_f32_32x32x32_bf16 v[72:87], v[68:71], v[112:119], v136
    buffer_load_dwordx4 v6, s[48:51], s33 offen offset:2048 lds
    buffer_load_dwordx4 v7, s[48:51], s33 offen offset:3072 lds
    v_exp_f32 v123, v123
    v_exp_f32 v124, v124
    v_exp_f32 v125, v125
    v_mfma_f32_32x32x16_bf16 v[104:119], v[48:51], v[40:43], 0
    ds_read_b128 v[56:59], v141 offset:4096
    v_exp_f32 v126, v126
    v_exp_f32 v127, v127
    v_exp_f32 v128, v128
    v_exp_f32 v129, v129
    v_exp_f32 v130, v130
    v_smfmac_f32_32x32x32_bf16 v[88:103], v[64:67], v[120:127], v136
    s_add_u32 m0, s30, 139264
    s_and_b32 s29, s29, 0x1ffff
    v_exp_f32 v131, v131
    v_exp_f32 v132, v132
    v_exp_f32 v133, v133
    v_exp_f32 v134, v134
    v_exp_f32 v135, v135
    v_exp_f32 v104, v104
    v_exp_f32 v105, v105
    v_exp_f32 v106, v106
    v_smfmac_f32_32x32x32_bf16 v[88:103], v[68:71], v[128:135], v136
    s_waitcnt lgkmcnt(0)
    v_exp_f32 v107, v107
    v_exp_f32 v108, v108
    v_exp_f32 v109, v109
    v_mfma_f32_32x32x16_bf16 v[120:135], v[48:51], v[44:47], 0
    ds_read_b128 v[48:51], v147 offset:0
    v_exp_f32 v110, v110
    v_exp_f32 v111, v111
    v_exp_f32 v112, v112
    v_exp_f32 v113, v113
    v_exp_f32 v114, v114
    v_smfmac_f32_32x32x32_bf16 v[72:87], v[56:59], v[104:111], v136
    ds_read_b128 v[68:71], v141 offset:6656
    v_exp_f32 v115, v115
    v_exp_f32 v116, v116
    v_exp_f32 v117, v117
    v_exp_f32 v118, v118
    v_exp_f32 v119, v119
    v_exp_f32 v120, v120
    v_exp_f32 v121, v121
    v_exp_f32 v122, v122
    v_smfmac_f32_32x32x32_bf16 v[72:87], v[60:63], v[112:119], v136
    buffer_load_dwordx4 v148, s[12:15], s29 offen sc1 lds
    buffer_load_dwordx4 v148, s[12:15], s29 offen offset:1024 sc1 lds
    v_exp_f32 v123, v123
    v_exp_f32 v124, v124
    v_exp_f32 v125, v125
    v_mfma_f32_32x32x16_bf16 v[104:119], v[52:55], v[40:43], 0
    ds_read_b128 v[64:67], v141 offset:6144
    v_exp_f32 v126, v126
    v_exp_f32 v127, v127
    v_exp_f32 v128, v128
    v_exp_f32 v129, v129
    v_exp_f32 v130, v130
    v_smfmac_f32_32x32x32_bf16 v[88:103], v[56:59], v[120:127], v136
    s_add_u32 m0, s34, 16384
    s_add_u32 s33, s33, 802816
    v_exp_f32 v131, v131
    v_exp_f32 v132, v132
    v_exp_f32 v133, v133
    v_exp_f32 v134, v134
    v_exp_f32 v135, v135
    v_exp_f32 v104, v104
    v_exp_f32 v105, v105
    v_exp_f32 v106, v106
    v_smfmac_f32_32x32x32_bf16 v[88:103], v[60:63], v[128:135], v136
    s_waitcnt vmcnt(12) lgkmcnt(0)
    ds_read_b64_tr_b16 a[80:81], v21 offset:4096
    ds_read_b64_tr_b16 a[82:83], v21 offset:5120
    ds_read_b64_tr_b16 a[84:85], v22 offset:4096
    ds_read_b64_tr_b16 a[86:87], v22 offset:5120
    ds_read_b64_tr_b16 a[88:89], v21 offset:6144
    ds_read_b64_tr_b16 a[90:91], v21 offset:7168
    ds_read_b64_tr_b16 a[92:93], v22 offset:6144
    ds_read_b64_tr_b16 a[94:95], v22 offset:7168
    v_exp_f32 v107, v107
    v_exp_f32 v108, v108
    v_exp_f32 v109, v109
    v_mfma_f32_32x32x16_bf16 v[120:135], v[52:55], v[44:47], 0
    ds_read_b128 v[52:55], v147 offset:2048
    v_exp_f32 v110, v110
    v_exp_f32 v111, v111
    v_exp_f32 v112, v112
    v_exp_f32 v113, v113
    v_exp_f32 v114, v114
    v_smfmac_f32_32x32x32_bf16 v[72:87], v[64:67], v[104:111], v136
    ds_read_b128 v[60:63], v142 offset:512
    v_exp_f32 v115, v115
    v_exp_f32 v116, v116
    v_exp_f32 v117, v117
    v_exp_f32 v118, v118
    v_exp_f32 v119, v119
    v_exp_f32 v120, v120
    v_exp_f32 v121, v121
    v_exp_f32 v122, v122
    v_smfmac_f32_32x32x32_bf16 v[72:87], v[68:71], v[112:119], v136
    buffer_load_dwordx4 v4, s[48:51], s33 offen offset:0 lds
    buffer_load_dwordx4 v5, s[48:51], s33 offen offset:1024 lds
    v_exp_f32 v123, v123
    v_exp_f32 v124, v124
    v_exp_f32 v125, v125
    v_mfma_f32_32x32x16_bf16 v[104:119], v[48:51], v[40:43], 0
    ds_read_b128 v[56:59], v142 offset:0
    v_exp_f32 v126, v126
    v_exp_f32 v127, v127
    v_exp_f32 v128, v128
    v_exp_f32 v129, v129
    v_exp_f32 v130, v130
    v_smfmac_f32_32x32x32_bf16 v[88:103], v[64:67], v[120:127], v136
    buffer_load_dwordx4 v6, s[48:51], s33 offen offset:2048 lds
    buffer_load_dwordx4 v7, s[48:51], s33 offen offset:3072 lds
    v_exp_f32 v131, v131
    v_exp_f32 v132, v132
    v_exp_f32 v133, v133
    v_exp_f32 v134, v134
    v_exp_f32 v135, v135
    v_exp_f32 v104, v104
    v_exp_f32 v105, v105
    v_exp_f32 v106, v106
    v_smfmac_f32_32x32x32_bf16 v[88:103], v[68:71], v[128:135], v136
    s_waitcnt lgkmcnt(0)
    s_add_u32 s29, s29, 8192
    s_lshl_b32 s24, s21, 2
    s_lshl_b32 s25, s23, 1
    s_add_u32 s24, s24, s25
    s_lshl_b32 s24, s24, 6
    s_lshl_b32 s25, s20, 1
    s_add_u32 s25, s25, s22
    s_add_u32 s24, s24, s25
    s_lshl_b32 s86, s24, 10
    s_add_u32 s86, s86, 16777216
    s_add_u32 s87, s86, 65536
    s_lshl_b32 s88, s24, 11
    s_add_u32 s88, s88, 18874368
    s_add_u32 s89, s88, 131072
    v_and_b32 v12, 7, v1
    v_lshlrev_b32 v12, 7, v12
    buffer_load_dword v13, v12, s[12:15], s86 offen
    buffer_load_dword v13, v12, s[12:15], s87 offen
    v_exp_f32 v107, v107
    v_exp_f32 v108, v108
    v_exp_f32 v109, v109
    v_mfma_f32_32x32x16_bf16 v[120:135], v[48:51], v[44:47], 0
    ds_read_b128 v[48:51], v147 offset:4096
    v_exp_f32 v110, v110
    v_exp_f32 v111, v111
    v_exp_f32 v112, v112
    v_exp_f32 v113, v113
    v_exp_f32 v114, v114
    v_smfmac_f32_32x32x32_bf16 v[72:87], v[56:59], v[104:111], v136
    ds_read_b128 v[68:71], v142 offset:2560
    v_exp_f32 v115, v115
    v_exp_f32 v116, v116
    v_exp_f32 v117, v117
    v_exp_f32 v118, v118
    v_exp_f32 v119, v119
    v_exp_f32 v120, v120
    v_exp_f32 v121, v121
    v_exp_f32 v122, v122
    v_smfmac_f32_32x32x32_bf16 v[72:87], v[60:63], v[112:119], v136
    s_add_u32 m0, s34, 20480
    s_add_u32 s33, s33, 114688
    v_exp_f32 v123, v123
    v_exp_f32 v124, v124
    v_exp_f32 v125, v125
    v_mfma_f32_32x32x16_bf16 v[104:119], v[52:55], v[40:43], 0
    ds_read_b128 v[64:67], v142 offset:2048
    v_exp_f32 v126, v126
    v_exp_f32 v127, v127
    v_exp_f32 v128, v128
    v_exp_f32 v129, v129
    v_exp_f32 v130, v130
    v_smfmac_f32_32x32x32_bf16 v[88:103], v[56:59], v[120:127], v136
    buffer_load_dwordx4 v4, s[48:51], s33 offen offset:0 lds
    buffer_load_dwordx4 v5, s[48:51], s33 offen offset:1024 lds
    v_exp_f32 v131, v131
    v_exp_f32 v132, v132
    v_exp_f32 v133, v133
    v_exp_f32 v134, v134
    v_exp_f32 v135, v135
    v_exp_f32 v104, v104
    v_exp_f32 v105, v105
    v_exp_f32 v106, v106
    v_smfmac_f32_32x32x32_bf16 v[88:103], v[60:63], v[128:135], v136
    s_waitcnt vmcnt(14) lgkmcnt(0)
    ds_read_b64_tr_b16 a[96:97], v21 offset:8192
    ds_read_b64_tr_b16 a[98:99], v21 offset:9216
    ds_read_b64_tr_b16 a[100:101], v22 offset:8192
    ds_read_b64_tr_b16 a[102:103], v22 offset:9216
    ds_read_b64_tr_b16 a[104:105], v21 offset:10240
    ds_read_b64_tr_b16 a[106:107], v21 offset:11264
    ds_read_b64_tr_b16 a[108:109], v22 offset:10240
    ds_read_b64_tr_b16 a[110:111], v22 offset:11264
    v_exp_f32 v107, v107
    v_exp_f32 v108, v108
    v_exp_f32 v109, v109
    v_mfma_f32_32x32x16_bf16 v[120:135], v[52:55], v[44:47], 0
    ds_read_b128 v[52:55], v147 offset:6144
    v_exp_f32 v110, v110
    v_exp_f32 v111, v111
    v_exp_f32 v112, v112
    v_exp_f32 v113, v113
    v_exp_f32 v114, v114
    v_smfmac_f32_32x32x32_bf16 v[72:87], v[64:67], v[104:111], v136
    ds_read_b128 v[60:63], v142 offset:4608
    v_exp_f32 v115, v115
    v_exp_f32 v116, v116
    v_exp_f32 v117, v117
    v_exp_f32 v118, v118
    v_exp_f32 v119, v119
    v_exp_f32 v120, v120
    v_exp_f32 v121, v121
    v_exp_f32 v122, v122
    v_smfmac_f32_32x32x32_bf16 v[72:87], v[68:71], v[112:119], v136
    buffer_load_dwordx4 v6, s[48:51], s33 offen offset:2048 lds
    buffer_load_dwordx4 v7, s[48:51], s33 offen offset:3072 lds
    v_exp_f32 v123, v123
    v_exp_f32 v124, v124
    v_exp_f32 v125, v125
    v_mfma_f32_32x32x16_bf16 v[104:119], v[48:51], v[40:43], 0
    ds_read_b128 v[56:59], v142 offset:4096
    v_exp_f32 v126, v126
    v_exp_f32 v127, v127
    v_exp_f32 v128, v128
    v_exp_f32 v129, v129
    v_exp_f32 v130, v130
    v_smfmac_f32_32x32x32_bf16 v[88:103], v[64:67], v[120:127], v136
    s_add_u32 m0, s30, 24576
    s_and_b32 s29, s29, 0x1ffff
    v_exp_f32 v131, v131
    v_exp_f32 v132, v132
    v_exp_f32 v133, v133
    v_exp_f32 v134, v134
    v_exp_f32 v135, v135
    v_exp_f32 v104, v104
    v_exp_f32 v105, v105
    v_exp_f32 v106, v106
    v_smfmac_f32_32x32x32_bf16 v[88:103], v[68:71], v[128:135], v136
    s_waitcnt vmcnt(20) lgkmcnt(0)
    s_barrier
    v_exp_f32 v107, v107
    v_exp_f32 v108, v108
    v_exp_f32 v109, v109
    v_mfma_f32_32x32x16_bf16 v[120:135], v[48:51], v[44:47], 0
    ds_read_b128 v[48:51], v147 offset:32768
    v_exp_f32 v110, v110
    v_exp_f32 v111, v111
    v_exp_f32 v112, v112
    v_exp_f32 v113, v113
    v_exp_f32 v114, v114
    v_smfmac_f32_32x32x32_bf16 v[72:87], v[56:59], v[104:111], v136
    ds_read_b128 v[68:71], v142 offset:6656
    v_exp_f32 v115, v115
    v_exp_f32 v116, v116
    v_exp_f32 v117, v117
    v_exp_f32 v118, v118
    v_exp_f32 v119, v119
    v_exp_f32 v120, v120
    v_exp_f32 v121, v121
    v_exp_f32 v122, v122
    v_smfmac_f32_32x32x32_bf16 v[72:87], v[60:63], v[112:119], v136
    buffer_load_dwordx4 v148, s[12:15], s29 offen sc1 lds
    buffer_load_dwordx4 v148, s[12:15], s29 offen offset:1024 sc1 lds
    v_exp_f32 v123, v123
    v_exp_f32 v124, v124
    v_exp_f32 v125, v125
    v_mfma_f32_32x32x16_bf16 v[104:119], v[52:55], v[40:43], 0
    ds_read_b128 v[64:67], v142 offset:6144
    v_exp_f32 v126, v126
    v_exp_f32 v127, v127
    v_exp_f32 v128, v128
    v_exp_f32 v129, v129
    v_exp_f32 v130, v130
    v_smfmac_f32_32x32x32_bf16 v[88:103], v[56:59], v[120:127], v136
    s_add_u32 m0, s34, 0
    s_add_u32 s33, s33, 802816
    v_exp_f32 v131, v131
    v_exp_f32 v132, v132
    v_exp_f32 v133, v133
    v_exp_f32 v134, v134
    v_exp_f32 v135, v135
    v_exp_f32 v104, v104
    v_exp_f32 v105, v105
    v_exp_f32 v106, v106
    v_smfmac_f32_32x32x32_bf16 v[88:103], v[60:63], v[128:135], v136
    s_waitcnt vmcnt(14) lgkmcnt(0)
    ds_read_b64_tr_b16 a[112:113], v21 offset:12288
    ds_read_b64_tr_b16 a[114:115], v21 offset:13312
    ds_read_b64_tr_b16 a[116:117], v22 offset:12288
    ds_read_b64_tr_b16 a[118:119], v22 offset:13312
    ds_read_b64_tr_b16 a[120:121], v21 offset:14336
    ds_read_b64_tr_b16 a[122:123], v21 offset:15360
    ds_read_b64_tr_b16 a[124:125], v22 offset:14336
    ds_read_b64_tr_b16 a[126:127], v22 offset:15360
    v_exp_f32 v107, v107
    v_exp_f32 v108, v108
    v_exp_f32 v109, v109
    v_mfma_f32_32x32x16_bf16 v[120:135], v[52:55], v[44:47], 0
    ds_read_b128 v[52:55], v147 offset:34816
    v_exp_f32 v110, v110
    v_exp_f32 v111, v111
    v_exp_f32 v112, v112
    v_exp_f32 v113, v113
    v_exp_f32 v114, v114
    v_smfmac_f32_32x32x32_bf16 v[72:87], v[64:67], v[104:111], v136
    ds_read_b128 v[60:63], v143 offset:512
    v_exp_f32 v115, v115
    v_exp_f32 v116, v116
    v_exp_f32 v117, v117
    v_exp_f32 v118, v118
    v_exp_f32 v119, v119
    v_exp_f32 v120, v120
    v_exp_f32 v121, v121
    v_exp_f32 v122, v122
    v_smfmac_f32_32x32x32_bf16 v[72:87], v[68:71], v[112:119], v136
    buffer_load_dwordx4 v4, s[48:51], s33 offen offset:0 lds
    buffer_load_dwordx4 v5, s[48:51], s33 offen offset:1024 lds
    v_exp_f32 v123, v123
    v_exp_f32 v124, v124
    v_exp_f32 v125, v125
    v_mfma_f32_32x32x16_bf16 v[104:119], v[48:51], v[40:43], 0
    ds_read_b128 v[56:59], v143 offset:0
    v_exp_f32 v126, v126
    v_exp_f32 v127, v127
    v_exp_f32 v128, v128
    v_exp_f32 v129, v129
    v_exp_f32 v130, v130
    v_smfmac_f32_32x32x32_bf16 v[88:103], v[64:67], v[120:127], v136
    buffer_load_dwordx4 v6, s[48:51], s33 offen offset:2048 lds
    buffer_load_dwordx4 v7, s[48:51], s33 offen offset:3072 lds
    v_exp_f32 v131, v131
    v_exp_f32 v132, v132
    v_exp_f32 v133, v133
    v_exp_f32 v134, v134
    v_exp_f32 v135, v135
    v_exp_f32 v104, v104
    v_exp_f32 v105, v105
    v_exp_f32 v106, v106
    v_smfmac_f32_32x32x32_bf16 v[88:103], v[68:71], v[128:135], v136
    s_waitcnt lgkmcnt(0)
    s_add_u32 s29, s29, 8192
    s_lshl_b32 s24, s20, 1
    s_add_u32 s24, s24, s22
    s_lshl_b32 s24, s24, 3
    s_add_u32 s24, s24, s21
    s_lshl_b32 s87, s24, 9
    s_add_u32 s87, s87, 15728640
    s_lshl_b32 s24, s24, 2
    s_add_u32 s24, s24, s23
    s_lshl_b32 s86, s24, 10
    s_add_u32 s86, s86, 8388608
    s_add_u32 s88, s86, 2048
    v_exp_f32 v107, v107
    v_exp_f32 v108, v108
    v_exp_f32 v109, v109
    v_mfma_f32_32x32x16_bf16 v[120:135], v[48:51], v[44:47], 0
    ds_read_b128 v[48:51], v147 offset:36864
    v_exp_f32 v110, v110
    v_exp_f32 v111, v111
    v_exp_f32 v112, v112
    v_exp_f32 v113, v113
    v_exp_f32 v114, v114
    v_smfmac_f32_32x32x32_bf16 v[72:87], v[56:59], v[104:111], v136
    ds_read_b128 v[68:71], v143 offset:2560
    v_exp_f32 v115, v115
    v_exp_f32 v116, v116
    v_exp_f32 v117, v117
    v_exp_f32 v118, v118
    v_exp_f32 v119, v119
    v_exp_f32 v120, v120
    v_exp_f32 v121, v121
    v_exp_f32 v122, v122
    v_smfmac_f32_32x32x32_bf16 v[72:87], v[60:63], v[112:119], v136
    s_add_u32 m0, s34, 4096
    s_add_u32 s33, s33, 114688
    v_exp_f32 v123, v123
    v_exp_f32 v124, v124
    v_exp_f32 v125, v125
    v_mfma_f32_32x32x16_bf16 v[104:119], v[52:55], v[40:43], 0
    ds_read_b128 v[64:67], v143 offset:2048
    v_exp_f32 v126, v126
    v_exp_f32 v127, v127
    v_exp_f32 v128, v128
    v_exp_f32 v129, v129
    v_exp_f32 v130, v130
    v_smfmac_f32_32x32x32_bf16 v[88:103], v[56:59], v[120:127], v136
    buffer_load_dwordx4 v4, s[48:51], s33 offen offset:0 lds
    buffer_load_dwordx4 v5, s[48:51], s33 offen offset:1024 lds
    v_exp_f32 v131, v131
    v_exp_f32 v132, v132
    v_exp_f32 v133, v133
    v_exp_f32 v134, v134
    v_exp_f32 v135, v135
    v_exp_f32 v104, v104
    v_exp_f32 v105, v105
    v_exp_f32 v106, v106
    v_smfmac_f32_32x32x32_bf16 v[88:103], v[60:63], v[128:135], v136
    s_waitcnt vmcnt(14) lgkmcnt(0)
    ds_read_b64_tr_b16 a[128:129], v21 offset:16384
    ds_read_b64_tr_b16 a[130:131], v21 offset:17408
    ds_read_b64_tr_b16 a[132:133], v22 offset:16384
    ds_read_b64_tr_b16 a[134:135], v22 offset:17408
    ds_read_b64_tr_b16 a[136:137], v21 offset:18432
    ds_read_b64_tr_b16 a[138:139], v21 offset:19456
    ds_read_b64_tr_b16 a[140:141], v22 offset:18432
    ds_read_b64_tr_b16 a[142:143], v22 offset:19456
    v_exp_f32 v107, v107
    v_exp_f32 v108, v108
    v_exp_f32 v109, v109
    v_mfma_f32_32x32x16_bf16 v[120:135], v[52:55], v[44:47], 0
    ds_read_b128 v[52:55], v147 offset:38912
    v_exp_f32 v110, v110
    v_exp_f32 v111, v111
    v_exp_f32 v112, v112
    v_exp_f32 v113, v113
    v_exp_f32 v114, v114
    v_smfmac_f32_32x32x32_bf16 v[72:87], v[64:67], v[104:111], v136
    ds_read_b128 v[60:63], v143 offset:4608
    v_exp_f32 v115, v115
    v_exp_f32 v116, v116
    v_exp_f32 v117, v117
    v_exp_f32 v118, v118
    v_exp_f32 v119, v119
    v_exp_f32 v120, v120
    v_exp_f32 v121, v121
    v_exp_f32 v122, v122
    v_smfmac_f32_32x32x32_bf16 v[72:87], v[68:71], v[112:119], v136
    buffer_load_dwordx4 v6, s[48:51], s33 offen offset:2048 lds
    buffer_load_dwordx4 v7, s[48:51], s33 offen offset:3072 lds
    v_exp_f32 v123, v123
    v_exp_f32 v124, v124
    v_exp_f32 v125, v125
    v_mfma_f32_32x32x16_bf16 v[104:119], v[48:51], v[40:43], 0
    ds_read_b128 v[56:59], v143 offset:4096
    v_exp_f32 v126, v126
    v_exp_f32 v127, v127
    v_exp_f32 v128, v128
    v_exp_f32 v129, v129
    v_exp_f32 v130, v130
    v_smfmac_f32_32x32x32_bf16 v[88:103], v[64:67], v[120:127], v136
    s_add_u32 m0, s30, 57344
    s_and_b32 s29, s29, 0x1ffff
    v_exp_f32 v131, v131
    v_exp_f32 v132, v132
    v_exp_f32 v133, v133
    v_exp_f32 v134, v134
    v_exp_f32 v135, v135
    v_exp_f32 v104, v104
    v_exp_f32 v105, v105
    v_exp_f32 v106, v106
    v_smfmac_f32_32x32x32_bf16 v[88:103], v[68:71], v[128:135], v136
    s_waitcnt lgkmcnt(0)
    v_exp_f32 v107, v107
    v_exp_f32 v108, v108
    v_exp_f32 v109, v109
    v_mfma_f32_32x32x16_bf16 v[120:135], v[48:51], v[44:47], 0
    ds_read_b128 v[48:51], v147 offset:40960
    v_exp_f32 v110, v110
    v_exp_f32 v111, v111
    v_exp_f32 v112, v112
    v_exp_f32 v113, v113
    v_exp_f32 v114, v114
    v_smfmac_f32_32x32x32_bf16 v[72:87], v[56:59], v[104:111], v136
    ds_read_b128 v[68:71], v143 offset:6656
    v_exp_f32 v115, v115
    v_exp_f32 v116, v116
    v_exp_f32 v117, v117
    v_exp_f32 v118, v118
    v_exp_f32 v119, v119
    v_exp_f32 v120, v120
    v_exp_f32 v121, v121
    v_exp_f32 v122, v122
    v_smfmac_f32_32x32x32_bf16 v[72:87], v[60:63], v[112:119], v136
    buffer_load_dwordx4 v148, s[12:15], s29 offen sc1 lds
    buffer_load_dwordx4 v148, s[12:15], s29 offen offset:1024 sc1 lds
    v_exp_f32 v123, v123
    v_exp_f32 v124, v124
    v_exp_f32 v125, v125
    v_mfma_f32_32x32x16_bf16 v[104:119], v[52:55], v[40:43], 0
    ds_read_b128 v[64:67], v143 offset:6144
    v_exp_f32 v126, v126
    v_exp_f32 v127, v127
    v_exp_f32 v128, v128
    v_exp_f32 v129, v129
    v_exp_f32 v130, v130
    v_smfmac_f32_32x32x32_bf16 v[88:103], v[56:59], v[120:127], v136
    s_add_u32 m0, s34, 8192
    s_add_u32 s33, s33, 802816
    v_exp_f32 v131, v131
    v_exp_f32 v132, v132
    v_exp_f32 v133, v133
    v_exp_f32 v134, v134
    v_exp_f32 v135, v135
    v_exp_f32 v104, v104
    v_exp_f32 v105, v105
    v_exp_f32 v106, v106
    v_smfmac_f32_32x32x32_bf16 v[88:103], v[60:63], v[128:135], v136
    s_waitcnt vmcnt(12) lgkmcnt(0)
    ds_read_b64_tr_b16 a[144:145], v21 offset:20480
    ds_read_b64_tr_b16 a[146:147], v21 offset:21504
    ds_read_b64_tr_b16 a[148:149], v22 offset:20480
    ds_read_b64_tr_b16 a[150:151], v22 offset:21504
    ds_read_b64_tr_b16 a[152:153], v21 offset:22528
    ds_read_b64_tr_b16 a[154:155], v21 offset:23552
    ds_read_b64_tr_b16 a[156:157], v22 offset:22528
    ds_read_b64_tr_b16 a[158:159], v22 offset:23552
    v_exp_f32 v107, v107
    v_exp_f32 v108, v108
    v_exp_f32 v109, v109
    v_mfma_f32_32x32x16_bf16 v[120:135], v[52:55], v[44:47], 0
    ds_read_b128 v[52:55], v147 offset:43008
    v_exp_f32 v110, v110
    v_exp_f32 v111, v111
    v_exp_f32 v112, v112
    v_exp_f32 v113, v113
    v_exp_f32 v114, v114
    v_smfmac_f32_32x32x32_bf16 v[72:87], v[64:67], v[104:111], v136
    ds_read_b128 v[60:63], v144 offset:512
    v_exp_f32 v115, v115
    v_exp_f32 v116, v116
    v_exp_f32 v117, v117
    v_exp_f32 v118, v118
    v_exp_f32 v119, v119
    v_exp_f32 v120, v120
    v_exp_f32 v121, v121
    v_exp_f32 v122, v122
    v_smfmac_f32_32x32x32_bf16 v[72:87], v[68:71], v[112:119], v136
    buffer_load_dwordx4 v4, s[48:51], s33 offen offset:0 lds
    buffer_load_dwordx4 v5, s[48:51], s33 offen offset:1024 lds
    v_exp_f32 v123, v123
    v_exp_f32 v124, v124
    v_exp_f32 v125, v125
    v_mfma_f32_32x32x16_bf16 v[104:119], v[48:51], v[40:43], 0
    ds_read_b128 v[56:59], v144 offset:0
    v_exp_f32 v126, v126
    v_exp_f32 v127, v127
    v_exp_f32 v128, v128
    v_exp_f32 v129, v129
    v_exp_f32 v130, v130
    v_smfmac_f32_32x32x32_bf16 v[88:103], v[64:67], v[120:127], v136
    buffer_load_dwordx4 v6, s[48:51], s33 offen offset:2048 lds
    buffer_load_dwordx4 v7, s[48:51], s33 offen offset:3072 lds
    v_exp_f32 v131, v131
    v_exp_f32 v132, v132
    v_exp_f32 v133, v133
    v_exp_f32 v134, v134
    v_exp_f32 v135, v135
    v_exp_f32 v104, v104
    v_exp_f32 v105, v105
    v_exp_f32 v106, v106
    v_smfmac_f32_32x32x32_bf16 v[88:103], v[68:71], v[128:135], v136
    s_waitcnt lgkmcnt(0)
    s_add_u32 s29, s29, 8192
    buffer_load_dword v139, v12, s[12:15], s86 offen
    buffer_load_dword v139, v12, s[12:15], s88 offen
    v_exp_f32 v107, v107
    v_exp_f32 v108, v108
    v_exp_f32 v109, v109
    v_mfma_f32_32x32x16_bf16 v[120:135], v[48:51], v[44:47], 0
    ds_read_b128 v[48:51], v147 offset:45056
    v_exp_f32 v110, v110
    v_exp_f32 v111, v111
    v_exp_f32 v112, v112
    v_exp_f32 v113, v113
    v_exp_f32 v114, v114
    v_smfmac_f32_32x32x32_bf16 v[72:87], v[56:59], v[104:111], v136
    ds_read_b128 v[68:71], v144 offset:2560
    v_exp_f32 v115, v115
    v_exp_f32 v116, v116
    v_exp_f32 v117, v117
    v_exp_f32 v118, v118
    v_exp_f32 v119, v119
    v_exp_f32 v120, v120
    v_exp_f32 v121, v121
    v_exp_f32 v122, v122
    v_smfmac_f32_32x32x32_bf16 v[72:87], v[60:63], v[112:119], v136
    s_add_u32 m0, s34, 12288
    s_add_u32 s33, s33, 114688
    v_exp_f32 v123, v123
    v_exp_f32 v124, v124
    v_exp_f32 v125, v125
    v_mfma_f32_32x32x16_bf16 v[104:119], v[52:55], v[40:43], 0
    ds_read_b128 v[64:67], v144 offset:2048
    v_exp_f32 v126, v126
    v_exp_f32 v127, v127
    v_exp_f32 v128, v128
    v_exp_f32 v129, v129
    v_exp_f32 v130, v130
    v_smfmac_f32_32x32x32_bf16 v[88:103], v[56:59], v[120:127], v136
    buffer_load_dwordx4 v4, s[48:51], s33 offen offset:0 lds
    buffer_load_dwordx4 v5, s[48:51], s33 offen offset:1024 lds
    v_exp_f32 v131, v131
    v_exp_f32 v132, v132
    v_exp_f32 v133, v133
    v_exp_f32 v134, v134
    v_exp_f32 v135, v135
    v_exp_f32 v104, v104
    v_exp_f32 v105, v105
    v_exp_f32 v106, v106
    v_smfmac_f32_32x32x32_bf16 v[88:103], v[60:63], v[128:135], v136
    s_waitcnt vmcnt(14) lgkmcnt(0)
    ds_read_b64_tr_b16 a[160:161], v21 offset:0
    ds_read_b64_tr_b16 a[162:163], v21 offset:1024
    ds_read_b64_tr_b16 a[164:165], v22 offset:0
    ds_read_b64_tr_b16 a[166:167], v22 offset:1024
L_pad_Q_2:
    s_cbranch_execz L_ret_Q_2
    ds_read_b64_tr_b16 a[168:169], v21 offset:2048
    ds_read_b64_tr_b16 a[170:171], v21 offset:3072
    ds_read_b64_tr_b16 a[172:173], v22 offset:2048
    ds_read_b64_tr_b16 a[174:175], v22 offset:3072
    v_exp_f32 v107, v107
    v_exp_f32 v108, v108
    v_exp_f32 v109, v109
    v_mfma_f32_32x32x16_bf16 v[120:135], v[52:55], v[44:47], 0
    ds_read_b128 v[52:55], v147 offset:47104
    v_exp_f32 v110, v110
    v_exp_f32 v111, v111
    v_exp_f32 v112, v112
    v_exp_f32 v113, v113
    v_exp_f32 v114, v114
    v_smfmac_f32_32x32x32_bf16 v[72:87], v[64:67], v[104:111], v136
    ds_read_b128 v[60:63], v144 offset:4608
    v_exp_f32 v115, v115
    v_exp_f32 v116, v116
    v_exp_f32 v117, v117
    v_exp_f32 v118, v118
    v_exp_f32 v119, v119
    v_exp_f32 v120, v120
    v_exp_f32 v121, v121
    v_exp_f32 v122, v122
    v_smfmac_f32_32x32x32_bf16 v[72:87], v[68:71], v[112:119], v136
    buffer_load_dwordx4 v6, s[48:51], s33 offen offset:2048 lds
    buffer_load_dwordx4 v7, s[48:51], s33 offen offset:3072 lds
    v_exp_f32 v123, v123
    v_exp_f32 v124, v124
    v_exp_f32 v125, v125
    v_mfma_f32_32x32x16_bf16 v[104:119], v[48:51], v[40:43], 0
    ds_read_b128 v[56:59], v144 offset:4096
    v_exp_f32 v126, v126
    v_exp_f32 v127, v127
    v_exp_f32 v128, v128
    v_exp_f32 v129, v129
    v_exp_f32 v130, v130
    v_smfmac_f32_32x32x32_bf16 v[88:103], v[64:67], v[120:127], v136
    s_add_u32 m0, s30, 90112
    s_and_b32 s29, s29, 0x1ffff
    v_exp_f32 v131, v131
    v_exp_f32 v132, v132
    v_exp_f32 v133, v133
    v_exp_f32 v134, v134
    v_exp_f32 v135, v135
    v_exp_f32 v104, v104
    v_exp_f32 v105, v105
    v_exp_f32 v106, v106
    v_smfmac_f32_32x32x32_bf16 v[88:103], v[68:71], v[128:135], v136
    s_waitcnt vmcnt(20) lgkmcnt(0)
    s_barrier
    v_exp_f32 v107, v107
    v_exp_f32 v108, v108
    v_exp_f32 v109, v109
    v_mfma_f32_32x32x16_bf16 v[120:135], v[48:51], v[44:47], 0
    ds_read_b128 v[48:51], v147 offset:49152
    v_exp_f32 v110, v110
    v_exp_f32 v111, v111
    v_exp_f32 v112, v112
    v_exp_f32 v113, v113
    v_exp_f32 v114, v114
    v_smfmac_f32_32x32x32_bf16 v[72:87], v[56:59], v[104:111], v136
    ds_read_b128 v[68:71], v144 offset:6656
    v_exp_f32 v115, v115
    v_exp_f32 v116, v116
    v_exp_f32 v117, v117
    v_exp_f32 v118, v118
    v_exp_f32 v119, v119
    v_exp_f32 v120, v120
    v_exp_f32 v121, v121
    v_exp_f32 v122, v122
    v_smfmac_f32_32x32x32_bf16 v[72:87], v[60:63], v[112:119], v136
    buffer_load_dwordx4 v148, s[12:15], s29 offen sc1 lds
    buffer_load_dwordx4 v148, s[12:15], s29 offen offset:1024 sc1 lds
    v_exp_f32 v123, v123
    v_exp_f32 v124, v124
    v_exp_f32 v125, v125
    v_mfma_f32_32x32x16_bf16 v[104:119], v[52:55], v[40:43], 0
    ds_read_b128 v[64:67], v144 offset:6144
    v_exp_f32 v126, v126
    v_exp_f32 v127, v127
    v_exp_f32 v128, v128
    v_exp_f32 v129, v129
    v_exp_f32 v130, v130
    v_smfmac_f32_32x32x32_bf16 v[88:103], v[56:59], v[120:127], v136
    s_add_u32 m0, s34, 16384
    s_add_u32 s33, s33, 802816
    v_exp_f32 v131, v131
    v_exp_f32 v132, v132
    v_exp_f32 v133, v133
    v_exp_f32 v134, v134
    v_exp_f32 v135, v135
    v_exp_f32 v104, v104
    v_exp_f32 v105, v105
    v_exp_f32 v106, v106
    v_smfmac_f32_32x32x32_bf16 v[88:103], v[60:63], v[128:135], v136
    s_waitcnt vmcnt(14) lgkmcnt(0)
    ds_read_b64_tr_b16 a[176:177], v21 offset:4096
    ds_read_b64_tr_b16 a[178:179], v21 offset:5120
    ds_read_b64_tr_b16 a[180:181], v22 offset:4096
    ds_read_b64_tr_b16 a[182:183], v22 offset:5120
    ds_read_b64_tr_b16 a[184:185], v21 offset:6144
    ds_read_b64_tr_b16 a[186:187], v21 offset:7168
    ds_read_b64_tr_b16 a[188:189], v22 offset:6144
    ds_read_b64_tr_b16 a[190:191], v22 offset:7168
    v_exp_f32 v107, v107
    v_exp_f32 v108, v108
    v_exp_f32 v109, v109
    v_mfma_f32_32x32x16_bf16 v[120:135], v[52:55], v[44:47], 0
    ds_read_b128 v[52:55], v147 offset:51200
    v_exp_f32 v110, v110
    v_exp_f32 v111, v111
    v_exp_f32 v112, v112
    v_exp_f32 v113, v113
    v_exp_f32 v114, v114
    v_smfmac_f32_32x32x32_bf16 v[72:87], v[64:67], v[104:111], v136
    ds_read_b128 v[60:63], v145 offset:512
    v_exp_f32 v115, v115
    v_exp_f32 v116, v116
    v_exp_f32 v117, v117
    v_exp_f32 v118, v118
    v_exp_f32 v119, v119
    v_exp_f32 v120, v120
    v_exp_f32 v121, v121
    v_exp_f32 v122, v122
    v_smfmac_f32_32x32x32_bf16 v[72:87], v[68:71], v[112:119], v136
    buffer_load_dwordx4 v4, s[48:51], s33 offen offset:0 lds
    buffer_load_dwordx4 v5, s[48:51], s33 offen offset:1024 lds
    v_exp_f32 v123, v123
    v_exp_f32 v124, v124
    v_exp_f32 v125, v125
    v_mfma_f32_32x32x16_bf16 v[104:119], v[48:51], v[40:43], 0
    ds_read_b128 v[56:59], v145 offset:0
    v_exp_f32 v126, v126
    v_exp_f32 v127, v127
    v_exp_f32 v128, v128
    v_exp_f32 v129, v129
    v_exp_f32 v130, v130
    v_smfmac_f32_32x32x32_bf16 v[88:103], v[64:67], v[120:127], v136
    buffer_load_dwordx4 v6, s[48:51], s33 offen offset:2048 lds
    buffer_load_dwordx4 v7, s[48:51], s33 offen offset:3072 lds
    v_exp_f32 v131, v131
    v_exp_f32 v132, v132
    v_exp_f32 v133, v133
    v_exp_f32 v134, v134
    v_exp_f32 v135, v135
    v_exp_f32 v104, v104
    v_exp_f32 v105, v105
    v_exp_f32 v106, v106
    v_smfmac_f32_32x32x32_bf16 v[88:103], v[68:71], v[128:135], v136
    s_waitcnt lgkmcnt(0)
    s_add_u32 s29, s29, 8192
    buffer_load_dword v139, v12, s[12:15], s87 offen
    v_exp_f32 v107, v107
    v_exp_f32 v108, v108
    v_exp_f32 v109, v109
    v_mfma_f32_32x32x16_bf16 v[120:135], v[48:51], v[44:47], 0
    ds_read_b128 v[48:51], v147 offset:53248
    v_exp_f32 v110, v110
    v_exp_f32 v111, v111
    v_exp_f32 v112, v112
    v_exp_f32 v113, v113
    v_exp_f32 v114, v114
    v_smfmac_f32_32x32x32_bf16 v[72:87], v[56:59], v[104:111], v136
    ds_read_b128 v[68:71], v145 offset:2560
    v_exp_f32 v115, v115
    v_exp_f32 v116, v116
    v_exp_f32 v117, v117
    v_exp_f32 v118, v118
    v_exp_f32 v119, v119
    v_exp_f32 v120, v120
    v_exp_f32 v121, v121
    v_exp_f32 v122, v122
    v_smfmac_f32_32x32x32_bf16 v[72:87], v[60:63], v[112:119], v136
    s_add_u32 m0, s34, 20480
    s_add_u32 s33, s33, 114688
    v_exp_f32 v123, v123
    v_exp_f32 v124, v124
    v_exp_f32 v125, v125
    v_mfma_f32_32x32x16_bf16 v[104:119], v[52:55], v[40:43], 0
    ds_read_b128 v[64:67], v145 offset:2048
    v_exp_f32 v126, v126
    v_exp_f32 v127, v127
    v_exp_f32 v128, v128
    v_exp_f32 v129, v129
    v_exp_f32 v130, v130
    v_smfmac_f32_32x32x32_bf16 v[88:103], v[56:59], v[120:127], v136
    buffer_load_dwordx4 v4, s[48:51], s33 offen offset:0 lds
    buffer_load_dwordx4 v5, s[48:51], s33 offen offset:1024 lds
    v_exp_f32 v131, v131
    v_exp_f32 v132, v132
    v_exp_f32 v133, v133
    v_exp_f32 v134, v134
    v_exp_f32 v135, v135
    v_exp_f32 v104, v104
    v_exp_f32 v105, v105
    v_exp_f32 v106, v106
    v_smfmac_f32_32x32x32_bf16 v[88:103], v[60:63], v[128:135], v136
    s_waitcnt vmcnt(15) lgkmcnt(0)
    ds_read_b64_tr_b16 a[192:193], v21 offset:8192
    ds_read_b64_tr_b16 a[194:195], v21 offset:9216
    ds_read_b64_tr_b16 a[196:197], v22 offset:8192
    ds_read_b64_tr_b16 a[198:199], v22 offset:9216
    ds_read_b64_tr_b16 a[200:201], v21 offset:10240
    ds_read_b64_tr_b16 a[202:203], v21 offset:11264
    ds_read_b64_tr_b16 a[204:205], v22 offset:10240
    ds_read_b64_tr_b16 a[206:207], v22 offset:11264
    v_and_b32 v12, 7, v1
    v_lshlrev_b32 v12, 7, v12
    s_lshl_b32 s89, s20, 2
    s_add_u32 s89, s89, s16
    s_lshl_b32 s89, s89, 11
    s_add_u32 s89, s89, 14417920
    v_exp_f32 v107, v107
    v_exp_f32 v108, v108
    v_exp_f32 v109, v109
    v_mfma_f32_32x32x16_bf16 v[120:135], v[52:55], v[44:47], 0
    ds_read_b128 v[52:55], v147 offset:55296
    v_exp_f32 v110, v110
    v_exp_f32 v111, v111
    v_exp_f32 v112, v112
    v_exp_f32 v113, v113
    v_exp_f32 v114, v114
    v_smfmac_f32_32x32x32_bf16 v[72:87], v[64:67], v[104:111], v136
    ds_read_b128 v[60:63], v145 offset:4608
    v_exp_f32 v115, v115
    v_exp_f32 v116, v116
    v_exp_f32 v117, v117
    v_exp_f32 v118, v118
    v_exp_f32 v119, v119
    v_exp_f32 v120, v120
    v_exp_f32 v121, v121
    v_exp_f32 v122, v122
    v_smfmac_f32_32x32x32_bf16 v[72:87], v[68:71], v[112:119], v136
    buffer_load_dwordx4 v6, s[48:51], s33 offen offset:2048 lds
    buffer_load_dwordx4 v7, s[48:51], s33 offen offset:3072 lds
    v_exp_f32 v123, v123
    v_exp_f32 v124, v124
    v_exp_f32 v125, v125
    v_mfma_f32_32x32x16_bf16 v[104:119], v[48:51], v[40:43], 0
    ds_read_b128 v[56:59], v145 offset:4096
    v_exp_f32 v126, v126
    v_exp_f32 v127, v127
    v_exp_f32 v128, v128
    v_exp_f32 v129, v129
    v_exp_f32 v130, v130
    v_smfmac_f32_32x32x32_bf16 v[88:103], v[64:67], v[120:127], v136
    s_add_u32 m0, s30, 122880
    s_and_b32 s29, s29, 0x1ffff
    v_exp_f32 v131, v131
    v_exp_f32 v132, v132
    v_exp_f32 v133, v133
    v_exp_f32 v134, v134
    v_exp_f32 v135, v135
    v_exp_f32 v104, v104
    v_exp_f32 v105, v105
    v_exp_f32 v106, v106
    v_smfmac_f32_32x32x32_bf16 v[88:103], v[68:71], v[128:135], v136
    s_waitcnt lgkmcnt(0)
    v_exp_f32 v107, v107
    v_exp_f32 v108, v108
    v_exp_f32 v109, v109
    v_mfma_f32_32x32x16_bf16 v[120:135], v[48:51], v[44:47], 0
    ds_read_b128 v[48:51], v146 offset:0
    v_exp_f32 v110, v110
    v_exp_f32 v111, v111
    v_exp_f32 v112, v112
    v_exp_f32 v113, v113
    v_exp_f32 v114, v114
    v_smfmac_f32_32x32x32_bf16 v[72:87], v[56:59], v[104:111], v136
    ds_read_b128 v[68:71], v145 offset:6656
    v_exp_f32 v115, v115
    v_exp_f32 v116, v116
    v_exp_f32 v117, v117
    v_exp_f32 v118, v118
    v_exp_f32 v119, v119
    v_exp_f32 v120, v120
    v_exp_f32 v121, v121
    v_exp_f32 v122, v122
    v_smfmac_f32_32x32x32_bf16 v[72:87], v[60:63], v[112:119], v136
    buffer_load_dwordx4 v148, s[12:15], s29 offen sc1 lds
    buffer_load_dwordx4 v148, s[12:15], s29 offen offset:1024 sc1 lds
    v_exp_f32 v123, v123
    v_exp_f32 v124, v124
    v_exp_f32 v125, v125
    v_mfma_f32_32x32x16_bf16 v[104:119], v[52:55], v[40:43], 0
    ds_read_b128 v[64:67], v145 offset:6144
    v_exp_f32 v126, v126
    v_exp_f32 v127, v127
    v_exp_f32 v128, v128
    v_exp_f32 v129, v129
    v_exp_f32 v130, v130
    v_smfmac_f32_32x32x32_bf16 v[88:103], v[56:59], v[120:127], v136
    v_mul_u32_u24 v4, 4096, v3
    v_add_u32 v4, v4, v8
    v_add_u32 v5, 31744, v4
    v_add_u32 v6, 63488, v4
    v_add_u32 v7, 95232, v4
    s_add_u32 s33, s91, 3276800
    s_add_u32 m0, s34, 0
    s_add_u32 s33, s33, 917504
    v_exp_f32 v131, v131
    v_exp_f32 v132, v132
    v_exp_f32 v133, v133
    v_exp_f32 v134, v134
    v_exp_f32 v135, v135
    v_exp_f32 v104, v104
    v_exp_f32 v105, v105
    v_exp_f32 v106, v106
    v_smfmac_f32_32x32x32_bf16 v[88:103], v[60:63], v[128:135], v136
    s_waitcnt vmcnt(13) lgkmcnt(0)
    ds_read_b64_tr_b16 a[208:209], v21 offset:12288
    ds_read_b64_tr_b16 a[210:211], v21 offset:13312
    ds_read_b64_tr_b16 a[212:213], v22 offset:12288
    ds_read_b64_tr_b16 a[214:215], v22 offset:13312
    ds_read_b64_tr_b16 a[216:217], v21 offset:14336
    ds_read_b64_tr_b16 a[218:219], v21 offset:15360
    ds_read_b64_tr_b16 a[220:221], v22 offset:14336
    ds_read_b64_tr_b16 a[222:223], v22 offset:15360
    v_exp_f32 v107, v107
    v_exp_f32 v108, v108
    v_exp_f32 v109, v109
    v_mfma_f32_32x32x16_bf16 v[120:135], v[52:55], v[44:47], 0
    ds_read_b128 v[52:55], v146 offset:2048
    v_exp_f32 v110, v110
    v_exp_f32 v111, v111
    v_exp_f32 v112, v112
    v_exp_f32 v113, v113
    v_exp_f32 v114, v114
    v_smfmac_f32_32x32x32_bf16 v[72:87], v[64:67], v[104:111], v136
    ds_read_b128 v[60:63], v140 offset:512
    v_exp_f32 v115, v115
    v_exp_f32 v116, v116
    v_exp_f32 v117, v117
    v_exp_f32 v118, v118
    v_exp_f32 v119, v119
    v_exp_f32 v120, v120
    v_exp_f32 v121, v121
    v_exp_f32 v122, v122
    v_smfmac_f32_32x32x32_bf16 v[72:87], v[68:71], v[112:119], v136
    buffer_load_dwordx4 v4, s[52:55], s33 offen offset:0 lds
    buffer_load_dwordx4 v5, s[52:55], s33 offen offset:1024 lds
    v_exp_f32 v123, v123
    v_exp_f32 v124, v124
    v_exp_f32 v125, v125
    v_mfma_f32_32x32x16_bf16 v[104:119], v[48:51], v[40:43], 0
    ds_read_b128 v[56:59], v140 offset:0
    v_exp_f32 v126, v126
    v_exp_f32 v127, v127
    v_exp_f32 v128, v128
    v_exp_f32 v129, v129
    v_exp_f32 v130, v130
    v_smfmac_f32_32x32x32_bf16 v[88:103], v[64:67], v[120:127], v136
    buffer_load_dwordx4 v6, s[52:55], s33 offen offset:2048 lds
    buffer_load_dwordx4 v7, s[52:55], s33 offen offset:3072 lds
    v_exp_f32 v131, v131
    v_exp_f32 v132, v132
    v_exp_f32 v133, v133
    v_exp_f32 v134, v134
    v_exp_f32 v135, v135
    v_exp_f32 v104, v104
    v_exp_f32 v105, v105
    v_exp_f32 v106, v106
    v_smfmac_f32_32x32x32_bf16 v[88:103], v[68:71], v[128:135], v136
    s_waitcnt lgkmcnt(0)
    s_add_u32 s29, s29, 8192
    buffer_load_dword v139, v12, s[12:15], s75 offen
    buffer_load_dword v139, v12, s[12:15], s77 offen
    v_exp_f32 v107, v107
    v_exp_f32 v108, v108
    v_exp_f32 v109, v109
    v_mfma_f32_32x32x16_bf16 v[120:135], v[48:51], v[44:47], 0
    ds_read_b128 v[48:51], v146 offset:4096
    v_exp_f32 v110, v110
    v_exp_f32 v111, v111
    v_exp_f32 v112, v112
    v_exp_f32 v113, v113
    v_exp_f32 v114, v114
    v_smfmac_f32_32x32x32_bf16 v[72:87], v[56:59], v[104:111], v136
    ds_read_b128 v[68:71], v140 offset:2560
    v_exp_f32 v115, v115
    v_exp_f32 v116, v116
    v_exp_f32 v117, v117
    v_exp_f32 v118, v118
    v_exp_f32 v119, v119
    v_exp_f32 v120, v120
    v_exp_f32 v121, v121
    v_exp_f32 v122, v122
    v_smfmac_f32_32x32x32_bf16 v[72:87], v[60:63], v[112:119], v136
    s_add_u32 m0, s34, 4096
    s_add_u32 s33, s33, 131072
    v_exp_f32 v123, v123
    v_exp_f32 v124, v124
    v_exp_f32 v125, v125
    v_mfma_f32_32x32x16_bf16 v[104:119], v[52:55], v[40:43], 0
    ds_read_b128 v[64:67], v140 offset:2048
    v_exp_f32 v126, v126
    v_exp_f32 v127, v127
    v_exp_f32 v128, v128
    v_exp_f32 v129, v129
    v_exp_f32 v130, v130
    v_smfmac_f32_32x32x32_bf16 v[88:103], v[56:59], v[120:127], v136
    buffer_load_dwordx4 v4, s[52:55], s33 offen offset:0 lds
    buffer_load_dwordx4 v5, s[52:55], s33 offen offset:1024 lds
    v_exp_f32 v131, v131
    v_exp_f32 v132, v132
    v_exp_f32 v133, v133
    v_exp_f32 v134, v134
    v_exp_f32 v135, v135
    v_exp_f32 v104, v104
    v_exp_f32 v105, v105
    v_exp_f32 v106, v106
    v_smfmac_f32_32x32x32_bf16 v[88:103], v[60:63], v[128:135], v136
    s_waitcnt vmcnt(15) lgkmcnt(0)
    ds_read_b64_tr_b16 a[224:225], v21 offset:16384
    ds_read_b64_tr_b16 a[226:227], v21 offset:17408
    ds_read_b64_tr_b16 a[228:229], v22 offset:16384
    ds_read_b64_tr_b16 a[230:231], v22 offset:17408
    ds_read_b64_tr_b16 a[232:233], v21 offset:18432
    ds_read_b64_tr_b16 a[234:235], v21 offset:19456
    ds_read_b64_tr_b16 a[236:237], v22 offset:18432
    ds_read_b64_tr_b16 a[238:239], v22 offset:19456
    s_mov_b32 s90, 14745600
    buffer_load_dword v14, v12, s[12:15], s90 offen sc1
    v_exp_f32 v107, v107
    v_exp_f32 v108, v108
    v_exp_f32 v109, v109
    v_mfma_f32_32x32x16_bf16 v[120:135], v[52:55], v[44:47], 0
    ds_read_b128 v[52:55], v146 offset:6144
    v_exp_f32 v110, v110
    v_exp_f32 v111, v111
    v_exp_f32 v112, v112
    v_exp_f32 v113, v113
    v_exp_f32 v114, v114
    v_smfmac_f32_32x32x32_bf16 v[72:87], v[64:67], v[104:111], v136
    ds_read_b128 v[60:63], v140 offset:4608
    v_exp_f32 v115, v115
    v_exp_f32 v116, v116
    v_exp_f32 v117, v117
    v_exp_f32 v118, v118
    v_exp_f32 v119, v119
    v_exp_f32 v120, v120
    v_exp_f32 v121, v121
    v_exp_f32 v122, v122
    v_smfmac_f32_32x32x32_bf16 v[72:87], v[68:71], v[112:119], v136
    buffer_load_dwordx4 v6, s[52:55], s33 offen offset:2048 lds
    buffer_load_dwordx4 v7, s[52:55], s33 offen offset:3072 lds
    v_exp_f32 v123, v123
    v_exp_f32 v124, v124
    v_exp_f32 v125, v125
    v_mfma_f32_32x32x16_bf16 v[104:119], v[48:51], v[40:43], 0
    ds_read_b128 v[56:59], v140 offset:4096
    v_exp_f32 v126, v126
    v_exp_f32 v127, v127
    v_exp_f32 v128, v128
    v_exp_f32 v129, v129
    v_exp_f32 v130, v130
    v_smfmac_f32_32x32x32_bf16 v[88:103], v[64:67], v[120:127], v136
    s_add_u32 m0, s30, 131072
    s_and_b32 s29, s29, 0x1ffff
    v_exp_f32 v131, v131
    v_exp_f32 v132, v132
    v_exp_f32 v133, v133
    v_exp_f32 v134, v134
    v_exp_f32 v135, v135
    v_exp_f32 v104, v104
    v_exp_f32 v105, v105
    v_exp_f32 v106, v106
    v_smfmac_f32_32x32x32_bf16 v[88:103], v[68:71], v[128:135], v136
    s_waitcnt vmcnt(22) lgkmcnt(0)
    s_barrier
    v_exp_f32 v107, v107
    v_exp_f32 v108, v108
    v_exp_f32 v109, v109
    v_mfma_f32_32x32x16_bf16 v[120:135], v[48:51], v[44:47], 0
    ds_read_b128 v[48:51], v146 offset:32768
    v_exp_f32 v110, v110
    v_exp_f32 v111, v111
    v_exp_f32 v112, v112
    v_exp_f32 v113, v113
    v_exp_f32 v114, v114
    v_smfmac_f32_32x32x32_bf16 v[72:87], v[56:59], v[104:111], v136
    ds_read_b128 v[68:71], v140 offset:6656
    v_exp_f32 v115, v115
    v_exp_f32 v116, v116
    v_exp_f32 v117, v117
    v_exp_f32 v118, v118
    v_exp_f32 v119, v119
    v_exp_f32 v120, v120
    v_exp_f32 v121, v121
    v_exp_f32 v122, v122
    v_smfmac_f32_32x32x32_bf16 v[72:87], v[60:63], v[112:119], v136
    buffer_load_dwordx4 v148, s[12:15], s29 offen sc1 lds
    buffer_load_dwordx4 v148, s[12:15], s29 offen offset:1024 sc1 lds
    v_exp_f32 v123, v123
    v_exp_f32 v124, v124
    v_exp_f32 v125, v125
    v_mfma_f32_32x32x16_bf16 v[104:119], v[52:55], v[40:43], 0
    ds_read_b128 v[64:67], v140 offset:6144
    v_exp_f32 v126, v126
    v_exp_f32 v127, v127
    v_exp_f32 v128, v128
    v_exp_f32 v129, v129
    v_exp_f32 v130, v130
    v_smfmac_f32_32x32x32_bf16 v[88:103], v[56:59], v[120:127], v136
    s_add_u32 m0, s34, 8192
    s_add_u32 s33, s33, 917504
    v_exp_f32 v131, v131
    v_exp_f32 v132, v132
    v_exp_f32 v133, v133
    v_exp_f32 v134, v134
    v_exp_f32 v135, v135
    v_exp_f32 v104, v104
    v_exp_f32 v105, v105
    v_exp_f32 v106, v106
    v_smfmac_f32_32x32x32_bf16 v[88:103], v[60:63], v[128:135], v136
    s_waitcnt vmcnt(15) lgkmcnt(0)
    ds_read_b64_tr_b16 a[240:241], v21 offset:20480
    ds_read_b64_tr_b16 a[242:243], v21 offset:21504
    ds_read_b64_tr_b16 a[244:245], v22 offset:20480
    ds_read_b64_tr_b16 a[246:247], v22 offset:21504
    ds_read_b64_tr_b16 a[248:249], v21 offset:22528
    ds_read_b64_tr_b16 a[250:251], v21 offset:23552
    ds_read_b64_tr_b16 a[252:253], v22 offset:22528
    ds_read_b64_tr_b16 a[254:255], v22 offset:23552
    v_and_b32 v138, 31, v1
    v_lshlrev_b32 v138, 12, v138
    s_lshr_b32 s24, s21, 1
    s_lshl_b32 s24, s24, 20
    s_add_u32 s24, s24, s91
    s_and_b32 s25, s21, 1
    s_lshl_b32 s25, s25, 17
    s_add_u32 s24, s24, s25
    buffer_load_dword v139, v138, s[52:55], s24 offen
    v_exp_f32 v107, v107
    v_exp_f32 v108, v108
    v_exp_f32 v109, v109
    v_mfma_f32_32x32x16_bf16 v[120:135], v[52:55], v[44:47], 0
    ds_read_b128 v[52:55], v146 offset:34816
    v_exp_f32 v110, v110
    v_exp_f32 v111, v111
    v_exp_f32 v112, v112
    v_exp_f32 v113, v113
    v_exp_f32 v114, v114
    v_smfmac_f32_32x32x32_bf16 v[72:87], v[64:67], v[104:111], v136
    ds_read_b128 v[60:63], v141 offset:512
    v_exp_f32 v115, v115
    v_exp_f32 v116, v116
    v_exp_f32 v117, v117
    v_exp_f32 v118, v118
    v_exp_f32 v119, v119
    v_exp_f32 v120, v120
    v_exp_f32 v121, v121
    v_exp_f32 v122, v122
    v_smfmac_f32_32x32x32_bf16 v[72:87], v[68:71], v[112:119], v136
    buffer_load_dwordx4 v4, s[52:55], s33 offen offset:0 lds
    buffer_load_dwordx4 v5, s[52:55], s33 offen offset:1024 lds
    v_exp_f32 v123, v123
    v_exp_f32 v124, v124
    v_exp_f32 v125, v125
    v_mfma_f32_32x32x16_bf16 v[104:119], v[48:51], v[40:43], 0
    ds_read_b128 v[56:59], v141 offset:0
    v_exp_f32 v126, v126
    v_exp_f32 v127, v127
    v_exp_f32 v128, v128
    v_exp_f32 v129, v129
    v_exp_f32 v130, v130
    v_smfmac_f32_32x32x32_bf16 v[88:103], v[64:67], v[120:127], v136
    buffer_load_dwordx4 v6, s[52:55], s33 offen offset:2048 lds
    buffer_load_dwordx4 v7, s[52:55], s33 offen offset:3072 lds
    s_add_u32 m0, s34, 12288
    s_add_u32 s33, s33, 131072
    v_exp_f32 v131, v131
    v_exp_f32 v132, v132
    v_exp_f32 v133, v133
    v_exp_f32 v134, v134
    v_exp_f32 v135, v135
    v_exp_f32 v104, v104
    v_exp_f32 v105, v105
    v_exp_f32 v106, v106
    v_smfmac_f32_32x32x32_bf16 v[88:103], v[68:71], v[128:135], v136
    s_waitcnt lgkmcnt(0)
    s_add_u32 s29, s29, 8192
    buffer_load_dword v139, v12, s[12:15], s89 offen
    s_add_u32 s89, s89, 1024
    v_exp_f32 v107, v107
    v_exp_f32 v108, v108
    v_exp_f32 v109, v109
    v_mfma_f32_32x32x16_bf16 v[120:135], v[48:51], v[44:47], 0
    ds_read_b128 v[48:51], v146 offset:36864
    v_exp_f32 v110, v110
    v_exp_f32 v111, v111
    v_exp_f32 v112, v112
    v_exp_f32 v113, v113
    v_exp_f32 v114, v114
    v_smfmac_f32_32x32x32_bf16 v[72:87], v[56:59], v[104:111], v136
    ds_read_b128 v[68:71], v141 offset:2560
    v_exp_f32 v115, v115
    v_exp_f32 v116, v116
    v_exp_f32 v117, v117
    v_exp_f32 v118, v118
    v_exp_f32 v119, v119
    v_exp_f32 v120, v120
    v_exp_f32 v121, v121
    v_exp_f32 v122, v122
    v_smfmac_f32_32x32x32_bf16 v[72:87], v[60:63], v[112:119], v136
    buffer_load_dwordx4 v4, s[52:55], s33 offen offset:0 lds
    buffer_load_dwordx4 v5, s[52:55], s33 offen offset:1024 lds
    v_exp_f32 v123, v123
    v_exp_f32 v124, v124
    v_exp_f32 v125, v125
    v_mfma_f32_32x32x16_bf16 v[104:119], v[52:55], v[40:43], 0
    ds_read_b128 v[64:67], v141 offset:2048
    v_exp_f32 v126, v126
    v_exp_f32 v127, v127
    v_exp_f32 v128, v128
    v_exp_f32 v129, v129
    v_exp_f32 v130, v130
    v_smfmac_f32_32x32x32_bf16 v[88:103], v[56:59], v[120:127], v136
    buffer_load_dwordx4 v6, s[52:55], s33 offen offset:2048 lds
    buffer_load_dwordx4 v7, s[52:55], s33 offen offset:3072 lds
    s_add_u32 m0, s34, 16384
    s_add_u32 s33, s33, 917504
    v_exp_f32 v131, v131
    v_exp_f32 v132, v132
    v_exp_f32 v133, v133
    v_exp_f32 v134, v134
    v_exp_f32 v135, v135
    v_exp_f32 v104, v104
    v_exp_f32 v105, v105
    v_exp_f32 v106, v106
    v_smfmac_f32_32x32x32_bf16 v[88:103], v[60:63], v[128:135], v136
    s_waitcnt vmcnt(14) lgkmcnt(0)
    s_lshl_b32 s24, s22, 6
    v_xor_b32 v21, s24, v9
    v_add_u32 v21, s34, v21
    v_xor_b32 v22, 64, v21
    ds_read_b64_tr_b16 v[160:161], v21 offset:0
    ds_read_b64_tr_b16 v[162:163], v21 offset:1024
    ds_read_b64_tr_b16 v[164:165], v22 offset:0
    ds_read_b64_tr_b16 v[166:167], v22 offset:1024
    ds_read_b64_tr_b16 v[168:169], v21 offset:2048
    ds_read_b64_tr_b16 v[170:171], v21 offset:3072
    ds_read_b64_tr_b16 v[172:173], v22 offset:2048
    ds_read_b64_tr_b16 v[174:175], v22 offset:3072
    v_cmp_gt_u32 vcc, 32, v14
    v_exp_f32 v107, v107
    v_exp_f32 v108, v108
    v_exp_f32 v109, v109
    v_mfma_f32_32x32x16_bf16 v[120:135], v[52:55], v[44:47], 0
    ds_read_b128 v[52:55], v146 offset:38912
    v_exp_f32 v110, v110
    v_exp_f32 v111, v111
    v_exp_f32 v112, v112
    v_exp_f32 v113, v113
    v_exp_f32 v114, v114
    v_smfmac_f32_32x32x32_bf16 v[72:87], v[64:67], v[104:111], v136
    s_cbranch_vccnz L_sn_11
L_sn_11_d:
    ds_read_b128 v[60:63], v141 offset:4608
    v_exp_f32 v115, v115
    v_exp_f32 v116, v116
    v_exp_f32 v117, v117
    v_exp_f32 v118, v118
    v_exp_f32 v119, v119
    v_exp_f32 v120, v120
    v_exp_f32 v121, v121
    v_exp_f32 v122, v122
    v_smfmac_f32_32x32x32_bf16 v[72:87], v[68:71], v[112:119], v136
    buffer_load_dwordx4 v4, s[52:55], s33 offen offset:0 lds
    buffer_load_dwordx4 v5, s[52:55], s33 offen offset:1024 lds
    v_exp_f32 v123, v123
    v_exp_f32 v124, v124
    v_exp_f32 v125, v125
    v_mfma_f32_32x32x16_bf16 v[104:119], v[48:51], v[40:43], 0
    ds_read_b128 v[56:59], v141 offset:4096
    v_exp_f32 v126, v126
    v_exp_f32 v127, v127
    v_exp_f32 v128, v128
    v_exp_f32 v129, v129
    v_exp_f32 v130, v130
    v_smfmac_f32_32x32x32_bf16 v[88:103], v[64:67], v[120:127], v136
    buffer_load_dwordx4 v6, s[52:55], s33 offen offset:2048 lds
    buffer_load_dwordx4 v7, s[52:55], s33 offen offset:3072 lds
    s_add_u32 m0, s30, 139264
    s_and_b32 s29, s29, 0x1ffff
    v_exp_f32 v131, v131
    v_exp_f32 v132, v132
    v_exp_f32 v133, v133
    v_exp_f32 v134, v134
    v_exp_f32 v135, v135
    v_exp_f32 v104, v104
    v_exp_f32 v105, v105
    v_exp_f32 v106, v106
    v_smfmac_f32_32x32x32_bf16 v[88:103], v[68:71], v[128:135], v136
    s_waitcnt lgkmcnt(0)
    v_exp_f32 v107, v107
    v_exp_f32 v108, v108
    v_exp_f32 v109, v109
    v_mfma_f32_32x32x16_bf16 v[120:135], v[48:51], v[44:47], 0
    ds_read_b128 v[48:51], v147 offset:0
    v_exp_f32 v110, v110
    v_exp_f32 v111, v111
    v_exp_f32 v112, v112
    v_exp_f32 v113, v113
    v_exp_f32 v114, v114
    v_smfmac_f32_32x32x32_bf16 v[72:87], v[56:59], v[104:111], v136
    ds_read_b128 v[68:71], v141 offset:6656
    v_exp_f32 v115, v115
    v_exp_f32 v116, v116
    v_exp_f32 v117, v117
    v_exp_f32 v118, v118
    v_exp_f32 v119, v119
    v_exp_f32 v120, v120
    v_exp_f32 v121, v121
    v_exp_f32 v122, v122
    v_smfmac_f32_32x32x32_bf16 v[72:87], v[60:63], v[112:119], v136
    buffer_load_dwordx4 v148, s[12:15], s29 offen sc1 lds
    buffer_load_dwordx4 v148, s[12:15], s29 offen offset:1024 sc1 lds
    s_add_u32 m0, s34, 20480
    s_add_u32 s33, s33, 131072
    v_exp_f32 v123, v123
    v_exp_f32 v124, v124
    v_exp_f32 v125, v125
    v_mfma_f32_32x32x16_bf16 v[104:119], v[52:55], v[40:43], 0
    ds_read_b128 v[64:67], v141 offset:6144
    v_exp_f32 v126, v126
    v_exp_f32 v127, v127
    v_exp_f32 v128, v128
    v_exp_f32 v129, v129
    v_exp_f32 v130, v130
    v_smfmac_f32_32x32x32_bf16 v[88:103], v[56:59], v[120:127], v136
    buffer_load_dwordx4 v4, s[52:55], s33 offen offset:0 lds
    buffer_load_dwordx4 v5, s[52:55], s33 offen offset:1024 lds
    v_exp_f32 v131, v131
    v_exp_f32 v132, v132
    v_exp_f32 v133, v133
    v_exp_f32 v134, v134
    v_exp_f32 v135, v135
    v_exp_f32 v104, v104
    v_exp_f32 v105, v105
    v_exp_f32 v106, v106
    v_smfmac_f32_32x32x32_bf16 v[88:103], v[60:63], v[128:135], v136
    s_waitcnt vmcnt(20) lgkmcnt(0)
    ds_read_b64_tr_b16 v[176:177], v21 offset:4096
    ds_read_b64_tr_b16 v[178:179], v21 offset:5120
    ds_read_b64_tr_b16 v[180:181], v22 offset:4096
    ds_read_b64_tr_b16 v[182:183], v22 offset:5120
    ds_read_b64_tr_b16 v[184:185], v21 offset:6144
    ds_read_b64_tr_b16 v[186:187], v21 offset:7168
    ds_read_b64_tr_b16 v[188:189], v22 offset:6144
    ds_read_b64_tr_b16 v[190:191], v22 offset:7168
    v_exp_f32 v107, v107
    v_exp_f32 v108, v108
    v_exp_f32 v109, v109
    v_mfma_f32_32x32x16_bf16 v[120:135], v[52:55], v[44:47], 0
L_pad_Q_3:
    s_cbranch_execz L_ret_Q_3
    ds_read_b128 v[52:55], v147 offset:2048
    v_exp_f32 v110, v110
    v_exp_f32 v111, v111
    v_exp_f32 v112, v112
    v_exp_f32 v113, v113
    v_exp_f32 v114, v114
    v_smfmac_f32_32x32x32_bf16 v[72:87], v[64:67], v[104:111], v136
    ds_read_b128 v[60:63], v142 offset:512
    v_exp_f32 v115, v115
    v_exp_f32 v116, v116
    v_exp_f32 v117, v117
    v_exp_f32 v118, v118
    v_exp_f32 v119, v119
    v_exp_f32 v120, v120
    v_exp_f32 v121, v121
    v_exp_f32 v122, v122
    v_smfmac_f32_32x32x32_bf16 v[72:87], v[68:71], v[112:119], v136
    buffer_load_dwordx4 v6, s[52:55], s33 offen offset:2048 lds
    buffer_load_dwordx4 v7, s[52:55], s33 offen offset:3072 lds
    v_bfe_u32 v11, v1, 4, 1
    v_lshlrev_b32 v11, 1, v11
    v_xor_b32 v11, v11, v1
    v_and_b32 v11, 7, v11
    v_lshlrev_b32 v11, 4, v11
    v_mul_u32_u24 v4, 1024, v3
    v_add_u32 v4, v4, v11
    v_add_u32 v5, 7168, v4
    v_add_u32 v6, 14336, v4
    v_add_u32 v7, 21504, v4
    s_lshl_b32 s33, s16, 17
    s_lshl_b32 s24, s21, 7
    s_add_u32 s33, s33, s24
    s_sub_u32 s33, s33, 32768
    s_add_u32 m0, s34, 0
    s_add_u32 s33, s33, 32768
    v_exp_f32 v123, v123
    v_exp_f32 v124, v124
    v_exp_f32 v125, v125
    v_mfma_f32_32x32x16_bf16 v[104:119], v[48:51], v[40:43], 0
    ds_read_b128 v[56:59], v142 offset:0
    v_exp_f32 v126, v126
    v_exp_f32 v127, v127
    v_exp_f32 v128, v128
    v_exp_f32 v129, v129
    v_exp_f32 v130, v130
    v_smfmac_f32_32x32x32_bf16 v[88:103], v[64:67], v[120:127], v136
    buffer_load_dwordx4 v4, s[8:11], s33 offen offset:0 lds
    buffer_load_dwordx4 v5, s[8:11], s33 offen offset:1024 lds
    v_exp_f32 v131, v131
    v_exp_f32 v132, v132
    v_exp_f32 v133, v133
    v_exp_f32 v134, v134
    v_exp_f32 v135, v135
    v_exp_f32 v104, v104
    v_exp_f32 v105, v105
    v_exp_f32 v106, v106
    v_smfmac_f32_32x32x32_bf16 v[88:103], v[68:71], v[128:135], v136
    s_waitcnt lgkmcnt(0)
    buffer_load_dword v139, v12, s[12:15], s89 offen
    v_exp_f32 v107, v107
    v_exp_f32 v108, v108
    v_exp_f32 v109, v109
    v_mfma_f32_32x32x16_bf16 v[120:135], v[48:51], v[44:47], 0
    ds_read_b128 v[48:51], v147 offset:4096
    v_exp_f32 v110, v110
    v_exp_f32 v111, v111
    v_exp_f32 v112, v112
    v_exp_f32 v113, v113
    v_exp_f32 v114, v114
    v_smfmac_f32_32x32x32_bf16 v[72:87], v[56:59], v[104:111], v136
    ds_read_b128 v[68:71], v142 offset:2560
    v_exp_f32 v115, v115
    v_exp_f32 v116, v116
    v_exp_f32 v117, v117
    v_exp_f32 v118, v118
    v_exp_f32 v119, v119
    v_exp_f32 v120, v120
    v_exp_f32 v121, v121
    v_exp_f32 v122, v122
    v_smfmac_f32_32x32x32_bf16 v[72:87], v[60:63], v[112:119], v136
    buffer_load_dwordx4 v6, s[8:11], s33 offen offset:2048 lds
    buffer_load_dwordx4 v7, s[8:11], s33 offen offset:3072 lds
    s_add_u32 m0, s34, 4096
    s_add_u32 s33, s33, 32768
    v_exp_f32 v123, v123
    v_exp_f32 v124, v124
    v_exp_f32 v125, v125
    v_mfma_f32_32x32x16_bf16 v[104:119], v[52:55], v[40:43], 0
    ds_read_b128 v[64:67], v142 offset:2048
    v_exp_f32 v126, v126
    v_exp_f32 v127, v127
    v_exp_f32 v128, v128
    v_exp_f32 v129, v129
    v_exp_f32 v130, v130
    v_smfmac_f32_32x32x32_bf16 v[88:103], v[56:59], v[120:127], v136
    buffer_load_dwordx4 v4, s[8:11], s33 offen offset:0 lds
    buffer_load_dwordx4 v5, s[8:11], s33 offen offset:1024 lds
    v_exp_f32 v131, v131
    v_exp_f32 v132, v132
    v_exp_f32 v133, v133
    v_exp_f32 v134, v134
    v_exp_f32 v135, v135
    v_exp_f32 v104, v104
    v_exp_f32 v105, v105
    v_exp_f32 v106, v106
    v_smfmac_f32_32x32x32_bf16 v[88:103], v[60:63], v[128:135], v136
    s_waitcnt vmcnt(22) lgkmcnt(0)
    ds_read_b64_tr_b16 v[192:193], v21 offset:8192
    ds_read_b64_tr_b16 v[194:195], v21 offset:9216
    ds_read_b64_tr_b16 v[196:197], v22 offset:8192
    ds_read_b64_tr_b16 v[198:199], v22 offset:9216
    ds_read_b64_tr_b16 v[200:201], v21 offset:10240
    ds_read_b64_tr_b16 v[202:203], v21 offset:11264
    ds_read_b64_tr_b16 v[204:205], v22 offset:10240
    ds_read_b64_tr_b16 v[206:207], v22 offset:11264
    v_exp_f32 v107, v107
    v_exp_f32 v108, v108
    v_exp_f32 v109, v109
    v_mfma_f32_32x32x16_bf16 v[120:135], v[52:55], v[44:47], 0
    ds_read_b128 v[52:55], v147 offset:6144
    v_exp_f32 v110, v110
    v_exp_f32 v111, v111
    v_exp_f32 v112, v112
    v_exp_f32 v113, v113
    v_exp_f32 v114, v114
    v_smfmac_f32_32x32x32_bf16 v[72:87], v[64:67], v[104:111], v136
    ds_read_b128 v[60:63], v142 offset:4608
    v_exp_f32 v115, v115
    v_exp_f32 v116, v116
    v_exp_f32 v117, v117
    v_exp_f32 v118, v118
    v_exp_f32 v119, v119
    v_exp_f32 v120, v120
    v_exp_f32 v121, v121
    v_exp_f32 v122, v122
    v_smfmac_f32_32x32x32_bf16 v[72:87], v[68:71], v[112:119], v136
    buffer_load_dwordx4 v6, s[8:11], s33 offen offset:2048 lds
    buffer_load_dwordx4 v7, s[8:11], s33 offen offset:3072 lds
    v_exp_f32 v123, v123
    v_exp_f32 v124, v124
    v_exp_f32 v125, v125
    v_mfma_f32_32x32x16_bf16 v[104:119], v[48:51], v[40:43], 0
    ds_read_b128 v[56:59], v142 offset:4096
    v_exp_f32 v126, v126
    v_exp_f32 v127, v127
    v_exp_f32 v128, v128
    v_exp_f32 v129, v129
    v_exp_f32 v130, v130
    v_smfmac_f32_32x32x32_bf16 v[88:103], v[64:67], v[120:127], v136
    v_exp_f32 v131, v131
    v_exp_f32 v132, v132
    v_exp_f32 v133, v133
    v_exp_f32 v134, v134
    v_exp_f32 v135, v135
    v_exp_f32 v104, v104
    v_exp_f32 v105, v105
    v_exp_f32 v106, v106
    v_smfmac_f32_32x32x32_bf16 v[88:103], v[68:71], v[128:135], v136
    s_waitcnt vmcnt(29) lgkmcnt(0)
    s_barrier
    v_exp_f32 v107, v107
    v_exp_f32 v108, v108
    v_exp_f32 v109, v109
    v_mfma_f32_32x32x16_bf16 v[120:135], v[48:51], v[44:47], 0
    ds_read_b128 v[48:51], v147 offset:32768
    v_exp_f32 v110, v110
    v_exp_f32 v111, v111
    v_exp_f32 v112, v112
    v_exp_f32 v113, v113
    v_exp_f32 v114, v114
    v_smfmac_f32_32x32x32_bf16 v[72:87], v[56:59], v[104:111], v136
    ds_read_b128 v[68:71], v142 offset:6656
    v_exp_f32 v115, v115
    v_exp_f32 v116, v116
    v_exp_f32 v117, v117
    v_exp_f32 v118, v118
    v_exp_f32 v119, v119
    v_exp_f32 v120, v120
    v_exp_f32 v121, v121
    v_exp_f32 v122, v122
    v_smfmac_f32_32x32x32_bf16 v[72:87], v[60:63], v[112:119], v136
    s_add_u32 m0, s34, 8192
    s_add_u32 s33, s33, 32768
    v_exp_f32 v123, v123
    v_exp_f32 v124, v124
    v_exp_f32 v125, v125
    v_mfma_f32_32x32x16_bf16 v[104:119], v[52:55], v[40:43], 0
    ds_read_b128 v[64:67], v142 offset:6144
    v_exp_f32 v126, v126
    v_exp_f32 v127, v127
    v_exp_f32 v128, v128
    v_exp_f32 v129, v129
    v_exp_f32 v130, v130
    v_smfmac_f32_32x32x32_bf16 v[88:103], v[56:59], v[120:127], v136
    buffer_load_dwordx4 v4, s[8:11], s33 offen offset:0 lds
    buffer_load_dwordx4 v5, s[8:11], s33 offen offset:1024 lds
    v_exp_f32 v131, v131
    v_exp_f32 v132, v132
    v_exp_f32 v133, v133
    v_exp_f32 v134, v134
    v_exp_f32 v135, v135
    v_exp_f32 v104, v104
    v_exp_f32 v105, v105
    v_exp_f32 v106, v106
    v_smfmac_f32_32x32x32_bf16 v[88:103], v[60:63], v[128:135], v136
    s_waitcnt vmcnt(21) lgkmcnt(0)
    ds_read_b64_tr_b16 v[208:209], v21 offset:12288
    ds_read_b64_tr_b16 v[210:211], v21 offset:13312
    ds_read_b64_tr_b16 v[212:213], v22 offset:12288
    ds_read_b64_tr_b16 v[214:215], v22 offset:13312
    ds_read_b64_tr_b16 v[216:217], v21 offset:14336
    ds_read_b64_tr_b16 v[218:219], v21 offset:15360
    ds_read_b64_tr_b16 v[220:221], v22 offset:14336
    ds_read_b64_tr_b16 v[222:223], v22 offset:15360
    v_exp_f32 v107, v107
    v_exp_f32 v108, v108
    v_exp_f32 v109, v109
    v_mfma_f32_32x32x16_bf16 v[120:135], v[52:55], v[44:47], 0
    ds_read_b128 v[52:55], v147 offset:34816
    v_exp_f32 v110, v110
    v_exp_f32 v111, v111
    v_exp_f32 v112, v112
    v_exp_f32 v113, v113
    v_exp_f32 v114, v114
    v_smfmac_f32_32x32x32_bf16 v[72:87], v[64:67], v[104:111], v136
    ds_read_b128 v[60:63], v143 offset:512
    v_exp_f32 v115, v115
    v_exp_f32 v116, v116
    v_exp_f32 v117, v117
    v_exp_f32 v118, v118
    v_exp_f32 v119, v119
    v_exp_f32 v120, v120
    v_exp_f32 v121, v121
    v_exp_f32 v122, v122
    v_smfmac_f32_32x32x32_bf16 v[72:87], v[68:71], v[112:119], v136
    buffer_load_dwordx4 v6, s[8:11], s33 offen offset:2048 lds
    buffer_load_dwordx4 v7, s[8:11], s33 offen offset:3072 lds
    v_exp_f32 v123, v123
    v_exp_f32 v124, v124
    v_exp_f32 v125, v125
    v_mfma_f32_32x32x16_bf16 v[104:119], v[48:51], v[40:43], 0
    ds_read_b128 v[56:59], v143 offset:0
    v_exp_f32 v126, v126
    v_exp_f32 v127, v127
    v_exp_f32 v128, v128
    v_exp_f32 v129, v129
    v_exp_f32 v130, v130
    v_smfmac_f32_32x32x32_bf16 v[88:103], v[64:67], v[120:127], v136
    s_add_u32 m0, s34, 12288
    s_add_u32 s33, s33, 32768
    v_exp_f32 v131, v131
    v_exp_f32 v132, v132
    v_exp_f32 v133, v133
    v_exp_f32 v134, v134
    v_exp_f32 v135, v135
    v_exp_f32 v104, v104
    v_exp_f32 v105, v105
    v_exp_f32 v106, v106
    v_smfmac_f32_32x32x32_bf16 v[88:103], v[68:71], v[128:135], v136
    s_waitcnt vmcnt(19) lgkmcnt(0)
    ds_read_b64_tr_b16 v[224:225], v21 offset:16384
    ds_read_b64_tr_b16 v[226:227], v21 offset:17408
    ds_read_b64_tr_b16 v[228:229], v22 offset:16384
    ds_read_b64_tr_b16 v[230:231], v22 offset:17408
    ds_read_b64_tr_b16 v[232:233], v21 offset:18432
    ds_read_b64_tr_b16 v[234:235], v21 offset:19456
    ds_read_b64_tr_b16 v[236:237], v22 offset:18432
    ds_read_b64_tr_b16 v[238:239], v22 offset:19456
    v_exp_f32 v107, v107
    v_exp_f32 v108, v108
    v_exp_f32 v109, v109
    v_mfma_f32_32x32x16_bf16 v[120:135], v[48:51], v[44:47], 0
    ds_read_b128 v[48:51], v147 offset:36864
    v_exp_f32 v110, v110
    v_exp_f32 v111, v111
    v_exp_f32 v112, v112
    v_exp_f32 v113, v113
    v_exp_f32 v114, v114
    v_smfmac_f32_32x32x32_bf16 v[72:87], v[56:59], v[104:111], v136
    ds_read_b128 v[68:71], v143 offset:2560
    v_exp_f32 v115, v115
    v_exp_f32 v116, v116
    v_exp_f32 v117, v117
    v_exp_f32 v118, v118
    v_exp_f32 v119, v119
    v_exp_f32 v120, v120
    v_exp_f32 v121, v121
    v_exp_f32 v122, v122
    v_smfmac_f32_32x32x32_bf16 v[72:87], v[60:63], v[112:119], v136
    buffer_load_dwordx4 v4, s[8:11], s33 offen offset:0 lds
    buffer_load_dwordx4 v5, s[8:11], s33 offen offset:1024 lds
    v_exp_f32 v123, v123
    v_exp_f32 v124, v124
    v_exp_f32 v125, v125
    v_mfma_f32_32x32x16_bf16 v[104:119], v[52:55], v[40:43], 0
    ds_read_b128 v[64:67], v143 offset:2048
    v_exp_f32 v126, v126
    v_exp_f32 v127, v127
    v_exp_f32 v128, v128
    v_exp_f32 v129, v129
    v_exp_f32 v130, v130
    v_smfmac_f32_32x32x32_bf16 v[88:103], v[56:59], v[120:127], v136
    buffer_load_dwordx4 v6, s[8:11], s33 offen offset:2048 lds
    buffer_load_dwordx4 v7, s[8:11], s33 offen offset:3072 lds
    v_mul_u32_u24 v4, 4096, v3
    v_add_u32 v4, v4, v8
    v_add_u32 v5, 31744, v4
    v_add_u32 v6, 63488, v4
    v_add_u32 v7, 95232, v4
    s_add_u32 s33, s91, 1179648
    s_add_u32 m0, s34, 16384
    s_add_u32 s33, s33, 917504
    v_exp_f32 v131, v131
    v_exp_f32 v132, v132
    v_exp_f32 v133, v133
    v_exp_f32 v134, v134
    v_exp_f32 v135, v135
    v_exp_f32 v104, v104
    v_exp_f32 v105, v105
    v_exp_f32 v106, v106
    v_smfmac_f32_32x32x32_bf16 v[88:103], v[60:63], v[128:135], v136
    s_waitcnt vmcnt(17) lgkmcnt(0)
    ds_read_b64_tr_b16 v[240:241], v21 offset:20480
    ds_read_b64_tr_b16 v[242:243], v21 offset:21504
    ds_read_b64_tr_b16 v[244:245], v22 offset:20480
    ds_read_b64_tr_b16 v[246:247], v22 offset:21504
    ds_read_b64_tr_b16 v[248:249], v21 offset:22528
    ds_read_b64_tr_b16 v[250:251], v21 offset:23552
    ds_read_b64_tr_b16 v[252:253], v22 offset:22528
    ds_read_b64_tr_b16 v[254:255], v22 offset:23552
    v_exp_f32 v107, v107
    v_exp_f32 v108, v108
    v_exp_f32 v109, v109
    v_mfma_f32_32x32x16_bf16 v[120:135], v[52:55], v[44:47], 0
    ds_read_b128 v[52:55], v147 offset:38912
    v_exp_f32 v110, v110
    v_exp_f32 v111, v111
    v_exp_f32 v112, v112
    v_exp_f32 v113, v113
    v_exp_f32 v114, v114
    v_smfmac_f32_32x32x32_bf16 v[72:87], v[64:67], v[104:111], v136
    ds_read_b128 v[60:63], v143 offset:4608
    v_exp_f32 v115, v115
    v_exp_f32 v116, v116
    v_exp_f32 v117, v117
    v_exp_f32 v118, v118
    v_exp_f32 v119, v119
    v_exp_f32 v120, v120
    v_exp_f32 v121, v121
    v_exp_f32 v122, v122
    v_smfmac_f32_32x32x32_bf16 v[72:87], v[68:71], v[112:119], v136
    buffer_load_dwordx4 v4, s[52:55], s33 offen offset:0 lds
    buffer_load_dwordx4 v5, s[52:55], s33 offen offset:1024 lds
    v_exp_f32 v123, v123
    v_exp_f32 v124, v124
    v_exp_f32 v125, v125
    v_mfma_f32_32x32x16_bf16 v[104:119], v[48:51], v[40:43], 0
    ds_read_b128 v[56:59], v143 offset:4096
    v_exp_f32 v126, v126
    v_exp_f32 v127, v127
    v_exp_f32 v128, v128
    v_exp_f32 v129, v129
    v_exp_f32 v130, v130
    v_smfmac_f32_32x32x32_bf16 v[88:103], v[64:67], v[120:127], v136
    buffer_load_dwordx4 v6, s[52:55], s33 offen offset:2048 lds
    buffer_load_dwordx4 v7, s[52:55], s33 offen offset:3072 lds
    v_exp_f32 v131, v131
    v_exp_f32 v132, v132
    v_exp_f32 v133, v133
    v_exp_f32 v134, v134
    v_exp_f32 v135, v135
    v_exp_f32 v104, v104
    v_exp_f32 v105, v105
    v_exp_f32 v106, v106
    v_smfmac_f32_32x32x32_bf16 v[88:103], v[68:71], v[128:135], v136
    s_waitcnt lgkmcnt(0)
    v_exp_f32 v107, v107
    v_exp_f32 v108, v108
    v_exp_f32 v109, v109
    v_mfma_f32_32x32x16_bf16 v[120:135], v[48:51], v[44:47], 0
    ds_read_b128 v[48:51], v147 offset:40960
    v_exp_f32 v110, v110
    v_exp_f32 v111, v111
    v_exp_f32 v112, v112
    v_exp_f32 v113, v113
    v_exp_f32 v114, v114
    v_smfmac_f32_32x32x32_bf16 v[72:87], v[56:59], v[104:111], v136
    ds_read_b128 v[68:71], v143 offset:6656
    v_exp_f32 v115, v115
    v_exp_f32 v116, v116
    v_exp_f32 v117, v117
    v_exp_f32 v118, v118
    v_exp_f32 v119, v119
    v_exp_f32 v120, v120
    v_exp_f32 v121, v121
    v_exp_f32 v122, v122
    v_smfmac_f32_32x32x32_bf16 v[72:87], v[60:63], v[112:119], v136
    s_add_u32 m0, s34, 20480
    s_add_u32 s33, s33, 131072
    v_exp_f32 v123, v123
    v_exp_f32 v124, v124
    v_exp_f32 v125, v125
    v_mfma_f32_32x32x16_bf16 v[104:119], v[52:55], v[40:43], 0
    ds_read_b128 v[64:67], v143 offset:6144
    v_exp_f32 v126, v126
    v_exp_f32 v127, v127
    v_exp_f32 v128, v128
    v_exp_f32 v129, v129
    v_exp_f32 v130, v130
    v_smfmac_f32_32x32x32_bf16 v[88:103], v[56:59], v[120:127], v136
    buffer_load_dwordx4 v4, s[52:55], s33 offen offset:0 lds
    buffer_load_dwordx4 v5, s[52:55], s33 offen offset:1024 lds
    v_exp_f32 v131, v131
    v_exp_f32 v132, v132
    v_exp_f32 v133, v133
    v_exp_f32 v134, v134
    v_exp_f32 v135, v135
    v_exp_f32 v104, v104
    v_exp_f32 v105, v105
    v_exp_f32 v106, v106
    v_smfmac_f32_32x32x32_bf16 v[88:103], v[60:63], v[128:135], v136
    s_waitcnt lgkmcnt(0)
    v_exp_f32 v107, v107
    v_exp_f32 v108, v108
    v_exp_f32 v109, v109
    v_mfma_f32_32x32x16_bf16 v[120:135], v[52:55], v[44:47], 0
    ds_read_b128 v[52:55], v147 offset:43008
    v_exp_f32 v110, v110
    v_exp_f32 v111, v111
    v_exp_f32 v112, v112
    v_exp_f32 v113, v113
    v_exp_f32 v114, v114
    v_smfmac_f32_32x32x32_bf16 v[72:87], v[64:67], v[104:111], v136
    ds_read_b128 v[60:63], v144 offset:512
    v_exp_f32 v115, v115
    v_exp_f32 v116, v116
    v_exp_f32 v117, v117
    v_exp_f32 v118, v118
    v_exp_f32 v119, v119
    v_exp_f32 v120, v120
    v_exp_f32 v121, v121
    v_exp_f32 v122, v122
    v_smfmac_f32_32x32x32_bf16 v[72:87], v[68:71], v[112:119], v136
    buffer_load_dwordx4 v6, s[52:55], s33 offen offset:2048 lds
    buffer_load_dwordx4 v7, s[52:55], s33 offen offset:3072 lds
    v_exp_f32 v123, v123
    v_exp_f32 v124, v124
    v_exp_f32 v125, v125
    v_mfma_f32_32x32x16_bf16 v[104:119], v[48:51], v[40:43], 0
    ds_read_b128 v[56:59], v144 offset:0
    v_exp_f32 v126, v126
    v_exp_f32 v127, v127
    v_exp_f32 v128, v128
    v_exp_f32 v129, v129
    v_exp_f32 v130, v130
    v_smfmac_f32_32x32x32_bf16 v[88:103], v[64:67], v[120:127], v136
    v_exp_f32 v131, v131
    v_exp_f32 v132, v132
    v_exp_f32 v133, v133
    v_exp_f32 v134, v134
    v_exp_f32 v135, v135
    v_exp_f32 v104, v104
    v_exp_f32 v105, v105
    v_exp_f32 v106, v106
    v_smfmac_f32_32x32x32_bf16 v[88:103], v[68:71], v[128:135], v136
    s_waitcnt lgkmcnt(0)
    v_exp_f32 v107, v107
    v_exp_f32 v108, v108
    v_exp_f32 v109, v109
    v_mfma_f32_32x32x16_bf16 v[120:135], v[48:51], v[44:47], 0
    ds_read_b128 v[48:51], v147 offset:45056
    v_exp_f32 v110, v110
    v_exp_f32 v111, v111
    v_exp_f32 v112, v112
    v_exp_f32 v113, v113
    v_exp_f32 v114, v114
    v_smfmac_f32_32x32x32_bf16 v[72:87], v[56:59], v[104:111], v136
    ds_read_b128 v[68:71], v144 offset:2560
    v_exp_f32 v115, v115
    v_exp_f32 v116, v116
    v_exp_f32 v117, v117
    v_exp_f32 v118, v118
    v_exp_f32 v119, v119
    v_exp_f32 v120, v120
    v_exp_f32 v121, v121
    v_exp_f32 v122, v122
    v_smfmac_f32_32x32x32_bf16 v[72:87], v[60:63], v[112:119], v136
    v_exp_f32 v123, v123
    v_exp_f32 v124, v124
    v_exp_f32 v125, v125
    v_mfma_f32_32x32x16_bf16 v[104:119], v[52:55], v[40:43], 0
    ds_read_b128 v[64:67], v144 offset:2048
    v_exp_f32 v126, v126
    v_exp_f32 v127, v127
    v_exp_f32 v128, v128
    v_exp_f32 v129, v129
    v_exp_f32 v130, v130
    v_smfmac_f32_32x32x32_bf16 v[88:103], v[56:59], v[120:127], v136
    v_exp_f32 v131, v131
    v_exp_f32 v132, v132
    v_exp_f32 v133, v133
    v_exp_f32 v134, v134
    v_exp_f32 v135, v135
    v_exp_f32 v104, v104
    v_exp_f32 v105, v105
    v_exp_f32 v106, v106
    v_smfmac_f32_32x32x32_bf16 v[88:103], v[60:63], v[128:135], v136
    s_waitcnt lgkmcnt(0)
    v_exp_f32 v107, v107
    v_exp_f32 v108, v108
    v_exp_f32 v109, v109
    v_mfma_f32_32x32x16_bf16 v[120:135], v[52:55], v[44:47], 0
    ds_read_b128 v[52:55], v147 offset:47104
    v_exp_f32 v110, v110
    v_exp_f32 v111, v111
    v_exp_f32 v112, v112
    v_exp_f32 v113, v113
    v_exp_f32 v114, v114
    v_smfmac_f32_32x32x32_bf16 v[72:87], v[64:67], v[104:111], v136
    ds_read_b128 v[60:63], v144 offset:4608
    v_exp_f32 v115, v115
    v_exp_f32 v116, v116
    v_exp_f32 v117, v117
    v_exp_f32 v118, v118
    v_exp_f32 v119, v119
    v_exp_f32 v120, v120
    v_exp_f32 v121, v121
    v_exp_f32 v122, v122
    v_smfmac_f32_32x32x32_bf16 v[72:87], v[68:71], v[112:119], v136
    v_exp_f32 v123, v123
    v_exp_f32 v124, v124
    v_exp_f32 v125, v125
    v_mfma_f32_32x32x16_bf16 v[104:119], v[48:51], v[40:43], 0
    ds_read_b128 v[56:59], v144 offset:4096
    v_exp_f32 v126, v126
    v_exp_f32 v127, v127
    v_exp_f32 v128, v128
    v_exp_f32 v129, v129
    v_exp_f32 v130, v130
    v_smfmac_f32_32x32x32_bf16 v[88:103], v[64:67], v[120:127], v136
    v_exp_f32 v131, v131
    v_exp_f32 v132, v132
    v_exp_f32 v133, v133
    v_exp_f32 v134, v134
    v_exp_f32 v135, v135
    v_exp_f32 v104, v104
    v_exp_f32 v105, v105
    v_exp_f32 v106, v106
    v_smfmac_f32_32x32x32_bf16 v[88:103], v[68:71], v[128:135], v136
    s_waitcnt vmcnt(8) lgkmcnt(0)
    s_barrier
    v_exp_f32 v107, v107
    v_exp_f32 v108, v108
    v_exp_f32 v109, v109
    v_mfma_f32_32x32x16_bf16 v[120:135], v[48:51], v[44:47], 0
    ds_read_b128 v[48:51], v147 offset:49152
    v_exp_f32 v110, v110
    v_exp_f32 v111, v111
    v_exp_f32 v112, v112
    v_exp_f32 v113, v113
    v_exp_f32 v114, v114
    v_smfmac_f32_32x32x32_bf16 v[72:87], v[56:59], v[104:111], v136
    ds_read_b128 v[68:71], v144 offset:6656
    v_exp_f32 v115, v115
    v_exp_f32 v116, v116
    v_exp_f32 v117, v117
    v_exp_f32 v118, v118
    v_exp_f32 v119, v119
    v_exp_f32 v120, v120
    v_exp_f32 v121, v121
    v_exp_f32 v122, v122
    v_smfmac_f32_32x32x32_bf16 v[72:87], v[60:63], v[112:119], v136
    v_lshrrev_b32 v4, 4, v1
    v_mul_u32_u24 v4, 6144, v4
    v_and_b32 v5, 15, v1
    v_lshl_add_u32 v4, v5, 4, v4
    v_add_u32 v5, 23552, v4
    v_add_u32 v6, 47104, v4
    v_add_u32 v7, 70656, v4
    s_min_u32 s24, s16, 2
    s_lshl_b32 s24, s24, 11
    s_lshl_b32 s33, s21, 8
    s_add_u32 s33, s33, s24
    s_add_u32 s33, s33, 15892480
    s_add_u32 m0, s34, 24576
    s_add_u32 s33, s33, 98304
    v_exp_f32 v123, v123
    v_exp_f32 v124, v124
    v_exp_f32 v125, v125
    v_mfma_f32_32x32x16_bf16 v[104:119], v[52:55], v[40:43], 0
    ds_read_b128 v[64:67], v144 offset:6144
    v_exp_f32 v126, v126
    v_exp_f32 v127, v127
    v_exp_f32 v128, v128
    v_exp_f32 v129, v129
    v_exp_f32 v130, v130
    v_smfmac_f32_32x32x32_bf16 v[88:103], v[56:59], v[120:127], v136
    buffer_load_dwordx4 v4, s[12:15], s33 offen offset:0 lds
    buffer_load_dwordx4 v5, s[12:15], s33 offen offset:1024 lds
    v_exp_f32 v131, v131
    v_exp_f32 v132, v132
    v_exp_f32 v133, v133
    v_exp_f32 v134, v134
    v_exp_f32 v135, v135
    v_exp_f32 v104, v104
    v_exp_f32 v105, v105
    v_exp_f32 v106, v106
    v_smfmac_f32_32x32x32_bf16 v[88:103], v[60:63], v[128:135], v136
    s_waitcnt lgkmcnt(0)
    v_exp_f32 v107, v107
    v_exp_f32 v108, v108
    v_exp_f32 v109, v109
    v_mfma_f32_32x32x16_bf16 v[120:135], v[52:55], v[44:47], 0
    ds_read_b128 v[52:55], v147 offset:51200
    v_exp_f32 v110, v110
    v_exp_f32 v111, v111
    v_exp_f32 v112, v112
    v_exp_f32 v113, v113
    v_exp_f32 v114, v114
    v_smfmac_f32_32x32x32_bf16 v[72:87], v[64:67], v[104:111], v136
    ds_read_b128 v[60:63], v145 offset:512
    v_exp_f32 v115, v115
    v_exp_f32 v116, v116
    v_exp_f32 v117, v117
    v_exp_f32 v118, v118
    v_exp_f32 v119, v119
    v_exp_f32 v120, v120
    v_exp_f32 v121, v121
    v_exp_f32 v122, v122
    v_smfmac_f32_32x32x32_bf16 v[72:87], v[68:71], v[112:119], v136
    buffer_load_dwordx4 v6, s[12:15], s33 offen offset:2048 lds
    buffer_load_dwordx4 v7, s[12:15], s33 offen offset:3072 lds
    s_add_u32 m0, s34, 28672
    s_add_u32 s33, s33, 98304
    v_exp_f32 v123, v123
    v_exp_f32 v124, v124
    v_exp_f32 v125, v125
    v_mfma_f32_32x32x16_bf16 v[104:119], v[48:51], v[40:43], 0
    ds_read_b128 v[56:59], v145 offset:0
    v_exp_f32 v126, v126
    v_exp_f32 v127, v127
    v_exp_f32 v128, v128
    v_exp_f32 v129, v129
    v_exp_f32 v130, v130
    v_smfmac_f32_32x32x32_bf16 v[88:103], v[64:67], v[120:127], v136
    buffer_load_dwordx4 v4, s[12:15], s33 offen offset:0 lds
    buffer_load_dwordx4 v5, s[12:15], s33 offen offset:1024 lds
    v_exp_f32 v131, v131
    v_exp_f32 v132, v132
    v_exp_f32 v133, v133
    v_exp_f32 v134, v134
    v_exp_f32 v135, v135
    v_exp_f32 v104, v104
    v_exp_f32 v105, v105
    v_exp_f32 v106, v106
    v_smfmac_f32_32x32x32_bf16 v[88:103], v[68:71], v[128:135], v136
    s_waitcnt lgkmcnt(0)
    v_exp_f32 v107, v107
    v_exp_f32 v108, v108
    v_exp_f32 v109, v109
    v_mfma_f32_32x32x16_bf16 v[120:135], v[48:51], v[44:47], 0
    ds_read_b128 v[48:51], v147 offset:53248
    v_exp_f32 v110, v110
    v_exp_f32 v111, v111
    v_exp_f32 v112, v112
    v_exp_f32 v113, v113
    v_exp_f32 v114, v114
    v_smfmac_f32_32x32x32_bf16 v[72:87], v[56:59], v[104:111], v136
    ds_read_b128 v[68:71], v145 offset:2560
    v_exp_f32 v115, v115
    v_exp_f32 v116, v116
    v_exp_f32 v117, v117
    v_exp_f32 v118, v118
    v_exp_f32 v119, v119
    v_exp_f32 v120, v120
    v_exp_f32 v121, v121
    v_exp_f32 v122, v122
    v_smfmac_f32_32x32x32_bf16 v[72:87], v[60:63], v[112:119], v136
    buffer_load_dwordx4 v6, s[12:15], s33 offen offset:2048 lds
    buffer_load_dwordx4 v7, s[12:15], s33 offen offset:3072 lds
    v_exp_f32 v123, v123
    v_exp_f32 v124, v124
    v_exp_f32 v125, v125
    v_mfma_f32_32x32x16_bf16 v[104:119], v[52:55], v[40:43], 0
    ds_read_b128 v[64:67], v145 offset:2048
    v_exp_f32 v126, v126
    v_exp_f32 v127, v127
    v_exp_f32 v128, v128
    v_exp_f32 v129, v129
    v_exp_f32 v130, v130
    v_smfmac_f32_32x32x32_bf16 v[88:103], v[56:59], v[120:127], v136
    v_exp_f32 v131, v131
    v_exp_f32 v132, v132
    v_exp_f32 v133, v133
    v_exp_f32 v134, v134
    v_exp_f32 v135, v135
    v_exp_f32 v104, v104
    v_exp_f32 v105, v105
    v_exp_f32 v106, v106
    v_smfmac_f32_32x32x32_bf16 v[88:103], v[60:63], v[128:135], v136
    s_waitcnt lgkmcnt(0)
    v_exp_f32 v107, v107
    v_exp_f32 v108, v108
    v_exp_f32 v109, v109
    v_mfma_f32_32x32x16_bf16 v[120:135], v[52:55], v[44:47], 0
    ds_read_b128 v[52:55], v147 offset:55296
    v_exp_f32 v110, v110
    v_exp_f32 v111, v111
    v_exp_f32 v112, v112
    v_exp_f32 v113, v113
    v_exp_f32 v114, v114
    v_smfmac_f32_32x32x32_bf16 v[72:87], v[64:67], v[104:111], v136
    ds_read_b128 v[60:63], v145 offset:4608
    v_exp_f32 v115, v115
    v_exp_f32 v116, v116
    v_exp_f32 v117, v117
    v_exp_f32 v118, v118
    v_exp_f32 v119, v119
    v_exp_f32 v120, v120
    v_exp_f32 v121, v121
    v_exp_f32 v122, v122
    v_smfmac_f32_32x32x32_bf16 v[72:87], v[68:71], v[112:119], v136
    v_exp_f32 v123, v123
    v_exp_f32 v124, v124
    v_exp_f32 v125, v125
    v_mfma_f32_32x32x16_bf16 v[104:119], v[48:51], v[40:43], 0
    ds_read_b128 v[56:59], v145 offset:4096
    v_exp_f32 v126, v126
    v_exp_f32 v127, v127
    v_exp_f32 v128, v128
    v_exp_f32 v129, v129
    v_exp_f32 v130, v130
    v_smfmac_f32_32x32x32_bf16 v[88:103], v[64:67], v[120:127], v136
    v_exp_f32 v131, v131
    v_exp_f32 v132, v132
    v_exp_f32 v133, v133
    v_exp_f32 v134, v134
    v_exp_f32 v135, v135
    v_exp_f32 v104, v104
    v_exp_f32 v105, v105
    v_exp_f32 v106, v106
    v_smfmac_f32_32x32x32_bf16 v[88:103], v[68:71], v[128:135], v136
    s_waitcnt lgkmcnt(0)
    v_exp_f32 v107, v107
    v_exp_f32 v108, v108
    v_exp_f32 v109, v109
    v_mfma_f32_32x32x16_bf16 v[120:135], v[48:51], v[44:47], 0
    s_nop 0
    v_exp_f32 v110, v110
    v_exp_f32 v111, v111
    v_exp_f32 v112, v112
    v_exp_f32 v113, v113
    v_exp_f32 v114, v114
    v_smfmac_f32_32x32x32_bf16 v[72:87], v[56:59], v[104:111], v136
    ds_read_b128 v[68:71], v145 offset:6656
    v_exp_f32 v115, v115
    v_exp_f32 v116, v116
    v_exp_f32 v117, v117
    v_exp_f32 v118, v118
    v_exp_f32 v119, v119
    v_exp_f32 v120, v120
    v_exp_f32 v121, v121
    v_exp_f32 v122, v122
    v_smfmac_f32_32x32x32_bf16 v[72:87], v[60:63], v[112:119], v136
    v_exp_f32 v123, v123
    v_exp_f32 v124, v124
    v_exp_f32 v125, v125
    v_mfma_f32_32x32x16_bf16 v[104:119], v[52:55], v[40:43], 0
    ds_read_b128 v[64:67], v145 offset:6144
    v_exp_f32 v126, v126
    v_exp_f32 v127, v127
    v_exp_f32 v128, v128
    v_exp_f32 v129, v129
    v_exp_f32 v130, v130
    v_smfmac_f32_32x32x32_bf16 v[88:103], v[56:59], v[120:127], v136
    v_exp_f32 v131, v131
    v_exp_f32 v132, v132
    v_exp_f32 v133, v133
    v_exp_f32 v134, v134
    v_exp_f32 v135, v135
    v_exp_f32 v104, v104
    v_exp_f32 v105, v105
    v_exp_f32 v106, v106
L_pad_Q_4:
    s_cbranch_execz L_ret_Q_4
    v_smfmac_f32_32x32x32_bf16 v[88:103], v[60:63], v[128:135], v136
    s_waitcnt lgkmcnt(0)
    v_exp_f32 v107, v107
    v_exp_f32 v108, v108
    v_exp_f32 v109, v109
    v_mfma_f32_32x32x16_bf16 v[120:135], v[52:55], v[44:47], 0
    s_nop 0
    v_exp_f32 v110, v110
    v_exp_f32 v111, v111
    v_exp_f32 v112, v112
    v_exp_f32 v113, v113
    v_exp_f32 v114, v114
    v_smfmac_f32_32x32x32_bf16 v[72:87], v[64:67], v[104:111], v136
    v_exp_f32 v115, v115
    v_exp_f32 v116, v116
    v_exp_f32 v117, v117
    v_exp_f32 v118, v118
    v_exp_f32 v119, v119
    v_exp_f32 v120, v120
    v_exp_f32 v121, v121
    v_exp_f32 v122, v122
    v_smfmac_f32_32x32x32_bf16 v[72:87], v[68:71], v[112:119], v136
    v_exp_f32 v123, v123
    v_exp_f32 v124, v124
    v_exp_f32 v125, v125
    v_exp_f32 v126, v126
    v_exp_f32 v127, v127
    v_exp_f32 v128, v128
    v_exp_f32 v129, v129
    v_exp_f32 v130, v130
    v_smfmac_f32_32x32x32_bf16 v[88:103], v[64:67], v[120:127], v136
    v_exp_f32 v131, v131
    v_exp_f32 v132, v132
    v_exp_f32 v133, v133
    v_exp_f32 v134, v134
    v_exp_f32 v135, v135
    s_nop 1
    v_smfmac_f32_32x32x32_bf16 v[88:103], v[68:71], v[128:135], v136
L_at_epi:
    s_mov_b32 s31, 0
L_at_fin:
    v_rcp_f32 v104, v80
    s_nop 0
    v_mul_f32 v72, v104, v72
    v_mul_f32 v73, v104, v73
    v_mul_f32 v74, v104, v74
    v_mul_f32 v75, v104, v75
    v_mul_f32 v76, v104, v76
    v_mul_f32 v77, v104, v77
    v_mul_f32 v78, v104, v78
    v_mul_f32 v79, v104, v79
    v_cvt_pk_bf16_f32 v48, v72, v73
    v_rcp_f32 v105, v96
    v_cvt_pk_bf16_f32 v49, v74, v75
    v_cvt_pk_bf16_f32 v50, v76, v77
    v_cvt_pk_bf16_f32 v51, v78, v79
    v_pk_mul_f32 v[88:89], v[88:89], v[104:105] op_sel:[0,1] op_sel_hi:[1,1]
    v_pk_mul_f32 v[90:91], v[90:91], v[104:105] op_sel:[0,1] op_sel_hi:[1,1]
    v_pk_mul_f32 v[92:93], v[92:93], v[104:105] op_sel:[0,1] op_sel_hi:[1,1]
    v_pk_mul_f32 v[94:95], v[94:95], v[104:105] op_sel:[0,1] op_sel_hi:[1,1]
    v_cvt_pk_bf16_f32 v52, v88, v89
    v_cvt_pk_bf16_f32 v53, v90, v91
    v_cvt_pk_bf16_f32 v54, v92, v93
    v_cvt_pk_bf16_f32 v55, v94, v95
    v_min_f32 v106, v80, v96
    v_max_f32 v107, v80, v96
    v_cmp_le_f32 vcc, 0x21800000, v106
    s_mov_b64 s[24:25], vcc
    v_cmp_ge_f32 vcc, 0x5d800000, v107
    s_and_b64 s[24:25], s[24:25], vcc
    v_pk_add_f32 v[108:109], v[72:73], v[72:73] neg_lo:[0,1] neg_hi:[0,1]
    v_pk_add_f32 v[110:111], v[74:75], v[74:75] neg_lo:[0,1] neg_hi:[0,1]
    v_pk_add_f32 v[112:113], v[76:77], v[76:77] neg_lo:[0,1] neg_hi:[0,1]
    v_pk_add_f32 v[114:115], v[78:79], v[78:79] neg_lo:[0,1] neg_hi:[0,1]
    v_pk_fma_f32 v[108:109], v[88:89], v[108:109], v[108:109]
    v_pk_fma_f32 v[110:111], v[90:91], v[110:111], v[110:111]
    v_pk_fma_f32 v[112:113], v[92:93], v[112:113], v[112:113]
    v_pk_fma_f32 v[114:115], v[94:95], v[114:115], v[114:115]
    v_pk_add_f32 v[108:109], v[108:109], v[110:111]
    v_pk_add_f32 v[112:113], v[112:113], v[114:115]
    v_pk_add_f32 v[108:109], v[108:109], v[112:113]
    v_cmp_eq_f32 vcc, v108, v109
    s_and_b64 s[24:25], s[24:25], vcc
    s_cmp_eq_u64 s[24:25], -1
    s_cbranch_scc0 L_at_slow
L_at_st:
    s_cmp_eq_u32 s35, 0
    s_cbranch_scc1 L_ls_16_g
    buffer_store_dwordx4 v[48:51], v2, s[12:15], s75 offen
    buffer_store_dwordx4 v[52:55], v2, s[12:15], s77 offen
L_ls_16_d:
    s_lshl_b32 s26, s20, 1
    s_add_u32 s26, s26, s22
    s_lshl_b32 s27, s26, 15
    s_add_u32 s27, s27, 6291456
    s_add_u32 s31, s27, s19
    v_bfe_u32 v11, v1, 4, 1
    v_and_b32 v128, 0xffffff9f, v9
    v_lshl_add_u32 v128, v11, 6, v128
    v_bfe_u32 v11, v1, 3, 1
    v_xor_b32 v11, s23, v11
    v_lshl_add_u32 v128, v11, 5, v128
    v_add_u32 v129, 65536, v128
    s_mov_b32 s94, 0
    s_cmp_lg_u32 s19, 0
    s_cbranch_scc1 L_ct_17
    v_add_u32 v11, s34, v2
    s_waitcnt vmcnt(2)
    ds_read_b128 v[80:83], v11 offset:24576
    ds_read_b128 v[84:87], v11 offset:25600
    ds_read_b128 v[88:91], v11 offset:26624
    ds_read_b128 v[92:95], v11 offset:27648
    ds_read_b128 v[96:99], v11 offset:28672
    ds_read_b128 v[100:103], v11 offset:29696
    ds_read_b128 v[104:107], v11 offset:30720
    ds_read_b128 v[108:111], v11 offset:31744
    v_mul_u32_u24 v4, 4096, v3
    v_add_u32 v4, v4, v8
    v_add_u32 v5, 31744, v4
    v_add_u32 v6, 63488, v4
    v_add_u32 v7, 95232, v4
    s_min_u32 s24, s16, 2
    s_lshl_b32 s24, s24, 8
    s_add_u32 s24, s24, 160768
    v_and_b32 v11, 0xf0, v2
    v_add_u32 v11, s24, v11
    s_waitcnt lgkmcnt(0)
    s_add_u32 m0, s34, 24576
    s_add_u32 s33, s91, 3145728
    buffer_load_dwordx4 v4, s[52:55], s33 offen offset:0 lds
    buffer_load_dwordx4 v5, s[52:55], s33 offen offset:1024 lds
    buffer_load_dwordx4 v6, s[52:55], s33 offen offset:2048 lds
    buffer_load_dwordx4 v7, s[52:55], s33 offen offset:3072 lds
    s_add_u32 m0, s34, 28672
    s_add_u32 s33, s91, 3276800
    buffer_load_dwordx4 v4, s[52:55], s33 offen offset:0 lds
    buffer_load_dwordx4 v5, s[52:55], s33 offen offset:1024 lds
    buffer_load_dwordx4 v6, s[52:55], s33 offen offset:2048 lds
    buffer_load_dwordx4 v7, s[52:55], s33 offen offset:3072 lds
    v_pk_add_f32 v[80:81], v[80:81], v[96:97]
    v_pk_add_f32 v[82:83], v[82:83], v[98:99]
    v_pk_add_f32 v[84:85], v[84:85], v[100:101]
    v_pk_add_f32 v[86:87], v[86:87], v[102:103]
    v_pk_add_f32 v[88:89], v[88:89], v[104:105]
    v_pk_add_f32 v[90:91], v[90:91], v[106:107]
    v_pk_add_f32 v[92:93], v[92:93], v[108:109]
    v_pk_add_f32 v[94:95], v[94:95], v[110:111]
    v_pk_add_f32 v[80:81], v[80:81], v[88:89]
    v_pk_add_f32 v[82:83], v[82:83], v[90:91]
    v_pk_add_f32 v[84:85], v[84:85], v[92:93]
    v_pk_add_f32 v[86:87], v[86:87], v[94:95]
    v_pk_add_f32 v[80:81], v[80:81], v[84:85]
    v_pk_add_f32 v[82:83], v[82:83], v[86:87]
    v_mov_b32 v84, v80
    v_mov_b32 v85, v81
    v_mov_b32 v86, v82
    v_mov_b32 v87, v83
    v_permlane32_swap_b32 v80, v84
    v_permlane32_swap_b32 v81, v85
    s_nop 0
    v_permlane32_swap_b32 v82, v86
    v_permlane32_swap_b32 v83, v87
    v_pk_add_f32 v[80:81], v[80:81], v[84:85]
    v_pk_add_f32 v[82:83], v[82:83], v[86:87]
    v_mov_b32 v84, v80
    v_mov_b32 v85, v81
    v_mov_b32 v86, v82
    v_mov_b32 v87, v83
    v_permlane16_swap_b32 v80, v84
    v_permlane16_swap_b32 v81, v85
    s_nop 0
    v_permlane16_swap_b32 v82, v86
    v_permlane16_swap_b32 v83, v87
    v_pk_add_f32 v[80:81], v[80:81], v[84:85]
    v_pk_add_f32 v[82:83], v[82:83], v[86:87]
    ds_write_b128 v11, v[80:83]
    s_waitcnt lgkmcnt(0)
L_ct_17:
    v_lshrrev_b32 v12, 5, v1
    v_and_b32 v11, 31, v1
    v_lshlrev_b32 v131, 4, v11
    v_lshl_add_u32 v131, v12, 11, v131
    v_lshlrev_b32 v134, 3, v12
    v_lshlrev_b32 v135, 1, v11
    v_lshlrev_b32 v13, 2, v12
    v_sub_u32 v13, v11, v13
    v_and_b32 v11, 15, v1
    v_lshl_add_u32 v130, v12, 5, v11
    s_lshl_b32 s24, s23, 4
    v_add_u32 v130, s24, v130
    v_lshlrev_b32 v130, 4, v130
    v_bfe_u32 v11, v1, 4, 1
    v_lshl_add_u32 v130, v11, 17, v130
    v_mov_b32 v11, 0x3f80
    v_mov_b32 v12, 0x3f800000
    v_cmp_eq_u32 vcc, 0, v13
    v_cmp_eq_u32 s[24:25], 1, v13
    v_cmp_eq_u32 s[28:29], 2, v13
    v_cmp_eq_u32 s[86:87], 3, v13
    v_cndmask_b32 v72, 0, v11, vcc
    v_cndmask_b32 v72, v72, v12, s[24:25]
    v_cndmask_b32 v73, 0, v11, s[28:29]
    v_cndmask_b32 v73, v73, v12, s[86:87]
    v_cmp_eq_u32 vcc, 8, v13
    v_cmp_eq_u32 s[24:25], 9, v13
    v_cmp_eq_u32 s[28:29], 10, v13
    v_cmp_eq_u32 s[86:87], 11, v13
    v_cndmask_b32 v74, 0, v11, vcc
    v_cndmask_b32 v74, v74, v12, s[24:25]
    v_cndmask_b32 v75, 0, v11, s[28:29]
    v_cndmask_b32 v75, v75, v12, s[86:87]
    v_cmp_eq_u32 vcc, 16, v13
    v_cmp_eq_u32 s[24:25], 17, v13
    v_cmp_eq_u32 s[28:29], 18, v13
    v_cmp_eq_u32 s[86:87], 19, v13
    v_cndmask_b32 v76, 0, v11, vcc
    v_cndmask_b32 v76, v76, v12, s[24:25]
    v_cndmask_b32 v77, 0, v11, s[28:29]
    v_cndmask_b32 v77, v77, v12, s[86:87]
    v_cmp_eq_u32 vcc, 24, v13
    v_cmp_eq_u32 s[24:25], 25, v13
    v_cmp_eq_u32 s[28:29], 26, v13
    v_cmp_eq_u32 s[86:87], 27, v13
    v_cndmask_b32 v78, 0, v11, vcc
    v_cndmask_b32 v78, v78, v12, s[24:25]
    v_cndmask_b32 v79, 0, v11, s[28:29]
    v_cndmask_b32 v79, v79, v12, s[86:87]
    s_waitcnt vmcnt(0)
    s_add_u32 s32, s31, 0
    buffer_load_dwordx4 v[80:83], v2, s[12:15], s32 offen offset:0 sc1
    buffer_load_dwordx4 v[84:87], v2, s[12:15], s32 offen offset:1024 sc1
    buffer_load_dwordx4 v[88:91], v2, s[12:15], s32 offen offset:2048 sc1
    buffer_load_dwordx4 v[92:95], v2, s[12:15], s32 offen offset:3072 sc1
    s_add_u32 s32, s31, 4096
    buffer_load_dwordx4 v[96:99], v2, s[12:15], s32 offen offset:0 sc1
    buffer_load_dwordx4 v[100:103], v2, s[12:15], s32 offen offset:1024 sc1
    buffer_load_dwordx4 v[104:107], v2, s[12:15], s32 offen offset:2048 sc1
    buffer_load_dwordx4 v[108:111], v2, s[12:15], s32 offen offset:3072 sc1
    s_add_u32 s32, s31, 8192
    buffer_load_dwordx4 v[112:115], v2, s[12:15], s32 offen offset:0 sc1
    buffer_load_dwordx4 v[116:119], v2, s[12:15], s32 offen offset:1024 sc1
    buffer_load_dwordx4 v[120:123], v2, s[12:15], s32 offen offset:2048 sc1
    buffer_load_dwordx4 v[124:127], v2, s[12:15], s32 offen offset:3072 sc1
    ds_read_b64_tr_b16 v[56:57], v128 offset:0
    ds_read_b64_tr_b16 v[58:59], v128 offset:1024
    ds_read_b64_tr_b16 v[60:61], v128 offset:2048
    ds_read_b64_tr_b16 v[62:63], v128 offset:3072
    ds_read_b64_tr_b16 v[64:65], v128 offset:4096
    ds_read_b64_tr_b16 v[66:67], v128 offset:5120
    s_lshl_b32 s28, s26, 12
    s_add_u32 s28, s28, 14417920
    s_add_u32 s28, s28, s19
    s_lshl_b32 s25, s21, 9
    s_add_u32 s25, s25, s28
    s_lshl_b32 s24, s23, 3
    s_add_u32 s25, s25, s24
    s_lshl_b32 s24, s21, 8
    s_lshl_b32 s27, s26, 1
    s_add_u32 s27, s27, s24
    s_lshl_b32 s27, s27, 10
    s_add_u32 s27, s27, 10485760
    s_add_u32 s27, s27, s19
    s_lshl_b32 s29, s37, 7
    s_lshl_b32 s24, s16, 5
    s_add_u32 s29, s29, s24
    s_lshl_b32 s30, s26, 6
    s_waitcnt vmcnt(11)
    v_max3_u32 v14, v80, v81, v82
    v_max_u32 v14, v14, v83
    v_cmp_eq_u32 vcc, -1, v14
    s_nop 3
    s_cbranch_vccnz L_ort0
L_ook0:
    s_waitcnt vmcnt(10)
    v_max3_u32 v14, v84, v85, v86
    v_max_u32 v14, v14, v87
    v_cmp_eq_u32 vcc, -1, v14
    s_waitcnt lgkmcnt(4)
    v_mfma_f32_32x32x16_bf16 v[24:39], v[56:59], v[80:83], v[24:39]
    s_add_u32 s32, s31, 12288
    buffer_load_dwordx4 v[80:83], v2, s[12:15], s32 offen offset:0 sc1
    ds_read_b64_tr_b16 v[68:69], v128 offset:6144
    ds_read_b64_tr_b16 v[70:71], v128 offset:7168
    s_cbranch_vccnz L_ort1
L_ook1:
    s_waitcnt vmcnt(10)
    v_max3_u32 v14, v88, v89, v90
    v_max_u32 v14, v14, v91
    v_cmp_eq_u32 vcc, -1, v14
    s_waitcnt lgkmcnt(4)
    v_mfma_f32_32x32x16_bf16 v[24:39], v[60:63], v[84:87], v[24:39]
    buffer_load_dwordx4 v[84:87], v2, s[12:15], s32 offen offset:1024 sc1
    ds_read_b64_tr_b16 v[56:57], v128 offset:8192
    ds_read_b64_tr_b16 v[58:59], v128 offset:9216
    s_cbranch_vccnz L_ort2
L_ook2:
    s_waitcnt vmcnt(10)
    v_max3_u32 v14, v92, v93, v94
    v_max_u32 v14, v14, v95
    v_cmp_eq_u32 vcc, -1, v14
    s_waitcnt lgkmcnt(4)
    v_mfma_f32_32x32x16_bf16 v[24:39], v[64:67], v[88:91], v[24:39]
    buffer_load_dwordx4 v[88:91], v2, s[12:15], s32 offen offset:2048 sc1
    ds_read_b64_tr_b16 v[60:61], v128 offset:10240
    ds_read_b64_tr_b16 v[62:63], v128 offset:11264
    s_cbranch_vccnz L_ort3
L_ook3:
    s_waitcnt vmcnt(10)
    v_max3_u32 v14, v96, v97, v98
    v_max_u32 v14, v14, v99
    v_cmp_eq_u32 vcc, -1, v14
    s_waitcnt lgkmcnt(4)
    v_mfma_f32_32x32x16_bf16 v[24:39], v[68:71], v[92:95], v[24:39]
    buffer_load_dwordx4 v[92:95], v2, s[12:15], s32 offen offset:3072 sc1
    ds_read_b64_tr_b16 v[64:65], v128 offset:12288
    ds_read_b64_tr_b16 v[66:67], v128 offset:13312
    s_cbranch_vccnz L_ort4
L_ook4:
    s_waitcnt vmcnt(10)
    v_max3_u32 v14, v100, v101, v102
    v_max_u32 v14, v14, v103
    v_cmp_eq_u32 vcc, -1, v14
    s_waitcnt lgkmcnt(4)
    v_mfma_f32_32x32x16_bf16 v[24:39], v[56:59], v[96:99], v[24:39]
    s_add_u32 s32, s31, 16384
    buffer_load_dwordx4 v[96:99], v2, s[12:15], s32 offen offset:0 sc1
    ds_read_b64_tr_b16 v[68:69], v128 offset:14336
    ds_read_b64_tr_b16 v[70:71], v128 offset:15360
    s_cbranch_vccnz L_ort5
L_ook5:
    s_waitcnt vmcnt(10)
    v_max3_u32 v14, v104, v105, v106
    v_max_u32 v14, v14, v107
    v_cmp_eq_u32 vcc, -1, v14
    s_waitcnt lgkmcnt(4)
    v_mfma_f32_32x32x16_bf16 v[24:39], v[60:63], v[100:103], v[24:39]
    buffer_load_dwordx4 v[100:103], v2, s[12:15], s32 offen offset:1024 sc1
    ds_read_b64_tr_b16 v[56:57], v128 offset:32768
    ds_read_b64_tr_b16 v[58:59], v128 offset:33792
    s_cbranch_vccnz L_ort6
L_ook6:
    s_waitcnt vmcnt(10)
    v_max3_u32 v14, v108, v109, v110
    v_max_u32 v14, v14, v111
    v_cmp_eq_u32 vcc, -1, v14
    s_waitcnt lgkmcnt(4)
    v_mfma_f32_32x32x16_bf16 v[24:39], v[64:67], v[104:107], v[24:39]
    buffer_load_dwordx4 v[104:107], v2, s[12:15], s32 offen offset:2048 sc1
    ds_read_b64_tr_b16 v[60:61], v128 offset:34816
    ds_read_b64_tr_b16 v[62:63], v128 offset:35840
    s_cbranch_vccnz L_ort7
L_ook7:
    s_waitcnt vmcnt(10)
    v_max3_u32 v14, v112, v113, v114
    v_max_u32 v14, v14, v115
    v_cmp_eq_u32 vcc, -1, v14
    s_waitcnt lgkmcnt(4)
    v_mfma_f32_32x32x16_bf16 v[24:39], v[68:71], v[108:111], v[24:39]
    buffer_load_dwordx4 v[108:111], v2, s[12:15], s32 offen offset:3072 sc1
    ds_read_b64_tr_b16 v[64:65], v128 offset:36864
    ds_read_b64_tr_b16 v[66:67], v128 offset:37888
    s_cbranch_vccnz L_ort8
L_ook8:
    s_waitcnt vmcnt(10)
    v_max3_u32 v14, v116, v117, v118
    v_max_u32 v14, v14, v119
    v_cmp_eq_u32 vcc, -1, v14
    s_waitcnt lgkmcnt(4)
    v_mfma_f32_32x32x16_bf16 v[24:39], v[56:59], v[112:115], v[24:39]
    s_add_u32 s32, s31, 20480
    buffer_load_dwordx4 v[112:115], v2, s[12:15], s32 offen offset:0 sc1
    ds_read_b64_tr_b16 v[68:69], v128 offset:38912
    ds_read_b64_tr_b16 v[70:71], v128 offset:39936
    s_cbranch_vccnz L_ort9
L_ook9:
    s_waitcnt vmcnt(10)
    v_max3_u32 v14, v120, v121, v122
    v_max_u32 v14, v14, v123
    v_cmp_eq_u32 vcc, -1, v14
    s_waitcnt lgkmcnt(4)
    v_mfma_f32_32x32x16_bf16 v[24:39], v[60:63], v[116:119], v[24:39]
    buffer_load_dwordx4 v[116:119], v2, s[12:15], s32 offen offset:1024 sc1
    ds_read_b64_tr_b16 v[56:57], v128 offset:40960
    ds_read_b64_tr_b16 v[58:59], v128 offset:41984
    s_cbranch_vccnz L_ort10
L_ook10:
    s_waitcnt vmcnt(10)
    v_max3_u32 v14, v124, v125, v126
    v_max_u32 v14, v14, v127
    v_cmp_eq_u32 vcc, -1, v14
    s_waitcnt lgkmcnt(4)
    v_mfma_f32_32x32x16_bf16 v[24:39], v[64:67], v[120:123], v[24:39]
    buffer_load_dwordx4 v[120:123], v2, s[12:15], s32 offen offset:2048 sc1
    ds_read_b64_tr_b16 v[60:61], v128 offset:43008
    ds_read_b64_tr_b16 v[62:63], v128 offset:44032
    s_cbranch_vccnz L_ort11
L_ook11:
    s_waitcnt vmcnt(10)
    v_max3_u32 v14, v80, v81, v82
    v_max_u32 v14, v14, v83
    v_cmp_eq_u32 vcc, -1, v14
    s_waitcnt lgkmcnt(4)
    v_mfma_f32_32x32x16_bf16 v[24:39], v[68:71], v[124:127], v[24:39]
    buffer_load_dwordx4 v[124:127], v2, s[12:15], s32 offen offset:3072 sc1
    ds_read_b64_tr_b16 v[64:65], v128 offset:45056
    ds_read_b64_tr_b16 v[66:67], v128 offset:46080
    s_cbranch_vccnz L_ort12
L_ook12:
    s_waitcnt vmcnt(10)
    v_max3_u32 v14, v84, v85, v86
    v_max_u32 v14, v14, v87
    v_cmp_eq_u32 vcc, -1, v14
    s_waitcnt lgkmcnt(4)
    v_mfma_f32_32x32x16_bf16 v[24:39], v[56:59], v[80:83], v[24:39]
    s_add_u32 s32, s31, 24576
    buffer_load_dwordx4 v[80:83], v2, s[12:15], s32 offen offset:0 sc1
    ds_read_b64_tr_b16 v[68:69], v128 offset:47104
    ds_read_b64_tr_b16 v[70:71], v128 offset:48128
    s_cbranch_vccnz L_ort13
L_ook13:
    s_waitcnt vmcnt(10)
    v_max3_u32 v14, v88, v89, v90
    v_max_u32 v14, v14, v91
    v_cmp_eq_u32 vcc, -1, v14
    s_waitcnt lgkmcnt(4)
    v_mfma_f32_32x32x16_bf16 v[24:39], v[60:63], v[84:87], v[24:39]
    buffer_load_dwordx4 v[84:87], v2, s[12:15], s32 offen offset:1024 sc1
    ds_read_b64_tr_b16 v[56:57], v129 offset:0
    ds_read_b64_tr_b16 v[58:59], v129 offset:1024
    s_cbranch_vccnz L_ort14
L_ook14:
    s_waitcnt vmcnt(10)
    v_max3_u32 v14, v92, v93, v94
    v_max_u32 v14, v14, v95
    v_cmp_eq_u32 vcc, -1, v14
    s_waitcnt lgkmcnt(4)
    v_mfma_f32_32x32x16_bf16 v[24:39], v[64:67], v[88:91], v[24:39]
    buffer_load_dwordx4 v[88:91], v2, s[12:15], s32 offen offset:2048 sc1
    ds_read_b64_tr_b16 v[60:61], v129 offset:2048
    ds_read_b64_tr_b16 v[62:63], v129 offset:3072
    s_cbranch_vccnz L_ort15
L_ook15:
    s_waitcnt vmcnt(10)
    v_max3_u32 v14, v96, v97, v98
    v_max_u32 v14, v14, v99
    v_cmp_eq_u32 vcc, -1, v14
    s_waitcnt lgkmcnt(4)
    v_mfma_f32_32x32x16_bf16 v[24:39], v[68:71], v[92:95], v[24:39]
    buffer_load_dwordx4 v[92:95], v2, s[12:15], s32 offen offset:3072 sc1
    ds_read_b64_tr_b16 v[64:65], v129 offset:4096
    ds_read_b64_tr_b16 v[66:67], v129 offset:5120
    s_cbranch_vccnz L_ort16
L_ook16:
    s_waitcnt vmcnt(10)
    v_max3_u32 v14, v100, v101, v102
    v_max_u32 v14, v14, v103
    v_cmp_eq_u32 vcc, -1, v14
    s_waitcnt lgkmcnt(4)
    v_mfma_f32_32x32x16_bf16 v[24:39], v[56:59], v[96:99], v[24:39]
    s_add_u32 s32, s31, 28672
    buffer_load_dwordx4 v[96:99], v2, s[12:15], s32 offen offset:0 sc1
    ds_read_b64_tr_b16 v[68:69], v129 offset:6144
    ds_read_b64_tr_b16 v[70:71], v129 offset:7168
    s_cbranch_vccnz L_ort17
L_ook17:
    s_waitcnt vmcnt(10)
    v_max3_u32 v14, v104, v105, v106
    v_max_u32 v14, v14, v107
    v_cmp_eq_u32 vcc, -1, v14
    s_waitcnt lgkmcnt(4)
    v_mfma_f32_32x32x16_bf16 v[24:39], v[60:63], v[100:103], v[24:39]
    buffer_load_dwordx4 v[100:103], v2, s[12:15], s32 offen offset:1024 sc1
    ds_read_b64_tr_b16 v[56:57], v129 offset:8192
    ds_read_b64_tr_b16 v[58:59], v129 offset:9216
    s_cbranch_vccnz L_ort18
L_ook18:
    s_waitcnt vmcnt(10)
    v_max3_u32 v14, v108, v109, v110
    v_max_u32 v14, v14, v111
    v_cmp_eq_u32 vcc, -1, v14
    s_waitcnt lgkmcnt(4)
    v_mfma_f32_32x32x16_bf16 v[24:39], v[64:67], v[104:107], v[24:39]
    buffer_load_dwordx4 v[104:107], v2, s[12:15], s32 offen offset:2048 sc1
    ds_read_b64_tr_b16 v[60:61], v129 offset:10240
    ds_read_b64_tr_b16 v[62:63], v129 offset:11264
    s_cbranch_vccnz L_ort19
L_ook19:
    s_waitcnt vmcnt(10)
    v_max3_u32 v14, v112, v113, v114
    v_max_u32 v14, v14, v115
    v_cmp_eq_u32 vcc, -1, v14
    s_waitcnt lgkmcnt(4)
    v_mfma_f32_32x32x16_bf16 v[24:39], v[68:71], v[108:111], v[24:39]
    buffer_load_dwordx4 v[108:111], v2, s[12:15], s32 offen offset:3072 sc1
    ds_read_b64_tr_b16 v[64:65], v129 offset:12288
    ds_read_b64_tr_b16 v[66:67], v129 offset:13312
    s_cbranch_vccnz L_ort20
L_ook20:
    s_waitcnt vmcnt(10)
    v_max3_u32 v14, v116, v117, v118
    v_max_u32 v14, v14, v119
    v_cmp_eq_u32 vcc, -1, v14
    s_waitcnt lgkmcnt(4)
    v_mfma_f32_32x32x16_bf16 v[24:39], v[56:59], v[112:115], v[24:39]
    ds_read_b64_tr_b16 v[68:69], v129 offset:14336
    ds_read_b64_tr_b16 v[70:71], v129 offset:15360
    s_cbranch_vccnz L_ort21
L_ook21:
    s_waitcnt vmcnt(9)
    v_max3_u32 v14, v120, v121, v122
    v_max_u32 v14, v14, v123
    v_cmp_eq_u32 vcc, -1, v14
    s_waitcnt lgkmcnt(4)
    v_mfma_f32_32x32x16_bf16 v[24:39], v[60:63], v[116:119], v[24:39]
    ds_read_b64_tr_b16 v[56:57], v129 offset:32768
    ds_read_b64_tr_b16 v[58:59], v129 offset:33792
    s_cbranch_vccnz L_ort22
L_ook22:
    s_waitcnt vmcnt(8)
    v_max3_u32 v14, v124, v125, v126
    v_max_u32 v14, v14, v127
    v_cmp_eq_u32 vcc, -1, v14
    s_waitcnt lgkmcnt(4)
    v_mfma_f32_32x32x16_bf16 v[24:39], v[64:67], v[120:123], v[24:39]
    ds_read_b64_tr_b16 v[60:61], v129 offset:34816
    ds_read_b64_tr_b16 v[62:63], v129 offset:35840
    s_cbranch_vccnz L_ort23
L_ook23:
    s_waitcnt vmcnt(7)
    v_max3_u32 v14, v80, v81, v82
    v_max_u32 v14, v14, v83
    v_cmp_eq_u32 vcc, -1, v14
    s_waitcnt lgkmcnt(4)
    v_mfma_f32_32x32x16_bf16 v[24:39], v[68:71], v[124:127], v[24:39]
    ds_read_b64_tr_b16 v[64:65], v129 offset:36864
    ds_read_b64_tr_b16 v[66:67], v129 offset:37888
    s_cbranch_vccnz L_ort24
L_ook24:
    s_waitcnt vmcnt(6)
    v_max3_u32 v14, v84, v85, v86
    v_max_u32 v14, v14, v87
    v_cmp_eq_u32 vcc, -1, v14
    s_waitcnt lgkmcnt(4)
    v_mfma_f32_32x32x16_bf16 v[24:39], v[56:59], v[80:83], v[24:39]
    ds_read_b64_tr_b16 v[68:69], v129 offset:38912
    ds_read_b64_tr_b16 v[70:71], v129 offset:39936
    s_cbranch_vccnz L_ort25
L_ook25:
    s_waitcnt vmcnt(5)
    v_max3_u32 v14, v88, v89, v90
    v_max_u32 v14, v14, v91
    v_cmp_eq_u32 vcc, -1, v14
    s_waitcnt lgkmcnt(4)
    v_mfma_f32_32x32x16_bf16 v[24:39], v[60:63], v[84:87], v[24:39]
    ds_read_b64_tr_b16 v[56:57], v129 offset:40960
    ds_read_b64_tr_b16 v[58:59], v129 offset:41984
    s_cbranch_vccnz L_ort26
L_ook26:
    s_waitcnt vmcnt(4)
    v_max3_u32 v14, v92, v93, v94
    v_max_u32 v14, v14, v95
    v_cmp_eq_u32 vcc, -1, v14
    s_waitcnt lgkmcnt(4)
    v_mfma_f32_32x32x16_bf16 v[24:39], v[64:67], v[88:91], v[24:39]
    ds_read_b64_tr_b16 v[60:61], v129 offset:43008
    ds_read_b64_tr_b16 v[62:63], v129 offset:44032
    s_cbranch_vccnz L_ort27
L_ook27:
    s_waitcnt vmcnt(3)
    v_max3_u32 v14, v96, v97, v98
    v_max_u32 v14, v14, v99
    v_cmp_eq_u32 vcc, -1, v14
    s_waitcnt lgkmcnt(4)
    v_mfma_f32_32x32x16_bf16 v[24:39], v[68:71], v[92:95], v[24:39]
    ds_read_b64_tr_b16 v[64:65], v129 offset:45056
    ds_read_b64_tr_b16 v[66:67], v129 offset:46080
    s_cbranch_vccnz L_ort28
L_ook28:
    s_waitcnt vmcnt(2)
    v_max3_u32 v14, v100, v101, v102
    v_max_u32 v14, v14, v103
    v_cmp_eq_u32 vcc, -1, v14
    s_waitcnt lgkmcnt(4)
    v_mfma_f32_32x32x16_bf16 v[24:39], v[56:59], v[96:99], v[24:39]
    ds_read_b64_tr_b16 v[68:69], v129 offset:47104
    ds_read_b64_tr_b16 v[70:71], v129 offset:48128
    s_cbranch_vccnz L_ort29
L_ook29:
    s_waitcnt vmcnt(1)
    v_max3_u32 v14, v104, v105, v106
    v_max_u32 v14, v14, v107
    v_cmp_eq_u32 vcc, -1, v14
    s_waitcnt lgkmcnt(4)
    v_mfma_f32_32x32x16_bf16 v[24:39], v[60:63], v[100:103], v[24:39]
    s_cbranch_vccnz L_ort30
L_ook30:
    s_waitcnt vmcnt(0)
    v_max3_u32 v14, v108, v109, v110
    v_max_u32 v14, v14, v111
    v_cmp_eq_u32 vcc, -1, v14
    s_waitcnt lgkmcnt(2)
    v_mfma_f32_32x32x16_bf16 v[24:39], v[64:67], v[104:107], v[24:39]
    s_cbranch_vccnz L_ort31
L_ook31:
    s_waitcnt lgkmcnt(0)
    v_mfma_f32_32x32x16_bf16 v[24:39], v[68:71], v[108:111], v[24:39]
    s_nop 11
    v_pk_add_f32 v[40:41], v[24:25], v[32:33]
    v_pk_add_f32 v[42:43], v[26:27], v[34:35]
    v_pk_add_f32 v[44:45], v[28:29], v[36:37]
    v_pk_add_f32 v[46:47], v[30:31], v[38:39]
    v_pk_mul_f32 v[48:49], v[24:25], v[24:25]
    v_pk_mul_f32 v[50:51], v[26:27], v[26:27]
    v_pk_fma_f32 v[48:49], v[28:29], v[28:29], v[48:49]
    v_pk_fma_f32 v[50:51], v[30:31], v[30:31], v[50:51]
    v_pk_fma_f32 v[48:49], v[32:33], v[32:33], v[48:49]
    v_pk_fma_f32 v[50:51], v[34:35], v[34:35], v[50:51]
    v_pk_fma_f32 v[48:49], v[36:37], v[36:37], v[48:49]
    v_pk_fma_f32 v[50:51], v[38:39], v[38:39], v[50:51]
    v_pk_add_f32 v[40:41], v[40:41], v[44:45]
    v_pk_add_f32 v[42:43], v[42:43], v[46:47]
    v_pk_add_f32 v[48:49], v[48:49], v[50:51]
    v_pk_add_f32 v[40:41], v[40:41], v[42:43]
    v_add_f32 v133, v48, v49
    v_add_f32 v132, v40, v41
    v_mov_b32 v11, v132
    v_mov_b32 v12, v133
    s_nop 0
    v_permlane32_swap_b32 v132, v11
    v_permlane32_swap_b32 v133, v12
    v_add_f32 v132, v132, v11
    v_add_f32 v133, v133, v12
    v_min_u32 v132, -2, v132
    v_min_u32 v133, -2, v133
    s_mov_b32 exec_hi, 0
    s_cmp_eq_u32 s35, 0
    s_cbranch_scc1 L_ls_19_g
    buffer_store_dwordx2 v[132:133], v131, s[12:15], s25 offen
L_ls_19_d:
    s_mov_b64 exec, -1
    s_barrier
    s_add_u32 m0, s34, 0
    s_add_u32 s33, s91, 0
    buffer_load_dwordx4 v4, s[52:55], s33 offen offset:0 lds
    buffer_load_dwordx4 v5, s[52:55], s33 offen offset:1024 lds
    buffer_load_dwordx4 v6, s[52:55], s33 offen offset:2048 lds
    buffer_load_dwordx4 v7, s[52:55], s33 offen offset:3072 lds
    s_waitcnt vmcnt(4)
    buffer_load_dwordx4 v[80:83], v131, s[12:15], s28 offen offset:0 sc1
    buffer_load_dwordx4 v[84:87], v131, s[12:15], s28 offen offset:512 sc1
    buffer_load_dwordx4 v[88:91], v131, s[12:15], s28 offen offset:1024 sc1
    buffer_load_dwordx4 v[92:95], v131, s[12:15], s28 offen offset:1536 sc1
    buffer_load_dwordx2 v[144:145], v134, s[56:59], s29 offen
    buffer_load_dwordx2 v[146:147], v134, s[56:59], s29 offen offset:16
    buffer_load_ushort v148, v135, s[60:63], s30 offen
    s_waitcnt vmcnt(3)
    v_pk_add_f32 v[80:81], v[80:81], v[88:89]
    v_pk_add_f32 v[82:83], v[82:83], v[90:91]
    v_pk_add_f32 v[84:85], v[84:85], v[92:93]
    v_pk_add_f32 v[86:87], v[86:87], v[94:95]
    v_pk_add_f32 v[80:81], v[80:81], v[84:85]
    v_pk_add_f32 v[82:83], v[82:83], v[86:87]
    v_pk_add_f32 v[132:133], v[80:81], v[82:83]
    v_mov_b32 v11, v132
    v_mov_b32 v12, v133
    s_nop 0
    v_permlane32_swap_b32 v132, v11
    v_permlane32_swap_b32 v133, v12
    v_add_f32 v132, v132, v11
    v_add_f32 v133, v133, v12
    v_cmp_u_f32 vcc, v132, v133
L_ex_18_got:
    v_mul_f32 v132, 0x3b000000, v132
    v_mul_f32 v133, 0x3b000000, v133
    v_fma_f32 v133, -v132, v132, v133
    v_max_f32 v133, 0, v133
    v_mov_b32 v11, 0x2edbe6ff
    s_cbranch_vccnz L_ex_18_poll
    v_fmamk_f32 v133, v133, 0x3f800054, v11
    v_rsq_f32 v133, v133
    s_nop 0
    v_mul_f32 v132, v132, v133
    v_pk_fma_f32 v[40:41], v[24:25], v[132:133], v[132:133] op_sel:[0,1,0] op_sel_hi:[1,1,0] neg_lo:[0,0,1] neg_hi:[0,0,1]
    v_pk_fma_f32 v[42:43], v[26:27], v[132:133], v[132:133] op_sel:[0,1,0] op_sel_hi:[1,1,0] neg_lo:[0,0,1] neg_hi:[0,0,1]
    v_pk_fma_f32 v[44:45], v[28:29], v[132:133], v[132:133] op_sel:[0,1,0] op_sel_hi:[1,1,0] neg_lo:[0,0,1] neg_hi:[0,0,1]
    v_pk_fma_f32 v[46:47], v[30:31], v[132:133], v[132:133] op_sel:[0,1,0] op_sel_hi:[1,1,0] neg_lo:[0,0,1] neg_hi:[0,0,1]
    v_pk_fma_f32 v[48:49], v[32:33], v[132:133], v[132:133] op_sel:[0,1,0] op_sel_hi:[1,1,0] neg_lo:[0,0,1] neg_hi:[0,0,1]
    v_pk_fma_f32 v[50:51], v[34:35], v[132:133], v[132:133] op_sel:[0,1,0] op_sel_hi:[1,1,0] neg_lo:[0,0,1] neg_hi:[0,0,1]
    v_pk_fma_f32 v[52:53], v[36:37], v[132:133], v[132:133] op_sel:[0,1,0] op_sel_hi:[1,1,0] neg_lo:[0,0,1] neg_hi:[0,0,1]
    v_pk_fma_f32 v[54:55], v[38:39], v[132:133], v[132:133] op_sel:[0,1,0] op_sel_hi:[1,1,0] neg_lo:[0,0,1] neg_hi:[0,0,1]
    v_cvt_pk_bf16_f32 v56, v40, v41
    v_cvt_pk_bf16_f32 v57, v42, v43
    v_cvt_pk_bf16_f32 v58, v44, v45
    v_cvt_pk_bf16_f32 v59, v46, v47
    v_cvt_pk_bf16_f32 v60, v48, v49
    v_cvt_pk_bf16_f32 v61, v50, v51
    v_mfma_f32_32x32x16_bf16 v[96:111], v[56:59], v[72:75], 0
    v_cvt_pk_bf16_f32 v62, v52, v53
    v_cvt_pk_bf16_f32 v63, v54, v55
    s_nop 1
    v_mfma_f32_32x32x16_bf16 v[96:111], v[60:63], v[76:79], v[96:111]
    s_nop 11
    v_cvt_pk_bf16_f32 v64, v96, v97
    v_cvt_pk_bf16_f32 v65, v98, v99
    v_cvt_pk_bf16_f32 v66, v100, v101
    v_cvt_pk_bf16_f32 v67, v102, v103
    v_min_u32 v64, -2, v64
    v_min_u32 v65, -2, v65
    v_min_u32 v66, -2, v66
    v_min_u32 v67, -2, v67
    buffer_store_dwordx4 v[64:67], v130, s[12:15], s27 offen offset:0 sc1
    v_cvt_pk_bf16_f32 v68, v104, v105
    v_cvt_pk_bf16_f32 v69, v106, v107
    v_cvt_pk_bf16_f32 v70, v108, v109
L_pad_Q_5:
    s_cbranch_execz L_ret_Q_5
    v_cvt_pk_bf16_f32 v71, v110, v111
    v_min_u32 v68, -2, v68
    v_min_u32 v69, -2, v69
    v_min_u32 v70, -2, v70
    v_min_u32 v71, -2, v71
    buffer_store_dwordx4 v[68:71], v130, s[12:15], s27 offen offset:1024 sc1
    s_add_u32 m0, s34, 4096
    s_add_u32 s33, s91, 131072
    buffer_load_dwordx4 v4, s[52:55], s33 offen offset:0 lds
    buffer_load_dwordx4 v5, s[52:55], s33 offen offset:1024 lds
    buffer_load_dwordx4 v6, s[52:55], s33 offen offset:2048 lds
    buffer_load_dwordx4 v7, s[52:55], s33 offen offset:3072 lds
    s_add_u32 m0, s34, 8192
    s_add_u32 s33, s91, 1048576
    buffer_load_dwordx4 v4, s[52:55], s33 offen offset:0 lds
    buffer_load_dwordx4 v5, s[52:55], s33 offen offset:1024 lds
    buffer_load_dwordx4 v6, s[52:55], s33 offen offset:2048 lds
    buffer_load_dwordx4 v7, s[52:55], s33 offen offset:3072 lds
    s_lshl_b32 s76, s36, 18
    s_lshl_b32 s24, s16, 12
    s_add_u32 s76, s76, s24
    s_add_u32 s76, s76, 10485760
    s_add_u32 s76, s76, s19
    s_mov_b32 s94, 0
    v_mov_b32 v140, v4
    v_mov_b32 v141, v5
    v_mov_b32 v142, v6
    v_mov_b32 v143, v7
    s_waitcnt vmcnt(10)
    v_lshlrev_b32 v40, 16, v144
    v_and_b32 v41, 0xffff0000, v144
    v_lshlrev_b32 v42, 16, v145
    v_and_b32 v43, 0xffff0000, v145
    v_lshlrev_b32 v44, 16, v146
    v_and_b32 v45, 0xffff0000, v146
    v_lshlrev_b32 v46, 16, v147
    v_and_b32 v47, 0xffff0000, v147
    v_mov_b32 v72, v40
    v_mov_b32 v48, 0
    v_mov_b32 v80, 0
    v_mov_b32 v73, v41
    v_mov_b32 v49, 0
    v_mov_b32 v81, 0
    v_mov_b32 v74, v42
    v_mov_b32 v50, 0
    v_mov_b32 v82, 0
    v_mov_b32 v75, v43
    v_mov_b32 v51, 0
    v_mov_b32 v83, 0
    v_mov_b32 v76, v44
    v_mov_b32 v52, 0
    v_mov_b32 v84, 0
    v_mov_b32 v77, v45
    v_mov_b32 v53, 0
    v_mov_b32 v85, 0
    v_mov_b32 v78, v46
    v_mov_b32 v54, 0
    v_mov_b32 v86, 0
    v_mov_b32 v79, v47
    v_mov_b32 v55, 0
    v_mov_b32 v87, 0
    v_lshlrev_b32 v148, 16, v148
    v_pk_add_f32 v[24:25], v[24:25], v[148:149] op_sel_hi:[1,0]
    v_pk_add_f32 v[26:27], v[26:27], v[148:149] op_sel_hi:[1,0]
    v_pk_add_f32 v[28:29], v[28:29], v[148:149] op_sel_hi:[1,0]
    v_pk_add_f32 v[30:31], v[30:31], v[148:149] op_sel_hi:[1,0]
    v_pk_add_f32 v[32:33], v[32:33], v[148:149] op_sel_hi:[1,0]
    v_pk_add_f32 v[34:35], v[34:35], v[148:149] op_sel_hi:[1,0]
    v_pk_add_f32 v[36:37], v[36:37], v[148:149] op_sel_hi:[1,0]
    v_pk_add_f32 v[38:39], v[38:39], v[148:149] op_sel_hi:[1,0]
    s_mul_i32 s25, s36, 224
    s_lshl_b32 s26, s37, 2
    s_add_u32 s26, s26, s16
    s_add_u32 s25, s25, s26
    s_lshl_b32 s25, s25, 10
    s_add_u32 s25, s25, 12582912
    s_add_u32 s74, s25, s19
    s_add_u32 s75, s74, 114688
    s_mul_i32 s77, s21, 229376
    s_lshl_b32 s24, s16, 12
    s_add_u32 s77, s77, s24
    s_add_u32 s77, s77, 12582912
    s_add_u32 s77, s77, s19
    v_mov_b32 v156, 0xbdd2d3e8
    v_mov_b32 v157, 0xc0135761
    s_lshl_b32 s24, s20, 1
    s_add_u32 s24, s24, s22
    s_lshl_b32 s25, s21, 2
    s_add_u32 s25, s25, s23
    s_lshl_b32 s30, s24, 5
    s_add_u32 s29, s30, s25
    s_lshl_b32 s72, s29, 7
    s_add_u32 s72, s72, 14811136
    s_add_u32 s72, s72, s19
    s_add_u32 s73, s72, 256
    s_cmp_lg_u32 s19, 0
    s_cbranch_scc1 L_l1_20
    s_lshl_b32 s78, s29, 10
    s_add_u32 s78, s78, 8388608
    s_add_u32 s79, s78, 2048
    s_mov_b32 s64, s12
    s_mov_b32 s65, s13
    s_mov_b32 s66, s14
    v_mov_b32 v158, v2
    s_lshl_b32 s92, s24, 12
    s_add_u32 s92, s92, 15728640
    s_lshl_b32 s26, s30, 7
    s_add_u32 s26, s26, 14811392
    s_add_u32 s30, s30, s23
    s_lshl_b32 s39, s30, 10
    s_add_u32 s39, s39, 8388608
    s_lshl_b32 s27, s30, 7
    s_add_u32 s27, s27, 14811136
    s_lshl_b32 s31, s22, 5
    s_add_u32 s31, s31, s23
    s_mul_i32 s31, s31, 1056
    s_lshl_b32 s28, s21, 9
    s_add_u32 s28, s28, s92
    v_min_u32 v20, 7, v1
    v_lshlrev_b32 v20, 9, v20
    v_mul_u32_u24 v159, 3072, v3
    v_add_u32 v159, v159, v8
    s_add_u32 s98, s98, 16777216
    s_add_u32 s99, s99, 16777216
    s_add_u32 s100, s100, 16777216
    s_add_u32 s101, s101, 16777216
    v_and_b32 v13, 7, v1
    v_lshlrev_b32 v13, 7, v13
    s_lshl_b32 s24, s23, 3
    s_add_u32 s28, s28, s24
L_l1_20_d:
    s_cmp_ge_u32 s21, 7
    s_cbranch_scc1 L_mlp_idle
    s_waitcnt vmcnt(8)
    s_add_u32 s32, s76, 0
    buffer_load_dwordx4 v[104:107], v2, s[12:15], s32 offen offset:0 sc1
    buffer_load_dwordx4 v[108:111], v2, s[12:15], s32 offen offset:1024 sc1
    buffer_load_dwordx4 v[112:115], v2, s[12:15], s32 offen offset:2048 sc1
    buffer_load_dwordx4 v[116:119], v2, s[12:15], s32 offen offset:3072 sc1
    s_add_u32 s32, s76, 16384
    buffer_load_dwordx4 v[120:123], v2, s[12:15], s32 offen offset:0 sc1
    buffer_load_dwordx4 v[124:127], v2, s[12:15], s32 offen offset:1024 sc1
    buffer_load_dwordx4 v[128:131], v2, s[12:15], s32 offen offset:2048 sc1
    buffer_load_dwordx4 v[132:135], v2, s[12:15], s32 offen offset:3072 sc1
    s_add_u32 s32, s76, 32768
    buffer_load_dwordx4 v[136:139], v2, s[12:15], s32 offen offset:0 sc1
    buffer_load_dwordx4 v[4:7], v2, s[12:15], s32 offen offset:1024 sc1
    s_add_u32 m0, s34, 12288
    s_add_u32 s33, s91, 1179648
    buffer_load_dwordx4 v140, s[52:55], s33 offen offset:0 lds
    buffer_load_dwordx4 v141, s[52:55], s33 offen offset:1024 lds
    buffer_load_dwordx4 v142, s[52:55], s33 offen offset:2048 lds
    buffer_load_dwordx4 v143, s[52:55], s33 offen offset:3072 lds
    s_waitcnt vmcnt(13)
    v_max3_u32 v14, v104, v105, v106
    v_max_u32 v14, v14, v107
    v_cmp_eq_u32 vcc, -1, v14
    s_nop 3
    s_cbranch_vccnz L_rt0
L_ok0:
    v_mfma_f32_32x32x16_bf16 v[40:55], a[0:3], v[104:107], v[40:55]
    s_waitcnt vmcnt(12)
    v_max3_u32 v14, v108, v109, v110
    v_max_u32 v14, v14, v111
    v_cmp_eq_u32 vcc, -1, v14
    v_mfma_f32_32x32x16_bf16 v[56:71], a[4:7], v[104:107], 0
    buffer_load_dwordx4 v[104:107], v2, s[12:15], s32 offen offset:2048 sc1
    s_cbranch_vccnz L_rt1
L_ok1:
    v_mfma_f32_32x32x16_bf16 v[40:55], a[8:11], v[108:111], v[40:55]
    s_waitcnt vmcnt(12)
    v_max3_u32 v14, v112, v113, v114
    v_max_u32 v14, v14, v115
    v_cmp_eq_u32 vcc, -1, v14
    v_mfma_f32_32x32x16_bf16 v[56:71], a[12:15], v[108:111], v[56:71]
    buffer_load_dwordx4 v[108:111], v2, s[12:15], s32 offen offset:3072 sc1
    s_cbranch_vccnz L_rt2
L_ok2:
    v_mfma_f32_32x32x16_bf16 v[40:55], a[16:19], v[112:115], v[40:55]
    s_waitcnt vmcnt(12)
    v_max3_u32 v14, v116, v117, v118
    v_max_u32 v14, v14, v119
    v_cmp_eq_u32 vcc, -1, v14
    v_mfma_f32_32x32x16_bf16 v[56:71], a[20:23], v[112:115], v[56:71]
    s_add_u32 s32, s76, 49152
    buffer_load_dwordx4 v[112:115], v2, s[12:15], s32 offen offset:0 sc1
    s_cbranch_vccnz L_rt3
L_ok3:
    v_mfma_f32_32x32x16_bf16 v[40:55], a[24:27], v[116:119], v[40:55]
    s_waitcnt vmcnt(12)
    v_max3_u32 v14, v120, v121, v122
    v_max_u32 v14, v14, v123
    v_cmp_eq_u32 vcc, -1, v14
    v_mfma_f32_32x32x16_bf16 v[56:71], a[28:31], v[116:119], v[56:71]
    buffer_load_dwordx4 v[116:119], v2, s[12:15], s32 offen offset:1024 sc1
    s_cbranch_vccnz L_rt4
L_ok4:
    v_mfma_f32_32x32x16_bf16 v[40:55], a[32:35], v[120:123], v[40:55]
    s_waitcnt vmcnt(12)
    v_max3_u32 v14, v124, v125, v126
    v_max_u32 v14, v14, v127
    v_cmp_eq_u32 vcc, -1, v14
    v_mfma_f32_32x32x16_bf16 v[56:71], a[36:39], v[120:123], v[56:71]
    buffer_load_dwordx4 v[120:123], v2, s[12:15], s32 offen offset:2048 sc1
    s_cbranch_vccnz L_rt5
L_ok5:
    v_mfma_f32_32x32x16_bf16 v[40:55], a[40:43], v[124:127], v[40:55]
    s_waitcnt vmcnt(12)
    v_max3_u32 v14, v128, v129, v130
    v_max_u32 v14, v14, v131
    v_cmp_eq_u32 vcc, -1, v14
    v_mfma_f32_32x32x16_bf16 v[56:71], a[44:47], v[124:127], v[56:71]
    buffer_load_dwordx4 v[124:127], v2, s[12:15], s32 offen offset:3072 sc1
    s_cbranch_vccnz L_rt6
L_ok6:
    v_mfma_f32_32x32x16_bf16 v[40:55], a[48:51], v[128:131], v[40:55]
    s_waitcnt vmcnt(12)
    v_max3_u32 v14, v132, v133, v134
    v_max_u32 v14, v14, v135
    v_cmp_eq_u32 vcc, -1, v14
    v_mfma_f32_32x32x16_bf16 v[56:71], a[52:55], v[128:131], v[56:71]
    s_add_u32 s32, s76, 65536
    buffer_load_dwordx4 v[128:131], v2, s[12:15], s32 offen offset:0 sc1
    s_cbranch_vccnz L_rt7
L_ok7:
    v_mfma_f32_32x32x16_bf16 v[40:55], a[56:59], v[132:135], v[40:55]
    s_waitcnt vmcnt(12)
    v_max3_u32 v14, v136, v137, v138
    v_max_u32 v14, v14, v139
    v_cmp_eq_u32 vcc, -1, v14
    v_mfma_f32_32x32x16_bf16 v[56:71], a[60:63], v[132:135], v[56:71]
    buffer_load_dwordx4 v[132:135], v2, s[12:15], s32 offen offset:1024 sc1
    s_cbranch_vccnz L_rt8
L_ok8:
    v_mfma_f32_32x32x16_bf16 v[40:55], a[64:67], v[136:139], v[40:55]
    s_waitcnt vmcnt(12)
    v_max3_u32 v14, v4, v5, v6
    v_max_u32 v14, v14, v7
    v_cmp_eq_u32 vcc, -1, v14
    v_mfma_f32_32x32x16_bf16 v[56:71], a[68:71], v[136:139], v[56:71]
    buffer_load_dwordx4 v[136:139], v2, s[12:15], s32 offen offset:2048 sc1
    s_cbranch_vccnz L_rt9
L_ok9:
    v_mfma_f32_32x32x16_bf16 v[40:55], a[72:75], v[4:7], v[40:55]
    s_waitcnt vmcnt(8)
    v_max3_u32 v14, v104, v105, v106
    v_max_u32 v14, v14, v107
    v_cmp_eq_u32 vcc, -1, v14
    v_mfma_f32_32x32x16_bf16 v[56:71], a[76:79], v[4:7], v[56:71]
    buffer_load_dwordx4 v[4:7], v2, s[12:15], s32 offen offset:3072 sc1
    s_cbranch_vccnz L_rt10
L_ok10:
    v_mfma_f32_32x32x16_bf16 v[40:55], a[80:83], v[104:107], v[40:55]
    s_waitcnt vmcnt(8)
    v_max3_u32 v14, v108, v109, v110
    v_max_u32 v14, v14, v111
    v_cmp_eq_u32 vcc, -1, v14
    v_mfma_f32_32x32x16_bf16 v[56:71], a[84:87], v[104:107], v[56:71]
    s_add_u32 s32, s76, 81920
    buffer_load_dwordx4 v[104:107], v2, s[12:15], s32 offen offset:0 sc1
    s_cbranch_vccnz L_rt11
L_ok11:
    v_mfma_f32_32x32x16_bf16 v[40:55], a[88:91], v[108:111], v[40:55]
    s_waitcnt vmcnt(8)
    v_max3_u32 v14, v112, v113, v114
    v_max_u32 v14, v14, v115
    v_cmp_eq_u32 vcc, -1, v14
    v_mfma_f32_32x32x16_bf16 v[56:71], a[92:95], v[108:111], v[56:71]
    buffer_load_dwordx4 v[108:111], v2, s[12:15], s32 offen offset:1024 sc1
    s_cbranch_vccnz L_rt12
L_ok12:
    v_mfma_f32_32x32x16_bf16 v[40:55], a[96:99], v[112:115], v[40:55]
    s_waitcnt vmcnt(8)
    v_max3_u32 v14, v116, v117, v118
    v_max_u32 v14, v14, v119
    v_cmp_eq_u32 vcc, -1, v14
    v_mfma_f32_32x32x16_bf16 v[56:71], a[100:103], v[112:115], v[56:71]
    buffer_load_dwordx4 v[112:115], v2, s[12:15], s32 offen offset:2048 sc1
    s_cbranch_vccnz L_rt13
L_ok13:
    v_mfma_f32_32x32x16_bf16 v[40:55], a[104:107], v[116:119], v[40:55]
    s_waitcnt vmcnt(8)
    v_max3_u32 v14, v120, v121, v122
    v_max_u32 v14, v14, v123
    v_cmp_eq_u32 vcc, -1, v14
    v_mfma_f32_32x32x16_bf16 v[56:71], a[108:111], v[116:119], v[56:71]
    buffer_load_dwordx4 v[116:119], v2, s[12:15], s32 offen offset:3072 sc1
    s_cbranch_vccnz L_rt14
L_ok14:
    v_mfma_f32_32x32x16_bf16 v[40:55], a[112:115], v[120:123], v[40:55]
    s_waitcnt vmcnt(8)
    v_max3_u32 v14, v124, v125, v126
    v_max_u32 v14, v14, v127
    v_cmp_eq_u32 vcc, -1, v14
    v_mfma_f32_32x32x16_bf16 v[56:71], a[116:119], v[120:123], v[56:71]
    s_add_u32 s32, s76, 98304
    buffer_load_dwordx4 v[120:123], v2, s[12:15], s32 offen offset:0 sc1
    s_cbranch_vccnz L_rt15
L_ok15:
    v_mfma_f32_32x32x16_bf16 v[40:55], a[120:123], v[124:127], v[40:55]
    s_waitcnt vmcnt(8)
    v_max3_u32 v14, v128, v129, v130
    v_max_u32 v14, v14, v131
    v_cmp_eq_u32 vcc, -1, v14
    v_mfma_f32_32x32x16_bf16 v[56:71], a[124:127], v[124:127], v[56:71]
    buffer_load_dwordx4 v[124:127], v2, s[12:15], s32 offen offset:1024 sc1
    s_cbranch_vccnz L_rt16
L_ok16:
    v_mfma_f32_32x32x16_bf16 v[40:55], a[128:131], v[128:131], v[40:55]
    s_waitcnt vmcnt(8)
    v_max3_u32 v14, v132, v133, v134
    v_max_u32 v14, v14, v135
    v_cmp_eq_u32 vcc, -1, v14
    v_mfma_f32_32x32x16_bf16 v[56:71], a[132:135], v[128:131], v[56:71]
    buffer_load_dwordx4 v[128:131], v2, s[12:15], s32 offen offset:2048 sc1
    s_cbranch_vccnz L_rt17
L_ok17:
    v_mfma_f32_32x32x16_bf16 v[40:55], a[136:139], v[132:135], v[40:55]
    s_waitcnt vmcnt(8)
    v_max3_u32 v14, v136, v137, v138
    v_max_u32 v14, v14, v139
    v_cmp_eq_u32 vcc, -1, v14
    v_mfma_f32_32x32x16_bf16 v[56:71], a[140:143], v[132:135], v[56:71]
    buffer_load_dwordx4 v[132:135], v2, s[12:15], s32 offen offset:3072 sc1
    s_cbranch_vccnz L_rt18
L_ok18:
    v_mfma_f32_32x32x16_bf16 v[40:55], a[144:147], v[136:139], v[40:55]
    s_waitcnt vmcnt(8)
    v_max3_u32 v14, v4, v5, v6
    v_max_u32 v14, v14, v7
    v_cmp_eq_u32 vcc, -1, v14
    v_mfma_f32_32x32x16_bf16 v[56:71], a[148:151], v[136:139], v[56:71]
    s_add_u32 s32, s76, 114688
    buffer_load_dwordx4 v[136:139], v2, s[12:15], s32 offen offset:0 sc1
    s_cbranch_vccnz L_rt19
L_ok19:
    v_mfma_f32_32x32x16_bf16 v[40:55], a[152:155], v[4:7], v[40:55]
    s_waitcnt vmcnt(8)
    v_max3_u32 v14, v104, v105, v106
    v_max_u32 v14, v14, v107
    v_cmp_eq_u32 vcc, -1, v14
    v_mfma_f32_32x32x16_bf16 v[56:71], a[156:159], v[4:7], v[56:71]
    buffer_load_dwordx4 v[4:7], v2, s[12:15], s32 offen offset:1024 sc1
    s_cbranch_vccnz L_rt20
L_ok20:
    v_mfma_f32_32x32x16_bf16 v[40:55], a[160:163], v[104:107], v[40:55]
    s_waitcnt vmcnt(8)
    v_max3_u32 v14, v108, v109, v110
    v_max_u32 v14, v14, v111
    v_cmp_eq_u32 vcc, -1, v14
    v_mfma_f32_32x32x16_bf16 v[56:71], a[164:167], v[104:107], v[56:71]
    buffer_load_dwordx4 v[104:107], v2, s[12:15], s32 offen offset:2048 sc1
    s_cbranch_vccnz L_rt21
L_ok21:
    v_mfma_f32_32x32x16_bf16 v[40:55], a[168:171], v[108:111], v[40:55]
    s_waitcnt vmcnt(8)
    v_max3_u32 v14, v112, v113, v114
    v_max_u32 v14, v14, v115
    v_cmp_eq_u32 vcc, -1, v14
    v_mfma_f32_32x32x16_bf16 v[56:71], a[172:175], v[108:111], v[56:71]
    buffer_load_dwordx4 v[108:111], v2, s[12:15], s32 offen offset:3072 sc1
    s_cbranch_vccnz L_rt22
L_ok22:
    v_mfma_f32_32x32x16_bf16 v[40:55], a[176:179], v[112:115], v[40:55]
    s_waitcnt vmcnt(8)
    v_max3_u32 v14, v116, v117, v118
    v_max_u32 v14, v14, v119
    v_cmp_eq_u32 vcc, -1, v14
    v_mfma_f32_32x32x16_bf16 v[56:71], a[180:183], v[112:115], v[56:71]
    s_add_u32 s32, s76, 131072
    buffer_load_dwordx4 v[112:115], v2, s[12:15], s32 offen offset:0 sc1
    s_cbranch_vccnz L_rt23
L_ok23:
    v_mfma_f32_32x32x16_bf16 v[40:55], a[184:187], v[116:119], v[40:55]
    s_waitcnt vmcnt(8)
    v_max3_u32 v14, v120, v121, v122
    v_max_u32 v14, v14, v123
    v_cmp_eq_u32 vcc, -1, v14
    v_mfma_f32_32x32x16_bf16 v[56:71], a[188:191], v[116:119], v[56:71]
    buffer_load_dwordx4 v[116:119], v2, s[12:15], s32 offen offset:1024 sc1
    s_cbranch_vccnz L_rt24
L_ok24:
    v_mfma_f32_32x32x16_bf16 v[40:55], a[192:195], v[120:123], v[40:55]
    s_waitcnt vmcnt(8)
    v_max3_u32 v14, v124, v125, v126
    v_max_u32 v14, v14, v127
    v_cmp_eq_u32 vcc, -1, v14
    v_mfma_f32_32x32x16_bf16 v[56:71], a[196:199], v[120:123], v[56:71]
    buffer_load_dwordx4 v[120:123], v2, s[12:15], s32 offen offset:2048 sc1
    s_cbranch_vccnz L_rt25
L_ok25:
    v_mfma_f32_32x32x16_bf16 v[40:55], a[200:203], v[124:127], v[40:55]
    s_waitcnt vmcnt(8)
    v_max3_u32 v14, v128, v129, v130
    v_max_u32 v14, v14, v131
    v_cmp_eq_u32 vcc, -1, v14
    v_mfma_f32_32x32x16_bf16 v[56:71], a[204:207], v[124:127], v[56:71]
    buffer_load_dwordx4 v[124:127], v2, s[12:15], s32 offen offset:3072 sc1
    s_cbranch_vccnz L_rt26
L_ok26:
    v_mfma_f32_32x32x16_bf16 v[40:55], a[208:211], v[128:131], v[40:55]
    s_waitcnt vmcnt(8)
    v_max3_u32 v14, v132, v133, v134
    v_max_u32 v14, v14, v135
    v_cmp_eq_u32 vcc, -1, v14
    v_mfma_f32_32x32x16_bf16 v[56:71], a[212:215], v[128:131], v[56:71]
    s_add_u32 s32, s76, 147456
    buffer_load_dwordx4 v[128:131], v2, s[12:15], s32 offen offset:0 sc1
    s_cbranch_vccnz L_rt27
L_ok27:
    v_mfma_f32_32x32x16_bf16 v[40:55], a[216:219], v[132:135], v[40:55]
    s_waitcnt vmcnt(8)
    v_max3_u32 v14, v136, v137, v138
    v_max_u32 v14, v14, v139
    v_cmp_eq_u32 vcc, -1, v14
    v_mfma_f32_32x32x16_bf16 v[56:71], a[220:223], v[132:135], v[56:71]
    buffer_load_dwordx4 v[132:135], v2, s[12:15], s32 offen offset:1024 sc1
    s_cbranch_vccnz L_rt28
L_ok28:
    v_mfma_f32_32x32x16_bf16 v[40:55], a[224:227], v[136:139], v[40:55]
    s_waitcnt vmcnt(8)
    v_max3_u32 v14, v4, v5, v6
    v_max_u32 v14, v14, v7
    v_cmp_eq_u32 vcc, -1, v14
    v_mfma_f32_32x32x16_bf16 v[56:71], a[228:231], v[136:139], v[56:71]
    buffer_load_dwordx4 v[136:139], v2, s[12:15], s32 offen offset:2048 sc1
    s_cbranch_vccnz L_rt29
L_ok29:
    v_mfma_f32_32x32x16_bf16 v[40:55], a[232:235], v[4:7], v[40:55]
    s_waitcnt vmcnt(8)
    v_max3_u32 v14, v104, v105, v106
    v_max_u32 v14, v14, v107
    v_cmp_eq_u32 vcc, -1, v14
    v_mfma_f32_32x32x16_bf16 v[56:71], a[236:239], v[4:7], v[56:71]
    buffer_load_dwordx4 v[4:7], v2, s[12:15], s32 offen offset:3072 sc1
    s_cbranch_vccnz L_rt30
L_ok30:
    v_mfma_f32_32x32x16_bf16 v[40:55], a[240:243], v[104:107], v[40:55]
    s_waitcnt vmcnt(8)
    v_max3_u32 v14, v108, v109, v110
    v_max_u32 v14, v14, v111
    v_cmp_eq_u32 vcc, -1, v14
    v_mfma_f32_32x32x16_bf16 v[56:71], a[244:247], v[104:107], v[56:71]
    s_add_u32 s32, s76, 163840
    buffer_load_dwordx4 v[104:107], v2, s[12:15], s32 offen offset:0 sc1
    s_cbranch_vccnz L_rt31
L_ok31:
    v_mfma_f32_32x32x16_bf16 v[40:55], a[248:251], v[108:111], v[40:55]
    s_waitcnt vmcnt(8)
    v_max3_u32 v14, v112, v113, v114
    v_max_u32 v14, v14, v115
    v_cmp_eq_u32 vcc, -1, v14
    v_mfma_f32_32x32x16_bf16 v[56:71], a[252:255], v[108:111], v[56:71]
    buffer_load_dwordx4 v[108:111], v2, s[12:15], s32 offen offset:1024 sc1
    s_cbranch_vccnz L_rt32
L_ok32:
    v_mfma_f32_32x32x16_bf16 v[72:87], a[0:3], v[112:115], v[72:87]
    s_waitcnt vmcnt(8)
    v_max3_u32 v14, v116, v117, v118
    v_max_u32 v14, v14, v119
    v_cmp_eq_u32 vcc, -1, v14
    v_mfma_f32_32x32x16_bf16 v[88:103], a[4:7], v[112:115], 0
    buffer_load_dwordx4 v[112:115], v2, s[12:15], s32 offen offset:2048 sc1
    s_cbranch_vccnz L_rt33
L_ok33:
    v_mfma_f32_32x32x16_bf16 v[72:87], a[8:11], v[116:119], v[72:87]
    ds_write_b128 v15, v[48:51]
    s_waitcnt vmcnt(8)
    v_max3_u32 v14, v120, v121, v122
    v_max_u32 v14, v14, v123
    v_cmp_eq_u32 vcc, -1, v14
    v_mfma_f32_32x32x16_bf16 v[88:103], a[12:15], v[116:119], v[88:103]
    buffer_load_dwordx4 v[116:119], v2, s[12:15], s32 offen offset:3072 sc1
    ds_write_b128 v15, v[52:55] offset:1024
    s_cbranch_vccnz L_rt34
L_ok34:
    v_mfma_f32_32x32x16_bf16 v[72:87], a[16:19], v[120:123], v[72:87]
    ds_write_b128 v16, v[56:59]
    s_waitcnt vmcnt(8)
    v_max3_u32 v14, v124, v125, v126
    v_max_u32 v14, v14, v127
    v_cmp_eq_u32 vcc, -1, v14
    v_mfma_f32_32x32x16_bf16 v[88:103], a[20:23], v[120:123], v[88:103]
    s_add_u32 s32, s76, 180224
    buffer_load_dwordx4 v[120:123], v2, s[12:15], s32 offen offset:0 sc1
    ds_write_b128 v16, v[60:63] offset:1024
    s_cbranch_vccnz L_rt35
L_ok35:
    v_mfma_f32_32x32x16_bf16 v[72:87], a[24:27], v[124:127], v[72:87]
    ds_write_b128 v17, v[64:67]
    s_waitcnt vmcnt(8)
    v_max3_u32 v14, v128, v129, v130
    v_max_u32 v14, v14, v131
    v_cmp_eq_u32 vcc, -1, v14
    v_mfma_f32_32x32x16_bf16 v[88:103], a[28:31], v[124:127], v[88:103]
    buffer_load_dwordx4 v[124:127], v2, s[12:15], s32 offen offset:1024 sc1
    ds_write_b128 v17, v[68:71] offset:1024
    s_cbranch_vccnz L_rt36
L_ok36:
    v_mfma_f32_32x32x16_bf16 v[72:87], a[32:35], v[128:131], v[72:87]
    s_waitcnt vmcnt(8)
    v_max3_u32 v14, v132, v133, v134
    v_max_u32 v14, v14, v135
    v_cmp_eq_u32 vcc, -1, v14
    v_mfma_f32_32x32x16_bf16 v[88:103], a[36:39], v[128:131], v[88:103]
    buffer_load_dwordx4 v[128:131], v2, s[12:15], s32 offen offset:2048 sc1
    s_waitcnt lgkmcnt(0)
    s_barrier
    ds_read_b128 v[48:51], v18 offset:0
    s_cbranch_vccnz L_rt37
L_ok37:
    v_mfma_f32_32x32x16_bf16 v[72:87], a[40:43], v[132:135], v[72:87]
    ds_read_b128 v[52:55], v18 offset:1024
    ds_read_b128 v[56:59], v18 offset:2048
    s_waitcnt vmcnt(8)
    v_max3_u32 v14, v136, v137, v138
    v_max_u32 v14, v14, v139
    v_cmp_eq_u32 vcc, -1, v14
    v_mfma_f32_32x32x16_bf16 v[88:103], a[44:47], v[132:135], v[88:103]
    buffer_load_dwordx4 v[132:135], v2, s[12:15], s32 offen offset:3072 sc1
    ds_read_b128 v[60:63], v18 offset:3072
    ds_read_b128 v[64:67], v18 offset:4096
    s_cbranch_vccnz L_rt38
L_ok38:
    v_mfma_f32_32x32x16_bf16 v[72:87], a[48:51], v[136:139], v[72:87]
    ds_read_b128 v[68:71], v18 offset:5120
    s_waitcnt vmcnt(8)
    v_max3_u32 v14, v4, v5, v6
    v_max_u32 v14, v14, v7
    v_cmp_eq_u32 vcc, -1, v14
    v_mfma_f32_32x32x16_bf16 v[88:103], a[52:55], v[136:139], v[88:103]
    s_add_u32 s32, s76, 196608
    buffer_load_dwordx4 v[136:139], v2, s[12:15], s32 offen offset:0 sc1
    s_waitcnt lgkmcnt(0)
    v_pk_add_f32 v[48:49], v[48:49], v[56:57]
    v_pk_add_f32 v[50:51], v[50:51], v[58:59]
    v_pk_add_f32 v[52:53], v[52:53], v[60:61]
    v_pk_add_f32 v[54:55], v[54:55], v[62:63]
    v_pk_add_f32 v[40:41], v[40:41], v[64:65]
    v_pk_add_f32 v[42:43], v[42:43], v[66:67]
    v_pk_add_f32 v[44:45], v[44:45], v[68:69]
    v_pk_add_f32 v[46:47], v[46:47], v[70:71]
    v_pk_add_f32 v[40:41], v[40:41], v[48:49]
    v_pk_add_f32 v[42:43], v[42:43], v[50:51]
    v_pk_add_f32 v[44:45], v[44:45], v[52:53]
    v_pk_add_f32 v[46:47], v[46:47], v[54:55]
    v_pk_mul_f32 v[48:49], v[40:41], v[40:41]
    v_pk_mul_f32 v[50:51], v[42:43], v[42:43]
    v_pk_mul_f32 v[52:53], v[44:45], v[44:45]
    v_pk_mul_f32 v[54:55], v[46:47], v[46:47]
    v_pk_fma_f32 v[48:49], v[48:49], v[156:157], v[156:157] op_sel:[0,0,1] op_sel_hi:[1,0,1]
    v_pk_fma_f32 v[50:51], v[50:51], v[156:157], v[156:157] op_sel:[0,0,1] op_sel_hi:[1,0,1]
    v_pk_fma_f32 v[52:53], v[52:53], v[156:157], v[156:157] op_sel:[0,0,1] op_sel_hi:[1,0,1]
    v_pk_fma_f32 v[54:55], v[54:55], v[156:157], v[156:157] op_sel:[0,0,1] op_sel_hi:[1,0,1]
    v_pk_mul_f32 v[48:49], v[48:49], v[40:41]
    v_pk_mul_f32 v[50:51], v[50:51], v[42:43]
    v_pk_mul_f32 v[52:53], v[52:53], v[44:45]
    v_pk_mul_f32 v[54:55], v[54:55], v[46:47]
    v_exp_f32 v48, v48
    v_exp_f32 v49, v49
    v_exp_f32 v50, v50
    v_exp_f32 v51, v51
    v_exp_f32 v52, v52
    v_exp_f32 v53, v53
    v_exp_f32 v54, v54
    v_exp_f32 v55, v55
    v_pk_add_f32 v[48:49], v[48:49], 1.0 op_sel_hi:[1,0]
    v_pk_add_f32 v[50:51], v[50:51], 1.0 op_sel_hi:[1,0]
    v_pk_add_f32 v[52:53], v[52:53], 1.0 op_sel_hi:[1,0]
    v_pk_add_f32 v[54:55], v[54:55], 1.0 op_sel_hi:[1,0]
    v_rcp_f32 v48, v48
    v_rcp_f32 v49, v49
    v_rcp_f32 v50, v50
    v_rcp_f32 v51, v51
    v_rcp_f32 v52, v52
    v_rcp_f32 v53, v53
    v_rcp_f32 v54, v54
    v_rcp_f32 v55, v55
    v_pk_mul_f32 v[40:41], v[48:49], v[40:41]
    v_pk_mul_f32 v[42:43], v[50:51], v[42:43]
    v_pk_mul_f32 v[44:45], v[52:53], v[44:45]
    v_pk_mul_f32 v[46:47], v[54:55], v[46:47]
    v_cvt_pk_bf16_f32 v56, v40, v41
    v_cvt_pk_bf16_f32 v57, v42, v43
    v_cvt_pk_bf16_f32 v58, v44, v45
    v_cvt_pk_bf16_f32 v59, v46, v47
    v_min_u32 v56, -2, v56
    v_min_u32 v57, -2, v57
    v_min_u32 v58, -2, v58
    v_min_u32 v59, -2, v59
    buffer_store_dwordx4 v[56:59], v2, s[12:15], s74 offen sc1
    s_barrier
    s_cbranch_vccnz L_rt39
L_ok39:
    v_mfma_f32_32x32x16_bf16 v[72:87], a[56:59], v[4:7], v[72:87]
    s_waitcnt vmcnt(9)
    v_max3_u32 v14, v104, v105, v106
    v_max_u32 v14, v14, v107
    v_cmp_eq_u32 vcc, -1, v14
    v_mfma_f32_32x32x16_bf16 v[88:103], a[60:63], v[4:7], v[88:103]
    buffer_load_dwordx4 v[4:7], v2, s[12:15], s32 offen offset:1024 sc1
    s_cbranch_vccnz L_rt40
L_ok40:
    v_mfma_f32_32x32x16_bf16 v[72:87], a[64:67], v[104:107], v[72:87]
    s_waitcnt vmcnt(9)
    v_max3_u32 v14, v108, v109, v110
    v_max_u32 v14, v14, v111
    v_cmp_eq_u32 vcc, -1, v14
    v_mfma_f32_32x32x16_bf16 v[88:103], a[68:71], v[104:107], v[88:103]
    buffer_load_dwordx4 v[104:107], v2, s[12:15], s32 offen offset:2048 sc1
    s_cbranch_vccnz L_rt41
L_ok41:
    v_mfma_f32_32x32x16_bf16 v[72:87], a[72:75], v[108:111], v[72:87]
    s_waitcnt vmcnt(9)
    v_max3_u32 v14, v112, v113, v114
    v_max_u32 v14, v14, v115
    v_cmp_eq_u32 vcc, -1, v14
    v_mfma_f32_32x32x16_bf16 v[88:103], a[76:79], v[108:111], v[88:103]
    buffer_load_dwordx4 v[108:111], v2, s[12:15], s32 offen offset:3072 sc1
    s_cbranch_vccnz L_rt42
L_ok42:
    v_mfma_f32_32x32x16_bf16 v[72:87], a[80:83], v[112:115], v[72:87]
    s_waitcnt vmcnt(9)
    v_max3_u32 v14, v116, v117, v118
    v_max_u32 v14, v14, v119
    v_cmp_eq_u32 vcc, -1, v14
    v_mfma_f32_32x32x16_bf16 v[88:103], a[84:87], v[112:115], v[88:103]
    s_add_u32 s32, s76, 212992
    buffer_load_dwordx4 v[112:115], v2, s[12:15], s32 offen offset:0 sc1
    s_cbranch_vccnz L_rt43
L_ok43:
    v_mfma_f32_32x32x16_bf16 v[72:87], a[88:91], v[116:119], v[72:87]
    s_waitcnt vmcnt(9)
    v_max3_u32 v14, v120, v121, v122
    v_max_u32 v14, v14, v123
    v_cmp_eq_u32 vcc, -1, v14
    v_mfma_f32_32x32x16_bf16 v[88:103], a[92:95], v[116:119], v[88:103]
    buffer_load_dwordx4 v[116:119], v2, s[12:15], s32 offen offset:1024 sc1
    s_cbranch_vccnz L_rt44
L_ok44:
    v_mfma_f32_32x32x16_bf16 v[72:87], a[96:99], v[120:123], v[72:87]
    s_waitcnt vmcnt(9)
    v_max3_u32 v14, v124, v125, v126
    v_max_u32 v14, v14, v127
    v_cmp_eq_u32 vcc, -1, v14
    v_mfma_f32_32x32x16_bf16 v[88:103], a[100:103], v[120:123], v[88:103]
    buffer_load_dwordx4 v[120:123], v2, s[12:15], s32 offen offset:2048 sc1
    s_cbranch_vccnz L_rt45
L_ok45:
    v_mfma_f32_32x32x16_bf16 v[72:87], a[104:107], v[124:127], v[72:87]
    s_waitcnt vmcnt(9)
    v_max3_u32 v14, v128, v129, v130
    v_max_u32 v14, v14, v131
    v_cmp_eq_u32 vcc, -1, v14
    v_mfma_f32_32x32x16_bf16 v[88:103], a[108:111], v[124:127], v[88:103]
    buffer_load_dwordx4 v[124:127], v2, s[12:15], s32 offen offset:3072 sc1
    s_cbranch_vccnz L_rt46
L_ok46:
    v_mfma_f32_32x32x16_bf16 v[72:87], a[112:115], v[128:131], v[72:87]
    s_waitcnt vmcnt(9)
    v_max3_u32 v14, v132, v133, v134
    v_max_u32 v14, v14, v135
    v_cmp_eq_u32 vcc, -1, v14
    v_mfma_f32_32x32x16_bf16 v[88:103], a[116:119], v[128:131], v[88:103]
    s_add_u32 s32, s76, 229376
    buffer_load_dwordx4 v[128:131], v2, s[12:15], s32 offen offset:0 sc1
    s_cbranch_vccnz L_rt47
L_ok47:
    v_mfma_f32_32x32x16_bf16 v[72:87], a[120:123], v[132:135], v[72:87]
    s_waitcnt vmcnt(9)
    v_max3_u32 v14, v136, v137, v138
    v_max_u32 v14, v14, v139
    v_cmp_eq_u32 vcc, -1, v14
    v_mfma_f32_32x32x16_bf16 v[88:103], a[124:127], v[132:135], v[88:103]
    buffer_load_dwordx4 v[132:135], v2, s[12:15], s32 offen offset:1024 sc1
    s_cbranch_vccnz L_rt48
L_ok48:
    v_mfma_f32_32x32x16_bf16 v[72:87], a[128:131], v[136:139], v[72:87]
    s_waitcnt vmcnt(8)
    v_max3_u32 v14, v4, v5, v6
    v_max_u32 v14, v14, v7
    v_cmp_eq_u32 vcc, -1, v14
    v_mfma_f32_32x32x16_bf16 v[88:103], a[132:135], v[136:139], v[88:103]
    buffer_load_dwordx4 v[136:139], v2, s[12:15], s32 offen offset:2048 sc1
    s_cbranch_vccnz L_rt49
L_ok49:
    v_mfma_f32_32x32x16_bf16 v[72:87], a[136:139], v[4:7], v[72:87]
    s_waitcnt vmcnt(8)
    v_max3_u32 v14, v104, v105, v106
    v_max_u32 v14, v14, v107
    v_cmp_eq_u32 vcc, -1, v14
    v_mfma_f32_32x32x16_bf16 v[88:103], a[140:143], v[4:7], v[88:103]
    buffer_load_dwordx4 v[4:7], v2, s[12:15], s32 offen offset:3072 sc1
    s_cbranch_vccnz L_rt50
L_ok50:
    v_mfma_f32_32x32x16_bf16 v[72:87], a[144:147], v[104:107], v[72:87]
    s_waitcnt vmcnt(8)
    v_max3_u32 v14, v108, v109, v110
    v_max_u32 v14, v14, v111
    v_cmp_eq_u32 vcc, -1, v14
    v_mfma_f32_32x32x16_bf16 v[88:103], a[148:151], v[104:107], v[88:103]
    s_add_u32 s32, s76, 245760
    buffer_load_dwordx4 v[104:107], v2, s[12:15], s32 offen offset:0 sc1
    s_cbranch_vccnz L_rt51
L_ok51:
    v_mfma_f32_32x32x16_bf16 v[72:87], a[152:155], v[108:111], v[72:87]
    s_waitcnt vmcnt(8)
    v_max3_u32 v14, v112, v113, v114
    v_max_u32 v14, v14, v115
    v_cmp_eq_u32 vcc, -1, v14
    v_mfma_f32_32x32x16_bf16 v[88:103], a[156:159], v[108:111], v[88:103]
    buffer_load_dwordx4 v[108:111], v2, s[12:15], s32 offen offset:1024 sc1
    s_cbranch_vccnz L_rt52
L_ok52:
    v_mfma_f32_32x32x16_bf16 v[72:87], a[160:163], v[112:115], v[72:87]
    s_waitcnt vmcnt(8)
    v_max3_u32 v14, v116, v117, v118
    v_max_u32 v14, v14, v119
    v_cmp_eq_u32 vcc, -1, v14
    v_mfma_f32_32x32x16_bf16 v[88:103], a[164:167], v[112:115], v[88:103]
    buffer_load_dwordx4 v[112:115], v2, s[12:15], s32 offen offset:2048 sc1
    s_cbranch_vccnz L_rt53
L_ok53:
    v_mfma_f32_32x32x16_bf16 v[72:87], a[168:171], v[116:119], v[72:87]
    s_waitcnt vmcnt(8)
    v_max3_u32 v14, v120, v121, v122
    v_max_u32 v14, v14, v123
    v_cmp_eq_u32 vcc, -1, v14
    v_mfma_f32_32x32x16_bf16 v[88:103], a[172:175], v[116:119], v[88:103]
    buffer_load_dwordx4 v[116:119], v2, s[12:15], s32 offen offset:3072 sc1
    s_cbranch_vccnz L_rt54
L_ok54:
    v_mfma_f32_32x32x16_bf16 v[72:87], a[176:179], v[120:123], v[72:87]
L_pad_Q_6:
    s_cbranch_execz L_ret_Q_6
    s_waitcnt vmcnt(8)
    v_max3_u32 v14, v124, v125, v126
    v_max_u32 v14, v14, v127
    v_cmp_eq_u32 vcc, -1, v14
    v_mfma_f32_32x32x16_bf16 v[88:103], a[180:183], v[120:123], v[88:103]
    s_add_u32 s32, s77, 0
    buffer_load_dwordx4 v[120:123], v19, s[12:15], s32 offen offset:0 sc1
    s_cbranch_vccnz L_rt55
L_ok55:
    v_mfma_f32_32x32x16_bf16 v[72:87], a[184:187], v[124:127], v[72:87]
    s_waitcnt vmcnt(8)
    v_max3_u32 v14, v128, v129, v130
    v_max_u32 v14, v14, v131
    v_cmp_eq_u32 vcc, -1, v14
    v_mfma_f32_32x32x16_bf16 v[88:103], a[188:191], v[124:127], v[88:103]
    buffer_load_dwordx4 v[124:127], v19, s[12:15], s32 offen offset:1024 sc1
    s_cbranch_vccnz L_rt56
L_ok56:
    v_mfma_f32_32x32x16_bf16 v[72:87], a[192:195], v[128:131], v[72:87]
    s_waitcnt vmcnt(8)
    v_max3_u32 v14, v132, v133, v134
    v_max_u32 v14, v14, v135
    v_cmp_eq_u32 vcc, -1, v14
    v_mfma_f32_32x32x16_bf16 v[88:103], a[196:199], v[128:131], v[88:103]
    buffer_load_dwordx4 v[128:131], v19, s[12:15], s32 offen offset:2048 sc1
    s_cbranch_vccnz L_rt57
L_ok57:
    v_mfma_f32_32x32x16_bf16 v[72:87], a[200:203], v[132:135], v[72:87]
    s_waitcnt vmcnt(8)
    v_max3_u32 v14, v136, v137, v138
    v_max_u32 v14, v14, v139
    v_cmp_eq_u32 vcc, -1, v14
    v_mfma_f32_32x32x16_bf16 v[88:103], a[204:207], v[132:135], v[88:103]
    buffer_load_dwordx4 v[132:135], v19, s[12:15], s32 offen offset:3072 sc1
    s_cbranch_vccnz L_rt58
L_ok58:
    v_mfma_f32_32x32x16_bf16 v[72:87], a[208:211], v[136:139], v[72:87]
    s_waitcnt vmcnt(8)
    v_max3_u32 v14, v4, v5, v6
    v_max_u32 v14, v14, v7
    v_cmp_eq_u32 vcc, -1, v14
    v_mfma_f32_32x32x16_bf16 v[88:103], a[212:215], v[136:139], v[88:103]
    s_add_u32 s32, s77, 16384
    buffer_load_dwordx4 v[136:139], v19, s[12:15], s32 offen offset:0 sc1
    s_cbranch_vccnz L_rt59
L_ok59:
    v_mfma_f32_32x32x16_bf16 v[72:87], a[216:219], v[4:7], v[72:87]
    s_waitcnt vmcnt(8)
    v_max3_u32 v14, v104, v105, v106
    v_max_u32 v14, v14, v107
    v_cmp_eq_u32 vcc, -1, v14
    v_mfma_f32_32x32x16_bf16 v[88:103], a[220:223], v[4:7], v[88:103]
    buffer_load_dwordx4 v[4:7], v19, s[12:15], s32 offen offset:1024 sc1
    s_cbranch_vccnz L_rt60
L_ok60:
    v_mfma_f32_32x32x16_bf16 v[72:87], a[224:227], v[104:107], v[72:87]
    s_waitcnt vmcnt(8)
    v_max3_u32 v14, v108, v109, v110
    v_max_u32 v14, v14, v111
    v_cmp_eq_u32 vcc, -1, v14
    v_mfma_f32_32x32x16_bf16 v[88:103], a[228:231], v[104:107], v[88:103]
    buffer_load_dwordx4 v[104:107], v19, s[12:15], s32 offen offset:2048 sc1
    s_cbranch_vccnz L_rt61
L_ok61:
    v_mfma_f32_32x32x16_bf16 v[72:87], a[232:235], v[108:111], v[72:87]
    s_waitcnt vmcnt(8)
    v_max3_u32 v14, v112, v113, v114
    v_max_u32 v14, v14, v115
    v_cmp_eq_u32 vcc, -1, v14
    v_mfma_f32_32x32x16_bf16 v[88:103], a[236:239], v[108:111], v[88:103]
    buffer_load_dwordx4 v[108:111], v19, s[12:15], s32 offen offset:3072 sc1
    s_cbranch_vccnz L_rt62
L_ok62:
    v_mfma_f32_32x32x16_bf16 v[72:87], a[240:243], v[112:115], v[72:87]
    ds_read_b64_tr_b16 v[140:141], v21 offset:0
    ds_read_b64_tr_b16 v[142:143], v21 offset:1024
    s_waitcnt vmcnt(8)
    v_max3_u32 v14, v116, v117, v118
    v_max_u32 v14, v14, v119
    v_cmp_eq_u32 vcc, -1, v14
    v_mfma_f32_32x32x16_bf16 v[88:103], a[244:247], v[112:115], v[88:103]
    s_add_u32 s32, s77, 32768
    buffer_load_dwordx4 v[112:115], v19, s[12:15], s32 offen offset:0 sc1
    ds_read_b64_tr_b16 v[144:145], v22 offset:0
    ds_read_b64_tr_b16 v[146:147], v22 offset:1024
    s_cbranch_vccnz L_rt63
L_ok63:
    v_mfma_f32_32x32x16_bf16 v[72:87], a[248:251], v[116:119], v[72:87]
    ds_read_b64_tr_b16 v[148:149], v21 offset:2048
    ds_read_b64_tr_b16 v[150:151], v21 offset:3072
    v_mfma_f32_32x32x16_bf16 v[88:103], a[252:255], v[116:119], v[88:103]
    buffer_load_dwordx4 v[116:119], v19, s[12:15], s32 offen offset:1024 sc1
    ds_read_b64_tr_b16 v[152:153], v22 offset:2048
    ds_read_b64_tr_b16 v[154:155], v22 offset:3072
L_mlp_p2:
    s_waitcnt vmcnt(9)
    v_max3_u32 v14, v120, v121, v122
    v_max_u32 v14, v14, v123
    v_cmp_eq_u32 vcc, -1, v14
    s_nop 3
    s_cbranch_vccnz L_rt64
L_ok64:
    s_waitcnt lgkmcnt(4)
    v_mfma_f32_32x32x16_bf16 v[40:55], v[120:123], v[140:143], 0
    ds_read_b64_tr_b16 v[140:141], v21 offset:4096
    ds_read_b64_tr_b16 v[142:143], v21 offset:5120
    s_waitcnt vmcnt(8)
    v_max3_u32 v14, v124, v125, v126
    v_max_u32 v14, v14, v127
    v_cmp_eq_u32 vcc, -1, v14
    v_mfma_f32_32x32x16_bf16 v[56:71], v[120:123], v[144:147], 0
    buffer_load_dwordx4 v[120:123], v19, s[12:15], s32 offen offset:2048 sc1
    ds_read_b64_tr_b16 v[144:145], v22 offset:4096
    ds_read_b64_tr_b16 v[146:147], v22 offset:5120
    s_cbranch_vccnz L_rt65
L_ok65:
    s_waitcnt lgkmcnt(4)
    v_mfma_f32_32x32x16_bf16 v[40:55], v[124:127], v[148:151], v[40:55]
    ds_read_b64_tr_b16 v[148:149], v21 offset:6144
    ds_read_b64_tr_b16 v[150:151], v21 offset:7168
    ds_write_b128 v15, v[80:83]
    s_waitcnt vmcnt(8)
    v_max3_u32 v14, v128, v129, v130
    v_max_u32 v14, v14, v131
    v_cmp_eq_u32 vcc, -1, v14
    v_mfma_f32_32x32x16_bf16 v[56:71], v[124:127], v[152:155], v[56:71]
    buffer_load_dwordx4 v[124:127], v19, s[12:15], s32 offen offset:3072 sc1
    ds_read_b64_tr_b16 v[152:153], v22 offset:6144
    ds_read_b64_tr_b16 v[154:155], v22 offset:7168
    ds_write_b128 v15, v[84:87] offset:1024
    s_cbranch_vccnz L_rt66
L_ok66:
    s_waitcnt lgkmcnt(6)
    v_mfma_f32_32x32x16_bf16 v[40:55], v[128:131], v[140:143], v[40:55]
    ds_read_b64_tr_b16 v[140:141], v21 offset:8192
    ds_read_b64_tr_b16 v[142:143], v21 offset:9216
    ds_write_b128 v16, v[88:91]
    s_waitcnt vmcnt(8)
    v_max3_u32 v14, v132, v133, v134
    v_max_u32 v14, v14, v135
    v_cmp_eq_u32 vcc, -1, v14
    v_mfma_f32_32x32x16_bf16 v[56:71], v[128:131], v[144:147], v[56:71]
    s_add_u32 s32, s77, 49152
    buffer_load_dwordx4 v[128:131], v19, s[12:15], s32 offen offset:0 sc1
    ds_read_b64_tr_b16 v[144:145], v22 offset:8192
    ds_read_b64_tr_b16 v[146:147], v22 offset:9216
    ds_write_b128 v16, v[92:95] offset:1024
    s_cbranch_vccnz L_rt67
L_ok67:
    s_waitcnt lgkmcnt(7)
    v_mfma_f32_32x32x16_bf16 v[40:55], v[132:135], v[148:151], v[40:55]
    ds_read_b64_tr_b16 v[148:149], v21 offset:10240
    ds_read_b64_tr_b16 v[150:151], v21 offset:11264
    ds_write_b128 v17, v[96:99]
    s_waitcnt vmcnt(8)
    v_max3_u32 v14, v136, v137, v138
    v_max_u32 v14, v14, v139
    v_cmp_eq_u32 vcc, -1, v14
    v_mfma_f32_32x32x16_bf16 v[56:71], v[132:135], v[152:155], v[56:71]
    buffer_load_dwordx4 v[132:135], v19, s[12:15], s32 offen offset:1024 sc1
    ds_read_b64_tr_b16 v[152:153], v22 offset:10240
    ds_read_b64_tr_b16 v[154:155], v22 offset:11264
    ds_write_b128 v17, v[100:103] offset:1024
    s_cbranch_vccnz L_rt68
L_ok68:
    s_waitcnt lgkmcnt(7)
    v_mfma_f32_32x32x16_bf16 v[40:55], v[136:139], v[140:143], v[40:55]
    ds_read_b64_tr_b16 v[140:141], v21 offset:12288
    ds_read_b64_tr_b16 v[142:143], v21 offset:13312
    s_waitcnt vmcnt(8)
    v_max3_u32 v14, v4, v5, v6
    v_max_u32 v14, v14, v7
    v_cmp_eq_u32 vcc, -1, v14
    v_mfma_f32_32x32x16_bf16 v[56:71], v[136:139], v[144:147], v[56:71]
    buffer_load_dwordx4 v[136:139], v19, s[12:15], s32 offen offset:2048 sc1
    ds_read_b64_tr_b16 v[144:145], v22 offset:12288
    ds_read_b64_tr_b16 v[146:147], v22 offset:13312
    s_waitcnt lgkmcnt(4)
    s_barrier
    ds_read_b128 v[80:83], v18 offset:0
    s_cbranch_vccnz L_rt69
L_ok69:
    s_waitcnt lgkmcnt(6)
    v_mfma_f32_32x32x16_bf16 v[40:55], v[4:7], v[148:151], v[40:55]
    ds_read_b64_tr_b16 v[148:149], v21 offset:14336
    ds_read_b64_tr_b16 v[150:151], v21 offset:15360
    ds_read_b128 v[84:87], v18 offset:1024
    ds_read_b128 v[88:91], v18 offset:2048
    s_waitcnt vmcnt(8)
    v_max3_u32 v14, v104, v105, v106
    v_max_u32 v14, v14, v107
    v_cmp_eq_u32 vcc, -1, v14
    v_mfma_f32_32x32x16_bf16 v[56:71], v[4:7], v[152:155], v[56:71]
    buffer_load_dwordx4 v[4:7], v19, s[12:15], s32 offen offset:3072 sc1
    ds_read_b64_tr_b16 v[152:153], v22 offset:14336
    ds_read_b64_tr_b16 v[154:155], v22 offset:15360
    ds_read_b128 v[92:95], v18 offset:3072
    ds_read_b128 v[96:99], v18 offset:4096
    s_cbranch_vccnz L_rt70
L_ok70:
    s_waitcnt lgkmcnt(9)
    v_mfma_f32_32x32x16_bf16 v[40:55], v[104:107], v[140:143], v[40:55]
    ds_read_b64_tr_b16 v[140:141], v21 offset:16384
    ds_read_b64_tr_b16 v[142:143], v21 offset:17408
    ds_read_b128 v[100:103], v18 offset:5120
    s_waitcnt vmcnt(8)
    v_max3_u32 v14, v108, v109, v110
    v_max_u32 v14, v14, v111
    v_cmp_eq_u32 vcc, -1, v14
    v_mfma_f32_32x32x16_bf16 v[56:71], v[104:107], v[144:147], v[56:71]
    s_add_u32 s32, s77, 65536
    buffer_load_dwordx4 v[104:107], v19, s[12:15], s32 offen offset:0 sc1
    ds_read_b64_tr_b16 v[144:145], v22 offset:16384
    ds_read_b64_tr_b16 v[146:147], v22 offset:17408
    s_waitcnt lgkmcnt(2)
    v_pk_add_f32 v[80:81], v[80:81], v[88:89]
    v_pk_add_f32 v[82:83], v[82:83], v[90:91]
    v_pk_add_f32 v[84:85], v[84:85], v[92:93]
    v_pk_add_f32 v[86:87], v[86:87], v[94:95]
    v_pk_add_f32 v[72:73], v[72:73], v[96:97]
    v_pk_add_f32 v[74:75], v[74:75], v[98:99]
    v_pk_add_f32 v[76:77], v[76:77], v[100:101]
    v_pk_add_f32 v[78:79], v[78:79], v[102:103]
    v_pk_add_f32 v[72:73], v[72:73], v[80:81]
    v_pk_add_f32 v[74:75], v[74:75], v[82:83]
    v_pk_add_f32 v[76:77], v[76:77], v[84:85]
    v_pk_add_f32 v[78:79], v[78:79], v[86:87]
    v_pk_mul_f32 v[80:81], v[72:73], v[72:73]
    v_pk_mul_f32 v[82:83], v[74:75], v[74:75]
    v_pk_mul_f32 v[84:85], v[76:77], v[76:77]
    v_pk_mul_f32 v[86:87], v[78:79], v[78:79]
    v_pk_fma_f32 v[80:81], v[80:81], v[156:157], v[156:157] op_sel:[0,0,1] op_sel_hi:[1,0,1]
    v_pk_fma_f32 v[82:83], v[82:83], v[156:157], v[156:157] op_sel:[0,0,1] op_sel_hi:[1,0,1]
    v_pk_fma_f32 v[84:85], v[84:85], v[156:157], v[156:157] op_sel:[0,0,1] op_sel_hi:[1,0,1]
    v_pk_fma_f32 v[86:87], v[86:87], v[156:157], v[156:157] op_sel:[0,0,1] op_sel_hi:[1,0,1]
    v_pk_mul_f32 v[80:81], v[80:81], v[72:73]
    v_pk_mul_f32 v[82:83], v[82:83], v[74:75]
    v_pk_mul_f32 v[84:85], v[84:85], v[76:77]
    v_pk_mul_f32 v[86:87], v[86:87], v[78:79]
    v_exp_f32 v80, v80
    v_exp_f32 v81, v81
    v_exp_f32 v82, v82
    v_exp_f32 v83, v83
    v_exp_f32 v84, v84
    v_exp_f32 v85, v85
    v_exp_f32 v86, v86
    v_exp_f32 v87, v87
    v_pk_add_f32 v[80:81], v[80:81], 1.0 op_sel_hi:[1,0]
    v_pk_add_f32 v[82:83], v[82:83], 1.0 op_sel_hi:[1,0]
    v_pk_add_f32 v[84:85], v[84:85], 1.0 op_sel_hi:[1,0]
    v_pk_add_f32 v[86:87], v[86:87], 1.0 op_sel_hi:[1,0]
    v_rcp_f32 v80, v80
    v_rcp_f32 v81, v81
    v_rcp_f32 v82, v82
    v_rcp_f32 v83, v83
    v_rcp_f32 v84, v84
    v_rcp_f32 v85, v85
    v_rcp_f32 v86, v86
    v_rcp_f32 v87, v87
    v_pk_mul_f32 v[72:73], v[80:81], v[72:73]
    v_pk_mul_f32 v[74:75], v[82:83], v[74:75]
    v_pk_mul_f32 v[76:77], v[84:85], v[76:77]
    v_pk_mul_f32 v[78:79], v[86:87], v[78:79]
    v_cvt_pk_bf16_f32 v88, v72, v73
    v_cvt_pk_bf16_f32 v89, v74, v75
    v_cvt_pk_bf16_f32 v90, v76, v77
    v_cvt_pk_bf16_f32 v91, v78, v79
    v_min_u32 v88, -2, v88
    v_min_u32 v89, -2, v89
    v_min_u32 v90, -2, v90
    v_min_u32 v91, -2, v91
    buffer_store_dwordx4 v[88:91], v2, s[12:15], s75 offen sc1
    s_barrier
    s_cbranch_vccnz L_rt71
L_ok71:
    s_waitcnt lgkmcnt(7)
    v_mfma_f32_32x32x16_bf16 v[40:55], v[108:111], v[148:151], v[40:55]
    ds_read_b64_tr_b16 v[148:149], v21 offset:18432
    ds_read_b64_tr_b16 v[150:151], v21 offset:19456
    s_waitcnt vmcnt(9)
    v_max3_u32 v14, v112, v113, v114
    v_max_u32 v14, v14, v115
    v_cmp_eq_u32 vcc, -1, v14
    v_mfma_f32_32x32x16_bf16 v[56:71], v[108:111], v[152:155], v[56:71]
    buffer_load_dwordx4 v[108:111], v19, s[12:15], s32 offen offset:1024 sc1
    ds_read_b64_tr_b16 v[152:153], v22 offset:18432
    ds_read_b64_tr_b16 v[154:155], v22 offset:19456
    s_cbranch_vccnz L_rt72
L_ok72:
    s_waitcnt lgkmcnt(4)
    v_mfma_f32_32x32x16_bf16 v[40:55], v[112:115], v[140:143], v[40:55]
    ds_read_b64_tr_b16 v[140:141], v21 offset:20480
    ds_read_b64_tr_b16 v[142:143], v21 offset:21504
    s_waitcnt vmcnt(9)
    v_max3_u32 v14, v116, v117, v118
    v_max_u32 v14, v14, v119
    v_cmp_eq_u32 vcc, -1, v14
    v_mfma_f32_32x32x16_bf16 v[56:71], v[112:115], v[144:147], v[56:71]
    buffer_load_dwordx4 v[112:115], v19, s[12:15], s32 offen offset:2048 sc1
    ds_read_b64_tr_b16 v[144:145], v22 offset:20480
    ds_read_b64_tr_b16 v[146:147], v22 offset:21504
    s_cbranch_vccnz L_rt73
L_ok73:
    s_waitcnt lgkmcnt(4)
    v_mfma_f32_32x32x16_bf16 v[40:55], v[116:119], v[148:151], v[40:55]
    ds_read_b64_tr_b16 v[148:149], v21 offset:22528
    ds_read_b64_tr_b16 v[150:151], v21 offset:23552
    s_waitcnt vmcnt(9)
    v_max3_u32 v14, v120, v121, v122
    v_max_u32 v14, v14, v123
    v_cmp_eq_u32 vcc, -1, v14
    v_mfma_f32_32x32x16_bf16 v[56:71], v[116:119], v[152:155], v[56:71]
    buffer_load_dwordx4 v[116:119], v19, s[12:15], s32 offen offset:3072 sc1
    ds_read_b64_tr_b16 v[152:153], v22 offset:22528
    ds_read_b64_tr_b16 v[154:155], v22 offset:23552
    s_cbranch_vccnz L_rt74
L_ok74:
    s_waitcnt lgkmcnt(4)
    v_mfma_f32_32x32x16_bf16 v[40:55], v[120:123], v[140:143], v[40:55]
    ds_read_b64_tr_b16 v[140:141], v21 offset:24576
    ds_read_b64_tr_b16 v[142:143], v21 offset:25600
    s_waitcnt vmcnt(9)
    v_max3_u32 v14, v124, v125, v126
    v_max_u32 v14, v14, v127
    v_cmp_eq_u32 vcc, -1, v14
    v_mfma_f32_32x32x16_bf16 v[56:71], v[120:123], v[144:147], v[56:71]
    s_add_u32 s32, s77, 81920
    buffer_load_dwordx4 v[120:123], v19, s[12:15], s32 offen offset:0 sc1
    ds_read_b64_tr_b16 v[144:145], v22 offset:24576
    ds_read_b64_tr_b16 v[146:147], v22 offset:25600
    s_cbranch_vccnz L_rt75
L_ok75:
    s_waitcnt lgkmcnt(4)
    v_mfma_f32_32x32x16_bf16 v[40:55], v[124:127], v[148:151], v[40:55]
    ds_read_b64_tr_b16 v[148:149], v21 offset:26624
    ds_read_b64_tr_b16 v[150:151], v21 offset:27648
    s_waitcnt vmcnt(9)
    v_max3_u32 v14, v128, v129, v130
    v_max_u32 v14, v14, v131
    v_cmp_eq_u32 vcc, -1, v14
    v_mfma_f32_32x32x16_bf16 v[56:71], v[124:127], v[152:155], v[56:71]
    buffer_load_dwordx4 v[124:127], v19, s[12:15], s32 offen offset:1024 sc1
    ds_read_b64_tr_b16 v[152:153], v22 offset:26624
    ds_read_b64_tr_b16 v[154:155], v22 offset:27648
    s_cbranch_vccnz L_rt76
L_ok76:
    s_waitcnt lgkmcnt(4)
    v_mfma_f32_32x32x16_bf16 v[40:55], v[128:131], v[140:143], v[40:55]
    ds_read_b64_tr_b16 v[140:141], v21 offset:28672
    ds_read_b64_tr_b16 v[142:143], v21 offset:29696
    s_waitcnt vmcnt(9)
    v_max3_u32 v14, v132, v133, v134
    v_max_u32 v14, v14, v135
    v_cmp_eq_u32 vcc, -1, v14
    v_mfma_f32_32x32x16_bf16 v[56:71], v[128:131], v[144:147], v[56:71]
    buffer_load_dwordx4 v[128:131], v19, s[12:15], s32 offen offset:2048 sc1
    ds_read_b64_tr_b16 v[144:145], v22 offset:28672
    ds_read_b64_tr_b16 v[146:147], v22 offset:29696
    s_cbranch_vccnz L_rt77
L_ok77:
    s_waitcnt lgkmcnt(4)
    v_mfma_f32_32x32x16_bf16 v[40:55], v[132:135], v[148:151], v[40:55]
    ds_read_b64_tr_b16 v[148:149], v21 offset:30720
    ds_read_b64_tr_b16 v[150:151], v21 offset:31744
    s_waitcnt vmcnt(9)
    v_max3_u32 v14, v136, v137, v138
    v_max_u32 v14, v14, v139
    v_cmp_eq_u32 vcc, -1, v14
    v_mfma_f32_32x32x16_bf16 v[56:71], v[132:135], v[152:155], v[56:71]
    buffer_load_dwordx4 v[132:135], v19, s[12:15], s32 offen offset:3072 sc1
    ds_read_b64_tr_b16 v[152:153], v22 offset:30720
    ds_read_b64_tr_b16 v[154:155], v22 offset:31744
    s_cbranch_vccnz L_rt78
L_ok78:
    s_waitcnt lgkmcnt(4)
    v_mfma_f32_32x32x16_bf16 v[40:55], v[136:139], v[140:143], v[40:55]
    s_waitcnt vmcnt(9)
    v_max3_u32 v14, v4, v5, v6
    v_max_u32 v14, v14, v7
    v_cmp_eq_u32 vcc, -1, v14
    v_mfma_f32_32x32x16_bf16 v[56:71], v[136:139], v[144:147], v[56:71]
    s_add_u32 s32, s77, 98304
    buffer_load_dwordx4 v[136:139], v19, s[12:15], s32 offen offset:0 sc1
    s_cbranch_vccnz L_rt79
L_ok79:
    s_waitcnt lgkmcnt(0)
    v_mfma_f32_32x32x16_bf16 v[40:55], v[4:7], v[148:151], v[40:55]
    s_waitcnt vmcnt(9)
    v_max3_u32 v14, v104, v105, v106
    v_max_u32 v14, v14, v107
    v_cmp_eq_u32 vcc, -1, v14
    v_mfma_f32_32x32x16_bf16 v[56:71], v[4:7], v[152:155], v[56:71]
    buffer_load_dwordx4 v[4:7], v19, s[12:15], s32 offen offset:1024 sc1
    s_cbranch_vccnz L_rt80
L_ok80:
    v_mfma_f32_32x32x16_bf16 v[40:55], v[104:107], v[160:163], v[40:55]
    s_waitcnt vmcnt(8)
    v_max3_u32 v14, v108, v109, v110
    v_max_u32 v14, v14, v111
    v_cmp_eq_u32 vcc, -1, v14
    v_mfma_f32_32x32x16_bf16 v[56:71], v[104:107], v[164:167], v[56:71]
    buffer_load_dwordx4 v[104:107], v19, s[12:15], s32 offen offset:2048 sc1
    s_cbranch_vccnz L_rt81
L_ok81:
    v_mfma_f32_32x32x16_bf16 v[40:55], v[108:111], v[168:171], v[40:55]
    s_waitcnt vmcnt(8)
    v_max3_u32 v14, v112, v113, v114
    v_max_u32 v14, v14, v115
    v_cmp_eq_u32 vcc, -1, v14
    v_mfma_f32_32x32x16_bf16 v[56:71], v[108:111], v[172:175], v[56:71]
    buffer_load_dwordx4 v[108:111], v19, s[12:15], s32 offen offset:3072 sc1
    s_cbranch_vccnz L_rt82
L_ok82:
    v_mfma_f32_32x32x16_bf16 v[40:55], v[112:115], v[176:179], v[40:55]
    s_waitcnt vmcnt(8)
    v_max3_u32 v14, v116, v117, v118
    v_max_u32 v14, v14, v119
    v_cmp_eq_u32 vcc, -1, v14
    v_mfma_f32_32x32x16_bf16 v[56:71], v[112:115], v[180:183], v[56:71]
    s_add_u32 s32, s77, 114688
    buffer_load_dwordx4 v[112:115], v19, s[12:15], s32 offen offset:0 sc1
    s_cbranch_vccnz L_rt83
L_ok83:
    v_mfma_f32_32x32x16_bf16 v[40:55], v[116:119], v[184:187], v[40:55]
    s_cmp_lg_u32 s19, 0
    s_cbranch_scc1 L_wm_21
    buffer_load_dword v12, v13, s[12:15], s78 offen
    buffer_load_dword v12, v13, s[12:15], s79 offen
    v_and_b32 v11, 0x180, v13
    buffer_load_dword v12, v11, s[12:15], s28 offen
    buffer_load_dword v12, v11, s[12:15], s72 offen
L_wm_21:
    s_waitcnt vmcnt(8)
    v_max3_u32 v14, v120, v121, v122
    v_max_u32 v14, v14, v123
    v_cmp_eq_u32 vcc, -1, v14
    v_mfma_f32_32x32x16_bf16 v[56:71], v[116:119], v[188:191], v[56:71]
    buffer_load_dwordx4 v[116:119], v19, s[12:15], s32 offen offset:1024 sc1
    s_cbranch_vccnz L_rt84
L_ok84:
    v_mfma_f32_32x32x16_bf16 v[40:55], v[120:123], v[192:195], v[40:55]
    s_waitcnt vmcnt(8)
    v_max3_u32 v14, v124, v125, v126
    v_max_u32 v14, v14, v127
    v_cmp_eq_u32 vcc, -1, v14
    v_mfma_f32_32x32x16_bf16 v[56:71], v[120:123], v[196:199], v[56:71]
    buffer_load_dwordx4 v[120:123], v19, s[12:15], s32 offen offset:2048 sc1
    s_cbranch_vccnz L_rt85
L_ok85:
    v_mfma_f32_32x32x16_bf16 v[40:55], v[124:127], v[200:203], v[40:55]
    s_waitcnt vmcnt(8)
    v_max3_u32 v14, v128, v129, v130
    v_max_u32 v14, v14, v131
    v_cmp_eq_u32 vcc, -1, v14
    v_mfma_f32_32x32x16_bf16 v[56:71], v[124:127], v[204:207], v[56:71]
    buffer_load_dwordx4 v[124:127], v19, s[12:15], s32 offen offset:3072 sc1
    s_cbranch_vccnz L_rt86
L_ok86:
    v_mfma_f32_32x32x16_bf16 v[40:55], v[128:131], v[208:211], v[40:55]
    s_waitcnt vmcnt(8)
    v_max3_u32 v14, v132, v133, v134
    v_max_u32 v14, v14, v135
    v_cmp_eq_u32 vcc, -1, v14
    v_mfma_f32_32x32x16_bf16 v[56:71], v[128:131], v[212:215], v[56:71]
    s_add_u32 s32, s77, 131072
    buffer_load_dwordx4 v[128:131], v19, s[12:15], s32 offen offset:0 sc1
    s_cbranch_vccnz L_rt87
L_ok87:
    v_mfma_f32_32x32x16_bf16 v[40:55], v[132:135], v[216:219], v[40:55]
    s_waitcnt vmcnt(8)
    v_max3_u32 v14, v136, v137, v138
    v_max_u32 v14, v14, v139
    v_cmp_eq_u32 vcc, -1, v14
    v_mfma_f32_32x32x16_bf16 v[56:71], v[132:135], v[220:223], v[56:71]
    buffer_load_dwordx4 v[132:135], v19, s[12:15], s32 offen offset:1024 sc1
    s_cbranch_vccnz L_rt88
L_ok88:
    v_mfma_f32_32x32x16_bf16 v[40:55], v[136:139], v[224:227], v[40:55]
    s_waitcnt vmcnt(8)
    v_max3_u32 v14, v4, v5, v6
    v_max_u32 v14, v14, v7
    v_cmp_eq_u32 vcc, -1, v14
    v_mfma_f32_32x32x16_bf16 v[56:71], v[136:139], v[228:231], v[56:71]
    buffer_load_dwordx4 v[136:139], v19, s[12:15], s32 offen offset:2048 sc1
    s_cbranch_vccnz L_rt89
L_ok89:
    v_mfma_f32_32x32x16_bf16 v[40:55], v[4:7], v[232:235], v[40:55]
    s_waitcnt vmcnt(8)
    v_max3_u32 v14, v104, v105, v106
    v_max_u32 v14, v14, v107
    v_cmp_eq_u32 vcc, -1, v14
    v_mfma_f32_32x32x16_bf16 v[56:71], v[4:7], v[236:239], v[56:71]
    buffer_load_dwordx4 v[4:7], v19, s[12:15], s32 offen offset:3072 sc1
    s_cbranch_vccnz L_rt90
L_ok90:
    v_mfma_f32_32x32x16_bf16 v[40:55], v[104:107], v[240:243], v[40:55]
    ds_read_b64_tr_b16 v[140:141], v21 offset:0
    ds_read_b64_tr_b16 v[142:143], v21 offset:1024
    s_waitcnt vmcnt(8)
    v_max3_u32 v14, v108, v109, v110
    v_max_u32 v14, v14, v111
    v_cmp_eq_u32 vcc, -1, v14
    v_mfma_f32_32x32x16_bf16 v[56:71], v[104:107], v[244:247], v[56:71]
    s_add_u32 s32, s77, 147456
    buffer_load_dwordx4 v[104:107], v19, s[12:15], s32 offen offset:0 sc1
    ds_read_b64_tr_b16 v[144:145], v22 offset:0
    ds_read_b64_tr_b16 v[146:147], v22 offset:1024
    s_cbranch_vccnz L_rt91
L_ok91:
    v_mfma_f32_32x32x16_bf16 v[40:55], v[108:111], v[248:251], v[40:55]
    ds_read_b64_tr_b16 v[148:149], v21 offset:2048
    ds_read_b64_tr_b16 v[150:151], v21 offset:3072
    s_waitcnt vmcnt(8)
    v_max3_u32 v14, v112, v113, v114
    v_max_u32 v14, v14, v115
    v_cmp_eq_u32 vcc, -1, v14
    v_mfma_f32_32x32x16_bf16 v[56:71], v[108:111], v[252:255], v[56:71]
    buffer_load_dwordx4 v[108:111], v19, s[12:15], s32 offen offset:1024 sc1
    ds_read_b64_tr_b16 v[152:153], v22 offset:2048
    ds_read_b64_tr_b16 v[154:155], v22 offset:3072
    s_cbranch_vccnz L_rt92
L_ok92:
    s_waitcnt lgkmcnt(4)
    v_mfma_f32_32x32x16_bf16 v[72:87], v[112:115], v[140:143], 0
    ds_read_b64_tr_b16 v[140:141], v21 offset:4096
    ds_read_b64_tr_b16 v[142:143], v21 offset:5120
    s_waitcnt vmcnt(8)
    v_max3_u32 v14, v116, v117, v118
    v_max_u32 v14, v14, v119
    v_cmp_eq_u32 vcc, -1, v14
    v_mfma_f32_32x32x16_bf16 v[88:103], v[112:115], v[144:147], 0
    buffer_load_dwordx4 v[112:115], v19, s[12:15], s32 offen offset:2048 sc1
    ds_read_b64_tr_b16 v[144:145], v22 offset:4096
    ds_read_b64_tr_b16 v[146:147], v22 offset:5120
    s_cbranch_vccnz L_rt93
L_ok93:
    s_waitcnt lgkmcnt(4)
    v_mfma_f32_32x32x16_bf16 v[72:87], v[116:119], v[148:151], v[72:87]
    ds_read_b64_tr_b16 v[148:149], v21 offset:6144
    ds_read_b64_tr_b16 v[150:151], v21 offset:7168
    ds_write_b128 v15, v[48:51]
    s_waitcnt vmcnt(8)
    v_max3_u32 v14, v120, v121, v122
    v_max_u32 v14, v14, v123
    v_cmp_eq_u32 vcc, -1, v14
    v_mfma_f32_32x32x16_bf16 v[88:103], v[116:119], v[152:155], v[88:103]
    buffer_load_dwordx4 v[116:119], v19, s[12:15], s32 offen offset:3072 sc1
    ds_read_b64_tr_b16 v[152:153], v22 offset:6144
    ds_read_b64_tr_b16 v[154:155], v22 offset:7168
    ds_write_b128 v15, v[52:55] offset:1024
    s_cbranch_vccnz L_rt94
L_ok94:
    s_waitcnt lgkmcnt(6)
    v_mfma_f32_32x32x16_bf16 v[72:87], v[120:123], v[140:143], v[72:87]
    ds_read_b64_tr_b16 v[140:141], v21 offset:8192
    ds_read_b64_tr_b16 v[142:143], v21 offset:9216
    ds_write_b128 v16, v[56:59]
    s_waitcnt vmcnt(8)
    v_max3_u32 v14, v124, v125, v126
    v_max_u32 v14, v14, v127
    v_cmp_eq_u32 vcc, -1, v14
    v_mfma_f32_32x32x16_bf16 v[88:103], v[120:123], v[144:147], v[88:103]
    s_add_u32 s32, s77, 163840
    buffer_load_dwordx4 v[120:123], v19, s[12:15], s32 offen offset:0 sc1
    ds_read_b64_tr_b16 v[144:145], v22 offset:8192
    ds_read_b64_tr_b16 v[146:147], v22 offset:9216
    ds_write_b128 v16, v[60:63] offset:1024
    s_cbranch_vccnz L_rt95
L_ok95:
    s_waitcnt lgkmcnt(7)
    v_mfma_f32_32x32x16_bf16 v[72:87], v[124:127], v[148:151], v[72:87]
    ds_read_b64_tr_b16 v[148:149], v21 offset:10240
    ds_read_b64_tr_b16 v[150:151], v21 offset:11264
    ds_write_b128 v17, v[64:67]
    s_waitcnt vmcnt(8)
    v_max3_u32 v14, v128, v129, v130
    v_max_u32 v14, v14, v131
    v_cmp_eq_u32 vcc, -1, v14
    v_mfma_f32_32x32x16_bf16 v[88:103], v[124:127], v[152:155], v[88:103]
    buffer_load_dwordx4 v[124:127], v19, s[12:15], s32 offen offset:1024 sc1
    ds_read_b64_tr_b16 v[152:153], v22 offset:10240
    ds_read_b64_tr_b16 v[154:155], v22 offset:11264
    ds_write_b128 v17, v[68:71] offset:1024
    s_cbranch_vccnz L_rt96
L_ok96:
    s_waitcnt lgkmcnt(7)
    v_mfma_f32_32x32x16_bf16 v[72:87], v[128:131], v[140:143], v[72:87]
    ds_read_b64_tr_b16 v[140:141], v21 offset:12288
    ds_read_b64_tr_b16 v[142:143], v21 offset:13312
    s_waitcnt vmcnt(8)
    v_max3_u32 v14, v132, v133, v134
    v_max_u32 v14, v14, v135
    v_cmp_eq_u32 vcc, -1, v14
    v_mfma_f32_32x32x16_bf16 v[88:103], v[128:131], v[144:147], v[88:103]
    buffer_load_dwordx4 v[128:131], v19, s[12:15], s32 offen offset:2048 sc1
    ds_read_b64_tr_b16 v[144:145], v22 offset:12288
    ds_read_b64_tr_b16 v[146:147], v22 offset:13312
    s_waitcnt lgkmcnt(4)
    s_barrier
    ds_read_b128 v[48:51], v18 offset:0
    s_cbranch_vccnz L_rt97
L_ok97:
    s_waitcnt lgkmcnt(6)
    v_mfma_f32_32x32x16_bf16 v[72:87], v[132:135], v[148:151], v[72:87]
    ds_read_b64_tr_b16 v[148:149], v21 offset:14336
    ds_read_b64_tr_b16 v[150:151], v21 offset:15360
    ds_read_b128 v[52:55], v18 offset:1024
    ds_read_b128 v[56:59], v18 offset:2048
    s_waitcnt vmcnt(8)
    v_max3_u32 v14, v136, v137, v138
    v_max_u32 v14, v14, v139
    v_cmp_eq_u32 vcc, -1, v14
    v_mfma_f32_32x32x16_bf16 v[88:103], v[132:135], v[152:155], v[88:103]
    buffer_load_dwordx4 v[132:135], v19, s[12:15], s32 offen offset:3072 sc1
    ds_read_b64_tr_b16 v[152:153], v22 offset:14336
    ds_read_b64_tr_b16 v[154:155], v22 offset:15360
    ds_read_b128 v[60:63], v18 offset:3072
    ds_read_b128 v[64:67], v18 offset:4096
    s_cbranch_vccnz L_rt98
L_ok98:
    s_waitcnt lgkmcnt(9)
    v_mfma_f32_32x32x16_bf16 v[72:87], v[136:139], v[140:143], v[72:87]
    ds_read_b64_tr_b16 v[140:141], v21 offset:16384
    ds_read_b64_tr_b16 v[142:143], v21 offset:17408
    ds_read_b128 v[68:71], v18 offset:5120
    s_waitcnt vmcnt(8)
    v_max3_u32 v14, v4, v5, v6
    v_max_u32 v14, v14, v7
    v_cmp_eq_u32 vcc, -1, v14
    v_mfma_f32_32x32x16_bf16 v[88:103], v[136:139], v[144:147], v[88:103]
    s_add_u32 s32, s77, 180224
    buffer_load_dwordx4 v[136:139], v19, s[12:15], s32 offen offset:0 sc1
    ds_read_b64_tr_b16 v[144:145], v22 offset:16384
    ds_read_b64_tr_b16 v[146:147], v22 offset:17408
    v_pk_add_f32 v[40:41], v[40:41], v[24:25]
    v_pk_add_f32 v[42:43], v[42:43], v[26:27]
    v_pk_add_f32 v[44:45], v[44:45], v[28:29]
    v_pk_add_f32 v[46:47], v[46:47], v[30:31]
    s_waitcnt lgkmcnt(2)
    v_pk_add_f32 v[48:49], v[48:49], v[56:57]
    v_pk_add_f32 v[50:51], v[50:51], v[58:59]
    v_pk_add_f32 v[52:53], v[52:53], v[60:61]
    v_pk_add_f32 v[54:55], v[54:55], v[62:63]
    v_pk_add_f32 v[40:41], v[40:41], v[64:65]
    v_pk_add_f32 v[42:43], v[42:43], v[66:67]
    v_pk_add_f32 v[44:45], v[44:45], v[68:69]
    v_pk_add_f32 v[46:47], v[46:47], v[70:71]
    v_pk_add_f32 v[24:25], v[40:41], v[48:49]
    v_pk_add_f32 v[26:27], v[42:43], v[50:51]
    v_pk_add_f32 v[28:29], v[44:45], v[52:53]
    v_pk_add_f32 v[30:31], v[46:47], v[54:55]
    v_cvt_pk_bf16_f32 v56, v24, v25
    v_cvt_pk_bf16_f32 v57, v26, v27
    v_cvt_pk_bf16_f32 v58, v28, v29
    v_cvt_pk_bf16_f32 v59, v30, v31
    v_pk_mul_f32 v[40:41], v[24:25], v[24:25]
    v_pk_mul_f32 v[42:43], v[26:27], v[26:27]
    v_permlane32_swap_b32 v56, v58
    v_permlane32_swap_b32 v57, v59
    s_cmp_eq_u32 s35, 0
    s_cbranch_scc1 L_ls_22_g
    buffer_store_dwordx4 v[56:59], v158, s[64:67], s78 offen
L_ls_22_d:
    v_pk_fma_f32 v[40:41], v[28:29], v[28:29], v[40:41]
    v_pk_fma_f32 v[42:43], v[30:31], v[30:31], v[42:43]
    v_pk_add_f32 v[48:49], v[24:25], v[26:27]
    v_pk_add_f32 v[50:51], v[28:29], v[30:31]
    v_pk_add_f32 v[40:41], v[40:41], v[42:43]
    v_pk_add_f32 v[48:49], v[48:49], v[50:51]
    v_add_f32 v156, v48, v49
    v_add_f32 v157, v40, v41
    s_barrier
    s_cbranch_vccnz L_rt99
L_ok99:
    s_waitcnt lgkmcnt(7)
    v_mfma_f32_32x32x16_bf16 v[72:87], v[4:7], v[148:151], v[72:87]
    ds_read_b64_tr_b16 v[148:149], v21 offset:18432
    ds_read_b64_tr_b16 v[150:151], v21 offset:19456
    s_waitcnt vmcnt(9)
    v_max3_u32 v14, v104, v105, v106
    v_max_u32 v14, v14, v107
L_pad_Q_7:
    s_cbranch_execz L_ret_Q_7
    v_cmp_eq_u32 vcc, -1, v14
    v_mfma_f32_32x32x16_bf16 v[88:103], v[4:7], v[152:155], v[88:103]
    buffer_load_dwordx4 v[4:7], v19, s[12:15], s32 offen offset:1024 sc1
    ds_read_b64_tr_b16 v[152:153], v22 offset:18432
    ds_read_b64_tr_b16 v[154:155], v22 offset:19456
    s_cbranch_vccnz L_rt100
L_ok100:
    s_waitcnt lgkmcnt(4)
    v_mfma_f32_32x32x16_bf16 v[72:87], v[104:107], v[140:143], v[72:87]
    ds_read_b64_tr_b16 v[140:141], v21 offset:20480
    ds_read_b64_tr_b16 v[142:143], v21 offset:21504
    s_waitcnt vmcnt(9)
    v_max3_u32 v14, v108, v109, v110
    v_max_u32 v14, v14, v111
    v_cmp_eq_u32 vcc, -1, v14
    v_mfma_f32_32x32x16_bf16 v[88:103], v[104:107], v[144:147], v[88:103]
    buffer_load_dwordx4 v[104:107], v19, s[12:15], s32 offen offset:2048 sc1
    ds_read_b64_tr_b16 v[144:145], v22 offset:20480
    ds_read_b64_tr_b16 v[146:147], v22 offset:21504
    s_cbranch_vccnz L_rt101
L_ok101:
    s_waitcnt lgkmcnt(4)
    v_mfma_f32_32x32x16_bf16 v[72:87], v[108:111], v[148:151], v[72:87]
    ds_read_b64_tr_b16 v[148:149], v21 offset:22528
    ds_read_b64_tr_b16 v[150:151], v21 offset:23552
    s_waitcnt vmcnt(9)
    v_max3_u32 v14, v112, v113, v114
    v_max_u32 v14, v14, v115
    v_cmp_eq_u32 vcc, -1, v14
    v_mfma_f32_32x32x16_bf16 v[88:103], v[108:111], v[152:155], v[88:103]
    buffer_load_dwordx4 v[108:111], v19, s[12:15], s32 offen offset:3072 sc1
    ds_read_b64_tr_b16 v[152:153], v22 offset:22528
    ds_read_b64_tr_b16 v[154:155], v22 offset:23552
    s_waitcnt vmcnt(3)
    v_mov_b32 v11, 1
    v_mov_b32 v12, 0
    s_mov_b64 exec, 1
    s_cmp_eq_u32 s35, 0
    s_cbranch_scc1 L_ls_23_g
    buffer_store_dword v11, v12, s[12:15], s72 offen
L_ls_23_d:
    s_mov_b64 exec, -1
    s_cbranch_vccnz L_rt102
L_ok102:
    s_waitcnt lgkmcnt(4)
    v_mfma_f32_32x32x16_bf16 v[72:87], v[112:115], v[140:143], v[72:87]
    ds_read_b64_tr_b16 v[140:141], v21 offset:24576
    ds_read_b64_tr_b16 v[142:143], v21 offset:25600
    s_waitcnt vmcnt(10)
    v_max3_u32 v14, v116, v117, v118
    v_max_u32 v14, v14, v119
    v_cmp_eq_u32 vcc, -1, v14
    v_mfma_f32_32x32x16_bf16 v[88:103], v[112:115], v[144:147], v[88:103]
    s_add_u32 s32, s77, 196608
    buffer_load_dwordx4 v[112:115], v19, s[12:15], s32 offen offset:0 sc1
    ds_read_b64_tr_b16 v[144:145], v22 offset:24576
    ds_read_b64_tr_b16 v[146:147], v22 offset:25600
    s_cbranch_vccnz L_rt103
L_ok103:
    s_waitcnt lgkmcnt(4)
    v_mfma_f32_32x32x16_bf16 v[72:87], v[116:119], v[148:151], v[72:87]
    ds_read_b64_tr_b16 v[148:149], v21 offset:26624
    ds_read_b64_tr_b16 v[150:151], v21 offset:27648
    s_waitcnt vmcnt(10)
    v_max3_u32 v14, v120, v121, v122
    v_max_u32 v14, v14, v123
    v_cmp_eq_u32 vcc, -1, v14
    v_mfma_f32_32x32x16_bf16 v[88:103], v[116:119], v[152:155], v[88:103]
    buffer_load_dwordx4 v[116:119], v19, s[12:15], s32 offen offset:1024 sc1
    ds_read_b64_tr_b16 v[152:153], v22 offset:26624
    ds_read_b64_tr_b16 v[154:155], v22 offset:27648
    s_cbranch_vccnz L_rt104
L_ok104:
    s_waitcnt lgkmcnt(4)
    v_mfma_f32_32x32x16_bf16 v[72:87], v[120:123], v[140:143], v[72:87]
    ds_read_b64_tr_b16 v[140:141], v21 offset:28672
    ds_read_b64_tr_b16 v[142:143], v21 offset:29696
    s_waitcnt vmcnt(10)
    v_max3_u32 v14, v124, v125, v126
    v_max_u32 v14, v14, v127
    v_cmp_eq_u32 vcc, -1, v14
    v_mfma_f32_32x32x16_bf16 v[88:103], v[120:123], v[144:147], v[88:103]
    buffer_load_dwordx4 v[120:123], v19, s[12:15], s32 offen offset:2048 sc1
    ds_read_b64_tr_b16 v[144:145], v22 offset:28672
    ds_read_b64_tr_b16 v[146:147], v22 offset:29696
    s_cbranch_vccnz L_rt105
L_ok105:
    s_waitcnt lgkmcnt(4)
    v_mfma_f32_32x32x16_bf16 v[72:87], v[124:127], v[148:151], v[72:87]
    ds_read_b64_tr_b16 v[148:149], v21 offset:30720
    ds_read_b64_tr_b16 v[150:151], v21 offset:31744
    s_waitcnt vmcnt(10)
    v_max3_u32 v14, v128, v129, v130
    v_max_u32 v14, v14, v131
    v_cmp_eq_u32 vcc, -1, v14
    v_mfma_f32_32x32x16_bf16 v[88:103], v[124:127], v[152:155], v[88:103]
    buffer_load_dwordx4 v[124:127], v19, s[12:15], s32 offen offset:3072 sc1
    ds_read_b64_tr_b16 v[152:153], v22 offset:30720
    ds_read_b64_tr_b16 v[154:155], v22 offset:31744
    s_cbranch_vccnz L_rt106
L_ok106:
    s_waitcnt lgkmcnt(4)
    v_mfma_f32_32x32x16_bf16 v[72:87], v[128:131], v[140:143], v[72:87]
    s_waitcnt vmcnt(10)
    v_max3_u32 v14, v132, v133, v134
    v_max_u32 v14, v14, v135
    v_cmp_eq_u32 vcc, -1, v14
    v_mfma_f32_32x32x16_bf16 v[88:103], v[128:131], v[144:147], v[88:103]
    s_add_u32 s32, s77, 212992
    buffer_load_dwordx4 v[128:131], v19, s[12:15], s32 offen offset:0 sc1
    s_cbranch_vccnz L_rt107
L_ok107:
    s_waitcnt lgkmcnt(0)
    v_mfma_f32_32x32x16_bf16 v[72:87], v[132:135], v[148:151], v[72:87]
    s_cmp_lg_u32 s19, 0
    s_cbranch_scc1 L_wm_24
    buffer_load_dword v44, v13, s[12:15], s98 offen
    buffer_load_dword v44, v13, s[12:15], s99 offen
    v_mov_b32 v40, -1
    v_mov_b32 v41, -1
    v_mov_b32 v42, -1
    v_mov_b32 v43, -1
    s_cmp_eq_u32 s35, 0
    s_cbranch_scc1 L_ls_25_g
    buffer_store_dwordx4 v[40:43], v2, s[12:15], s98 offen
    buffer_store_dwordx4 v[40:43], v2, s[12:15], s99 offen
L_ls_25_d:
L_wm_24:
    s_waitcnt vmcnt(10)
    v_max3_u32 v14, v136, v137, v138
    v_max_u32 v14, v14, v139
    v_cmp_eq_u32 vcc, -1, v14
    v_mfma_f32_32x32x16_bf16 v[88:103], v[132:135], v[152:155], v[88:103]
    buffer_load_dwordx4 v[132:135], v19, s[12:15], s32 offen offset:1024 sc1
    s_cbranch_vccnz L_rt108
L_ok108:
    v_mfma_f32_32x32x16_bf16 v[72:87], v[136:139], v[160:163], v[72:87]
    v_add_u32 v140, 23552, v159
    s_barrier
    s_add_u32 m0, s97, 0
    s_waitcnt vmcnt(9)
    v_max3_u32 v14, v4, v5, v6
    v_max_u32 v14, v14, v7
    v_cmp_eq_u32 vcc, -1, v14
    v_mfma_f32_32x32x16_bf16 v[88:103], v[136:139], v[164:167], v[88:103]
    buffer_load_dwordx4 v[136:139], v19, s[12:15], s32 offen offset:2048 sc1
    s_add_u32 s84, s95, 1024
    buffer_load_dwordx4 v159, s[4:7], s84 offen lds
    s_cbranch_vccnz L_rt109
L_ok109:
    v_mfma_f32_32x32x16_bf16 v[72:87], v[4:7], v[168:171], v[72:87]
    buffer_load_dwordx4 v159, s[4:7], s84 offen offset:1024 lds
    s_waitcnt vmcnt(11)
    v_max3_u32 v14, v104, v105, v106
    v_max_u32 v14, v14, v107
    v_cmp_eq_u32 vcc, -1, v14
    v_mfma_f32_32x32x16_bf16 v[88:103], v[4:7], v[172:175], v[88:103]
    buffer_load_dwordx4 v[4:7], v19, s[12:15], s32 offen offset:3072 sc1
    s_add_u32 m0, s97, 8192
    s_add_u32 s84, s95, 197632
    buffer_load_dwordx4 v159, s[4:7], s84 offen lds
    s_cbranch_vccnz L_rt110
L_ok110:
    v_mfma_f32_32x32x16_bf16 v[72:87], v[104:107], v[176:179], v[72:87]
    buffer_load_dwordx4 v159, s[4:7], s84 offen offset:1024 lds
    s_waitcnt vmcnt(13)
    v_max3_u32 v14, v108, v109, v110
    v_max_u32 v14, v14, v111
    v_cmp_eq_u32 vcc, -1, v14
    v_mfma_f32_32x32x16_bf16 v[88:103], v[104:107], v[180:183], v[88:103]
    s_add_u32 m0, s97, 16384
    s_add_u32 s84, s96, 0
    buffer_load_dwordx4 v159, s[4:7], s84 offen lds
    s_cbranch_vccnz L_rt111
L_ok111:
    v_mfma_f32_32x32x16_bf16 v[72:87], v[108:111], v[184:187], v[72:87]
    buffer_load_dwordx4 v140, s[4:7], s84 offen offset:1024 lds
    s_waitcnt vmcnt(13)
    v_max3_u32 v14, v112, v113, v114
    v_max_u32 v14, v14, v115
    v_cmp_eq_u32 vcc, -1, v14
    v_mfma_f32_32x32x16_bf16 v[88:103], v[108:111], v[188:191], v[88:103]
    s_add_u32 m0, s97, 24576
    s_add_u32 s84, s95, 394240
    buffer_load_dwordx4 v159, s[4:7], s84 offen lds
    s_cbranch_vccnz L_rt112
L_ok112:
    v_mfma_f32_32x32x16_bf16 v[72:87], v[112:115], v[192:195], v[72:87]
    buffer_load_dwordx4 v159, s[4:7], s84 offen offset:1024 lds
    s_waitcnt vmcnt(14)
    v_max3_u32 v14, v116, v117, v118
    v_max_u32 v14, v14, v119
    v_cmp_eq_u32 vcc, -1, v14
    v_mfma_f32_32x32x16_bf16 v[88:103], v[112:115], v[196:199], v[88:103]
    s_add_u32 m0, s97, 32768
    s_add_u32 s84, s95, 590848
    buffer_load_dwordx4 v159, s[4:7], s84 offen lds
    s_cbranch_vccnz L_rt113
L_ok113:
    v_mfma_f32_32x32x16_bf16 v[72:87], v[116:119], v[200:203], v[72:87]
    buffer_load_dwordx4 v159, s[4:7], s84 offen offset:1024 lds
    s_waitcnt vmcnt(15)
    v_max3_u32 v14, v120, v121, v122
    v_max_u32 v14, v14, v123
    v_cmp_eq_u32 vcc, -1, v14
    v_mfma_f32_32x32x16_bf16 v[88:103], v[116:119], v[204:207], v[88:103]
    s_cbranch_vccnz L_rt114
L_ok114:
    v_mfma_f32_32x32x16_bf16 v[72:87], v[120:123], v[208:211], v[72:87]
    s_waitcnt vmcnt(14)
    v_max3_u32 v14, v124, v125, v126
    v_max_u32 v14, v14, v127
    v_cmp_eq_u32 vcc, -1, v14
    v_mfma_f32_32x32x16_bf16 v[88:103], v[120:123], v[212:215], v[88:103]
    s_cbranch_vccnz L_rt115
L_ok115:
    v_mfma_f32_32x32x16_bf16 v[72:87], v[124:127], v[216:219], v[72:87]
    s_waitcnt vmcnt(13)
    v_max3_u32 v14, v128, v129, v130
    v_max_u32 v14, v14, v131
    v_cmp_eq_u32 vcc, -1, v14
    v_mfma_f32_32x32x16_bf16 v[88:103], v[124:127], v[220:223], v[88:103]
    s_cbranch_vccnz L_rt116
L_ok116:
    v_mfma_f32_32x32x16_bf16 v[72:87], v[128:131], v[224:227], v[72:87]
    s_waitcnt vmcnt(12)
    v_max3_u32 v14, v132, v133, v134
    v_max_u32 v14, v14, v135
    v_cmp_eq_u32 vcc, -1, v14
    v_mfma_f32_32x32x16_bf16 v[88:103], v[128:131], v[228:231], v[88:103]
    s_cbranch_vccnz L_rt117
L_ok117:
    v_mfma_f32_32x32x16_bf16 v[72:87], v[132:135], v[232:235], v[72:87]
    s_waitcnt vmcnt(11)
    v_max3_u32 v14, v136, v137, v138
    v_max_u32 v14, v14, v139
    v_cmp_eq_u32 vcc, -1, v14
    v_mfma_f32_32x32x16_bf16 v[88:103], v[132:135], v[236:239], v[88:103]
    s_cbranch_vccnz L_rt118
L_ok118:
    v_mfma_f32_32x32x16_bf16 v[72:87], v[136:139], v[240:243], v[72:87]
    s_waitcnt vmcnt(8)
    v_max3_u32 v14, v4, v5, v6
    v_max_u32 v14, v14, v7
    v_cmp_eq_u32 vcc, -1, v14
    v_mfma_f32_32x32x16_bf16 v[88:103], v[136:139], v[244:247], v[88:103]
    s_cbranch_vccnz L_rt119
L_ok119:
    v_mfma_f32_32x32x16_bf16 v[72:87], v[4:7], v[248:251], v[72:87]
    v_mfma_f32_32x32x16_bf16 v[88:103], v[4:7], v[252:255], v[88:103]
    buffer_load_dword v14, v20, s[12:15], s27 offen sc1
    s_nop 9
    ds_write_b128 v15, v[80:83]
    ds_write_b128 v15, v[84:87] offset:1024
    ds_write_b128 v16, v[88:91]
    ds_write_b128 v16, v[92:95] offset:1024
    ds_write_b128 v17, v[96:99]
    ds_write_b128 v17, v[100:103] offset:1024
    s_waitcnt lgkmcnt(0)
    s_barrier
    ds_read_b128 v[80:83], v18 offset:0
    ds_read_b128 v[84:87], v18 offset:1024
    ds_read_b128 v[88:91], v18 offset:2048
    ds_read_b128 v[92:95], v18 offset:3072
    ds_read_b128 v[96:99], v18 offset:4096
    ds_read_b128 v[100:103], v18 offset:5120
    s_cmp_lg_u32 s19, 0
    s_cbranch_scc1 L_noq_26
    v_mov_b32 v4, v159
    v_add_u32 v5, 23552, v159
    s_waitcnt vmcnt(0)
    v_cmp_eq_u32 vcc, 0, v14
    s_mov_b32 s24, 0
    s_nop 0
    s_cbranch_vccz L_pl_27_go
L_pl_27:
    buffer_load_dword v14, v20, s[12:15], s27 offen sc1
    s_add_u32 s24, s24, 1
    s_waitcnt vmcnt(0)
    v_cmp_eq_u32 vcc, 0, v14
    s_cmp_ge_u32 s24, 65536
    s_cbranch_scc1 L_pl_27_x
    s_cbranch_vccz L_pl_27_x
    s_mov_b64 exec, vcc
    s_branch L_pl_27
L_pl_27_x:
    s_mov_b64 exec, -1
L_pl_27_go:
    s_add_u32 m0, s31, 0
    s_add_u32 s84, s39, 0
    buffer_load_dwordx4 v2, s[12:15], s84 offen sc1 lds
    s_add_u32 m0, s31, 4224
    s_add_u32 s84, s39, 4096
    buffer_load_dwordx4 v2, s[12:15], s84 offen sc1 lds
    s_add_u32 m0, s31, 8448
    s_add_u32 s84, s39, 8192
    buffer_load_dwordx4 v2, s[12:15], s84 offen sc1 lds
    s_add_u32 m0, s31, 12672
    s_add_u32 s84, s39, 12288
    buffer_load_dwordx4 v2, s[12:15], s84 offen sc1 lds
    s_add_u32 m0, s97, 40960
    s_add_u32 s84, s96, 393216
    buffer_load_dwordx4 v4, s[4:7], s84 offen lds
    buffer_load_dwordx4 v5, s[4:7], s84 offen offset:1024 lds
L_noq_26:
    v_pk_add_f32 v[72:73], v[72:73], v[32:33]
    v_pk_add_f32 v[74:75], v[74:75], v[34:35]
    v_pk_add_f32 v[76:77], v[76:77], v[36:37]
    v_pk_add_f32 v[78:79], v[78:79], v[38:39]
    s_waitcnt lgkmcnt(0)
    v_pk_add_f32 v[80:81], v[80:81], v[88:89]
    v_pk_add_f32 v[82:83], v[82:83], v[90:91]
    v_pk_add_f32 v[84:85], v[84:85], v[92:93]
    v_pk_add_f32 v[86:87], v[86:87], v[94:95]
    v_pk_add_f32 v[72:73], v[72:73], v[96:97]
    v_pk_add_f32 v[74:75], v[74:75], v[98:99]
    v_pk_add_f32 v[76:77], v[76:77], v[100:101]
    v_pk_add_f32 v[78:79], v[78:79], v[102:103]
    v_pk_add_f32 v[32:33], v[72:73], v[80:81]
    v_pk_add_f32 v[34:35], v[74:75], v[82:83]
    v_pk_add_f32 v[36:37], v[76:77], v[84:85]
    v_pk_add_f32 v[38:39], v[78:79], v[86:87]
    v_cvt_pk_bf16_f32 v88, v32, v33
    v_cvt_pk_bf16_f32 v89, v34, v35
    v_cvt_pk_bf16_f32 v90, v36, v37
    v_cvt_pk_bf16_f32 v91, v38, v39
    v_pk_mul_f32 v[72:73], v[32:33], v[32:33]
    v_pk_mul_f32 v[74:75], v[34:35], v[34:35]
    v_permlane32_swap_b32 v88, v90
    v_permlane32_swap_b32 v89, v91
    s_cmp_eq_u32 s35, 0
    s_cbranch_scc1 L_ls_28_g
    buffer_store_dwordx4 v[88:91], v158, s[64:67], s79 offen
L_ls_28_d:
    s_cmp_lg_u32 s19, 0
    s_cbranch_scc1 L_finish
    v_pk_fma_f32 v[72:73], v[36:37], v[36:37], v[72:73]
    v_pk_fma_f32 v[74:75], v[38:39], v[38:39], v[74:75]
    v_pk_add_f32 v[80:81], v[32:33], v[34:35]
    v_pk_add_f32 v[82:83], v[36:37], v[38:39]
    v_pk_add_f32 v[72:73], v[72:73], v[74:75]
    v_pk_add_f32 v[80:81], v[80:81], v[82:83]
    v_add_f32 v80, v80, v81
    v_add_f32 v81, v72, v73
    v_pk_add_f32 v[156:157], v[156:157], v[80:81]
    v_mov_b32 v11, v156
    v_mov_b32 v12, v157
    s_nop 0
    v_permlane32_swap_b32 v156, v11
    v_permlane32_swap_b32 v157, v12
    v_add_f32 v156, v156, v11
    v_add_f32 v157, v157, v12
    s_mov_b32 exec_hi, 0
    s_cmp_eq_u32 s35, 0
    s_cbranch_scc1 L_ls_29_g
    buffer_store_dwordx2 v[156:157], v2, s[12:15], s28 offen
L_ls_29_d:
    s_mov_b64 exec, -1
    s_barrier
L_reg_E:
    s_add_u32 m0, s31, 16896
    s_add_u32 s84, s39, 16384
    buffer_load_dwordx4 v2, s[12:15], s84 offen sc1 lds
    s_add_u32 m0, s31, 21120
    s_add_u32 s84, s39, 20480
    buffer_load_dwordx4 v2, s[12:15], s84 offen sc1 lds
    s_add_u32 m0, s97, 49152
    s_add_u32 s84, s95, 787456
    buffer_load_dwordx4 v4, s[4:7], s84 offen lds
    buffer_load_dwordx4 v4, s[4:7], s84 offen offset:1024 lds
    s_add_u32 m0, s97, 57344
    s_add_u32 s84, s95, 984064
    buffer_load_dwordx4 v4, s[4:7], s84 offen lds
    buffer_load_dwordx4 v4, s[4:7], s84 offen offset:1024 lds
    s_add_u32 m0, s97, 65536
    s_add_u32 s84, s96, 786432
    buffer_load_dwordx4 v4, s[4:7], s84 offen lds
    buffer_load_dwordx4 v5, s[4:7], s84 offen offset:1024 lds
    v_min_u32 v11, 15, v1
    v_lshrrev_b32 v12, 1, v11
    v_and_b32 v11, 1, v11
    v_lshlrev_b32 v11, 7, v11
    v_lshl_add_u32 v20, v12, 9, v11
    v_and_b32 v11, 31, v1
    v_lshrrev_b32 v12, 5, v1
    v_lshlrev_b32 v155, 4, v11
    v_lshl_add_u32 v155, v12, 11, v155
    s_lshl_b32 s24, s23, 6
    v_and_b32 v11, 0x1ff, v9
    v_xor_b32 v11, s24, v11
    v_add_u32 v11, 67584, v11
    v_lshrrev_b32 v12, 5, v1
    v_lshl_add_u32 v153, v12, 11, v11
    v_add_u32 v154, 65536, v153
    v_lshl_add_u32 v157, v12, 10, v11
    v_add_u32 v158, 65536, v157
    s_mul_i32 s24, s22, 33792
    v_add_u32 v152, s24, v2
    v_and_b32 v156, 15, v1
    v_lshlrev_b32 v156, 4, v156
    v_lshrrev_b32 v12, 5, v1
    v_lshl_add_u32 v156, v12, 8, v156
    v_bfe_u32 v12, v1, 4, 1
    v_lshl_add_u32 v156, v12, 17, v156
    s_waitcnt vmcnt(8)
    v_mov_b32 v11, 1
    v_mov_b32 v12, 0
    s_mov_b64 exec, 1
    s_cmp_eq_u32 s35, 0
    s_cbranch_scc1 L_ls_30_g
    buffer_store_dword v11, v12, s[12:15], s73 offen
L_ls_30_d:
    s_mov_b64 exec, -1
    s_waitcnt vmcnt(15)
    s_barrier
    ds_read_b128 v[88:91], v152 offset:0
    ds_read_b64_tr_b16 v[104:105], v153 offset:0
    ds_read_b64_tr_b16 v[106:107], v153 offset:512
    ds_read_b64_tr_b16 v[108:109], v153 offset:1024
    ds_read_b64_tr_b16 v[110:111], v153 offset:1536
    ds_read_b64_tr_b16 v[92:93], v157 offset:16384
    ds_read_b64_tr_b16 v[94:95], v157 offset:16896
    ds_read_b128 v[96:99], v152 offset:1056
    ds_read_b64_tr_b16 v[112:113], v153 offset:4096
    ds_read_b64_tr_b16 v[114:115], v153 offset:4608
    ds_read_b64_tr_b16 v[116:117], v153 offset:5120
    ds_read_b64_tr_b16 v[118:119], v153 offset:5632
    ds_read_b64_tr_b16 v[100:101], v157 offset:18432
    ds_read_b64_tr_b16 v[102:103], v157 offset:18944
    s_waitcnt lgkmcnt(7)
    v_mfma_f32_32x32x16_bf16 v[40:55], v[104:107], v[88:91], 0
    ds_read_b64_tr_b16 v[104:105], v153 offset:8192
    ds_read_b64_tr_b16 v[106:107], v153 offset:8704
    s_add_u32 m0, s31, 25344
    s_add_u32 s84, s39, 24576
    buffer_load_dwordx4 v2, s[12:15], s84 offen sc1 lds
    v_mfma_f32_32x32x16_bf16 v[56:71], v[88:91], v[108:111], 0
    ds_read_b64_tr_b16 v[108:109], v153 offset:9216
    ds_read_b64_tr_b16 v[110:111], v153 offset:9728
    s_add_u32 m0, s31, 29568
    s_add_u32 s84, s39, 28672
    buffer_load_dwordx4 v2, s[12:15], s84 offen sc1 lds
    v_mfma_f32_32x32x16_bf16 v[72:87], v[92:95], v[88:91], 0
    ds_read_b128 v[88:91], v152 offset:4224
    ds_read_b64_tr_b16 v[92:93], v157 offset:20480
    ds_read_b64_tr_b16 v[94:95], v157 offset:20992
    s_add_u32 m0, s97, 73728
    s_waitcnt lgkmcnt(7)
    v_mfma_f32_32x32x16_bf16 v[40:55], v[112:115], v[96:99], v[40:55]
    ds_read_b64_tr_b16 v[112:113], v153 offset:12288
    ds_read_b64_tr_b16 v[114:115], v153 offset:12800
    s_add_u32 s84, s95, 1180672
    buffer_load_dwordx4 v4, s[4:7], s84 offen lds
    buffer_load_dwordx4 v4, s[4:7], s84 offen offset:1024 lds
    v_mfma_f32_32x32x16_bf16 v[56:71], v[96:99], v[116:119], v[56:71]
    ds_read_b64_tr_b16 v[116:117], v153 offset:13312
    ds_read_b64_tr_b16 v[118:119], v153 offset:13824
    s_add_u32 m0, s97, 81920
    s_add_u32 s84, s95, 1377280
    buffer_load_dwordx4 v4, s[4:7], s84 offen lds
    v_mfma_f32_32x32x16_bf16 v[72:87], v[100:103], v[96:99], v[72:87]
    ds_read_b128 v[96:99], v152 offset:5280
    ds_read_b64_tr_b16 v[100:101], v157 offset:22528
    ds_read_b64_tr_b16 v[102:103], v157 offset:23040
    buffer_load_dwordx4 v4, s[4:7], s84 offen offset:1024 lds
    s_waitcnt lgkmcnt(7)
    v_mfma_f32_32x32x16_bf16 v[40:55], v[104:107], v[88:91], v[40:55]
    s_waitcnt vmcnt(17)
    s_barrier
    ds_read_b64_tr_b16 v[104:105], v153 offset:24576
    ds_read_b64_tr_b16 v[106:107], v153 offset:25088
    s_add_u32 m0, s97, 0
    s_add_u32 s84, s96, 1179648
    buffer_load_dwordx4 v4, s[4:7], s84 offen lds
    v_mfma_f32_32x32x16_bf16 v[56:71], v[88:91], v[108:111], v[56:71]
    ds_read_b64_tr_b16 v[108:109], v153 offset:25600
    ds_read_b64_tr_b16 v[110:111], v153 offset:26112
    buffer_load_dwordx4 v5, s[4:7], s84 offen offset:1024 lds
    v_mfma_f32_32x32x16_bf16 v[72:87], v[92:95], v[88:91], v[72:87]
    ds_read_b128 v[88:91], v152 offset:8448
    ds_read_b64_tr_b16 v[92:93], v157 offset:40960
    ds_read_b64_tr_b16 v[94:95], v157 offset:41472
    s_waitcnt lgkmcnt(7)
    v_mfma_f32_32x32x16_bf16 v[40:55], v[112:115], v[96:99], v[40:55]
    ds_read_b64_tr_b16 v[112:113], v153 offset:28672
    ds_read_b64_tr_b16 v[114:115], v153 offset:29184
    v_mfma_f32_32x32x16_bf16 v[56:71], v[96:99], v[116:119], v[56:71]
    ds_read_b64_tr_b16 v[116:117], v153 offset:29696
    ds_read_b64_tr_b16 v[118:119], v153 offset:30208
    v_mfma_f32_32x32x16_bf16 v[72:87], v[100:103], v[96:99], v[72:87]
    ds_read_b128 v[96:99], v152 offset:9504
    ds_read_b64_tr_b16 v[100:101], v157 offset:43008
    ds_read_b64_tr_b16 v[102:103], v157 offset:43520
    s_waitcnt lgkmcnt(7)
    v_mfma_f32_32x32x16_bf16 v[40:55], v[104:107], v[88:91], v[40:55]
    ds_read_b64_tr_b16 v[104:105], v153 offset:32768
    ds_read_b64_tr_b16 v[106:107], v153 offset:33280
    v_mfma_f32_32x32x16_bf16 v[56:71], v[88:91], v[108:111], v[56:71]
    ds_read_b64_tr_b16 v[108:109], v153 offset:33792
    ds_read_b64_tr_b16 v[110:111], v153 offset:34304
    v_mfma_f32_32x32x16_bf16 v[72:87], v[92:95], v[88:91], v[72:87]
    ds_read_b128 v[88:91], v152 offset:12672
    ds_read_b64_tr_b16 v[92:93], v157 offset:45056
    ds_read_b64_tr_b16 v[94:95], v157 offset:45568
    s_waitcnt lgkmcnt(7)
    v_mfma_f32_32x32x16_bf16 v[40:55], v[112:115], v[96:99], v[40:55]
    ds_read_b64_tr_b16 v[112:113], v153 offset:36864
    ds_read_b64_tr_b16 v[114:115], v153 offset:37376
    v_mfma_f32_32x32x16_bf16 v[56:71], v[96:99], v[116:119], v[56:71]
    ds_read_b64_tr_b16 v[116:117], v153 offset:37888
    ds_read_b64_tr_b16 v[118:119], v153 offset:38400
    v_mfma_f32_32x32x16_bf16 v[72:87], v[100:103], v[96:99], v[72:87]
    ds_read_b128 v[96:99], v152 offset:13728
    ds_read_b64_tr_b16 v[100:101], v157 offset:47104
    ds_read_b64_tr_b16 v[102:103], v157 offset:47616
    s_waitcnt lgkmcnt(7)
    v_mfma_f32_32x32x16_bf16 v[40:55], v[104:107], v[88:91], v[40:55]
    s_waitcnt vmcnt(9)
    s_barrier
    ds_read_b64_tr_b16 v[104:105], v153 offset:49152
    ds_read_b64_tr_b16 v[106:107], v153 offset:49664
    s_add_u32 m0, s97, 8192
    s_add_u32 s84, s95, 99328
    buffer_load_dwordx4 v4, s[4:7], s84 offen lds
    v_mfma_f32_32x32x16_bf16 v[56:71], v[88:91], v[108:111], v[56:71]
    ds_read_b64_tr_b16 v[108:109], v153 offset:50176
    ds_read_b64_tr_b16 v[110:111], v153 offset:50688
    buffer_load_dwordx4 v4, s[4:7], s84 offen offset:1024 lds
    s_add_u32 m0, s97, 16384
    s_add_u32 s84, s95, 295936
    v_mfma_f32_32x32x16_bf16 v[72:87], v[92:95], v[88:91], v[72:87]
    ds_read_b128 v[88:91], v152 offset:16896
    ds_read_b64_tr_b16 v[92:93], v158 offset:0
    ds_read_b64_tr_b16 v[94:95], v158 offset:512
    buffer_load_dwordx4 v4, s[4:7], s84 offen lds
    buffer_load_dword v14, v20, s[12:15], s26 offen sc1
    s_waitcnt lgkmcnt(7)
    v_mfma_f32_32x32x16_bf16 v[40:55], v[112:115], v[96:99], v[40:55]
    ds_read_b64_tr_b16 v[112:113], v153 offset:53248
    ds_read_b64_tr_b16 v[114:115], v153 offset:53760
    buffer_load_dwordx4 v4, s[4:7], s84 offen offset:1024 lds
    s_add_u32 m0, s97, 24576
    s_add_u32 s84, s95, 492544
    v_mfma_f32_32x32x16_bf16 v[56:71], v[96:99], v[116:119], v[56:71]
    ds_read_b64_tr_b16 v[116:117], v153 offset:54272
    ds_read_b64_tr_b16 v[118:119], v153 offset:54784
    buffer_load_dwordx4 v4, s[4:7], s84 offen lds
    buffer_load_dwordx4 v4, s[4:7], s84 offen offset:1024 lds
    v_mfma_f32_32x32x16_bf16 v[72:87], v[100:103], v[96:99], v[72:87]
    ds_read_b128 v[96:99], v152 offset:17952
    ds_read_b64_tr_b16 v[100:101], v158 offset:2048
    ds_read_b64_tr_b16 v[102:103], v158 offset:2560
    s_waitcnt lgkmcnt(7)
    v_mfma_f32_32x32x16_bf16 v[40:55], v[104:107], v[88:91], v[40:55]
    ds_read_b64_tr_b16 v[104:105], v153 offset:57344
    ds_read_b64_tr_b16 v[106:107], v153 offset:57856
    v_mfma_f32_32x32x16_bf16 v[56:71], v[88:91], v[108:111], v[56:71]
    ds_read_b64_tr_b16 v[108:109], v153 offset:58368
    ds_read_b64_tr_b16 v[110:111], v153 offset:58880
    v_mfma_f32_32x32x16_bf16 v[72:87], v[92:95], v[88:91], v[72:87]
    ds_read_b128 v[88:91], v152 offset:21120
    ds_read_b64_tr_b16 v[92:93], v158 offset:4096
    ds_read_b64_tr_b16 v[94:95], v158 offset:4608
    s_waitcnt lgkmcnt(7)
    v_mfma_f32_32x32x16_bf16 v[40:55], v[112:115], v[96:99], v[40:55]
    ds_read_b64_tr_b16 v[112:113], v153 offset:61440
    ds_read_b64_tr_b16 v[114:115], v153 offset:61952
    v_mfma_f32_32x32x16_bf16 v[56:71], v[96:99], v[116:119], v[56:71]
    ds_read_b64_tr_b16 v[116:117], v153 offset:62464
    ds_read_b64_tr_b16 v[118:119], v153 offset:62976
    v_mfma_f32_32x32x16_bf16 v[72:87], v[100:103], v[96:99], v[72:87]
    ds_read_b128 v[96:99], v152 offset:22176
    ds_read_b64_tr_b16 v[100:101], v158 offset:6144
    ds_read_b64_tr_b16 v[102:103], v158 offset:6656
    s_waitcnt lgkmcnt(7)
    v_mfma_f32_32x32x16_bf16 v[40:55], v[104:107], v[88:91], v[40:55]
    s_waitcnt vmcnt(7)
    s_barrier
    ds_read_b64_tr_b16 v[104:105], v154 offset:8192
    ds_read_b64_tr_b16 v[106:107], v154 offset:8704
    s_add_u32 m0, s97, 32768
    s_add_u32 s84, s95, 689152
    buffer_load_dwordx4 v4, s[4:7], s84 offen lds
    v_mfma_f32_32x32x16_bf16 v[56:71], v[88:91], v[108:111], v[56:71]
    ds_read_b64_tr_b16 v[108:109], v154 offset:9216
    ds_read_b64_tr_b16 v[110:111], v154 offset:9728
    buffer_load_dwordx4 v4, s[4:7], s84 offen offset:1024 lds
    s_add_u32 m0, s97, 40960
    s_add_u32 s84, s95, 885760
    v_mfma_f32_32x32x16_bf16 v[72:87], v[92:95], v[88:91], v[72:87]
    ds_read_b128 v[88:91], v152 offset:25344
    ds_read_b64_tr_b16 v[92:93], v157 offset:0
    ds_read_b64_tr_b16 v[94:95], v157 offset:512
    buffer_load_dwordx4 v4, s[4:7], s84 offen lds
    s_waitcnt vmcnt(6)
    v_cmp_eq_u32 vcc, 0, v14
    s_mov_b32 s24, 0
    s_nop 0
    s_cbranch_vccz L_pl_31_go
L_pl_31:
    buffer_load_dword v14, v20, s[12:15], s26 offen sc1
    s_add_u32 s24, s24, 1
    s_waitcnt vmcnt(0)
    v_cmp_eq_u32 vcc, 0, v14
    s_cmp_ge_u32 s24, 65536
    s_cbranch_scc1 L_pl_31_x
    s_cbranch_vccz L_pl_31_x
    s_mov_b64 exec, vcc
    s_branch L_pl_31
L_pl_31_x:
    s_mov_b64 exec, -1
L_pl_31_go:
    buffer_load_dwordx4 v4, s[4:7], s84 offen offset:1024 lds
    s_waitcnt lgkmcnt(7)
    v_mfma_f32_32x32x16_bf16 v[40:55], v[112:115], v[96:99], v[40:55]
    ds_read_b64_tr_b16 v[112:113], v154 offset:12288
    ds_read_b64_tr_b16 v[114:115], v154 offset:12800
    s_add_u32 m0, s31, 2112
    s_add_u32 s84, s39, 2048
    buffer_load_dwordx4 v2, s[12:15], s84 offen sc1 lds
    v_mfma_f32_32x32x16_bf16 v[56:71], v[96:99], v[116:119], v[56:71]
    ds_read_b64_tr_b16 v[116:117], v154 offset:13312
    ds_read_b64_tr_b16 v[118:119], v154 offset:13824
    s_add_u32 m0, s31, 6336
    s_add_u32 s84, s39, 6144
    buffer_load_dwordx4 v2, s[12:15], s84 offen sc1 lds
    v_mfma_f32_32x32x16_bf16 v[72:87], v[100:103], v[96:99], v[72:87]
    ds_read_b128 v[96:99], v152 offset:26400
    ds_read_b64_tr_b16 v[100:101], v157 offset:2048
    ds_read_b64_tr_b16 v[102:103], v157 offset:2560
    s_add_u32 m0, s31, 10560
    s_waitcnt lgkmcnt(7)
    v_mfma_f32_32x32x16_bf16 v[40:55], v[104:107], v[88:91], v[40:55]
    ds_read_b64_tr_b16 v[104:105], v154 offset:16384
    ds_read_b64_tr_b16 v[106:107], v154 offset:16896
    s_add_u32 s84, s39, 10240
    buffer_load_dwordx4 v2, s[12:15], s84 offen sc1 lds
    s_add_u32 m0, s31, 14784
    v_mfma_f32_32x32x16_bf16 v[56:71], v[88:91], v[108:111], v[56:71]
    ds_read_b64_tr_b16 v[108:109], v154 offset:17408
    ds_read_b64_tr_b16 v[110:111], v154 offset:17920
    s_add_u32 s84, s39, 14336
    buffer_load_dwordx4 v2, s[12:15], s84 offen sc1 lds
    s_add_u32 m0, s31, 19008
    v_mfma_f32_32x32x16_bf16 v[72:87], v[92:95], v[88:91], v[72:87]
    ds_read_b128 v[88:91], v152 offset:29568
    ds_read_b64_tr_b16 v[92:93], v157 offset:4096
L_pad_E_2:
    s_cbranch_execz L_ret_E_2
    ds_read_b64_tr_b16 v[94:95], v157 offset:4608
    s_add_u32 s84, s39, 18432
    s_waitcnt lgkmcnt(7)
    v_mfma_f32_32x32x16_bf16 v[40:55], v[112:115], v[96:99], v[40:55]
    ds_read_b64_tr_b16 v[112:113], v154 offset:20480
    ds_read_b64_tr_b16 v[114:115], v154 offset:20992
    buffer_load_dwordx4 v2, s[12:15], s84 offen sc1 lds
    s_add_u32 m0, s31, 23232
    s_add_u32 s84, s39, 22528
    v_mfma_f32_32x32x16_bf16 v[56:71], v[96:99], v[116:119], v[56:71]
    ds_read_b64_tr_b16 v[116:117], v154 offset:21504
    ds_read_b64_tr_b16 v[118:119], v154 offset:22016
    buffer_load_dwordx4 v2, s[12:15], s84 offen sc1 lds
    s_add_u32 m0, s31, 27456
    s_add_u32 s84, s39, 26624
    v_mfma_f32_32x32x16_bf16 v[72:87], v[100:103], v[96:99], v[72:87]
    ds_read_b128 v[96:99], v152 offset:30624
    ds_read_b64_tr_b16 v[100:101], v157 offset:6144
    ds_read_b64_tr_b16 v[102:103], v157 offset:6656
    buffer_load_dwordx4 v2, s[12:15], s84 offen sc1 lds
    s_waitcnt lgkmcnt(7)
    v_mfma_f32_32x32x16_bf16 v[40:55], v[104:107], v[88:91], v[40:55]
    s_add_u32 m0, s31, 31680
    s_add_u32 s84, s39, 30720
    buffer_load_dwordx4 v2, s[12:15], s84 offen sc1 lds
    buffer_load_dwordx4 v[124:127], v155, s[12:15], s92 offen offset:0 sc1
    buffer_load_dwordx4 v[128:131], v155, s[12:15], s92 offen offset:512 sc1
    s_waitcnt vmcnt(8)
    s_barrier
    ds_read_b64_tr_b16 v[104:105], v153 offset:8192
    ds_read_b64_tr_b16 v[106:107], v153 offset:8704
    buffer_load_dwordx4 v[132:135], v155, s[12:15], s92 offen offset:1024 sc1
    buffer_load_dwordx4 v[136:139], v155, s[12:15], s92 offen offset:1536 sc1
    v_mfma_f32_32x32x16_bf16 v[56:71], v[88:91], v[108:111], v[56:71]
    ds_read_b64_tr_b16 v[108:109], v153 offset:9216
    ds_read_b64_tr_b16 v[110:111], v153 offset:9728
    s_add_u32 m0, s97, 49152
    s_add_u32 s84, s95, 1082368
    buffer_load_dwordx4 v4, s[4:7], s84 offen lds
    v_mfma_f32_32x32x16_bf16 v[72:87], v[92:95], v[88:91], v[72:87]
    ds_read_b128 v[88:91], v152 offset:2112
    buffer_load_dwordx4 v4, s[4:7], s84 offen offset:1024 lds
    s_add_u32 m0, s97, 57344
    s_waitcnt lgkmcnt(5)
    v_mfma_f32_32x32x16_bf16 v[40:55], v[112:115], v[96:99], v[40:55]
    ds_read_b64_tr_b16 v[112:113], v153 offset:12288
    ds_read_b64_tr_b16 v[114:115], v153 offset:12800
    s_add_u32 s84, s95, 1278976
    buffer_load_dwordx4 v4, s[4:7], s84 offen lds
    buffer_load_dwordx4 v4, s[4:7], s84 offen offset:1024 lds
    v_mfma_f32_32x32x16_bf16 v[56:71], v[96:99], v[116:119], v[56:71]
    ds_read_b64_tr_b16 v[116:117], v153 offset:13312
    ds_read_b64_tr_b16 v[118:119], v153 offset:13824
    s_add_u32 m0, s97, 65536
    s_add_u32 s84, s95, 1475584
    buffer_load_dwordx4 v4, s[4:7], s84 offen lds
    v_mfma_f32_32x32x16_bf16 v[72:87], v[100:103], v[96:99], v[72:87]
    ds_read_b128 v[96:99], v152 offset:3168
    buffer_load_dwordx4 v4, s[4:7], s84 offen offset:1024 lds
    s_add_u32 m0, s97, 73728
    s_waitcnt lgkmcnt(5)
    v_mfma_f32_32x32x16_bf16 v[40:55], v[104:107], v[88:91], v[40:55]
    ds_read_b64_tr_b16 v[104:105], v153 offset:16384
    ds_read_b64_tr_b16 v[106:107], v153 offset:16896
    s_add_u32 s84, s96, 98304
    buffer_load_dwordx4 v4, s[4:7], s84 offen lds
    buffer_load_dwordx4 v5, s[4:7], s84 offen offset:1024 lds
    v_mfma_f32_32x32x16_bf16 v[56:71], v[88:91], v[108:111], v[56:71]
    ds_read_b128 v[88:91], v152 offset:6336
    ds_read_b64_tr_b16 v[108:109], v153 offset:17408
    ds_read_b64_tr_b16 v[110:111], v153 offset:17920
    s_waitcnt lgkmcnt(5)
    v_mfma_f32_32x32x16_bf16 v[40:55], v[112:115], v[96:99], v[40:55]
    ds_read_b64_tr_b16 v[112:113], v153 offset:20480
    ds_read_b64_tr_b16 v[114:115], v153 offset:20992
    v_mfma_f32_32x32x16_bf16 v[56:71], v[96:99], v[116:119], v[56:71]
    ds_read_b128 v[96:99], v152 offset:7392
    ds_read_b64_tr_b16 v[116:117], v153 offset:21504
    ds_read_b64_tr_b16 v[118:119], v153 offset:22016
    s_waitcnt lgkmcnt(5)
    v_mfma_f32_32x32x16_bf16 v[40:55], v[104:107], v[88:91], v[40:55]
    s_waitcnt vmcnt(16)
    s_barrier
    ds_read_b64_tr_b16 v[104:105], v153 offset:24576
    ds_read_b64_tr_b16 v[106:107], v153 offset:25088
    s_add_u32 m0, s97, 81920
    s_add_u32 s84, s96, 491520
    buffer_load_dwordx4 v4, s[4:7], s84 offen lds
    v_mfma_f32_32x32x16_bf16 v[56:71], v[88:91], v[108:111], v[56:71]
    ds_read_b128 v[88:91], v152 offset:10560
    ds_read_b64_tr_b16 v[108:109], v153 offset:25600
    ds_read_b64_tr_b16 v[110:111], v153 offset:26112
    buffer_load_dwordx4 v5, s[4:7], s84 offen offset:1024 lds
    s_waitcnt lgkmcnt(5)
    v_mfma_f32_32x32x16_bf16 v[40:55], v[112:115], v[96:99], v[40:55]
    ds_read_b64_tr_b16 v[112:113], v153 offset:28672
    ds_read_b64_tr_b16 v[114:115], v153 offset:29184
    s_add_u32 m0, s97, 0
    s_add_u32 s84, s96, 884736
    buffer_load_dwordx4 v4, s[4:7], s84 offen lds
    v_mfma_f32_32x32x16_bf16 v[56:71], v[96:99], v[116:119], v[56:71]
    ds_read_b128 v[96:99], v152 offset:11616
    ds_read_b64_tr_b16 v[116:117], v153 offset:29696
    ds_read_b64_tr_b16 v[118:119], v153 offset:30208
    buffer_load_dwordx4 v5, s[4:7], s84 offen offset:1024 lds
    s_waitcnt lgkmcnt(5)
    v_mfma_f32_32x32x16_bf16 v[40:55], v[104:107], v[88:91], v[40:55]
    ds_read_b64_tr_b16 v[104:105], v153 offset:32768
    ds_read_b64_tr_b16 v[106:107], v153 offset:33280
    s_add_u32 m0, s97, 8192
    s_add_u32 s84, s96, 1277952
    buffer_load_dwordx4 v4, s[4:7], s84 offen lds
    v_mfma_f32_32x32x16_bf16 v[56:71], v[88:91], v[108:111], v[56:71]
    ds_read_b128 v[88:91], v152 offset:14784
    ds_read_b64_tr_b16 v[108:109], v153 offset:33792
    ds_read_b64_tr_b16 v[110:111], v153 offset:34304
    buffer_load_dwordx4 v5, s[4:7], s84 offen offset:1024 lds
    s_waitcnt lgkmcnt(5)
    v_mfma_f32_32x32x16_bf16 v[40:55], v[112:115], v[96:99], v[40:55]
    ds_read_b64_tr_b16 v[112:113], v153 offset:36864
    ds_read_b64_tr_b16 v[114:115], v153 offset:37376
    s_waitcnt vmcnt(14)
    v_add_f32 v124, v124, v132
    v_add_f32 v125, v125, v133
    v_add_f32 v126, v126, v134
    v_mfma_f32_32x32x16_bf16 v[56:71], v[96:99], v[116:119], v[56:71]
    ds_read_b128 v[96:99], v152 offset:15840
    ds_read_b64_tr_b16 v[116:117], v153 offset:37888
    ds_read_b64_tr_b16 v[118:119], v153 offset:38400
    v_add_f32 v127, v127, v135
    s_waitcnt lgkmcnt(5)
    v_mfma_f32_32x32x16_bf16 v[40:55], v[104:107], v[88:91], v[40:55]
    s_waitcnt vmcnt(12)
    s_barrier
    ds_read_b64_tr_b16 v[104:105], v153 offset:40960
    ds_read_b64_tr_b16 v[106:107], v153 offset:41472
    v_add_f32 v128, v128, v136
    v_add_f32 v129, v129, v137
    v_add_f32 v130, v130, v138
    v_add_f32 v131, v131, v139
    v_mfma_f32_32x32x16_bf16 v[56:71], v[88:91], v[108:111], v[56:71]
    ds_read_b128 v[88:91], v152 offset:19008
    ds_read_b64_tr_b16 v[108:109], v153 offset:41984
    ds_read_b64_tr_b16 v[110:111], v153 offset:42496
    v_add_f32 v124, v124, v128
    s_waitcnt lgkmcnt(5)
    v_mfma_f32_32x32x16_bf16 v[40:55], v[112:115], v[96:99], v[40:55]
    ds_read_b64_tr_b16 v[112:113], v153 offset:45056
    ds_read_b64_tr_b16 v[114:115], v153 offset:45568
    v_add_f32 v125, v125, v129
    v_add_f32 v126, v126, v130
    v_add_f32 v127, v127, v131
    v_add_f32 v148, v124, v126
    v_mfma_f32_32x32x16_bf16 v[56:71], v[96:99], v[116:119], v[56:71]
    ds_read_b128 v[96:99], v152 offset:20064
    ds_read_b64_tr_b16 v[116:117], v153 offset:46080
    ds_read_b64_tr_b16 v[118:119], v153 offset:46592
    v_add_f32 v149, v125, v127
    s_waitcnt lgkmcnt(5)
    v_mfma_f32_32x32x16_bf16 v[40:55], v[104:107], v[88:91], v[40:55]
    ds_read_b64_tr_b16 v[104:105], v153 offset:49152
    ds_read_b64_tr_b16 v[106:107], v153 offset:49664
    v_mov_b32 v11, v148
    v_mov_b32 v12, v149
    s_nop 0
    v_permlane32_swap_b32 v148, v11
    v_mfma_f32_32x32x16_bf16 v[56:71], v[88:91], v[108:111], v[56:71]
    ds_read_b128 v[88:91], v152 offset:23232
    ds_read_b64_tr_b16 v[108:109], v153 offset:50176
    ds_read_b64_tr_b16 v[110:111], v153 offset:50688
    v_permlane32_swap_b32 v149, v12
    s_waitcnt lgkmcnt(5)
    v_mfma_f32_32x32x16_bf16 v[40:55], v[112:115], v[96:99], v[40:55]
    ds_read_b64_tr_b16 v[112:113], v153 offset:53248
    ds_read_b64_tr_b16 v[114:115], v153 offset:53760
    v_add_f32 v148, v148, v11
    v_add_f32 v149, v149, v12
    v_mul_f32 v148, 0x3b000000, v148
    v_mul_f32 v149, 0x3b000000, v149
    v_mfma_f32_32x32x16_bf16 v[56:71], v[96:99], v[116:119], v[56:71]
    ds_read_b128 v[96:99], v152 offset:24288
    ds_read_b64_tr_b16 v[116:117], v153 offset:54272
    ds_read_b64_tr_b16 v[118:119], v153 offset:54784
    v_fma_f32 v149, -v148, v148, v149
    s_waitcnt lgkmcnt(5)
    v_mfma_f32_32x32x16_bf16 v[40:55], v[104:107], v[88:91], v[40:55]
    s_waitcnt vmcnt(8)
    s_barrier
    ds_read_b64_tr_b16 v[104:105], v153 offset:57344
    ds_read_b64_tr_b16 v[106:107], v153 offset:57856
    v_max_f32 v149, 0, v149
    v_add_f32 v149, 0x3727c5ac, v149
    v_rsq_f32 v149, v149
    v_mfma_f32_32x32x16_bf16 v[56:71], v[88:91], v[108:111], v[56:71]
    ds_read_b128 v[88:91], v152 offset:27456
    ds_read_b64_tr_b16 v[108:109], v153 offset:58368
    ds_read_b64_tr_b16 v[110:111], v153 offset:58880
    v_and_b32 v12, 31, v1
    s_waitcnt lgkmcnt(5)
    v_mfma_f32_32x32x16_bf16 v[40:55], v[112:115], v[96:99], v[40:55]
    ds_read_b64_tr_b16 v[112:113], v153 offset:61440
    ds_read_b64_tr_b16 v[114:115], v153 offset:61952
    v_lshlrev_b32 v12, 2, v12
    s_lshl_b32 s24, s16, 8
    s_add_u32 s24, s24, 162816
    v_add_u32 v11, s24, v12
    v_mfma_f32_32x32x16_bf16 v[56:71], v[96:99], v[116:119], v[56:71]
    ds_read_b128 v[96:99], v152 offset:28512
    ds_read_b64_tr_b16 v[116:117], v153 offset:62464
    ds_read_b64_tr_b16 v[118:119], v153 offset:62976
    ds_write_b32 v11, v148
    s_waitcnt lgkmcnt(6)
    v_mfma_f32_32x32x16_bf16 v[40:55], v[104:107], v[88:91], v[40:55]
    ds_read_b64_tr_b16 v[104:105], v154 offset:0
    ds_read_b64_tr_b16 v[106:107], v154 offset:512
    ds_write_b32 v11, v149 offset:128
    v_mul_f32 v151, 0x3eb8aa3b, v149
    v_lshrrev_b32 v13, 5, v1
    v_lshlrev_b32 v13, 4, v13
    v_mfma_f32_32x32x16_bf16 v[56:71], v[88:91], v[108:111], v[56:71]
    ds_read_b128 v[88:91], v152 offset:31680
    ds_read_b64_tr_b16 v[108:109], v154 offset:1024
    ds_read_b64_tr_b16 v[110:111], v154 offset:1536
    v_add_u32 v14, s24, v13
    s_waitcnt lgkmcnt(7)
    v_mfma_f32_32x32x16_bf16 v[40:55], v[112:115], v[96:99], v[40:55]
    ds_read_b64_tr_b16 v[112:113], v154 offset:4096
    ds_read_b64_tr_b16 v[114:115], v154 offset:4608
    s_lshl_b32 s24, s23, 7
    s_add_u32 s24, s24, 160768
    v_add_u32 v13, s24, v13
    v_add_u32 v12, s24, v12
    v_mfma_f32_32x32x16_bf16 v[56:71], v[96:99], v[116:119], v[56:71]
    ds_read_b128 v[96:99], v152 offset:32736
    ds_read_b64_tr_b16 v[116:117], v154 offset:5120
    ds_read_b64_tr_b16 v[118:119], v154 offset:5632
    ds_read_b32 v150, v12 offset:512
    s_waitcnt lgkmcnt(6)
    v_mfma_f32_32x32x16_bf16 v[40:55], v[104:107], v[88:91], v[40:55]
    s_waitcnt vmcnt(4)
    s_barrier
    ds_read_b64_tr_b16 v[92:93], v158 offset:8192
    ds_read_b64_tr_b16 v[94:95], v158 offset:8704
    ds_read_b128 v[132:135], v13 offset:256
    ds_read_b128 v[136:139], v13 offset:288
    v_mfma_f32_32x32x16_bf16 v[56:71], v[88:91], v[108:111], v[56:71]
    ds_read_b128 v[88:91], v152 offset:2112
    ds_read_b128 v[140:143], v13 offset:320
    ds_read_b128 v[144:147], v13 offset:352
    s_waitcnt lgkmcnt(8)
    v_mfma_f32_32x32x16_bf16 v[40:55], v[112:115], v[96:99], v[40:55]
    ds_read_b64_tr_b16 v[100:101], v158 offset:10240
    ds_read_b64_tr_b16 v[102:103], v158 offset:10752
    v_and_b32 v155, 0x33, v1
    v_bfe_u32 v12, v1, 2, 1
    v_lshl_add_u32 v155, v12, 3, v155
    v_bfe_u32 v12, v1, 3, 1
    v_mfma_f32_32x32x16_bf16 v[56:71], v[96:99], v[116:119], v[56:71]
    ds_read_b128 v[96:99], v152 offset:3168
    v_lshl_add_u32 v155, v12, 2, v155
    v_lshlrev_b32 v155, 4, v155
    ds_read_b128 v[104:107], v14 offset:0
    ds_read_b128 v[108:111], v14 offset:32
    ds_read_b128 v[112:115], v14 offset:64
    ds_read_b128 v[116:119], v14 offset:96
    s_waitcnt lgkmcnt(9)
    v_mfma_f32_32x32x16_bf16 v[72:87], v[92:95], v[88:91], v[72:87]
    ds_read_b128 v[88:91], v152 offset:6336
    ds_read_b64_tr_b16 v[92:93], v158 offset:12288
    ds_read_b64_tr_b16 v[94:95], v158 offset:12800
    s_waitcnt lgkmcnt(7)
    v_mfma_f32_32x32x16_bf16 v[72:87], v[100:103], v[96:99], v[72:87]
    ds_read_b128 v[96:99], v152 offset:7392
    ds_read_b64_tr_b16 v[100:101], v158 offset:14336
    ds_read_b64_tr_b16 v[102:103], v158 offset:14848
    s_waitcnt lgkmcnt(3)
    v_mfma_f32_32x32x16_bf16 v[72:87], v[92:95], v[88:91], v[72:87]
    ds_read_b128 v[88:91], v152 offset:10560
    ds_read_b64_tr_b16 v[92:93], v158 offset:16384
    ds_read_b64_tr_b16 v[94:95], v158 offset:16896
    s_waitcnt lgkmcnt(9)
    v_sub_f32 v148, 0, v148
    v_sub_f32 v150, 0, v150
    v_pk_fma_f32 v[40:41], v[132:133], v[148:149], v[40:41] op_sel_hi:[1,0,1]
    v_pk_fma_f32 v[42:43], v[134:135], v[148:149], v[42:43] op_sel_hi:[1,0,1]
    v_pk_fma_f32 v[44:45], v[136:137], v[148:149], v[44:45] op_sel_hi:[1,0,1]
    v_pk_fma_f32 v[46:47], v[138:139], v[148:149], v[46:47] op_sel_hi:[1,0,1]
    v_pk_fma_f32 v[48:49], v[140:141], v[148:149], v[48:49] op_sel_hi:[1,0,1]
    v_pk_fma_f32 v[50:51], v[142:143], v[148:149], v[50:51] op_sel_hi:[1,0,1]
    v_pk_fma_f32 v[52:53], v[144:145], v[148:149], v[52:53] op_sel_hi:[1,0,1]
    v_pk_fma_f32 v[54:55], v[146:147], v[148:149], v[54:55] op_sel_hi:[1,0,1]
    ds_read_b128 v[132:135], v14 offset:128
    ds_read_b128 v[136:139], v14 offset:160
    ds_read_b128 v[140:143], v14 offset:192
    ds_read_b128 v[144:147], v14 offset:224
    v_pk_mul_f32 v[40:41], v[40:41], v[148:149] op_sel:[0,1] op_sel_hi:[1,1]
    v_pk_mul_f32 v[42:43], v[42:43], v[148:149] op_sel:[0,1] op_sel_hi:[1,1]
    v_pk_mul_f32 v[44:45], v[44:45], v[148:149] op_sel:[0,1] op_sel_hi:[1,1]
    v_pk_mul_f32 v[46:47], v[46:47], v[148:149] op_sel:[0,1] op_sel_hi:[1,1]
    v_pk_mul_f32 v[48:49], v[48:49], v[148:149] op_sel:[0,1] op_sel_hi:[1,1]
    v_pk_mul_f32 v[50:51], v[50:51], v[148:149] op_sel:[0,1] op_sel_hi:[1,1]
    v_pk_mul_f32 v[52:53], v[52:53], v[148:149] op_sel:[0,1] op_sel_hi:[1,1]
    v_pk_mul_f32 v[54:55], v[54:55], v[148:149] op_sel:[0,1] op_sel_hi:[1,1]
    v_cvt_pk_bf16_f32 v40, v40, v41
    v_cvt_pk_bf16_f32 v41, v42, v43
    v_cvt_pk_bf16_f32 v42, v44, v45
    v_cvt_pk_bf16_f32 v43, v46, v47
    v_cvt_pk_bf16_f32 v44, v48, v49
    v_cvt_pk_bf16_f32 v45, v50, v51
    v_cvt_pk_bf16_f32 v46, v52, v53
    v_cvt_pk_bf16_f32 v47, v54, v55
    buffer_store_dwordx4 v[40:43], v155, s[12:15], s100 offen sc1
    buffer_store_dwordx4 v[44:47], v155, s[12:15], s101 offen sc1
    v_pk_fma_f32 v[56:57], v[104:105], v[150:151], v[56:57] op_sel_hi:[1,0,1]
    v_pk_fma_f32 v[58:59], v[106:107], v[150:151], v[58:59] op_sel_hi:[1,0,1]
    v_pk_fma_f32 v[60:61], v[108:109], v[150:151], v[60:61] op_sel_hi:[1,0,1]
    v_pk_fma_f32 v[62:63], v[110:111], v[150:151], v[62:63] op_sel_hi:[1,0,1]
    v_pk_fma_f32 v[64:65], v[112:113], v[150:151], v[64:65] op_sel_hi:[1,0,1]
    v_pk_fma_f32 v[66:67], v[114:115], v[150:151], v[66:67] op_sel_hi:[1,0,1]
    v_pk_fma_f32 v[68:69], v[116:117], v[150:151], v[68:69] op_sel_hi:[1,0,1]
    v_pk_fma_f32 v[70:71], v[118:119], v[150:151], v[70:71] op_sel_hi:[1,0,1]
    s_waitcnt lgkmcnt(0)
    v_pk_mul_f32 v[56:57], v[56:57], v[132:133]
    v_pk_mul_f32 v[58:59], v[58:59], v[134:135]
    v_pk_mul_f32 v[60:61], v[60:61], v[136:137]
    v_pk_mul_f32 v[62:63], v[62:63], v[138:139]
    v_pk_mul_f32 v[64:65], v[64:65], v[140:141]
    v_pk_mul_f32 v[66:67], v[66:67], v[142:143]
    v_pk_mul_f32 v[68:69], v[68:69], v[144:145]
    v_pk_mul_f32 v[70:71], v[70:71], v[146:147]
    ds_read_b128 v[104:107], v13 offset:0
    ds_read_b128 v[108:111], v13 offset:32
    ds_read_b128 v[112:115], v13 offset:64
    ds_read_b128 v[116:119], v13 offset:96
    v_cvt_pk_bf16_f32 v56, v56, v57
    v_cvt_pk_bf16_f32 v57, v58, v59
    v_cvt_pk_bf16_f32 v58, v60, v61
    v_cvt_pk_bf16_f32 v59, v62, v63
    v_cvt_pk_bf16_f32 v60, v64, v65
    v_cvt_pk_bf16_f32 v61, v66, v67
    v_cvt_pk_bf16_f32 v62, v68, v69
    v_cvt_pk_bf16_f32 v63, v70, v71
    buffer_store_dwordx4 v[56:59], v156, s[12:15], s100 offen offset:1024 sc1
    buffer_store_dwordx4 v[60:63], v156, s[12:15], s100 offen offset:1536 sc1
    s_waitcnt lgkmcnt(11)
    v_mfma_f32_32x32x16_bf16 v[72:87], v[100:103], v[96:99], v[72:87]
    ds_read_b128 v[96:99], v152 offset:11616
    ds_read_b64_tr_b16 v[100:101], v158 offset:18432
    ds_read_b64_tr_b16 v[102:103], v158 offset:18944
    s_waitcnt lgkmcnt(11)
    v_mfma_f32_32x32x16_bf16 v[72:87], v[92:95], v[88:91], v[72:87]
    ds_read_b128 v[88:91], v152 offset:14784
    ds_read_b64_tr_b16 v[92:93], v158 offset:20480
    ds_read_b64_tr_b16 v[94:95], v158 offset:20992
    s_waitcnt lgkmcnt(3)
    v_mfma_f32_32x32x16_bf16 v[72:87], v[100:103], v[96:99], v[72:87]
    ds_read_b128 v[96:99], v152 offset:15840
    ds_read_b64_tr_b16 v[100:101], v158 offset:22528
    ds_read_b64_tr_b16 v[102:103], v158 offset:23040
    s_waitcnt lgkmcnt(3)
    v_mfma_f32_32x32x16_bf16 v[72:87], v[92:95], v[88:91], v[72:87]
    s_waitcnt vmcnt(4)
    s_barrier
    ds_read_b128 v[88:91], v152 offset:19008
    ds_read_b64_tr_b16 v[92:93], v157 offset:0
    ds_read_b64_tr_b16 v[94:95], v157 offset:512
    s_waitcnt lgkmcnt(3)
    v_mfma_f32_32x32x16_bf16 v[72:87], v[100:103], v[96:99], v[72:87]
    ds_read_b128 v[96:99], v152 offset:20064
    ds_read_b64_tr_b16 v[100:101], v157 offset:2048
    ds_read_b64_tr_b16 v[102:103], v157 offset:2560
    s_waitcnt lgkmcnt(3)
    v_mfma_f32_32x32x16_bf16 v[72:87], v[92:95], v[88:91], v[72:87]
    ds_read_b128 v[88:91], v152 offset:23232
    ds_read_b64_tr_b16 v[92:93], v157 offset:4096
    ds_read_b64_tr_b16 v[94:95], v157 offset:4608
    s_waitcnt lgkmcnt(3)
    v_mfma_f32_32x32x16_bf16 v[72:87], v[100:103], v[96:99], v[72:87]
    ds_read_b128 v[96:99], v152 offset:24288
    ds_read_b64_tr_b16 v[100:101], v157 offset:6144
    ds_read_b64_tr_b16 v[102:103], v157 offset:6656
    s_waitcnt lgkmcnt(3)
    v_mfma_f32_32x32x16_bf16 v[72:87], v[92:95], v[88:91], v[72:87]
    ds_read_b128 v[88:91], v152 offset:27456
    ds_read_b64_tr_b16 v[92:93], v157 offset:8192
    ds_read_b64_tr_b16 v[94:95], v157 offset:8704
    s_waitcnt lgkmcnt(3)
    v_mfma_f32_32x32x16_bf16 v[72:87], v[100:103], v[96:99], v[72:87]
    ds_read_b128 v[96:99], v152 offset:28512
    ds_read_b64_tr_b16 v[100:101], v157 offset:10240
    ds_read_b64_tr_b16 v[102:103], v157 offset:10752
    s_waitcnt lgkmcnt(3)
    v_mfma_f32_32x32x16_bf16 v[72:87], v[92:95], v[88:91], v[72:87]
    ds_read_b128 v[88:91], v152 offset:31680
    ds_read_b64_tr_b16 v[92:93], v157 offset:12288
    ds_read_b64_tr_b16 v[94:95], v157 offset:12800
    s_waitcnt lgkmcnt(3)
    v_mfma_f32_32x32x16_bf16 v[72:87], v[100:103], v[96:99], v[72:87]
    ds_read_b128 v[96:99], v152 offset:32736
    ds_read_b64_tr_b16 v[100:101], v157 offset:14336
    ds_read_b64_tr_b16 v[102:103], v157 offset:14848
    s_waitcnt lgkmcnt(3)
    v_mfma_f32_32x32x16_bf16 v[72:87], v[92:95], v[88:91], v[72:87]
    s_waitcnt lgkmcnt(0)
    v_mfma_f32_32x32x16_bf16 v[72:87], v[100:103], v[96:99], v[72:87]
    s_lshl_b32 s24, s21, 5
    s_add_u32 s24, s24, s20
    s_lshl_b32 s24, s24, 7
    s_add_u32 s72, s24, 31457280
    s_add_u32 s73, s72, 32768
    s_waitcnt vmcnt(0)
    s_barrier
    s_cmp_lg_u32 s16, 0
    s_cbranch_scc1 L_f1_32
    v_mov_b32 v11, 1
    v_mov_b32 v12, 0
    s_mov_b64 exec, 1
    s_cmp_eq_u32 s35, 0
    s_cbranch_scc1 L_ls_33_g
    buffer_store_dword v11, v12, s[12:15], s73 offen
L_ls_33_d:
    s_mov_b64 exec, -1
L_f1_32:
    s_cmp_lg_u32 s16, 1
    s_cbranch_scc1 L_f1_34
    v_mov_b32 v11, 1
    v_mov_b32 v12, 0
    s_mov_b64 exec, 1
    buffer_store_dword v11, v12, s[12:15], s72 offen sc1
    s_mov_b64 exec, -1
L_f1_34:
    s_mov_b32 s19, 16777216
    v_pk_fma_f32 v[72:73], v[104:105], v[148:149], v[72:73] op_sel_hi:[1,0,1]
    v_pk_fma_f32 v[74:75], v[106:107], v[148:149], v[74:75] op_sel_hi:[1,0,1]
    v_pk_fma_f32 v[76:77], v[108:109], v[148:149], v[76:77] op_sel_hi:[1,0,1]
    v_pk_fma_f32 v[78:79], v[110:111], v[148:149], v[78:79] op_sel_hi:[1,0,1]
    v_pk_fma_f32 v[80:81], v[112:113], v[148:149], v[80:81] op_sel_hi:[1,0,1]
    v_pk_fma_f32 v[82:83], v[114:115], v[148:149], v[82:83] op_sel_hi:[1,0,1]
    v_pk_fma_f32 v[84:85], v[116:117], v[148:149], v[84:85] op_sel_hi:[1,0,1]
    v_pk_fma_f32 v[86:87], v[118:119], v[148:149], v[86:87] op_sel_hi:[1,0,1]
    v_pk_mul_f32 v[72:73], v[72:73], v[150:151] op_sel:[0,1] op_sel_hi:[1,1]
    v_pk_mul_f32 v[74:75], v[74:75], v[150:151] op_sel:[0,1] op_sel_hi:[1,1]
    v_pk_mul_f32 v[76:77], v[76:77], v[150:151] op_sel:[0,1] op_sel_hi:[1,1]
    v_pk_mul_f32 v[78:79], v[78:79], v[150:151] op_sel:[0,1] op_sel_hi:[1,1]
    v_pk_mul_f32 v[80:81], v[80:81], v[150:151] op_sel:[0,1] op_sel_hi:[1,1]
    v_pk_mul_f32 v[82:83], v[82:83], v[150:151] op_sel:[0,1] op_sel_hi:[1,1]
    v_pk_mul_f32 v[84:85], v[84:85], v[150:151] op_sel:[0,1] op_sel_hi:[1,1]
    v_pk_mul_f32 v[86:87], v[86:87], v[150:151] op_sel:[0,1] op_sel_hi:[1,1]
    v_cvt_pk_bf16_f32 v72, v72, v73
    v_cvt_pk_bf16_f32 v73, v74, v75
    v_cvt_pk_bf16_f32 v74, v76, v77
    v_cvt_pk_bf16_f32 v75, v78, v79
    v_cvt_pk_bf16_f32 v76, v80, v81
    v_cvt_pk_bf16_f32 v77, v82, v83
    v_cvt_pk_bf16_f32 v78, v84, v85
    v_cvt_pk_bf16_f32 v79, v86, v87
    v_min_u32 v72, -2, v72
    v_min_u32 v73, -2, v73
    v_min_u32 v74, -2, v74
    v_min_u32 v75, -2, v75
    v_min_u32 v76, -2, v76
    v_min_u32 v77, -2, v77
    v_min_u32 v78, -2, v78
    v_min_u32 v79, -2, v79
    s_cmp_eq_u32 s35, 0
    s_cbranch_scc1 L_ls_35_g
    buffer_store_dwordx4 v[72:75], v2, s[12:15], s98 offen
    buffer_store_dwordx4 v[76:79], v2, s[12:15], s99 offen
L_ls_35_d:
    s_lshl_b32 s28, s18, 17
    s_add_u32 s28, s28, 18874368
    s_lshl_b32 s30, s16, 11
    s_add_u32 s24, s28, s30
    v_add_u32 v148, s24, v2
    s_lshl_b32 s29, s17, 14
    s_lshl_b32 s27, s17, 2
    s_add_u32 s27, s27, s16
    s_lshl_b32 s26, s18, 5
    s_add_u32 s26, s26, s27
    s_lshl_b32 s26, s26, 11
    s_add_u32 s26, s26, 16777216
    s_lshl_b32 s24, s21, 12
    s_lshl_b32 s25, s22, 7
    s_add_u32 s25, s25, s24
    s_add_u32 s76, s25, 31457280
    s_lshl_b32 s25, s17, 9
    s_add_u32 s25, s25, s24
    s_add_u32 s25, s25, 31490048
    s_lshl_b32 s75, s27, 6
    s_add_u32 s75, s75, s18
    s_lshl_b32 s75, s75, 10
    s_add_u32 s75, s75, 23068672
    s_add_u32 s77, s75, 32768
    v_min_u32 v20, 3, v1
    v_lshlrev_b32 v20, 7, v20
    v_and_b32 v11, 1, v1
    v_bfe_u32 v12, v1, 1, 1
    v_lshlrev_b32 v13, 4, v11
    v_lshl_add_u32 v13, v12, 6, v13
    v_bfe_u32 v12, v1, 2, 1
    v_lshl_add_u32 v13, v12, 9, v13
    v_bfe_u32 v12, v1, 3, 2
    v_lshl_add_u32 v13, v12, 11, v13
    v_add_u32 v13, 155648, v13
    v_cmp_eq_u32 vcc, 0, v11
    v_mov_b32 v12, 0x3f803f80
    v_mov_b32 v136, 0xdddd
    v_cndmask_b32 v48, 0, v12, vcc
    v_cndmask_b32 v49, 0, v12, vcc
    v_cndmask_b32 v50, 0, v12, vcc
    v_cndmask_b32 v51, 0, v12, vcc
    ds_write_b128 v13, v[48:51]
    v_add_u32 v146, 24576, v2
    v_add_u32 v147, 90112, v2
    v_and_b32 v11, 15, v1
    v_lshlrev_b32 v12, 4, v11
    v_lshrrev_b32 v13, 5, v1
    v_lshl_add_u32 v12, v13, 8, v12
    v_add_u32 v13, 4, v11
    v_bfe_u32 v13, v13, 3, 1
    v_lshlrev_b32 v13, 6, v13
    v_and_b32 v11, 11, v11
    v_cmp_ne_u32 vcc, 0, v11
    v_add_u32 v13, 155648, v13
    v_add_u32 v14, 16, v13
    v_cndmask_b32 v13, v13, v14, vcc
    v_and_b32 v11, 16, v1
    v_cmp_ne_u32 vcc, 0, v11
    v_add_u32 v140, 25600, v12
    v_add_u32 v141, 58368, v12
    v_add_u32 v142, 91136, v12
    v_add_u32 v143, 123904, v12
    v_add_u32 v144, 132096, v12
    v_add_u32 v145, 140288, v12
    v_cndmask_b32 v140, v140, v13, vcc
    v_cndmask_b32 v141, v141, v13, vcc
    v_cndmask_b32 v142, v142, v13, vcc
    v_cndmask_b32 v143, v143, v13, vcc
    v_cndmask_b32 v144, v144, v13, vcc
    v_cndmask_b32 v145, v145, v13, vcc
    v_pk_mov_b32 v[72:73], 0, 0
    v_pk_mov_b32 v[74:75], 0, 0
    v_pk_mov_b32 v[76:77], 0, 0
    v_pk_mov_b32 v[78:79], 0, 0
    v_pk_mov_b32 v[80:81], 0, 0
    v_pk_mov_b32 v[82:83], 0, 0
    v_pk_mov_b32 v[84:85], 0, 0
    v_pk_mov_b32 v[86:87], 0, 0
    v_pk_mov_b32 v[88:89], 0, 0
    v_pk_mov_b32 v[90:91], 0, 0
    v_pk_mov_b32 v[92:93], 0, 0
    v_pk_mov_b32 v[94:95], 0, 0
    v_pk_mov_b32 v[96:97], 0, 0
    v_pk_mov_b32 v[98:99], 0, 0
    v_pk_mov_b32 v[100:101], 0, 0
    v_pk_mov_b32 v[102:103], 0, 0
    s_cmp_lg_u32 s16, 2
    s_cbranch_scc1 L_qp_36
    s_mov_b32 s24, 0
L_pl_37:
    buffer_load_dword v14, v20, s[12:15], s25 offen sc1
    s_add_u32 s24, s24, 1
    s_waitcnt vmcnt(0)
    v_cmp_eq_u32 vcc, 0, v14
    s_cmp_ge_u32 s24, 65536
    s_cbranch_scc1 L_pl_37_x
    s_cbranch_vccz L_pl_37_x
    s_mov_b64 exec, vcc
    s_branch L_pl_37
L_pl_37_x:
    s_mov_b64 exec, -1
L_pl_37_go:
L_qp_36:
    s_barrier
    s_add_u32 m0, s30, 90112
    s_and_b32 s29, s29, 0x1ffff
    buffer_load_dwordx4 v148, s[12:15], s29 offen sc1 lds
    buffer_load_dwordx4 v148, s[12:15], s29 offen offset:1024 sc1 lds
    buffer_load_dwordx4 v[40:43], v2, s[12:15], s26 offen offset:0 sc1
    buffer_load_dwordx4 v[44:47], v2, s[12:15], s26 offen offset:1024 sc1
    s_add_u32 s29, s29, 8192
    s_add_u32 m0, s30, 122880
    s_and_b32 s29, s29, 0x1ffff
    buffer_load_dwordx4 v148, s[12:15], s29 offen sc1 lds
    buffer_load_dwordx4 v148, s[12:15], s29 offen offset:1024 sc1 lds
    v_min_u32 v20, 15, v1
    v_lshlrev_b32 v20, 8, v20
    s_cmp_lg_u32 s16, 0
    s_cbranch_scc1 L_ts_A_0
    s_mov_b64 exec, 0
    s_branch L_pad_A_0
L_ret_A_0:
    s_branch L_pad_A_4
L_ret_A_4:
    s_mov_b64 exec, -1
L_ts_A_0:
    s_cmp_lg_u32 s16, 1
    s_cbranch_scc1 L_ts_A_1
    s_mov_b64 exec, 0
    s_branch L_pad_A_1
L_ret_A_1:
    s_branch L_ret_A_5
L_ret_A_5:
    s_mov_b64 exec, -1
L_ts_A_1:
    s_cmp_lg_u32 s16, 2
    s_cbranch_scc1 L_ts_A_2
    s_mov_b64 exec, 0
    s_branch L_pad_A_2
L_ret_A_2:
    s_branch L_ret_A_6
L_ret_A_6:
    s_mov_b64 exec, -1
L_ts_A_2:
    s_cmp_lg_u32 s16, 3
    s_cbranch_scc1 L_ts_A_3
    s_mov_b64 exec, 0
    s_branch L_pad_A_3
L_ret_A_3:
    s_branch L_ret_A_7
L_ret_A_7:
    s_mov_b64 exec, -1
L_ts_A_3:
L_reg_A:
    s_waitcnt vmcnt(2)
    v_max3_u32 v14, v40, v41, v42
    v_max3_u32 v13, v44, v45, v46
    v_max3_u32 v14, v14, v43, v47
    v_max_u32 v14, v14, v13
    v_cmp_eq_u32 vcc, -1, v14
    s_waitcnt lgkmcnt(0)
    s_barrier
    ds_read_b128 v[48:51], v147 offset:0
    ds_read_b128 v[52:55], v147 offset:2048
L_pad_A_0:
    s_cbranch_execz L_ret_A_0
    ds_read_b128 v[56:59], v142 offset:0
    ds_read_b128 v[60:63], v142 offset:512
    s_cbranch_vccnz L_qt_38
L_qt_38_d:
    s_waitcnt lgkmcnt(3)
    v_mfma_f32_32x32x16_bf16 v[104:119], v[48:51], v[40:43], 0
    s_nop 11
    v_exp_f32 v104, v104
    v_exp_f32 v105, v105
    v_exp_f32 v106, v106
    s_waitcnt lgkmcnt(0)
    v_exp_f32 v107, v107
    v_exp_f32 v108, v108
    v_exp_f32 v109, v109
    v_mfma_f32_32x32x16_bf16 v[120:135], v[48:51], v[44:47], 0
    ds_read_b128 v[48:51], v147 offset:4096
    v_exp_f32 v110, v110
    v_exp_f32 v111, v111
    v_exp_f32 v112, v112
    v_exp_f32 v113, v113
    v_exp_f32 v114, v114
    v_smfmac_f32_32x32x32_bf16 v[72:87], v[56:59], v[104:111], v136
    ds_read_b128 v[68:71], v142 offset:2560
    v_exp_f32 v115, v115
    v_exp_f32 v116, v116
    v_exp_f32 v117, v117
    v_exp_f32 v118, v118
    v_exp_f32 v119, v119
    v_exp_f32 v120, v120
    v_exp_f32 v121, v121
    v_exp_f32 v122, v122
    v_smfmac_f32_32x32x32_bf16 v[72:87], v[60:63], v[112:119], v136
    v_exp_f32 v123, v123
    v_exp_f32 v124, v124
    v_exp_f32 v125, v125
    v_mfma_f32_32x32x16_bf16 v[104:119], v[52:55], v[40:43], 0
    ds_read_b128 v[64:67], v142 offset:2048
    v_exp_f32 v126, v126
    v_exp_f32 v127, v127
    v_exp_f32 v128, v128
    v_exp_f32 v129, v129
    v_exp_f32 v130, v130
    v_smfmac_f32_32x32x32_bf16 v[88:103], v[56:59], v[120:127], v136
    v_exp_f32 v131, v131
    v_exp_f32 v132, v132
    v_exp_f32 v133, v133
    v_exp_f32 v134, v134
    v_exp_f32 v135, v135
    v_exp_f32 v104, v104
    v_exp_f32 v105, v105
    v_exp_f32 v106, v106
    v_smfmac_f32_32x32x32_bf16 v[88:103], v[60:63], v[128:135], v136
    s_waitcnt lgkmcnt(0)
    v_exp_f32 v107, v107
    v_exp_f32 v108, v108
    v_exp_f32 v109, v109
    v_mfma_f32_32x32x16_bf16 v[120:135], v[52:55], v[44:47], 0
    ds_read_b128 v[52:55], v147 offset:6144
    v_exp_f32 v110, v110
    v_exp_f32 v111, v111
    v_exp_f32 v112, v112
    v_exp_f32 v113, v113
    v_exp_f32 v114, v114
    v_smfmac_f32_32x32x32_bf16 v[72:87], v[64:67], v[104:111], v136
    ds_read_b128 v[60:63], v142 offset:4608
    v_exp_f32 v115, v115
    v_exp_f32 v116, v116
    v_exp_f32 v117, v117
    v_exp_f32 v118, v118
    v_exp_f32 v119, v119
    v_exp_f32 v120, v120
    v_exp_f32 v121, v121
    v_exp_f32 v122, v122
    v_smfmac_f32_32x32x32_bf16 v[72:87], v[68:71], v[112:119], v136
    buffer_load_dword v14, v20, s[12:15], s76 offen sc1
    v_exp_f32 v123, v123
    v_exp_f32 v124, v124
    v_exp_f32 v125, v125
    v_mfma_f32_32x32x16_bf16 v[104:119], v[48:51], v[40:43], 0
    ds_read_b128 v[56:59], v142 offset:4096
    v_exp_f32 v126, v126
    v_exp_f32 v127, v127
    v_exp_f32 v128, v128
    v_exp_f32 v129, v129
    v_exp_f32 v130, v130
    v_smfmac_f32_32x32x32_bf16 v[88:103], v[64:67], v[120:127], v136
    v_exp_f32 v131, v131
    v_exp_f32 v132, v132
    v_exp_f32 v133, v133
    v_exp_f32 v134, v134
    v_exp_f32 v135, v135
    v_exp_f32 v104, v104
    v_exp_f32 v105, v105
    v_exp_f32 v106, v106
    v_smfmac_f32_32x32x32_bf16 v[88:103], v[68:71], v[128:135], v136
    s_waitcnt vmcnt(1) lgkmcnt(0)
    s_barrier
    v_exp_f32 v107, v107
    v_exp_f32 v108, v108
    v_exp_f32 v109, v109
    v_mfma_f32_32x32x16_bf16 v[120:135], v[48:51], v[44:47], 0
    ds_read_b128 v[48:51], v147 offset:32768
    v_exp_f32 v110, v110
    v_exp_f32 v111, v111
    v_exp_f32 v112, v112
    v_exp_f32 v113, v113
    v_exp_f32 v114, v114
    v_smfmac_f32_32x32x32_bf16 v[72:87], v[56:59], v[104:111], v136
    ds_read_b128 v[68:71], v142 offset:6656
    v_exp_f32 v115, v115
    v_exp_f32 v116, v116
    v_exp_f32 v117, v117
    v_exp_f32 v118, v118
    v_exp_f32 v119, v119
    v_exp_f32 v120, v120
    v_exp_f32 v121, v121
    v_exp_f32 v122, v122
    v_smfmac_f32_32x32x32_bf16 v[72:87], v[60:63], v[112:119], v136
    v_exp_f32 v123, v123
    v_exp_f32 v124, v124
    v_exp_f32 v125, v125
    v_mfma_f32_32x32x16_bf16 v[104:119], v[52:55], v[40:43], 0
    ds_read_b128 v[64:67], v142 offset:6144
    v_exp_f32 v126, v126
    v_exp_f32 v127, v127
    v_exp_f32 v128, v128
    v_exp_f32 v129, v129
    v_exp_f32 v130, v130
    v_smfmac_f32_32x32x32_bf16 v[88:103], v[56:59], v[120:127], v136
    v_exp_f32 v131, v131
    v_exp_f32 v132, v132
    v_exp_f32 v133, v133
    v_exp_f32 v134, v134
    v_exp_f32 v135, v135
    v_exp_f32 v104, v104
    v_exp_f32 v105, v105
    v_exp_f32 v106, v106
    v_smfmac_f32_32x32x32_bf16 v[88:103], v[60:63], v[128:135], v136
    s_waitcnt vmcnt(0) lgkmcnt(0)
    v_cmp_eq_u32 vcc, 0, v14
    v_exp_f32 v107, v107
    v_exp_f32 v108, v108
    v_exp_f32 v109, v109
    v_mfma_f32_32x32x16_bf16 v[120:135], v[52:55], v[44:47], 0
    ds_read_b128 v[52:55], v147 offset:34816
    v_exp_f32 v110, v110
    v_exp_f32 v111, v111
    v_exp_f32 v112, v112
    v_exp_f32 v113, v113
    v_exp_f32 v114, v114
    v_smfmac_f32_32x32x32_bf16 v[72:87], v[64:67], v[104:111], v136
    s_cbranch_vccnz L_gq_40
L_gq_40_d:
    s_add_u32 s29, s29, 8192
    s_add_u32 m0, s30, 131072
    s_and_b32 s29, s29, 0x1ffff
    buffer_load_dwordx4 v148, s[12:15], s29 offen sc1 lds
    buffer_load_dwordx4 v148, s[12:15], s29 offen offset:1024 sc1 lds
    s_add_u32 s29, s29, 8192
    s_add_u32 m0, s30, 139264
    s_and_b32 s29, s29, 0x1ffff
    buffer_load_dwordx4 v148, s[12:15], s29 offen sc1 lds
    buffer_load_dwordx4 v148, s[12:15], s29 offen offset:1024 sc1 lds
    ds_read_b128 v[60:63], v143 offset:512
    v_exp_f32 v115, v115
    v_exp_f32 v116, v116
    v_exp_f32 v117, v117
    v_exp_f32 v118, v118
    v_exp_f32 v119, v119
    v_exp_f32 v120, v120
    v_exp_f32 v121, v121
    v_exp_f32 v122, v122
    v_smfmac_f32_32x32x32_bf16 v[72:87], v[68:71], v[112:119], v136
    v_exp_f32 v123, v123
    v_exp_f32 v124, v124
    v_exp_f32 v125, v125
    v_mfma_f32_32x32x16_bf16 v[104:119], v[48:51], v[40:43], 0
    ds_read_b128 v[56:59], v143 offset:0
    v_exp_f32 v126, v126
    v_exp_f32 v127, v127
    v_exp_f32 v128, v128
    v_exp_f32 v129, v129
    v_exp_f32 v130, v130
    v_smfmac_f32_32x32x32_bf16 v[88:103], v[64:67], v[120:127], v136
    v_exp_f32 v131, v131
    v_exp_f32 v132, v132
    v_exp_f32 v133, v133
    v_exp_f32 v134, v134
    v_exp_f32 v135, v135
    v_exp_f32 v104, v104
    v_exp_f32 v105, v105
    v_exp_f32 v106, v106
    v_smfmac_f32_32x32x32_bf16 v[88:103], v[68:71], v[128:135], v136
    s_waitcnt lgkmcnt(0)
    v_exp_f32 v107, v107
    v_exp_f32 v108, v108
    v_exp_f32 v109, v109
    v_mfma_f32_32x32x16_bf16 v[120:135], v[48:51], v[44:47], 0
    ds_read_b128 v[48:51], v147 offset:36864
    v_exp_f32 v110, v110
    v_exp_f32 v111, v111
    v_exp_f32 v112, v112
    v_exp_f32 v113, v113
    v_exp_f32 v114, v114
    v_smfmac_f32_32x32x32_bf16 v[72:87], v[56:59], v[104:111], v136
    s_add_u32 s29, s29, 8192
    s_add_u32 m0, s30, 24576
    s_and_b32 s29, s29, 0x1ffff
    buffer_load_dwordx4 v148, s[12:15], s29 offen sc1 lds
    buffer_load_dwordx4 v148, s[12:15], s29 offen offset:1024 sc1 lds
    s_add_u32 s29, s29, 8192
    ds_read_b128 v[68:71], v143 offset:2560
    v_exp_f32 v115, v115
    v_exp_f32 v116, v116
    v_exp_f32 v117, v117
    v_exp_f32 v118, v118
    v_exp_f32 v119, v119
    v_exp_f32 v120, v120
    v_exp_f32 v121, v121
    v_exp_f32 v122, v122
    v_smfmac_f32_32x32x32_bf16 v[72:87], v[60:63], v[112:119], v136
    v_exp_f32 v123, v123
    v_exp_f32 v124, v124
    v_exp_f32 v125, v125
    v_mfma_f32_32x32x16_bf16 v[104:119], v[52:55], v[40:43], 0
    ds_read_b128 v[64:67], v143 offset:2048
    v_exp_f32 v126, v126
    v_exp_f32 v127, v127
    v_exp_f32 v128, v128
    v_exp_f32 v129, v129
    v_exp_f32 v130, v130
    v_smfmac_f32_32x32x32_bf16 v[88:103], v[56:59], v[120:127], v136
    v_exp_f32 v131, v131
    v_exp_f32 v132, v132
    v_exp_f32 v133, v133
    v_exp_f32 v134, v134
    v_exp_f32 v135, v135
    v_exp_f32 v104, v104
    v_exp_f32 v105, v105
    v_exp_f32 v106, v106
    v_smfmac_f32_32x32x32_bf16 v[88:103], v[60:63], v[128:135], v136
    s_waitcnt lgkmcnt(0)
    v_exp_f32 v107, v107
    v_exp_f32 v108, v108
    v_exp_f32 v109, v109
    v_mfma_f32_32x32x16_bf16 v[120:135], v[52:55], v[44:47], 0
    ds_read_b128 v[52:55], v147 offset:38912
    v_exp_f32 v110, v110
    v_exp_f32 v111, v111
    v_exp_f32 v112, v112
    v_exp_f32 v113, v113
    v_exp_f32 v114, v114
    v_smfmac_f32_32x32x32_bf16 v[72:87], v[64:67], v[104:111], v136
    ds_read_b128 v[60:63], v143 offset:4608
    v_exp_f32 v115, v115
    v_exp_f32 v116, v116
    v_exp_f32 v117, v117
    v_exp_f32 v118, v118
    v_exp_f32 v119, v119
    v_exp_f32 v120, v120
    v_exp_f32 v121, v121
    v_exp_f32 v122, v122
    v_smfmac_f32_32x32x32_bf16 v[72:87], v[68:71], v[112:119], v136
    v_exp_f32 v123, v123
    v_exp_f32 v124, v124
    v_exp_f32 v125, v125
    v_mfma_f32_32x32x16_bf16 v[104:119], v[48:51], v[40:43], 0
    ds_read_b128 v[56:59], v143 offset:4096
    v_exp_f32 v126, v126
    v_exp_f32 v127, v127
    v_exp_f32 v128, v128
    v_exp_f32 v129, v129
    v_exp_f32 v130, v130
    v_smfmac_f32_32x32x32_bf16 v[88:103], v[64:67], v[120:127], v136
    s_add_u32 m0, s30, 57344
    s_and_b32 s29, s29, 0x1ffff
    v_exp_f32 v131, v131
    v_exp_f32 v132, v132
    v_exp_f32 v133, v133
    v_exp_f32 v134, v134
    v_exp_f32 v135, v135
    v_exp_f32 v104, v104
    v_exp_f32 v105, v105
    v_exp_f32 v106, v106
    v_smfmac_f32_32x32x32_bf16 v[88:103], v[68:71], v[128:135], v136
    s_waitcnt vmcnt(4) lgkmcnt(0)
    s_barrier
    v_exp_f32 v107, v107
    v_exp_f32 v108, v108
    v_exp_f32 v109, v109
    v_mfma_f32_32x32x16_bf16 v[120:135], v[48:51], v[44:47], 0
    ds_read_b128 v[48:51], v147 offset:40960
    v_exp_f32 v110, v110
    v_exp_f32 v111, v111
    v_exp_f32 v112, v112
    v_exp_f32 v113, v113
    v_exp_f32 v114, v114
    v_smfmac_f32_32x32x32_bf16 v[72:87], v[56:59], v[104:111], v136
    ds_read_b128 v[68:71], v143 offset:6656
    v_exp_f32 v115, v115
    v_exp_f32 v116, v116
    v_exp_f32 v117, v117
    v_exp_f32 v118, v118
    v_exp_f32 v119, v119
    v_exp_f32 v120, v120
    v_exp_f32 v121, v121
    v_exp_f32 v122, v122
    v_smfmac_f32_32x32x32_bf16 v[72:87], v[60:63], v[112:119], v136
    buffer_load_dwordx4 v148, s[12:15], s29 offen sc1 lds
    buffer_load_dwordx4 v148, s[12:15], s29 offen offset:1024 sc1 lds
    v_exp_f32 v123, v123
    v_exp_f32 v124, v124
    v_exp_f32 v125, v125
    v_mfma_f32_32x32x16_bf16 v[104:119], v[52:55], v[40:43], 0
    ds_read_b128 v[64:67], v143 offset:6144
    v_exp_f32 v126, v126
    v_exp_f32 v127, v127
    v_exp_f32 v128, v128
    v_exp_f32 v129, v129
    v_exp_f32 v130, v130
    v_smfmac_f32_32x32x32_bf16 v[88:103], v[56:59], v[120:127], v136
    v_exp_f32 v131, v131
    v_exp_f32 v132, v132
    v_exp_f32 v133, v133
    v_exp_f32 v134, v134
    v_exp_f32 v135, v135
    v_exp_f32 v104, v104
    v_exp_f32 v105, v105
    v_exp_f32 v106, v106
    v_smfmac_f32_32x32x32_bf16 v[88:103], v[60:63], v[128:135], v136
    s_waitcnt lgkmcnt(0)
    v_exp_f32 v107, v107
    v_exp_f32 v108, v108
    v_exp_f32 v109, v109
    v_mfma_f32_32x32x16_bf16 v[120:135], v[52:55], v[44:47], 0
    ds_read_b128 v[52:55], v147 offset:43008
    v_exp_f32 v110, v110
    v_exp_f32 v111, v111
    v_exp_f32 v112, v112
    v_exp_f32 v113, v113
    v_exp_f32 v114, v114
    v_smfmac_f32_32x32x32_bf16 v[72:87], v[64:67], v[104:111], v136
    ds_read_b128 v[60:63], v144 offset:512
    v_exp_f32 v115, v115
    v_exp_f32 v116, v116
    v_exp_f32 v117, v117
    v_exp_f32 v118, v118
    v_exp_f32 v119, v119
    v_exp_f32 v120, v120
    v_exp_f32 v121, v121
    v_exp_f32 v122, v122
    v_smfmac_f32_32x32x32_bf16 v[72:87], v[68:71], v[112:119], v136
    v_exp_f32 v123, v123
    v_exp_f32 v124, v124
    v_exp_f32 v125, v125
    v_mfma_f32_32x32x16_bf16 v[104:119], v[48:51], v[40:43], 0
    ds_read_b128 v[56:59], v144 offset:0
    v_exp_f32 v126, v126
    v_exp_f32 v127, v127
    v_exp_f32 v128, v128
    v_exp_f32 v129, v129
    v_exp_f32 v130, v130
    v_smfmac_f32_32x32x32_bf16 v[88:103], v[64:67], v[120:127], v136
    v_exp_f32 v131, v131
    v_exp_f32 v132, v132
    v_exp_f32 v133, v133
    v_exp_f32 v134, v134
    v_exp_f32 v135, v135
    v_exp_f32 v104, v104
    v_exp_f32 v105, v105
    v_exp_f32 v106, v106
    v_smfmac_f32_32x32x32_bf16 v[88:103], v[68:71], v[128:135], v136
    s_waitcnt lgkmcnt(0)
    s_add_u32 s29, s29, 8192
    v_exp_f32 v107, v107
    v_exp_f32 v108, v108
    v_exp_f32 v109, v109
    v_mfma_f32_32x32x16_bf16 v[120:135], v[48:51], v[44:47], 0
    ds_read_b128 v[48:51], v147 offset:45056
    v_exp_f32 v110, v110
    v_exp_f32 v111, v111
    v_exp_f32 v112, v112
    v_exp_f32 v113, v113
    v_exp_f32 v114, v114
    v_smfmac_f32_32x32x32_bf16 v[72:87], v[56:59], v[104:111], v136
    ds_read_b128 v[68:71], v144 offset:2560
    v_exp_f32 v115, v115
    v_exp_f32 v116, v116
    v_exp_f32 v117, v117
    v_exp_f32 v118, v118
    v_exp_f32 v119, v119
    v_exp_f32 v120, v120
    v_exp_f32 v121, v121
    v_exp_f32 v122, v122
    v_smfmac_f32_32x32x32_bf16 v[72:87], v[60:63], v[112:119], v136
    v_exp_f32 v123, v123
    v_exp_f32 v124, v124
    v_exp_f32 v125, v125
    v_mfma_f32_32x32x16_bf16 v[104:119], v[52:55], v[40:43], 0
    ds_read_b128 v[64:67], v144 offset:2048
    v_exp_f32 v126, v126
    v_exp_f32 v127, v127
    v_exp_f32 v128, v128
    v_exp_f32 v129, v129
    v_exp_f32 v130, v130
    v_smfmac_f32_32x32x32_bf16 v[88:103], v[56:59], v[120:127], v136
    v_exp_f32 v131, v131
    v_exp_f32 v132, v132
    v_exp_f32 v133, v133
    v_exp_f32 v134, v134
    v_exp_f32 v135, v135
    v_exp_f32 v104, v104
    v_exp_f32 v105, v105
    v_exp_f32 v106, v106
    v_smfmac_f32_32x32x32_bf16 v[88:103], v[60:63], v[128:135], v136
    s_waitcnt lgkmcnt(0)
    s_lshl_b32 s72, s21, 1
    s_add_u32 s72, s72, s22
    s_lshl_b32 s72, s72, 6
    s_lshl_b32 s73, s20, 1
    s_add_u32 s72, s72, s73
    s_add_u32 s72, s72, s23
    s_lshl_b32 s72, s72, 11
    s_add_u32 s72, s72, 27262976
    s_mul_i32 s73, s36, 224
    s_lshl_b32 s74, s37, 2
    s_add_u32 s73, s73, s74
    s_add_u32 s73, s73, s16
    s_lshl_b32 s73, s73, 10
    s_add_u32 s73, s73, 29360128
    s_add_u32 s74, s73, 114688
    v_mov_b32 v150, -1
    v_mov_b32 v151, -1
    v_mov_b32 v152, -1
    v_mov_b32 v153, -1
    v_exp_f32 v107, v107
    v_exp_f32 v108, v108
    v_exp_f32 v109, v109
    v_mfma_f32_32x32x16_bf16 v[120:135], v[52:55], v[44:47], 0
    ds_read_b128 v[52:55], v147 offset:47104
    v_exp_f32 v110, v110
    v_exp_f32 v111, v111
    v_exp_f32 v112, v112
    v_exp_f32 v113, v113
    v_exp_f32 v114, v114
    v_smfmac_f32_32x32x32_bf16 v[72:87], v[64:67], v[104:111], v136
    ds_read_b128 v[60:63], v144 offset:4608
    v_exp_f32 v115, v115
    v_exp_f32 v116, v116
    v_exp_f32 v117, v117
    v_exp_f32 v118, v118
    v_exp_f32 v119, v119
    v_exp_f32 v120, v120
    v_exp_f32 v121, v121
    v_exp_f32 v122, v122
    v_smfmac_f32_32x32x32_bf16 v[72:87], v[68:71], v[112:119], v136
    v_exp_f32 v123, v123
    v_exp_f32 v124, v124
    v_exp_f32 v125, v125
    v_mfma_f32_32x32x16_bf16 v[104:119], v[48:51], v[40:43], 0
    ds_read_b128 v[56:59], v144 offset:4096
    v_exp_f32 v126, v126
    v_exp_f32 v127, v127
    v_exp_f32 v128, v128
    v_exp_f32 v129, v129
    v_exp_f32 v130, v130
    v_smfmac_f32_32x32x32_bf16 v[88:103], v[64:67], v[120:127], v136
    s_add_u32 m0, s30, 90112
    s_and_b32 s29, s29, 0x1ffff
    v_exp_f32 v131, v131
    v_exp_f32 v132, v132
    v_exp_f32 v133, v133
    v_exp_f32 v134, v134
    v_exp_f32 v135, v135
    v_exp_f32 v104, v104
    v_exp_f32 v105, v105
    v_exp_f32 v106, v106
    v_smfmac_f32_32x32x32_bf16 v[88:103], v[68:71], v[128:135], v136
    s_waitcnt vmcnt(2) lgkmcnt(0)
    s_barrier
    buffer_store_dwordx4 v[150:153], v2, s[12:15], s72 offen offset:0 sc1
    buffer_store_dwordx4 v[150:153], v2, s[12:15], s72 offen offset:1024 sc1
    v_exp_f32 v107, v107
    v_exp_f32 v108, v108
    v_exp_f32 v109, v109
    v_mfma_f32_32x32x16_bf16 v[120:135], v[48:51], v[44:47], 0
    ds_read_b128 v[48:51], v147 offset:49152
    v_exp_f32 v110, v110
    v_exp_f32 v111, v111
    v_exp_f32 v112, v112
    v_exp_f32 v113, v113
    v_exp_f32 v114, v114
    v_smfmac_f32_32x32x32_bf16 v[72:87], v[56:59], v[104:111], v136
    ds_read_b128 v[68:71], v144 offset:6656
    v_exp_f32 v115, v115
    v_exp_f32 v116, v116
    v_exp_f32 v117, v117
    v_exp_f32 v118, v118
    v_exp_f32 v119, v119
    v_exp_f32 v120, v120
    v_exp_f32 v121, v121
    v_exp_f32 v122, v122
    v_smfmac_f32_32x32x32_bf16 v[72:87], v[60:63], v[112:119], v136
    buffer_load_dwordx4 v148, s[12:15], s29 offen sc1 lds
    buffer_load_dwordx4 v148, s[12:15], s29 offen offset:1024 sc1 lds
    v_exp_f32 v123, v123
    v_exp_f32 v124, v124
    v_exp_f32 v125, v125
    v_mfma_f32_32x32x16_bf16 v[104:119], v[52:55], v[40:43], 0
    ds_read_b128 v[64:67], v144 offset:6144
    v_exp_f32 v126, v126
    v_exp_f32 v127, v127
    v_exp_f32 v128, v128
    v_exp_f32 v129, v129
    v_exp_f32 v130, v130
    v_smfmac_f32_32x32x32_bf16 v[88:103], v[56:59], v[120:127], v136
    v_exp_f32 v131, v131
    v_exp_f32 v132, v132
    v_exp_f32 v133, v133
    v_exp_f32 v134, v134
    v_exp_f32 v135, v135
    v_exp_f32 v104, v104
    v_exp_f32 v105, v105
    v_exp_f32 v106, v106
    v_smfmac_f32_32x32x32_bf16 v[88:103], v[60:63], v[128:135], v136
    s_waitcnt lgkmcnt(0)
    buffer_store_dwordx4 v[150:153], v2, s[12:15], s73 offen offset:0 sc1
    buffer_store_dwordx4 v[150:153], v2, s[12:15], s74 offen offset:0 sc1
    v_exp_f32 v107, v107
    v_exp_f32 v108, v108
    v_exp_f32 v109, v109
    v_mfma_f32_32x32x16_bf16 v[120:135], v[52:55], v[44:47], 0
    ds_read_b128 v[52:55], v147 offset:51200
    v_exp_f32 v110, v110
    v_exp_f32 v111, v111
    v_exp_f32 v112, v112
    v_exp_f32 v113, v113
    v_exp_f32 v114, v114
    v_smfmac_f32_32x32x32_bf16 v[72:87], v[64:67], v[104:111], v136
    ds_read_b128 v[60:63], v145 offset:512
    v_exp_f32 v115, v115
    v_exp_f32 v116, v116
    v_exp_f32 v117, v117
    v_exp_f32 v118, v118
    v_exp_f32 v119, v119
    v_exp_f32 v120, v120
    v_exp_f32 v121, v121
    v_exp_f32 v122, v122
    v_smfmac_f32_32x32x32_bf16 v[72:87], v[68:71], v[112:119], v136
    v_exp_f32 v123, v123
    v_exp_f32 v124, v124
    v_exp_f32 v125, v125
    v_mfma_f32_32x32x16_bf16 v[104:119], v[48:51], v[40:43], 0
    ds_read_b128 v[56:59], v145 offset:0
    v_exp_f32 v126, v126
    v_exp_f32 v127, v127
    v_exp_f32 v128, v128
    v_exp_f32 v129, v129
    v_exp_f32 v130, v130
    v_smfmac_f32_32x32x32_bf16 v[88:103], v[64:67], v[120:127], v136
    v_exp_f32 v131, v131
    v_exp_f32 v132, v132
    v_exp_f32 v133, v133
    v_exp_f32 v134, v134
    v_exp_f32 v135, v135
    v_exp_f32 v104, v104
    v_exp_f32 v105, v105
    v_exp_f32 v106, v106
    v_smfmac_f32_32x32x32_bf16 v[88:103], v[68:71], v[128:135], v136
    s_waitcnt lgkmcnt(0)
    s_add_u32 s29, s29, 8192
    s_cmp_eq_u32 s35, 0
    s_cbranch_scc1 L_ls_41_g
    buffer_store_dwordx4 v[150:153], v2, s[12:15], s75 offen
    buffer_store_dwordx4 v[150:153], v2, s[12:15], s77 offen
L_ls_41_d:
    v_exp_f32 v107, v107
    v_exp_f32 v108, v108
    v_exp_f32 v109, v109
    v_mfma_f32_32x32x16_bf16 v[120:135], v[48:51], v[44:47], 0
    ds_read_b128 v[48:51], v147 offset:53248
    v_exp_f32 v110, v110
    v_exp_f32 v111, v111
    v_exp_f32 v112, v112
    v_exp_f32 v113, v113
    v_exp_f32 v114, v114
    v_smfmac_f32_32x32x32_bf16 v[72:87], v[56:59], v[104:111], v136
    ds_read_b128 v[68:71], v145 offset:2560
    v_exp_f32 v115, v115
    v_exp_f32 v116, v116
    v_exp_f32 v117, v117
    v_exp_f32 v118, v118
    v_exp_f32 v119, v119
    v_exp_f32 v120, v120
    v_exp_f32 v121, v121
    v_exp_f32 v122, v122
    v_smfmac_f32_32x32x32_bf16 v[72:87], v[60:63], v[112:119], v136
    v_exp_f32 v123, v123
    v_exp_f32 v124, v124
    v_exp_f32 v125, v125
    v_mfma_f32_32x32x16_bf16 v[104:119], v[52:55], v[40:43], 0
    ds_read_b128 v[64:67], v145 offset:2048
    v_exp_f32 v126, v126
    v_exp_f32 v127, v127
    v_exp_f32 v128, v128
    v_exp_f32 v129, v129
    v_exp_f32 v130, v130
    v_smfmac_f32_32x32x32_bf16 v[88:103], v[56:59], v[120:127], v136
    v_exp_f32 v131, v131
    v_exp_f32 v132, v132
    v_exp_f32 v133, v133
    v_exp_f32 v134, v134
    v_exp_f32 v135, v135
    v_exp_f32 v104, v104
    v_exp_f32 v105, v105
    v_exp_f32 v106, v106
    v_smfmac_f32_32x32x32_bf16 v[88:103], v[60:63], v[128:135], v136
    s_waitcnt lgkmcnt(0)
    v_lshlrev_b32 v138, 2, v1
    s_lshl_b32 s24, s20, 1
    s_add_u32 s24, s24, s22
    s_lshl_b32 s24, s24, 3
    s_add_u32 s24, s24, s21
    s_lshl_b32 s24, s24, 1
    s_add_u32 s24, s24, s23
    s_lshl_b32 s24, s24, 8
    s_add_u32 s72, s24, 31195136
    s_cmp_eq_u32 s35, 0
    s_cbranch_scc1 L_ls_42_g
    buffer_store_dword v150, v138, s[12:15], s72 offen
L_ls_42_d:
    v_exp_f32 v107, v107
    v_exp_f32 v108, v108
    v_exp_f32 v109, v109
    v_mfma_f32_32x32x16_bf16 v[120:135], v[52:55], v[44:47], 0
    ds_read_b128 v[52:55], v147 offset:55296
    v_exp_f32 v110, v110
    v_exp_f32 v111, v111
    v_exp_f32 v112, v112
    v_exp_f32 v113, v113
    v_exp_f32 v114, v114
    v_smfmac_f32_32x32x32_bf16 v[72:87], v[64:67], v[104:111], v136
    ds_read_b128 v[60:63], v145 offset:4608
    v_exp_f32 v115, v115
    v_exp_f32 v116, v116
    v_exp_f32 v117, v117
    v_exp_f32 v118, v118
    v_exp_f32 v119, v119
    v_exp_f32 v120, v120
    v_exp_f32 v121, v121
    v_exp_f32 v122, v122
    v_smfmac_f32_32x32x32_bf16 v[72:87], v[68:71], v[112:119], v136
    v_exp_f32 v123, v123
    v_exp_f32 v124, v124
    v_exp_f32 v125, v125
    v_mfma_f32_32x32x16_bf16 v[104:119], v[48:51], v[40:43], 0
    ds_read_b128 v[56:59], v145 offset:4096
    v_exp_f32 v126, v126
    v_exp_f32 v127, v127
    v_exp_f32 v128, v128
    v_exp_f32 v129, v129
    v_exp_f32 v130, v130
    v_smfmac_f32_32x32x32_bf16 v[88:103], v[64:67], v[120:127], v136
    s_add_u32 m0, s30, 122880
    s_and_b32 s29, s29, 0x1ffff
    v_exp_f32 v131, v131
    v_exp_f32 v132, v132
    v_exp_f32 v133, v133
    v_exp_f32 v134, v134
    v_exp_f32 v135, v135
    v_exp_f32 v104, v104
    v_exp_f32 v105, v105
    v_exp_f32 v106, v106
    v_smfmac_f32_32x32x32_bf16 v[88:103], v[68:71], v[128:135], v136
    s_waitcnt lgkmcnt(0)
    v_exp_f32 v107, v107
    v_exp_f32 v108, v108
    v_exp_f32 v109, v109
    v_mfma_f32_32x32x16_bf16 v[120:135], v[48:51], v[44:47], 0
    ds_read_b128 v[48:51], v146 offset:0
    v_exp_f32 v110, v110
    v_exp_f32 v111, v111
    v_exp_f32 v112, v112
    v_exp_f32 v113, v113
    v_exp_f32 v114, v114
    v_smfmac_f32_32x32x32_bf16 v[72:87], v[56:59], v[104:111], v136
    ds_read_b128 v[68:71], v145 offset:6656
    v_exp_f32 v115, v115
    v_exp_f32 v116, v116
    v_exp_f32 v117, v117
    v_exp_f32 v118, v118
    v_exp_f32 v119, v119
    v_exp_f32 v120, v120
    v_exp_f32 v121, v121
    v_exp_f32 v122, v122
    v_smfmac_f32_32x32x32_bf16 v[72:87], v[60:63], v[112:119], v136
    buffer_load_dwordx4 v148, s[12:15], s29 offen sc1 lds
    buffer_load_dwordx4 v148, s[12:15], s29 offen offset:1024 sc1 lds
    v_exp_f32 v123, v123
    v_exp_f32 v124, v124
    v_exp_f32 v125, v125
    v_mfma_f32_32x32x16_bf16 v[104:119], v[52:55], v[40:43], 0
    ds_read_b128 v[64:67], v145 offset:6144
    v_exp_f32 v126, v126
    v_exp_f32 v127, v127
    v_exp_f32 v128, v128
    v_exp_f32 v129, v129
    v_exp_f32 v130, v130
    v_smfmac_f32_32x32x32_bf16 v[88:103], v[56:59], v[120:127], v136
    v_exp_f32 v131, v131
    v_exp_f32 v132, v132
    v_exp_f32 v133, v133
    v_exp_f32 v134, v134
    v_exp_f32 v135, v135
    v_exp_f32 v104, v104
    v_exp_f32 v105, v105
    v_exp_f32 v106, v106
    v_smfmac_f32_32x32x32_bf16 v[88:103], v[60:63], v[128:135], v136
    s_waitcnt lgkmcnt(0)
    v_exp_f32 v107, v107
    v_exp_f32 v108, v108
    v_exp_f32 v109, v109
    v_mfma_f32_32x32x16_bf16 v[120:135], v[52:55], v[44:47], 0
    ds_read_b128 v[52:55], v146 offset:2048
    v_exp_f32 v110, v110
    v_exp_f32 v111, v111
    v_exp_f32 v112, v112
    v_exp_f32 v113, v113
    v_exp_f32 v114, v114
    v_smfmac_f32_32x32x32_bf16 v[72:87], v[64:67], v[104:111], v136
    ds_read_b128 v[60:63], v140 offset:512
    v_exp_f32 v115, v115
    v_exp_f32 v116, v116
    v_exp_f32 v117, v117
    v_exp_f32 v118, v118
    v_exp_f32 v119, v119
    v_exp_f32 v120, v120
    v_exp_f32 v121, v121
    v_exp_f32 v122, v122
    v_smfmac_f32_32x32x32_bf16 v[72:87], v[68:71], v[112:119], v136
    v_exp_f32 v123, v123
    v_exp_f32 v124, v124
    v_exp_f32 v125, v125
    v_mfma_f32_32x32x16_bf16 v[104:119], v[48:51], v[40:43], 0
    ds_read_b128 v[56:59], v140 offset:0
    v_exp_f32 v126, v126
    v_exp_f32 v127, v127
    v_exp_f32 v128, v128
    v_exp_f32 v129, v129
    v_exp_f32 v130, v130
    v_smfmac_f32_32x32x32_bf16 v[88:103], v[64:67], v[120:127], v136
    v_exp_f32 v131, v131
    v_exp_f32 v132, v132
    v_exp_f32 v133, v133
    v_exp_f32 v134, v134
    v_exp_f32 v135, v135
    v_exp_f32 v104, v104
    v_exp_f32 v105, v105
    v_exp_f32 v106, v106
    v_smfmac_f32_32x32x32_bf16 v[88:103], v[68:71], v[128:135], v136
    s_waitcnt lgkmcnt(0)
    s_add_u32 s29, s29, 8192
    v_exp_f32 v107, v107
    v_exp_f32 v108, v108
    v_exp_f32 v109, v109
    v_mfma_f32_32x32x16_bf16 v[120:135], v[48:51], v[44:47], 0
    ds_read_b128 v[48:51], v146 offset:4096
    v_exp_f32 v110, v110
    v_exp_f32 v111, v111
    v_exp_f32 v112, v112
    v_exp_f32 v113, v113
    v_exp_f32 v114, v114
    v_smfmac_f32_32x32x32_bf16 v[72:87], v[56:59], v[104:111], v136
    ds_read_b128 v[68:71], v140 offset:2560
    v_exp_f32 v115, v115
    v_exp_f32 v116, v116
    v_exp_f32 v117, v117
    v_exp_f32 v118, v118
    v_exp_f32 v119, v119
    v_exp_f32 v120, v120
    v_exp_f32 v121, v121
    v_exp_f32 v122, v122
    v_smfmac_f32_32x32x32_bf16 v[72:87], v[60:63], v[112:119], v136
    v_exp_f32 v123, v123
    v_exp_f32 v124, v124
    v_exp_f32 v125, v125
    v_mfma_f32_32x32x16_bf16 v[104:119], v[52:55], v[40:43], 0
    ds_read_b128 v[64:67], v140 offset:2048
    v_exp_f32 v126, v126
    v_exp_f32 v127, v127
    v_exp_f32 v128, v128
    v_exp_f32 v129, v129
    v_exp_f32 v130, v130
    v_smfmac_f32_32x32x32_bf16 v[88:103], v[56:59], v[120:127], v136
    v_exp_f32 v131, v131
    v_exp_f32 v132, v132
    v_exp_f32 v133, v133
    v_exp_f32 v134, v134
    v_exp_f32 v135, v135
    v_exp_f32 v104, v104
    v_exp_f32 v105, v105
    v_exp_f32 v106, v106
    v_smfmac_f32_32x32x32_bf16 v[88:103], v[60:63], v[128:135], v136
    s_waitcnt lgkmcnt(0)
    v_exp_f32 v107, v107
    v_exp_f32 v108, v108
    v_exp_f32 v109, v109
    v_mfma_f32_32x32x16_bf16 v[120:135], v[52:55], v[44:47], 0
    ds_read_b128 v[52:55], v146 offset:6144
    v_exp_f32 v110, v110
    v_exp_f32 v111, v111
    v_exp_f32 v112, v112
    v_exp_f32 v113, v113
    v_exp_f32 v114, v114
    v_smfmac_f32_32x32x32_bf16 v[72:87], v[64:67], v[104:111], v136
    ds_read_b128 v[60:63], v140 offset:4608
    v_exp_f32 v115, v115
    v_exp_f32 v116, v116
    v_exp_f32 v117, v117
    v_exp_f32 v118, v118
    v_exp_f32 v119, v119
    v_exp_f32 v120, v120
    v_exp_f32 v121, v121
L_pad_A_1:
    s_cbranch_execz L_ret_A_1
    v_exp_f32 v122, v122
    v_smfmac_f32_32x32x32_bf16 v[72:87], v[68:71], v[112:119], v136
    v_exp_f32 v123, v123
    v_exp_f32 v124, v124
    v_exp_f32 v125, v125
    v_mfma_f32_32x32x16_bf16 v[104:119], v[48:51], v[40:43], 0
    ds_read_b128 v[56:59], v140 offset:4096
    v_exp_f32 v126, v126
    v_exp_f32 v127, v127
    v_exp_f32 v128, v128
    v_exp_f32 v129, v129
    v_exp_f32 v130, v130
    v_smfmac_f32_32x32x32_bf16 v[88:103], v[64:67], v[120:127], v136
    s_add_u32 m0, s30, 131072
    s_and_b32 s29, s29, 0x1ffff
    v_exp_f32 v131, v131
    v_exp_f32 v132, v132
    v_exp_f32 v133, v133
    v_exp_f32 v134, v134
    v_exp_f32 v135, v135
    v_exp_f32 v104, v104
    v_exp_f32 v105, v105
    v_exp_f32 v106, v106
    v_smfmac_f32_32x32x32_bf16 v[88:103], v[68:71], v[128:135], v136
    s_waitcnt vmcnt(2) lgkmcnt(0)
    s_barrier
    s_cmp_lg_u32 s16, 3
    s_cbranch_scc1 L_a2_43
    s_lshl_b32 s24, s17, 7
    s_add_u32 s24, s24, 31522816
    v_mov_b32 v138, 1
    v_mov_b32 v139, 0
    s_mov_b64 exec, 1
    buffer_atomic_add v138, v139, s[12:15], s24 offen sc1
    s_mov_b64 exec, -1
L_a2_43:
    v_exp_f32 v107, v107
    v_exp_f32 v108, v108
    v_exp_f32 v109, v109
    v_mfma_f32_32x32x16_bf16 v[120:135], v[48:51], v[44:47], 0
    ds_read_b128 v[48:51], v146 offset:32768
    v_exp_f32 v110, v110
    v_exp_f32 v111, v111
    v_exp_f32 v112, v112
    v_exp_f32 v113, v113
    v_exp_f32 v114, v114
    v_smfmac_f32_32x32x32_bf16 v[72:87], v[56:59], v[104:111], v136
    ds_read_b128 v[68:71], v140 offset:6656
    v_exp_f32 v115, v115
    v_exp_f32 v116, v116
    v_exp_f32 v117, v117
    v_exp_f32 v118, v118
    v_exp_f32 v119, v119
    v_exp_f32 v120, v120
    v_exp_f32 v121, v121
    v_exp_f32 v122, v122
    v_smfmac_f32_32x32x32_bf16 v[72:87], v[60:63], v[112:119], v136
    buffer_load_dwordx4 v148, s[12:15], s29 offen sc1 lds
    buffer_load_dwordx4 v148, s[12:15], s29 offen offset:1024 sc1 lds
    v_exp_f32 v123, v123
    v_exp_f32 v124, v124
    v_exp_f32 v125, v125
    v_mfma_f32_32x32x16_bf16 v[104:119], v[52:55], v[40:43], 0
    ds_read_b128 v[64:67], v140 offset:6144
    v_exp_f32 v126, v126
    v_exp_f32 v127, v127
    v_exp_f32 v128, v128
    v_exp_f32 v129, v129
    v_exp_f32 v130, v130
    v_smfmac_f32_32x32x32_bf16 v[88:103], v[56:59], v[120:127], v136
    v_exp_f32 v131, v131
    v_exp_f32 v132, v132
    v_exp_f32 v133, v133
    v_exp_f32 v134, v134
    v_exp_f32 v135, v135
    v_exp_f32 v104, v104
    v_exp_f32 v105, v105
    v_exp_f32 v106, v106
    v_smfmac_f32_32x32x32_bf16 v[88:103], v[60:63], v[128:135], v136
    s_waitcnt lgkmcnt(0)
    v_exp_f32 v107, v107
    v_exp_f32 v108, v108
    v_exp_f32 v109, v109
    v_mfma_f32_32x32x16_bf16 v[120:135], v[52:55], v[44:47], 0
    ds_read_b128 v[52:55], v146 offset:34816
    v_exp_f32 v110, v110
    v_exp_f32 v111, v111
    v_exp_f32 v112, v112
    v_exp_f32 v113, v113
    v_exp_f32 v114, v114
    v_smfmac_f32_32x32x32_bf16 v[72:87], v[64:67], v[104:111], v136
    ds_read_b128 v[60:63], v141 offset:512
    v_exp_f32 v115, v115
    v_exp_f32 v116, v116
    v_exp_f32 v117, v117
    v_exp_f32 v118, v118
    v_exp_f32 v119, v119
    v_exp_f32 v120, v120
    v_exp_f32 v121, v121
    v_exp_f32 v122, v122
    v_smfmac_f32_32x32x32_bf16 v[72:87], v[68:71], v[112:119], v136
    v_exp_f32 v123, v123
    v_exp_f32 v124, v124
    v_exp_f32 v125, v125
    v_mfma_f32_32x32x16_bf16 v[104:119], v[48:51], v[40:43], 0
    ds_read_b128 v[56:59], v141 offset:0
    v_exp_f32 v126, v126
    v_exp_f32 v127, v127
    v_exp_f32 v128, v128
    v_exp_f32 v129, v129
    v_exp_f32 v130, v130
    v_smfmac_f32_32x32x32_bf16 v[88:103], v[64:67], v[120:127], v136
    v_exp_f32 v131, v131
    v_exp_f32 v132, v132
    v_exp_f32 v133, v133
    v_exp_f32 v134, v134
    v_exp_f32 v135, v135
    v_exp_f32 v104, v104
    v_exp_f32 v105, v105
    v_exp_f32 v106, v106
    v_smfmac_f32_32x32x32_bf16 v[88:103], v[68:71], v[128:135], v136
    s_waitcnt lgkmcnt(0)
    s_add_u32 s29, s29, 8192
    v_exp_f32 v107, v107
    v_exp_f32 v108, v108
    v_exp_f32 v109, v109
    v_mfma_f32_32x32x16_bf16 v[120:135], v[48:51], v[44:47], 0
    ds_read_b128 v[48:51], v146 offset:36864
    v_exp_f32 v110, v110
    v_exp_f32 v111, v111
    v_exp_f32 v112, v112
    v_exp_f32 v113, v113
    v_exp_f32 v114, v114
    v_smfmac_f32_32x32x32_bf16 v[72:87], v[56:59], v[104:111], v136
    ds_read_b128 v[68:71], v141 offset:2560
    v_exp_f32 v115, v115
    v_exp_f32 v116, v116
    v_exp_f32 v117, v117
    v_exp_f32 v118, v118
    v_exp_f32 v119, v119
    v_exp_f32 v120, v120
    v_exp_f32 v121, v121
    v_exp_f32 v122, v122
    v_smfmac_f32_32x32x32_bf16 v[72:87], v[60:63], v[112:119], v136
    v_exp_f32 v123, v123
    v_exp_f32 v124, v124
    v_exp_f32 v125, v125
    v_mfma_f32_32x32x16_bf16 v[104:119], v[52:55], v[40:43], 0
    ds_read_b128 v[64:67], v141 offset:2048
    v_exp_f32 v126, v126
    v_exp_f32 v127, v127
    v_exp_f32 v128, v128
    v_exp_f32 v129, v129
    v_exp_f32 v130, v130
    v_smfmac_f32_32x32x32_bf16 v[88:103], v[56:59], v[120:127], v136
    v_exp_f32 v131, v131
    v_exp_f32 v132, v132
    v_exp_f32 v133, v133
    v_exp_f32 v134, v134
    v_exp_f32 v135, v135
    v_exp_f32 v104, v104
    v_exp_f32 v105, v105
    v_exp_f32 v106, v106
    v_smfmac_f32_32x32x32_bf16 v[88:103], v[60:63], v[128:135], v136
    s_waitcnt lgkmcnt(0)
    v_exp_f32 v107, v107
    v_exp_f32 v108, v108
    v_exp_f32 v109, v109
    v_mfma_f32_32x32x16_bf16 v[120:135], v[52:55], v[44:47], 0
    ds_read_b128 v[52:55], v146 offset:38912
    v_exp_f32 v110, v110
    v_exp_f32 v111, v111
    v_exp_f32 v112, v112
    v_exp_f32 v113, v113
    v_exp_f32 v114, v114
    v_smfmac_f32_32x32x32_bf16 v[72:87], v[64:67], v[104:111], v136
    ds_read_b128 v[60:63], v141 offset:4608
    v_exp_f32 v115, v115
    v_exp_f32 v116, v116
    v_exp_f32 v117, v117
    v_exp_f32 v118, v118
    v_exp_f32 v119, v119
    v_exp_f32 v120, v120
    v_exp_f32 v121, v121
    v_exp_f32 v122, v122
    v_smfmac_f32_32x32x32_bf16 v[72:87], v[68:71], v[112:119], v136
    v_exp_f32 v123, v123
    v_exp_f32 v124, v124
    v_exp_f32 v125, v125
    v_mfma_f32_32x32x16_bf16 v[104:119], v[48:51], v[40:43], 0
    ds_read_b128 v[56:59], v141 offset:4096
    v_exp_f32 v126, v126
    v_exp_f32 v127, v127
    v_exp_f32 v128, v128
    v_exp_f32 v129, v129
    v_exp_f32 v130, v130
    v_smfmac_f32_32x32x32_bf16 v[88:103], v[64:67], v[120:127], v136
    s_add_u32 m0, s30, 139264
    s_and_b32 s29, s29, 0x1ffff
    v_exp_f32 v131, v131
    v_exp_f32 v132, v132
    v_exp_f32 v133, v133
    v_exp_f32 v134, v134
    v_exp_f32 v135, v135
    v_exp_f32 v104, v104
    v_exp_f32 v105, v105
    v_exp_f32 v106, v106
    v_smfmac_f32_32x32x32_bf16 v[88:103], v[68:71], v[128:135], v136
    s_waitcnt lgkmcnt(0)
    v_exp_f32 v107, v107
    v_exp_f32 v108, v108
    v_exp_f32 v109, v109
    v_mfma_f32_32x32x16_bf16 v[120:135], v[48:51], v[44:47], 0
    ds_read_b128 v[48:51], v147 offset:0
    v_exp_f32 v110, v110
    v_exp_f32 v111, v111
    v_exp_f32 v112, v112
    v_exp_f32 v113, v113
    v_exp_f32 v114, v114
    v_smfmac_f32_32x32x32_bf16 v[72:87], v[56:59], v[104:111], v136
    ds_read_b128 v[68:71], v141 offset:6656
    v_exp_f32 v115, v115
    v_exp_f32 v116, v116
    v_exp_f32 v117, v117
    v_exp_f32 v118, v118
    v_exp_f32 v119, v119
    v_exp_f32 v120, v120
    v_exp_f32 v121, v121
    v_exp_f32 v122, v122
    v_smfmac_f32_32x32x32_bf16 v[72:87], v[60:63], v[112:119], v136
    buffer_load_dwordx4 v148, s[12:15], s29 offen sc1 lds
    buffer_load_dwordx4 v148, s[12:15], s29 offen offset:1024 sc1 lds
    v_exp_f32 v123, v123
    v_exp_f32 v124, v124
    v_exp_f32 v125, v125
    v_mfma_f32_32x32x16_bf16 v[104:119], v[52:55], v[40:43], 0
    ds_read_b128 v[64:67], v141 offset:6144
    v_exp_f32 v126, v126
    v_exp_f32 v127, v127
    v_exp_f32 v128, v128
    v_exp_f32 v129, v129
    v_exp_f32 v130, v130
    v_smfmac_f32_32x32x32_bf16 v[88:103], v[56:59], v[120:127], v136
    v_exp_f32 v131, v131
    v_exp_f32 v132, v132
    v_exp_f32 v133, v133
    v_exp_f32 v134, v134
    v_exp_f32 v135, v135
    v_exp_f32 v104, v104
    v_exp_f32 v105, v105
    v_exp_f32 v106, v106
    v_smfmac_f32_32x32x32_bf16 v[88:103], v[60:63], v[128:135], v136
    s_waitcnt lgkmcnt(0)
    v_exp_f32 v107, v107
    v_exp_f32 v108, v108
    v_exp_f32 v109, v109
    v_mfma_f32_32x32x16_bf16 v[120:135], v[52:55], v[44:47], 0
    ds_read_b128 v[52:55], v147 offset:2048
    v_exp_f32 v110, v110
    v_exp_f32 v111, v111
    v_exp_f32 v112, v112
    v_exp_f32 v113, v113
    v_exp_f32 v114, v114
    v_smfmac_f32_32x32x32_bf16 v[72:87], v[64:67], v[104:111], v136
    ds_read_b128 v[60:63], v142 offset:512
    v_exp_f32 v115, v115
    v_exp_f32 v116, v116
    v_exp_f32 v117, v117
    v_exp_f32 v118, v118
    v_exp_f32 v119, v119
    v_exp_f32 v120, v120
    v_exp_f32 v121, v121
    v_exp_f32 v122, v122
    v_smfmac_f32_32x32x32_bf16 v[72:87], v[68:71], v[112:119], v136
    v_exp_f32 v123, v123
    v_exp_f32 v124, v124
    v_exp_f32 v125, v125
    v_mfma_f32_32x32x16_bf16 v[104:119], v[48:51], v[40:43], 0
    ds_read_b128 v[56:59], v142 offset:0
    v_exp_f32 v126, v126
    v_exp_f32 v127, v127
    v_exp_f32 v128, v128
    v_exp_f32 v129, v129
    v_exp_f32 v130, v130
    v_smfmac_f32_32x32x32_bf16 v[88:103], v[64:67], v[120:127], v136
    v_exp_f32 v131, v131
    v_exp_f32 v132, v132
    v_exp_f32 v133, v133
    v_exp_f32 v134, v134
    v_exp_f32 v135, v135
    v_exp_f32 v104, v104
    v_exp_f32 v105, v105
    v_exp_f32 v106, v106
    v_smfmac_f32_32x32x32_bf16 v[88:103], v[68:71], v[128:135], v136
    s_waitcnt lgkmcnt(0)
    s_add_u32 s29, s29, 8192
    v_exp_f32 v107, v107
    v_exp_f32 v108, v108
    v_exp_f32 v109, v109
    v_mfma_f32_32x32x16_bf16 v[120:135], v[48:51], v[44:47], 0
    ds_read_b128 v[48:51], v147 offset:4096
    v_exp_f32 v110, v110
    v_exp_f32 v111, v111
    v_exp_f32 v112, v112
    v_exp_f32 v113, v113
    v_exp_f32 v114, v114
    v_smfmac_f32_32x32x32_bf16 v[72:87], v[56:59], v[104:111], v136
    ds_read_b128 v[68:71], v142 offset:2560
    v_exp_f32 v115, v115
    v_exp_f32 v116, v116
    v_exp_f32 v117, v117
    v_exp_f32 v118, v118
    v_exp_f32 v119, v119
    v_exp_f32 v120, v120
    v_exp_f32 v121, v121
    v_exp_f32 v122, v122
    v_smfmac_f32_32x32x32_bf16 v[72:87], v[60:63], v[112:119], v136
    v_exp_f32 v123, v123
    v_exp_f32 v124, v124
    v_exp_f32 v125, v125
    v_mfma_f32_32x32x16_bf16 v[104:119], v[52:55], v[40:43], 0
    ds_read_b128 v[64:67], v142 offset:2048
    v_exp_f32 v126, v126
    v_exp_f32 v127, v127
    v_exp_f32 v128, v128
    v_exp_f32 v129, v129
    v_exp_f32 v130, v130
    v_smfmac_f32_32x32x32_bf16 v[88:103], v[56:59], v[120:127], v136
    v_exp_f32 v131, v131
    v_exp_f32 v132, v132
    v_exp_f32 v133, v133
    v_exp_f32 v134, v134
    v_exp_f32 v135, v135
    v_exp_f32 v104, v104
    v_exp_f32 v105, v105
    v_exp_f32 v106, v106
    v_smfmac_f32_32x32x32_bf16 v[88:103], v[60:63], v[128:135], v136
    s_waitcnt lgkmcnt(0)
    v_exp_f32 v107, v107
    v_exp_f32 v108, v108
    v_exp_f32 v109, v109
    v_mfma_f32_32x32x16_bf16 v[120:135], v[52:55], v[44:47], 0
    ds_read_b128 v[52:55], v147 offset:6144
    v_exp_f32 v110, v110
    v_exp_f32 v111, v111
    v_exp_f32 v112, v112
    v_exp_f32 v113, v113
    v_exp_f32 v114, v114
    v_smfmac_f32_32x32x32_bf16 v[72:87], v[64:67], v[104:111], v136
    ds_read_b128 v[60:63], v142 offset:4608
    v_exp_f32 v115, v115
    v_exp_f32 v116, v116
    v_exp_f32 v117, v117
    v_exp_f32 v118, v118
    v_exp_f32 v119, v119
    v_exp_f32 v120, v120
    v_exp_f32 v121, v121
    v_exp_f32 v122, v122
    v_smfmac_f32_32x32x32_bf16 v[72:87], v[68:71], v[112:119], v136
    v_exp_f32 v123, v123
    v_exp_f32 v124, v124
    v_exp_f32 v125, v125
    v_mfma_f32_32x32x16_bf16 v[104:119], v[48:51], v[40:43], 0
    ds_read_b128 v[56:59], v142 offset:4096
    v_exp_f32 v126, v126
    v_exp_f32 v127, v127
    v_exp_f32 v128, v128
    v_exp_f32 v129, v129
    v_exp_f32 v130, v130
    v_smfmac_f32_32x32x32_bf16 v[88:103], v[64:67], v[120:127], v136
    s_add_u32 m0, s30, 24576
    s_and_b32 s29, s29, 0x1ffff
    v_exp_f32 v131, v131
    v_exp_f32 v132, v132
    v_exp_f32 v133, v133
    v_exp_f32 v134, v134
    v_exp_f32 v135, v135
    v_exp_f32 v104, v104
    v_exp_f32 v105, v105
    v_exp_f32 v106, v106
    v_smfmac_f32_32x32x32_bf16 v[88:103], v[68:71], v[128:135], v136
    s_waitcnt vmcnt(2) lgkmcnt(0)
    s_barrier
    v_exp_f32 v107, v107
    v_exp_f32 v108, v108
    v_exp_f32 v109, v109
    v_mfma_f32_32x32x16_bf16 v[120:135], v[48:51], v[44:47], 0
    ds_read_b128 v[48:51], v147 offset:32768
    v_exp_f32 v110, v110
    v_exp_f32 v111, v111
    v_exp_f32 v112, v112
    v_exp_f32 v113, v113
    v_exp_f32 v114, v114
    v_smfmac_f32_32x32x32_bf16 v[72:87], v[56:59], v[104:111], v136
    ds_read_b128 v[68:71], v142 offset:6656
    v_exp_f32 v115, v115
    v_exp_f32 v116, v116
    v_exp_f32 v117, v117
    v_exp_f32 v118, v118
    v_exp_f32 v119, v119
    v_exp_f32 v120, v120
    v_exp_f32 v121, v121
    v_exp_f32 v122, v122
    v_smfmac_f32_32x32x32_bf16 v[72:87], v[60:63], v[112:119], v136
    buffer_load_dwordx4 v148, s[12:15], s29 offen sc1 lds
    buffer_load_dwordx4 v148, s[12:15], s29 offen offset:1024 sc1 lds
    v_exp_f32 v123, v123
    v_exp_f32 v124, v124
    v_exp_f32 v125, v125
    v_mfma_f32_32x32x16_bf16 v[104:119], v[52:55], v[40:43], 0
    ds_read_b128 v[64:67], v142 offset:6144
    v_exp_f32 v126, v126
    v_exp_f32 v127, v127
    v_exp_f32 v128, v128
    v_exp_f32 v129, v129
    v_exp_f32 v130, v130
    v_smfmac_f32_32x32x32_bf16 v[88:103], v[56:59], v[120:127], v136
    v_exp_f32 v131, v131
    v_exp_f32 v132, v132
    v_exp_f32 v133, v133
    v_exp_f32 v134, v134
    v_exp_f32 v135, v135
    v_exp_f32 v104, v104
    v_exp_f32 v105, v105
    v_exp_f32 v106, v106
    v_smfmac_f32_32x32x32_bf16 v[88:103], v[60:63], v[128:135], v136
    s_waitcnt lgkmcnt(0)
    v_exp_f32 v107, v107
    v_exp_f32 v108, v108
    v_exp_f32 v109, v109
    v_mfma_f32_32x32x16_bf16 v[120:135], v[52:55], v[44:47], 0
    ds_read_b128 v[52:55], v147 offset:34816
    v_exp_f32 v110, v110
    v_exp_f32 v111, v111
    v_exp_f32 v112, v112
    v_exp_f32 v113, v113
    v_exp_f32 v114, v114
    v_smfmac_f32_32x32x32_bf16 v[72:87], v[64:67], v[104:111], v136
    ds_read_b128 v[60:63], v143 offset:512
    v_exp_f32 v115, v115
    v_exp_f32 v116, v116
    v_exp_f32 v117, v117
    v_exp_f32 v118, v118
    v_exp_f32 v119, v119
    v_exp_f32 v120, v120
    v_exp_f32 v121, v121
    v_exp_f32 v122, v122
    v_smfmac_f32_32x32x32_bf16 v[72:87], v[68:71], v[112:119], v136
    v_exp_f32 v123, v123
    v_exp_f32 v124, v124
    v_exp_f32 v125, v125
    v_mfma_f32_32x32x16_bf16 v[104:119], v[48:51], v[40:43], 0
    ds_read_b128 v[56:59], v143 offset:0
    v_exp_f32 v126, v126
    v_exp_f32 v127, v127
    v_exp_f32 v128, v128
    v_exp_f32 v129, v129
    v_exp_f32 v130, v130
    v_smfmac_f32_32x32x32_bf16 v[88:103], v[64:67], v[120:127], v136
    v_exp_f32 v131, v131
    v_exp_f32 v132, v132
    v_exp_f32 v133, v133
    v_exp_f32 v134, v134
    v_exp_f32 v135, v135
    v_exp_f32 v104, v104
    v_exp_f32 v105, v105
    v_exp_f32 v106, v106
    v_smfmac_f32_32x32x32_bf16 v[88:103], v[68:71], v[128:135], v136
    s_waitcnt lgkmcnt(0)
    s_add_u32 s29, s29, 8192
    v_exp_f32 v107, v107
    v_exp_f32 v108, v108
    v_exp_f32 v109, v109
    v_mfma_f32_32x32x16_bf16 v[120:135], v[48:51], v[44:47], 0
    ds_read_b128 v[48:51], v147 offset:36864
    v_exp_f32 v110, v110
    v_exp_f32 v111, v111
    v_exp_f32 v112, v112
    v_exp_f32 v113, v113
    v_exp_f32 v114, v114
    v_smfmac_f32_32x32x32_bf16 v[72:87], v[56:59], v[104:111], v136
    ds_read_b128 v[68:71], v143 offset:2560
    v_exp_f32 v115, v115
    v_exp_f32 v116, v116
    v_exp_f32 v117, v117
    v_exp_f32 v118, v118
    v_exp_f32 v119, v119
    v_exp_f32 v120, v120
    v_exp_f32 v121, v121
    v_exp_f32 v122, v122
    v_smfmac_f32_32x32x32_bf16 v[72:87], v[60:63], v[112:119], v136
    v_exp_f32 v123, v123
    v_exp_f32 v124, v124
    v_exp_f32 v125, v125
    v_mfma_f32_32x32x16_bf16 v[104:119], v[52:55], v[40:43], 0
    ds_read_b128 v[64:67], v143 offset:2048
    v_exp_f32 v126, v126
    v_exp_f32 v127, v127
    v_exp_f32 v128, v128
    v_exp_f32 v129, v129
    v_exp_f32 v130, v130
    v_smfmac_f32_32x32x32_bf16 v[88:103], v[56:59], v[120:127], v136
    v_exp_f32 v131, v131
    v_exp_f32 v132, v132
    v_exp_f32 v133, v133
    v_exp_f32 v134, v134
    v_exp_f32 v135, v135
    v_exp_f32 v104, v104
    v_exp_f32 v105, v105
    v_exp_f32 v106, v106
    v_smfmac_f32_32x32x32_bf16 v[88:103], v[60:63], v[128:135], v136
    s_waitcnt lgkmcnt(0)
    v_exp_f32 v107, v107
    v_exp_f32 v108, v108
    v_exp_f32 v109, v109
    v_mfma_f32_32x32x16_bf16 v[120:135], v[52:55], v[44:47], 0
    ds_read_b128 v[52:55], v147 offset:38912
    v_exp_f32 v110, v110
    v_exp_f32 v111, v111
    v_exp_f32 v112, v112
    v_exp_f32 v113, v113
    v_exp_f32 v114, v114
    v_smfmac_f32_32x32x32_bf16 v[72:87], v[64:67], v[104:111], v136
    ds_read_b128 v[60:63], v143 offset:4608
    v_exp_f32 v115, v115
    v_exp_f32 v116, v116
    v_exp_f32 v117, v117
    v_exp_f32 v118, v118
    v_exp_f32 v119, v119
    v_exp_f32 v120, v120
    v_exp_f32 v121, v121
    v_exp_f32 v122, v122
    v_smfmac_f32_32x32x32_bf16 v[72:87], v[68:71], v[112:119], v136
    v_exp_f32 v123, v123
    v_exp_f32 v124, v124
    v_exp_f32 v125, v125
    v_mfma_f32_32x32x16_bf16 v[104:119], v[48:51], v[40:43], 0
    ds_read_b128 v[56:59], v143 offset:4096
    v_exp_f32 v126, v126
    v_exp_f32 v127, v127
    v_exp_f32 v128, v128
    v_exp_f32 v129, v129
    v_exp_f32 v130, v130
    v_smfmac_f32_32x32x32_bf16 v[88:103], v[64:67], v[120:127], v136
    s_add_u32 m0, s30, 57344
    s_and_b32 s29, s29, 0x1ffff
    v_exp_f32 v131, v131
    v_exp_f32 v132, v132
    v_exp_f32 v133, v133
    v_exp_f32 v134, v134
    v_exp_f32 v135, v135
    v_exp_f32 v104, v104
    v_exp_f32 v105, v105
    v_exp_f32 v106, v106
    v_smfmac_f32_32x32x32_bf16 v[88:103], v[68:71], v[128:135], v136
    s_waitcnt lgkmcnt(0)
    v_exp_f32 v107, v107
    v_exp_f32 v108, v108
    v_exp_f32 v109, v109
    v_mfma_f32_32x32x16_bf16 v[120:135], v[48:51], v[44:47], 0
    ds_read_b128 v[48:51], v147 offset:40960
    v_exp_f32 v110, v110
    v_exp_f32 v111, v111
    v_exp_f32 v112, v112
    v_exp_f32 v113, v113
    v_exp_f32 v114, v114
    v_smfmac_f32_32x32x32_bf16 v[72:87], v[56:59], v[104:111], v136
    ds_read_b128 v[68:71], v143 offset:6656
    v_exp_f32 v115, v115
    v_exp_f32 v116, v116
    v_exp_f32 v117, v117
    v_exp_f32 v118, v118
    v_exp_f32 v119, v119
    v_exp_f32 v120, v120
    v_exp_f32 v121, v121
    v_exp_f32 v122, v122
    v_smfmac_f32_32x32x32_bf16 v[72:87], v[60:63], v[112:119], v136
    buffer_load_dwordx4 v148, s[12:15], s29 offen sc1 lds
    buffer_load_dwordx4 v148, s[12:15], s29 offen offset:1024 sc1 lds
    v_exp_f32 v123, v123
    v_exp_f32 v124, v124
    v_exp_f32 v125, v125
    v_mfma_f32_32x32x16_bf16 v[104:119], v[52:55], v[40:43], 0
    ds_read_b128 v[64:67], v143 offset:6144
    v_exp_f32 v126, v126
    v_exp_f32 v127, v127
    v_exp_f32 v128, v128
    v_exp_f32 v129, v129
    v_exp_f32 v130, v130
    v_smfmac_f32_32x32x32_bf16 v[88:103], v[56:59], v[120:127], v136
    v_bfe_u32 v11, v1, 4, 1
    v_lshlrev_b32 v11, 1, v11
    v_xor_b32 v11, v11, v1
    v_and_b32 v11, 7, v11
    v_lshlrev_b32 v11, 4, v11
    v_mul_u32_u24 v4, 1024, v3
    v_add_u32 v4, v4, v11
    v_add_u32 v5, 7168, v4
    v_add_u32 v6, 14336, v4
    v_add_u32 v7, 21504, v4
    s_lshl_b32 s33, s16, 17
    s_lshl_b32 s24, s21, 7
    s_add_u32 s33, s33, s24
    s_sub_u32 s33, s33, 32768
    s_add_u32 m0, s34, 0
    s_add_u32 s33, s33, 32768
    v_exp_f32 v131, v131
    v_exp_f32 v132, v132
    v_exp_f32 v133, v133
    v_exp_f32 v134, v134
    v_exp_f32 v135, v135
    v_exp_f32 v104, v104
    v_exp_f32 v105, v105
    v_exp_f32 v106, v106
    v_smfmac_f32_32x32x32_bf16 v[88:103], v[60:63], v[128:135], v136
    s_waitcnt lgkmcnt(0)
    v_exp_f32 v107, v107
    v_exp_f32 v108, v108
    v_exp_f32 v109, v109
    v_mfma_f32_32x32x16_bf16 v[120:135], v[52:55], v[44:47], 0
    ds_read_b128 v[52:55], v147 offset:43008
    v_exp_f32 v110, v110
    v_exp_f32 v111, v111
    v_exp_f32 v112, v112
    v_exp_f32 v113, v113
    v_exp_f32 v114, v114
    v_smfmac_f32_32x32x32_bf16 v[72:87], v[64:67], v[104:111], v136
    ds_read_b128 v[60:63], v144 offset:512
    v_exp_f32 v115, v115
    v_exp_f32 v116, v116
    v_exp_f32 v117, v117
    v_exp_f32 v118, v118
    v_exp_f32 v119, v119
    v_exp_f32 v120, v120
    v_exp_f32 v121, v121
    v_exp_f32 v122, v122
    v_smfmac_f32_32x32x32_bf16 v[72:87], v[68:71], v[112:119], v136
    buffer_load_dwordx4 v4, s[8:11], s33 offen offset:0 lds
    buffer_load_dwordx4 v5, s[8:11], s33 offen offset:1024 lds
    v_exp_f32 v123, v123
    v_exp_f32 v124, v124
    v_exp_f32 v125, v125
    v_mfma_f32_32x32x16_bf16 v[104:119], v[48:51], v[40:43], 0
    ds_read_b128 v[56:59], v144 offset:0
    v_exp_f32 v126, v126
    v_exp_f32 v127, v127
    v_exp_f32 v128, v128
    v_exp_f32 v129, v129
    v_exp_f32 v130, v130
    v_smfmac_f32_32x32x32_bf16 v[88:103], v[64:67], v[120:127], v136
    buffer_load_dwordx4 v6, s[8:11], s33 offen offset:2048 lds
    buffer_load_dwordx4 v7, s[8:11], s33 offen offset:3072 lds
    v_exp_f32 v131, v131
    v_exp_f32 v132, v132
    v_exp_f32 v133, v133
    v_exp_f32 v134, v134
    v_exp_f32 v135, v135
    v_exp_f32 v104, v104
    v_exp_f32 v105, v105
    v_exp_f32 v106, v106
    v_smfmac_f32_32x32x32_bf16 v[88:103], v[68:71], v[128:135], v136
    s_waitcnt lgkmcnt(0)
    s_add_u32 s29, s29, 8192
    v_exp_f32 v107, v107
    v_exp_f32 v108, v108
    v_exp_f32 v109, v109
    v_mfma_f32_32x32x16_bf16 v[120:135], v[48:51], v[44:47], 0
    ds_read_b128 v[48:51], v147 offset:45056
    v_exp_f32 v110, v110
    v_exp_f32 v111, v111
    v_exp_f32 v112, v112
    v_exp_f32 v113, v113
    v_exp_f32 v114, v114
    v_smfmac_f32_32x32x32_bf16 v[72:87], v[56:59], v[104:111], v136
    ds_read_b128 v[68:71], v144 offset:2560
    v_exp_f32 v115, v115
    v_exp_f32 v116, v116
    v_exp_f32 v117, v117
    v_exp_f32 v118, v118
    v_exp_f32 v119, v119
    v_exp_f32 v120, v120
    v_exp_f32 v121, v121
    v_exp_f32 v122, v122
    v_smfmac_f32_32x32x32_bf16 v[72:87], v[60:63], v[112:119], v136
    s_add_u32 m0, s34, 4096
    s_add_u32 s33, s33, 32768
    v_exp_f32 v123, v123
    v_exp_f32 v124, v124
    v_exp_f32 v125, v125
    v_mfma_f32_32x32x16_bf16 v[104:119], v[52:55], v[40:43], 0
    ds_read_b128 v[64:67], v144 offset:2048
    v_exp_f32 v126, v126
    v_exp_f32 v127, v127
    v_exp_f32 v128, v128
    v_exp_f32 v129, v129
    v_exp_f32 v130, v130
    v_smfmac_f32_32x32x32_bf16 v[88:103], v[56:59], v[120:127], v136
    buffer_load_dwordx4 v4, s[8:11], s33 offen offset:0 lds
    buffer_load_dwordx4 v5, s[8:11], s33 offen offset:1024 lds
    v_exp_f32 v131, v131
    v_exp_f32 v132, v132
    v_exp_f32 v133, v133
    v_exp_f32 v134, v134
    v_exp_f32 v135, v135
    v_exp_f32 v104, v104
    v_exp_f32 v105, v105
    v_exp_f32 v106, v106
    v_smfmac_f32_32x32x32_bf16 v[88:103], v[60:63], v[128:135], v136
    s_waitcnt lgkmcnt(0)
    v_exp_f32 v107, v107
    v_exp_f32 v108, v108
    v_exp_f32 v109, v109
    v_mfma_f32_32x32x16_bf16 v[120:135], v[52:55], v[44:47], 0
    ds_read_b128 v[52:55], v147 offset:47104
    v_exp_f32 v110, v110
    v_exp_f32 v111, v111
    v_exp_f32 v112, v112
    v_exp_f32 v113, v113
    v_exp_f32 v114, v114
    v_smfmac_f32_32x32x32_bf16 v[72:87], v[64:67], v[104:111], v136
    ds_read_b128 v[60:63], v144 offset:4608
    v_exp_f32 v115, v115
    v_exp_f32 v116, v116
    v_exp_f32 v117, v117
    v_exp_f32 v118, v118
    v_exp_f32 v119, v119
    v_exp_f32 v120, v120
    v_exp_f32 v121, v121
    v_exp_f32 v122, v122
    v_smfmac_f32_32x32x32_bf16 v[72:87], v[68:71], v[112:119], v136
    buffer_load_dwordx4 v6, s[8:11], s33 offen offset:2048 lds
    buffer_load_dwordx4 v7, s[8:11], s33 offen offset:3072 lds
    v_exp_f32 v123, v123
    v_exp_f32 v124, v124
    v_exp_f32 v125, v125
    v_mfma_f32_32x32x16_bf16 v[104:119], v[48:51], v[40:43], 0
    ds_read_b128 v[56:59], v144 offset:4096
    v_exp_f32 v126, v126
    v_exp_f32 v127, v127
    v_exp_f32 v128, v128
    v_exp_f32 v129, v129
    v_exp_f32 v130, v130
    v_smfmac_f32_32x32x32_bf16 v[88:103], v[64:67], v[120:127], v136
    s_add_u32 m0, s30, 90112
    s_and_b32 s29, s29, 0x1ffff
    v_exp_f32 v131, v131
    v_exp_f32 v132, v132
    v_exp_f32 v133, v133
    v_exp_f32 v134, v134
    v_exp_f32 v135, v135
    v_exp_f32 v104, v104
    v_exp_f32 v105, v105
    v_exp_f32 v106, v106
    v_smfmac_f32_32x32x32_bf16 v[88:103], v[68:71], v[128:135], v136
    s_waitcnt vmcnt(10) lgkmcnt(0)
    s_barrier
    v_exp_f32 v107, v107
    v_exp_f32 v108, v108
    v_exp_f32 v109, v109
    v_mfma_f32_32x32x16_bf16 v[120:135], v[48:51], v[44:47], 0
    ds_read_b128 v[48:51], v147 offset:49152
    v_exp_f32 v110, v110
    v_exp_f32 v111, v111
    v_exp_f32 v112, v112
    v_exp_f32 v113, v113
    v_exp_f32 v114, v114
    v_smfmac_f32_32x32x32_bf16 v[72:87], v[56:59], v[104:111], v136
    ds_read_b128 v[68:71], v144 offset:6656
    v_exp_f32 v115, v115
    v_exp_f32 v116, v116
    v_exp_f32 v117, v117
    v_exp_f32 v118, v118
    v_exp_f32 v119, v119
    v_exp_f32 v120, v120
    v_exp_f32 v121, v121
    v_exp_f32 v122, v122
    v_smfmac_f32_32x32x32_bf16 v[72:87], v[60:63], v[112:119], v136
    buffer_load_dwordx4 v148, s[12:15], s29 offen sc1 lds
    buffer_load_dwordx4 v148, s[12:15], s29 offen offset:1024 sc1 lds
    v_exp_f32 v123, v123
    v_exp_f32 v124, v124
    v_exp_f32 v125, v125
    v_mfma_f32_32x32x16_bf16 v[104:119], v[52:55], v[40:43], 0
    ds_read_b128 v[64:67], v144 offset:6144
    v_exp_f32 v126, v126
    v_exp_f32 v127, v127
    v_exp_f32 v128, v128
    v_exp_f32 v129, v129
    v_exp_f32 v130, v130
    v_smfmac_f32_32x32x32_bf16 v[88:103], v[56:59], v[120:127], v136
    s_add_u32 m0, s34, 8192
    s_add_u32 s33, s33, 32768
    v_exp_f32 v131, v131
    v_exp_f32 v132, v132
    v_exp_f32 v133, v133
    v_exp_f32 v134, v134
    v_exp_f32 v135, v135
    v_exp_f32 v104, v104
    v_exp_f32 v105, v105
    v_exp_f32 v106, v106
    v_smfmac_f32_32x32x32_bf16 v[88:103], v[60:63], v[128:135], v136
    s_waitcnt lgkmcnt(0)
    v_exp_f32 v107, v107
    v_exp_f32 v108, v108
    v_exp_f32 v109, v109
    v_mfma_f32_32x32x16_bf16 v[120:135], v[52:55], v[44:47], 0
    ds_read_b128 v[52:55], v147 offset:51200
    v_exp_f32 v110, v110
    v_exp_f32 v111, v111
    v_exp_f32 v112, v112
    v_exp_f32 v113, v113
    v_exp_f32 v114, v114
    v_smfmac_f32_32x32x32_bf16 v[72:87], v[64:67], v[104:111], v136
    ds_read_b128 v[60:63], v145 offset:512
    v_exp_f32 v115, v115
    v_exp_f32 v116, v116
    v_exp_f32 v117, v117
L_pad_A_2:
    s_cbranch_execz L_ret_A_2
    v_exp_f32 v118, v118
    v_exp_f32 v119, v119
    v_exp_f32 v120, v120
    v_exp_f32 v121, v121
    v_exp_f32 v122, v122
    v_smfmac_f32_32x32x32_bf16 v[72:87], v[68:71], v[112:119], v136
    buffer_load_dwordx4 v4, s[8:11], s33 offen offset:0 lds
    buffer_load_dwordx4 v5, s[8:11], s33 offen offset:1024 lds
    v_exp_f32 v123, v123
    v_exp_f32 v124, v124
    v_exp_f32 v125, v125
    v_mfma_f32_32x32x16_bf16 v[104:119], v[48:51], v[40:43], 0
    ds_read_b128 v[56:59], v145 offset:0
    v_exp_f32 v126, v126
    v_exp_f32 v127, v127
    v_exp_f32 v128, v128
    v_exp_f32 v129, v129
    v_exp_f32 v130, v130
    v_smfmac_f32_32x32x32_bf16 v[88:103], v[64:67], v[120:127], v136
    buffer_load_dwordx4 v6, s[8:11], s33 offen offset:2048 lds
    buffer_load_dwordx4 v7, s[8:11], s33 offen offset:3072 lds
    v_exp_f32 v131, v131
    v_exp_f32 v132, v132
    v_exp_f32 v133, v133
    v_exp_f32 v134, v134
    v_exp_f32 v135, v135
    v_exp_f32 v104, v104
    v_exp_f32 v105, v105
    v_exp_f32 v106, v106
    v_smfmac_f32_32x32x32_bf16 v[88:103], v[68:71], v[128:135], v136
    s_waitcnt lgkmcnt(0)
    s_add_u32 s29, s29, 8192
    v_exp_f32 v107, v107
    v_exp_f32 v108, v108
    v_exp_f32 v109, v109
    v_mfma_f32_32x32x16_bf16 v[120:135], v[48:51], v[44:47], 0
    ds_read_b128 v[48:51], v147 offset:53248
    v_exp_f32 v110, v110
    v_exp_f32 v111, v111
    v_exp_f32 v112, v112
    v_exp_f32 v113, v113
    v_exp_f32 v114, v114
    v_smfmac_f32_32x32x32_bf16 v[72:87], v[56:59], v[104:111], v136
    ds_read_b128 v[68:71], v145 offset:2560
    v_exp_f32 v115, v115
    v_exp_f32 v116, v116
    v_exp_f32 v117, v117
    v_exp_f32 v118, v118
    v_exp_f32 v119, v119
    v_exp_f32 v120, v120
    v_exp_f32 v121, v121
    v_exp_f32 v122, v122
    v_smfmac_f32_32x32x32_bf16 v[72:87], v[60:63], v[112:119], v136
    s_add_u32 m0, s34, 12288
    s_add_u32 s33, s33, 32768
    v_exp_f32 v123, v123
    v_exp_f32 v124, v124
    v_exp_f32 v125, v125
    v_mfma_f32_32x32x16_bf16 v[104:119], v[52:55], v[40:43], 0
    ds_read_b128 v[64:67], v145 offset:2048
    v_exp_f32 v126, v126
    v_exp_f32 v127, v127
    v_exp_f32 v128, v128
    v_exp_f32 v129, v129
    v_exp_f32 v130, v130
    v_smfmac_f32_32x32x32_bf16 v[88:103], v[56:59], v[120:127], v136
    buffer_load_dwordx4 v4, s[8:11], s33 offen offset:0 lds
    buffer_load_dwordx4 v5, s[8:11], s33 offen offset:1024 lds
    v_exp_f32 v131, v131
    v_exp_f32 v132, v132
    v_exp_f32 v133, v133
    v_exp_f32 v134, v134
    v_exp_f32 v135, v135
    v_exp_f32 v104, v104
    v_exp_f32 v105, v105
    v_exp_f32 v106, v106
    v_smfmac_f32_32x32x32_bf16 v[88:103], v[60:63], v[128:135], v136
    s_waitcnt lgkmcnt(0)
    v_and_b32 v12, 7, v1
    v_lshlrev_b32 v12, 7, v12
    s_lshl_b32 s89, s20, 2
    s_add_u32 s89, s89, s16
    s_lshl_b32 s89, s89, 11
    s_add_u32 s89, s89, 31195136
    v_exp_f32 v107, v107
    v_exp_f32 v108, v108
    v_exp_f32 v109, v109
    v_mfma_f32_32x32x16_bf16 v[120:135], v[52:55], v[44:47], 0
    ds_read_b128 v[52:55], v147 offset:55296
    v_exp_f32 v110, v110
    v_exp_f32 v111, v111
    v_exp_f32 v112, v112
    v_exp_f32 v113, v113
    v_exp_f32 v114, v114
    v_smfmac_f32_32x32x32_bf16 v[72:87], v[64:67], v[104:111], v136
    ds_read_b128 v[60:63], v145 offset:4608
    v_exp_f32 v115, v115
    v_exp_f32 v116, v116
    v_exp_f32 v117, v117
    v_exp_f32 v118, v118
    v_exp_f32 v119, v119
    v_exp_f32 v120, v120
    v_exp_f32 v121, v121
    v_exp_f32 v122, v122
    v_smfmac_f32_32x32x32_bf16 v[72:87], v[68:71], v[112:119], v136
    buffer_load_dwordx4 v6, s[8:11], s33 offen offset:2048 lds
    buffer_load_dwordx4 v7, s[8:11], s33 offen offset:3072 lds
    v_exp_f32 v123, v123
    v_exp_f32 v124, v124
    v_exp_f32 v125, v125
    v_mfma_f32_32x32x16_bf16 v[104:119], v[48:51], v[40:43], 0
    ds_read_b128 v[56:59], v145 offset:4096
    v_exp_f32 v126, v126
    v_exp_f32 v127, v127
    v_exp_f32 v128, v128
    v_exp_f32 v129, v129
    v_exp_f32 v130, v130
    v_smfmac_f32_32x32x32_bf16 v[88:103], v[64:67], v[120:127], v136
    s_add_u32 m0, s30, 122880
    s_and_b32 s29, s29, 0x1ffff
    v_exp_f32 v131, v131
    v_exp_f32 v132, v132
    v_exp_f32 v133, v133
    v_exp_f32 v134, v134
    v_exp_f32 v135, v135
    v_exp_f32 v104, v104
    v_exp_f32 v105, v105
    v_exp_f32 v106, v106
    v_smfmac_f32_32x32x32_bf16 v[88:103], v[68:71], v[128:135], v136
    s_waitcnt lgkmcnt(0)
    v_exp_f32 v107, v107
    v_exp_f32 v108, v108
    v_exp_f32 v109, v109
    v_mfma_f32_32x32x16_bf16 v[120:135], v[48:51], v[44:47], 0
    ds_read_b128 v[48:51], v146 offset:0
    v_exp_f32 v110, v110
    v_exp_f32 v111, v111
    v_exp_f32 v112, v112
    v_exp_f32 v113, v113
    v_exp_f32 v114, v114
    v_smfmac_f32_32x32x32_bf16 v[72:87], v[56:59], v[104:111], v136
    ds_read_b128 v[68:71], v145 offset:6656
    v_exp_f32 v115, v115
    v_exp_f32 v116, v116
    v_exp_f32 v117, v117
    v_exp_f32 v118, v118
    v_exp_f32 v119, v119
    v_exp_f32 v120, v120
    v_exp_f32 v121, v121
    v_exp_f32 v122, v122
    v_smfmac_f32_32x32x32_bf16 v[72:87], v[60:63], v[112:119], v136
    buffer_load_dwordx4 v148, s[12:15], s29 offen sc1 lds
    buffer_load_dwordx4 v148, s[12:15], s29 offen offset:1024 sc1 lds
    v_exp_f32 v123, v123
    v_exp_f32 v124, v124
    v_exp_f32 v125, v125
    v_mfma_f32_32x32x16_bf16 v[104:119], v[52:55], v[40:43], 0
    ds_read_b128 v[64:67], v145 offset:6144
    v_exp_f32 v126, v126
    v_exp_f32 v127, v127
    v_exp_f32 v128, v128
    v_exp_f32 v129, v129
    v_exp_f32 v130, v130
    v_smfmac_f32_32x32x32_bf16 v[88:103], v[56:59], v[120:127], v136
    v_mul_u32_u24 v4, 4096, v3
    v_add_u32 v4, v4, v8
    v_add_u32 v5, 31744, v4
    v_add_u32 v6, 63488, v4
    v_add_u32 v7, 95232, v4
    s_add_u32 s33, s91, 1179648
    s_add_u32 m0, s34, 16384
    s_add_u32 s33, s33, 917504
    v_exp_f32 v131, v131
    v_exp_f32 v132, v132
    v_exp_f32 v133, v133
    v_exp_f32 v134, v134
    v_exp_f32 v135, v135
    v_exp_f32 v104, v104
    v_exp_f32 v105, v105
    v_exp_f32 v106, v106
    v_smfmac_f32_32x32x32_bf16 v[88:103], v[60:63], v[128:135], v136
    s_waitcnt lgkmcnt(0)
    v_exp_f32 v107, v107
    v_exp_f32 v108, v108
    v_exp_f32 v109, v109
    v_mfma_f32_32x32x16_bf16 v[120:135], v[52:55], v[44:47], 0
    ds_read_b128 v[52:55], v146 offset:2048
    v_exp_f32 v110, v110
    v_exp_f32 v111, v111
    v_exp_f32 v112, v112
    v_exp_f32 v113, v113
    v_exp_f32 v114, v114
    v_smfmac_f32_32x32x32_bf16 v[72:87], v[64:67], v[104:111], v136
    ds_read_b128 v[60:63], v140 offset:512
    v_exp_f32 v115, v115
    v_exp_f32 v116, v116
    v_exp_f32 v117, v117
    v_exp_f32 v118, v118
    v_exp_f32 v119, v119
    v_exp_f32 v120, v120
    v_exp_f32 v121, v121
    v_exp_f32 v122, v122
    v_smfmac_f32_32x32x32_bf16 v[72:87], v[68:71], v[112:119], v136
    buffer_load_dwordx4 v4, s[52:55], s33 offen offset:0 lds
    buffer_load_dwordx4 v5, s[52:55], s33 offen offset:1024 lds
    v_exp_f32 v123, v123
    v_exp_f32 v124, v124
    v_exp_f32 v125, v125
    v_mfma_f32_32x32x16_bf16 v[104:119], v[48:51], v[40:43], 0
    ds_read_b128 v[56:59], v140 offset:0
    v_exp_f32 v126, v126
    v_exp_f32 v127, v127
    v_exp_f32 v128, v128
    v_exp_f32 v129, v129
    v_exp_f32 v130, v130
    v_smfmac_f32_32x32x32_bf16 v[88:103], v[64:67], v[120:127], v136
    buffer_load_dwordx4 v6, s[52:55], s33 offen offset:2048 lds
    buffer_load_dwordx4 v7, s[52:55], s33 offen offset:3072 lds
    v_exp_f32 v131, v131
    v_exp_f32 v132, v132
    v_exp_f32 v133, v133
    v_exp_f32 v134, v134
    v_exp_f32 v135, v135
    v_exp_f32 v104, v104
    v_exp_f32 v105, v105
    v_exp_f32 v106, v106
    v_smfmac_f32_32x32x32_bf16 v[88:103], v[68:71], v[128:135], v136
    s_waitcnt lgkmcnt(0)
    s_add_u32 s29, s29, 8192
    buffer_load_dword v139, v12, s[12:15], s75 offen
    buffer_load_dword v139, v12, s[12:15], s77 offen
    v_exp_f32 v107, v107
    v_exp_f32 v108, v108
    v_exp_f32 v109, v109
    v_mfma_f32_32x32x16_bf16 v[120:135], v[48:51], v[44:47], 0
    ds_read_b128 v[48:51], v146 offset:4096
    v_exp_f32 v110, v110
    v_exp_f32 v111, v111
    v_exp_f32 v112, v112
    v_exp_f32 v113, v113
    v_exp_f32 v114, v114
    v_smfmac_f32_32x32x32_bf16 v[72:87], v[56:59], v[104:111], v136
    ds_read_b128 v[68:71], v140 offset:2560
    v_exp_f32 v115, v115
    v_exp_f32 v116, v116
    v_exp_f32 v117, v117
    v_exp_f32 v118, v118
    v_exp_f32 v119, v119
    v_exp_f32 v120, v120
    v_exp_f32 v121, v121
    v_exp_f32 v122, v122
    v_smfmac_f32_32x32x32_bf16 v[72:87], v[60:63], v[112:119], v136
    s_add_u32 m0, s34, 20480
    s_add_u32 s33, s33, 131072
    v_exp_f32 v123, v123
    v_exp_f32 v124, v124
    v_exp_f32 v125, v125
    v_mfma_f32_32x32x16_bf16 v[104:119], v[52:55], v[40:43], 0
    ds_read_b128 v[64:67], v140 offset:2048
    v_exp_f32 v126, v126
    v_exp_f32 v127, v127
    v_exp_f32 v128, v128
    v_exp_f32 v129, v129
    v_exp_f32 v130, v130
    v_smfmac_f32_32x32x32_bf16 v[88:103], v[56:59], v[120:127], v136
    buffer_load_dwordx4 v4, s[52:55], s33 offen offset:0 lds
    buffer_load_dwordx4 v5, s[52:55], s33 offen offset:1024 lds
    v_exp_f32 v131, v131
    v_exp_f32 v132, v132
    v_exp_f32 v133, v133
    v_exp_f32 v134, v134
    v_exp_f32 v135, v135
    v_exp_f32 v104, v104
    v_exp_f32 v105, v105
    v_exp_f32 v106, v106
    v_smfmac_f32_32x32x32_bf16 v[88:103], v[60:63], v[128:135], v136
    s_waitcnt lgkmcnt(0)
    s_mov_b32 s90, 31522816
    buffer_load_dword v14, v12, s[12:15], s90 offen sc1
    v_exp_f32 v107, v107
    v_exp_f32 v108, v108
    v_exp_f32 v109, v109
    v_mfma_f32_32x32x16_bf16 v[120:135], v[52:55], v[44:47], 0
    ds_read_b128 v[52:55], v146 offset:6144
    v_exp_f32 v110, v110
    v_exp_f32 v111, v111
    v_exp_f32 v112, v112
    v_exp_f32 v113, v113
    v_exp_f32 v114, v114
    v_smfmac_f32_32x32x32_bf16 v[72:87], v[64:67], v[104:111], v136
    ds_read_b128 v[60:63], v140 offset:4608
    v_exp_f32 v115, v115
    v_exp_f32 v116, v116
    v_exp_f32 v117, v117
    v_exp_f32 v118, v118
    v_exp_f32 v119, v119
    v_exp_f32 v120, v120
    v_exp_f32 v121, v121
    v_exp_f32 v122, v122
    v_smfmac_f32_32x32x32_bf16 v[72:87], v[68:71], v[112:119], v136
    buffer_load_dwordx4 v6, s[52:55], s33 offen offset:2048 lds
    buffer_load_dwordx4 v7, s[52:55], s33 offen offset:3072 lds
    v_exp_f32 v123, v123
    v_exp_f32 v124, v124
    v_exp_f32 v125, v125
    v_mfma_f32_32x32x16_bf16 v[104:119], v[48:51], v[40:43], 0
    ds_read_b128 v[56:59], v140 offset:4096
    v_exp_f32 v126, v126
    v_exp_f32 v127, v127
    v_exp_f32 v128, v128
    v_exp_f32 v129, v129
    v_exp_f32 v130, v130
    v_smfmac_f32_32x32x32_bf16 v[88:103], v[64:67], v[120:127], v136
    s_add_u32 m0, s30, 131072
    s_and_b32 s29, s29, 0x1ffff
    v_exp_f32 v131, v131
    v_exp_f32 v132, v132
    v_exp_f32 v133, v133
    v_exp_f32 v134, v134
    v_exp_f32 v135, v135
    v_exp_f32 v104, v104
    v_exp_f32 v105, v105
    v_exp_f32 v106, v106
    v_smfmac_f32_32x32x32_bf16 v[88:103], v[68:71], v[128:135], v136
    s_waitcnt vmcnt(21) lgkmcnt(0)
    s_barrier
    v_exp_f32 v107, v107
    v_exp_f32 v108, v108
    v_exp_f32 v109, v109
    v_mfma_f32_32x32x16_bf16 v[120:135], v[48:51], v[44:47], 0
    ds_read_b128 v[48:51], v146 offset:32768
    v_exp_f32 v110, v110
    v_exp_f32 v111, v111
    v_exp_f32 v112, v112
    v_exp_f32 v113, v113
    v_exp_f32 v114, v114
    v_smfmac_f32_32x32x32_bf16 v[72:87], v[56:59], v[104:111], v136
    ds_read_b128 v[68:71], v140 offset:6656
    v_exp_f32 v115, v115
    v_exp_f32 v116, v116
    v_exp_f32 v117, v117
    v_exp_f32 v118, v118
    v_exp_f32 v119, v119
    v_exp_f32 v120, v120
    v_exp_f32 v121, v121
    v_exp_f32 v122, v122
    v_smfmac_f32_32x32x32_bf16 v[72:87], v[60:63], v[112:119], v136
    buffer_load_dwordx4 v148, s[12:15], s29 offen sc1 lds
    buffer_load_dwordx4 v148, s[12:15], s29 offen offset:1024 sc1 lds
    v_exp_f32 v123, v123
    v_exp_f32 v124, v124
    v_exp_f32 v125, v125
    v_mfma_f32_32x32x16_bf16 v[104:119], v[52:55], v[40:43], 0
    ds_read_b128 v[64:67], v140 offset:6144
    v_exp_f32 v126, v126
    v_exp_f32 v127, v127
    v_exp_f32 v128, v128
    v_exp_f32 v129, v129
    v_exp_f32 v130, v130
    v_smfmac_f32_32x32x32_bf16 v[88:103], v[56:59], v[120:127], v136
    v_exp_f32 v131, v131
    v_exp_f32 v132, v132
    v_exp_f32 v133, v133
    v_exp_f32 v134, v134
    v_exp_f32 v135, v135
    v_exp_f32 v104, v104
    v_exp_f32 v105, v105
    v_exp_f32 v106, v106
    v_smfmac_f32_32x32x32_bf16 v[88:103], v[60:63], v[128:135], v136
    s_waitcnt lgkmcnt(0)
    v_exp_f32 v107, v107
    v_exp_f32 v108, v108
    v_exp_f32 v109, v109
    v_mfma_f32_32x32x16_bf16 v[120:135], v[52:55], v[44:47], 0
    ds_read_b128 v[52:55], v146 offset:34816
    v_exp_f32 v110, v110
    v_exp_f32 v111, v111
    v_exp_f32 v112, v112
    v_exp_f32 v113, v113
    v_exp_f32 v114, v114
    v_smfmac_f32_32x32x32_bf16 v[72:87], v[64:67], v[104:111], v136
    ds_read_b128 v[60:63], v141 offset:512
    v_exp_f32 v115, v115
    v_exp_f32 v116, v116
    v_exp_f32 v117, v117
    v_exp_f32 v118, v118
    v_exp_f32 v119, v119
    v_exp_f32 v120, v120
    v_exp_f32 v121, v121
    v_exp_f32 v122, v122
    v_smfmac_f32_32x32x32_bf16 v[72:87], v[68:71], v[112:119], v136
    v_exp_f32 v123, v123
    v_exp_f32 v124, v124
    v_exp_f32 v125, v125
    v_mfma_f32_32x32x16_bf16 v[104:119], v[48:51], v[40:43], 0
    ds_read_b128 v[56:59], v141 offset:0
    v_exp_f32 v126, v126
    v_exp_f32 v127, v127
    v_exp_f32 v128, v128
    v_exp_f32 v129, v129
    v_exp_f32 v130, v130
    v_smfmac_f32_32x32x32_bf16 v[88:103], v[64:67], v[120:127], v136
    v_exp_f32 v131, v131
    v_exp_f32 v132, v132
    v_exp_f32 v133, v133
    v_exp_f32 v134, v134
    v_exp_f32 v135, v135
    v_exp_f32 v104, v104
    v_exp_f32 v105, v105
    v_exp_f32 v106, v106
    v_smfmac_f32_32x32x32_bf16 v[88:103], v[68:71], v[128:135], v136
    s_waitcnt lgkmcnt(0)
    s_add_u32 s29, s29, 8192
    buffer_load_dword v139, v12, s[12:15], s89 offen
    s_add_u32 s89, s89, 1024
    v_exp_f32 v107, v107
    v_exp_f32 v108, v108
    v_exp_f32 v109, v109
    v_mfma_f32_32x32x16_bf16 v[120:135], v[48:51], v[44:47], 0
    ds_read_b128 v[48:51], v146 offset:36864
    v_exp_f32 v110, v110
    v_exp_f32 v111, v111
    v_exp_f32 v112, v112
    v_exp_f32 v113, v113
    v_exp_f32 v114, v114
    v_smfmac_f32_32x32x32_bf16 v[72:87], v[56:59], v[104:111], v136
    ds_read_b128 v[68:71], v141 offset:2560
    v_exp_f32 v115, v115
    v_exp_f32 v116, v116
    v_exp_f32 v117, v117
    v_exp_f32 v118, v118
    v_exp_f32 v119, v119
    v_exp_f32 v120, v120
    v_exp_f32 v121, v121
    v_exp_f32 v122, v122
    v_smfmac_f32_32x32x32_bf16 v[72:87], v[60:63], v[112:119], v136
    v_exp_f32 v123, v123
    v_exp_f32 v124, v124
    v_exp_f32 v125, v125
    v_mfma_f32_32x32x16_bf16 v[104:119], v[52:55], v[40:43], 0
    ds_read_b128 v[64:67], v141 offset:2048
    v_exp_f32 v126, v126
    v_exp_f32 v127, v127
    v_exp_f32 v128, v128
    v_exp_f32 v129, v129
    v_exp_f32 v130, v130
    v_smfmac_f32_32x32x32_bf16 v[88:103], v[56:59], v[120:127], v136
    v_exp_f32 v131, v131
    v_exp_f32 v132, v132
    v_exp_f32 v133, v133
    v_exp_f32 v134, v134
    v_exp_f32 v135, v135
    v_exp_f32 v104, v104
    v_exp_f32 v105, v105
    v_exp_f32 v106, v106
    v_smfmac_f32_32x32x32_bf16 v[88:103], v[60:63], v[128:135], v136
    s_waitcnt vmcnt(5) lgkmcnt(0)
    v_cmp_gt_u32 vcc, 32, v14
    v_exp_f32 v107, v107
    v_exp_f32 v108, v108
    v_exp_f32 v109, v109
    v_mfma_f32_32x32x16_bf16 v[120:135], v[52:55], v[44:47], 0
    ds_read_b128 v[52:55], v146 offset:38912
    v_exp_f32 v110, v110
    v_exp_f32 v111, v111
    v_exp_f32 v112, v112
    v_exp_f32 v113, v113
    v_exp_f32 v114, v114
    v_smfmac_f32_32x32x32_bf16 v[72:87], v[64:67], v[104:111], v136
    s_cbranch_vccnz L_sn_39
L_sn_39_d:
    ds_read_b128 v[60:63], v141 offset:4608
    v_exp_f32 v115, v115
    v_exp_f32 v116, v116
    v_exp_f32 v117, v117
    v_exp_f32 v118, v118
    v_exp_f32 v119, v119
    v_exp_f32 v120, v120
    v_exp_f32 v121, v121
    v_exp_f32 v122, v122
    v_smfmac_f32_32x32x32_bf16 v[72:87], v[68:71], v[112:119], v136
    v_exp_f32 v123, v123
    v_exp_f32 v124, v124
    v_exp_f32 v125, v125
    v_mfma_f32_32x32x16_bf16 v[104:119], v[48:51], v[40:43], 0
    ds_read_b128 v[56:59], v141 offset:4096
    v_exp_f32 v126, v126
    v_exp_f32 v127, v127
    v_exp_f32 v128, v128
    v_exp_f32 v129, v129
    v_exp_f32 v130, v130
    v_smfmac_f32_32x32x32_bf16 v[88:103], v[64:67], v[120:127], v136
    s_add_u32 m0, s30, 139264
    s_and_b32 s29, s29, 0x1ffff
    v_exp_f32 v131, v131
    v_exp_f32 v132, v132
    v_exp_f32 v133, v133
    v_exp_f32 v134, v134
    v_exp_f32 v135, v135
    v_exp_f32 v104, v104
    v_exp_f32 v105, v105
    v_exp_f32 v106, v106
    v_smfmac_f32_32x32x32_bf16 v[88:103], v[68:71], v[128:135], v136
    s_waitcnt lgkmcnt(0)
    v_exp_f32 v107, v107
    v_exp_f32 v108, v108
    v_exp_f32 v109, v109
    v_mfma_f32_32x32x16_bf16 v[120:135], v[48:51], v[44:47], 0
    ds_read_b128 v[48:51], v147 offset:0
    v_exp_f32 v110, v110
    v_exp_f32 v111, v111
    v_exp_f32 v112, v112
    v_exp_f32 v113, v113
    v_exp_f32 v114, v114
    v_smfmac_f32_32x32x32_bf16 v[72:87], v[56:59], v[104:111], v136
    ds_read_b128 v[68:71], v141 offset:6656
    v_exp_f32 v115, v115
    v_exp_f32 v116, v116
    v_exp_f32 v117, v117
    v_exp_f32 v118, v118
    v_exp_f32 v119, v119
    v_exp_f32 v120, v120
    v_exp_f32 v121, v121
    v_exp_f32 v122, v122
    v_smfmac_f32_32x32x32_bf16 v[72:87], v[60:63], v[112:119], v136
    buffer_load_dwordx4 v148, s[12:15], s29 offen sc1 lds
    buffer_load_dwordx4 v148, s[12:15], s29 offen offset:1024 sc1 lds
    v_exp_f32 v123, v123
    v_exp_f32 v124, v124
    v_exp_f32 v125, v125
    v_mfma_f32_32x32x16_bf16 v[104:119], v[52:55], v[40:43], 0
    ds_read_b128 v[64:67], v141 offset:6144
    v_exp_f32 v126, v126
    v_exp_f32 v127, v127
    v_exp_f32 v128, v128
    v_exp_f32 v129, v129
    v_exp_f32 v130, v130
    v_smfmac_f32_32x32x32_bf16 v[88:103], v[56:59], v[120:127], v136
    v_exp_f32 v131, v131
    v_exp_f32 v132, v132
    v_exp_f32 v133, v133
    v_exp_f32 v134, v134
    v_exp_f32 v135, v135
    v_exp_f32 v104, v104
    v_exp_f32 v105, v105
    v_exp_f32 v106, v106
    v_smfmac_f32_32x32x32_bf16 v[88:103], v[60:63], v[128:135], v136
    s_waitcnt lgkmcnt(0)
    v_exp_f32 v107, v107
    v_exp_f32 v108, v108
    v_exp_f32 v109, v109
    v_mfma_f32_32x32x16_bf16 v[120:135], v[52:55], v[44:47], 0
    ds_read_b128 v[52:55], v147 offset:2048
    v_exp_f32 v110, v110
    v_exp_f32 v111, v111
    v_exp_f32 v112, v112
    v_exp_f32 v113, v113
    v_exp_f32 v114, v114
    v_smfmac_f32_32x32x32_bf16 v[72:87], v[64:67], v[104:111], v136
    ds_read_b128 v[60:63], v142 offset:512
    v_exp_f32 v115, v115
    v_exp_f32 v116, v116
    v_exp_f32 v117, v117
    v_exp_f32 v118, v118
    v_exp_f32 v119, v119
    v_exp_f32 v120, v120
    v_exp_f32 v121, v121
    v_exp_f32 v122, v122
    v_smfmac_f32_32x32x32_bf16 v[72:87], v[68:71], v[112:119], v136
    v_exp_f32 v123, v123
    v_exp_f32 v124, v124
    v_exp_f32 v125, v125
    v_mfma_f32_32x32x16_bf16 v[104:119], v[48:51], v[40:43], 0
    ds_read_b128 v[56:59], v142 offset:0
    v_exp_f32 v126, v126
    v_exp_f32 v127, v127
    v_exp_f32 v128, v128
    v_exp_f32 v129, v129
    v_exp_f32 v130, v130
    v_smfmac_f32_32x32x32_bf16 v[88:103], v[64:67], v[120:127], v136
    v_exp_f32 v131, v131
    v_exp_f32 v132, v132
    v_exp_f32 v133, v133
    v_exp_f32 v134, v134
    v_exp_f32 v135, v135
    v_exp_f32 v104, v104
    v_exp_f32 v105, v105
    v_exp_f32 v106, v106
    v_smfmac_f32_32x32x32_bf16 v[88:103], v[68:71], v[128:135], v136
    s_waitcnt lgkmcnt(0)
    buffer_load_dword v139, v12, s[12:15], s89 offen
    v_exp_f32 v107, v107
    v_exp_f32 v108, v108
    v_exp_f32 v109, v109
    v_mfma_f32_32x32x16_bf16 v[120:135], v[48:51], v[44:47], 0
    ds_read_b128 v[48:51], v147 offset:4096
    v_exp_f32 v110, v110
    v_exp_f32 v111, v111
    v_exp_f32 v112, v112
    v_exp_f32 v113, v113
    v_exp_f32 v114, v114
    v_smfmac_f32_32x32x32_bf16 v[72:87], v[56:59], v[104:111], v136
    ds_read_b128 v[68:71], v142 offset:2560
    v_exp_f32 v115, v115
    v_exp_f32 v116, v116
    v_exp_f32 v117, v117
    v_exp_f32 v118, v118
    v_exp_f32 v119, v119
    v_exp_f32 v120, v120
    v_exp_f32 v121, v121
    v_exp_f32 v122, v122
    v_smfmac_f32_32x32x32_bf16 v[72:87], v[60:63], v[112:119], v136
    v_exp_f32 v123, v123
    v_exp_f32 v124, v124
    v_exp_f32 v125, v125
    v_mfma_f32_32x32x16_bf16 v[104:119], v[52:55], v[40:43], 0
    ds_read_b128 v[64:67], v142 offset:2048
    v_exp_f32 v126, v126
    v_exp_f32 v127, v127
    v_exp_f32 v128, v128
    v_exp_f32 v129, v129
    v_exp_f32 v130, v130
    v_smfmac_f32_32x32x32_bf16 v[88:103], v[56:59], v[120:127], v136
    v_exp_f32 v131, v131
    v_exp_f32 v132, v132
    v_exp_f32 v133, v133
    v_exp_f32 v134, v134
    v_exp_f32 v135, v135
    v_exp_f32 v104, v104
    v_exp_f32 v105, v105
    v_exp_f32 v106, v106
    v_smfmac_f32_32x32x32_bf16 v[88:103], v[60:63], v[128:135], v136
    s_waitcnt lgkmcnt(0)
    v_exp_f32 v107, v107
    v_exp_f32 v108, v108
    v_exp_f32 v109, v109
    v_mfma_f32_32x32x16_bf16 v[120:135], v[52:55], v[44:47], 0
    ds_read_b128 v[52:55], v147 offset:6144
    v_exp_f32 v110, v110
    v_exp_f32 v111, v111
    v_exp_f32 v112, v112
    v_exp_f32 v113, v113
    v_exp_f32 v114, v114
    v_smfmac_f32_32x32x32_bf16 v[72:87], v[64:67], v[104:111], v136
    ds_read_b128 v[60:63], v142 offset:4608
    v_exp_f32 v115, v115
    v_exp_f32 v116, v116
    v_exp_f32 v117, v117
    v_exp_f32 v118, v118
    v_exp_f32 v119, v119
    v_exp_f32 v120, v120
    v_exp_f32 v121, v121
    v_exp_f32 v122, v122
    v_smfmac_f32_32x32x32_bf16 v[72:87], v[68:71], v[112:119], v136
    v_exp_f32 v123, v123
    v_exp_f32 v124, v124
    v_exp_f32 v125, v125
    v_mfma_f32_32x32x16_bf16 v[104:119], v[48:51], v[40:43], 0
    ds_read_b128 v[56:59], v142 offset:4096
    v_exp_f32 v126, v126
    v_exp_f32 v127, v127
    v_exp_f32 v128, v128
    v_exp_f32 v129, v129
    v_exp_f32 v130, v130
    v_smfmac_f32_32x32x32_bf16 v[88:103], v[64:67], v[120:127], v136
    v_exp_f32 v131, v131
    v_exp_f32 v132, v132
    v_exp_f32 v133, v133
    v_exp_f32 v134, v134
    v_exp_f32 v135, v135
    v_exp_f32 v104, v104
    v_exp_f32 v105, v105
    v_exp_f32 v106, v106
    v_smfmac_f32_32x32x32_bf16 v[88:103], v[68:71], v[128:135], v136
    s_waitcnt vmcnt(4) lgkmcnt(0)
    s_barrier
    v_exp_f32 v107, v107
    v_exp_f32 v108, v108
    v_exp_f32 v109, v109
    v_mfma_f32_32x32x16_bf16 v[120:135], v[48:51], v[44:47], 0
    ds_read_b128 v[48:51], v147 offset:32768
    v_exp_f32 v110, v110
    v_exp_f32 v111, v111
    v_exp_f32 v112, v112
    v_exp_f32 v113, v113
    v_exp_f32 v114, v114
    v_smfmac_f32_32x32x32_bf16 v[72:87], v[56:59], v[104:111], v136
    ds_read_b128 v[68:71], v142 offset:6656
    v_exp_f32 v115, v115
    v_exp_f32 v116, v116
    v_exp_f32 v117, v117
    v_exp_f32 v118, v118
    v_exp_f32 v119, v119
    v_exp_f32 v120, v120
    v_exp_f32 v121, v121
    v_exp_f32 v122, v122
    v_smfmac_f32_32x32x32_bf16 v[72:87], v[60:63], v[112:119], v136
    v_exp_f32 v123, v123
    v_exp_f32 v124, v124
    v_exp_f32 v125, v125
    v_mfma_f32_32x32x16_bf16 v[104:119], v[52:55], v[40:43], 0
    ds_read_b128 v[64:67], v142 offset:6144
    v_exp_f32 v126, v126
    v_exp_f32 v127, v127
    v_exp_f32 v128, v128
    v_exp_f32 v129, v129
    v_exp_f32 v130, v130
    v_smfmac_f32_32x32x32_bf16 v[88:103], v[56:59], v[120:127], v136
    v_exp_f32 v131, v131
    v_exp_f32 v132, v132
    v_exp_f32 v133, v133
    v_exp_f32 v134, v134
    v_exp_f32 v135, v135
    v_exp_f32 v104, v104
    v_exp_f32 v105, v105
    v_exp_f32 v106, v106
    v_smfmac_f32_32x32x32_bf16 v[88:103], v[60:63], v[128:135], v136
    s_waitcnt lgkmcnt(0)
    v_exp_f32 v107, v107
    v_exp_f32 v108, v108
    v_exp_f32 v109, v109
    v_mfma_f32_32x32x16_bf16 v[120:135], v[52:55], v[44:47], 0
    ds_read_b128 v[52:55], v147 offset:34816
    v_exp_f32 v110, v110
    v_exp_f32 v111, v111
    v_exp_f32 v112, v112
    v_exp_f32 v113, v113
    v_exp_f32 v114, v114
    v_smfmac_f32_32x32x32_bf16 v[72:87], v[64:67], v[104:111], v136
    ds_read_b128 v[60:63], v143 offset:512
    v_exp_f32 v115, v115
    v_exp_f32 v116, v116
    v_exp_f32 v117, v117
    v_exp_f32 v118, v118
    v_exp_f32 v119, v119
    v_exp_f32 v120, v120
    v_exp_f32 v121, v121
    v_exp_f32 v122, v122
    v_smfmac_f32_32x32x32_bf16 v[72:87], v[68:71], v[112:119], v136
    v_exp_f32 v123, v123
    v_exp_f32 v124, v124
    v_exp_f32 v125, v125
    v_mfma_f32_32x32x16_bf16 v[104:119], v[48:51], v[40:43], 0
    ds_read_b128 v[56:59], v143 offset:0
    v_exp_f32 v126, v126
    v_exp_f32 v127, v127
    v_exp_f32 v128, v128
    v_exp_f32 v129, v129
    v_exp_f32 v130, v130
    v_smfmac_f32_32x32x32_bf16 v[88:103], v[64:67], v[120:127], v136
    v_exp_f32 v131, v131
    v_exp_f32 v132, v132
    v_exp_f32 v133, v133
    v_exp_f32 v134, v134
    v_exp_f32 v135, v135
    v_exp_f32 v104, v104
    v_exp_f32 v105, v105
    v_exp_f32 v106, v106
    v_smfmac_f32_32x32x32_bf16 v[88:103], v[68:71], v[128:135], v136
    s_waitcnt lgkmcnt(0)
    v_and_b32 v138, 31, v1
    v_lshlrev_b32 v138, 12, v138
    s_lshr_b32 s24, s21, 1
    s_lshl_b32 s24, s24, 20
    s_add_u32 s24, s24, s91
    s_and_b32 s25, s21, 1
    s_lshl_b32 s25, s25, 17
    s_add_u32 s24, s24, s25
    buffer_load_dword v139, v138, s[52:55], s24 offen
    v_exp_f32 v107, v107
    v_exp_f32 v108, v108
    v_exp_f32 v109, v109
    v_mfma_f32_32x32x16_bf16 v[120:135], v[48:51], v[44:47], 0
    ds_read_b128 v[48:51], v147 offset:36864
    v_exp_f32 v110, v110
    v_exp_f32 v111, v111
    v_exp_f32 v112, v112
    v_exp_f32 v113, v113
    v_exp_f32 v114, v114
    v_smfmac_f32_32x32x32_bf16 v[72:87], v[56:59], v[104:111], v136
    ds_read_b128 v[68:71], v143 offset:2560
    v_exp_f32 v115, v115
    v_exp_f32 v116, v116
    v_exp_f32 v117, v117
    v_exp_f32 v118, v118
    v_exp_f32 v119, v119
    v_exp_f32 v120, v120
    v_exp_f32 v121, v121
    v_exp_f32 v122, v122
    v_smfmac_f32_32x32x32_bf16 v[72:87], v[60:63], v[112:119], v136
    v_exp_f32 v123, v123
    v_exp_f32 v124, v124
    v_exp_f32 v125, v125
    v_mfma_f32_32x32x16_bf16 v[104:119], v[52:55], v[40:43], 0
    ds_read_b128 v[64:67], v143 offset:2048
    v_exp_f32 v126, v126
    v_exp_f32 v127, v127
    v_exp_f32 v128, v128
    v_exp_f32 v129, v129
    v_exp_f32 v130, v130
    v_smfmac_f32_32x32x32_bf16 v[88:103], v[56:59], v[120:127], v136
    v_exp_f32 v131, v131
    v_exp_f32 v132, v132
    v_exp_f32 v133, v133
    v_exp_f32 v134, v134
    v_exp_f32 v135, v135
    v_exp_f32 v104, v104
    v_exp_f32 v105, v105
    v_exp_f32 v106, v106
    v_smfmac_f32_32x32x32_bf16 v[88:103], v[60:63], v[128:135], v136
    s_waitcnt lgkmcnt(0)
    v_exp_f32 v107, v107
    v_exp_f32 v108, v108
    v_exp_f32 v109, v109
    v_mfma_f32_32x32x16_bf16 v[120:135], v[52:55], v[44:47], 0
L_pad_A_3:
    s_cbranch_execz L_ret_A_3
    ds_read_b128 v[52:55], v147 offset:38912
    v_exp_f32 v110, v110
    v_exp_f32 v111, v111
    v_exp_f32 v112, v112
    v_exp_f32 v113, v113
    v_exp_f32 v114, v114
    v_smfmac_f32_32x32x32_bf16 v[72:87], v[64:67], v[104:111], v136
    ds_read_b128 v[60:63], v143 offset:4608
    v_exp_f32 v115, v115
    v_exp_f32 v116, v116
    v_exp_f32 v117, v117
    v_exp_f32 v118, v118
    v_exp_f32 v119, v119
    v_exp_f32 v120, v120
    v_exp_f32 v121, v121
    v_exp_f32 v122, v122
    v_smfmac_f32_32x32x32_bf16 v[72:87], v[68:71], v[112:119], v136
    v_exp_f32 v123, v123
    v_exp_f32 v124, v124
    v_exp_f32 v125, v125
    v_mfma_f32_32x32x16_bf16 v[104:119], v[48:51], v[40:43], 0
    ds_read_b128 v[56:59], v143 offset:4096
    v_exp_f32 v126, v126
    v_exp_f32 v127, v127
    v_exp_f32 v128, v128
    v_exp_f32 v129, v129
    v_exp_f32 v130, v130
    v_smfmac_f32_32x32x32_bf16 v[88:103], v[64:67], v[120:127], v136
    v_exp_f32 v131, v131
    v_exp_f32 v132, v132
    v_exp_f32 v133, v133
    v_exp_f32 v134, v134
    v_exp_f32 v135, v135
    v_exp_f32 v104, v104
    v_exp_f32 v105, v105
    v_exp_f32 v106, v106
    v_smfmac_f32_32x32x32_bf16 v[88:103], v[68:71], v[128:135], v136
    s_waitcnt lgkmcnt(0)
    v_exp_f32 v107, v107
    v_exp_f32 v108, v108
    v_exp_f32 v109, v109
    v_mfma_f32_32x32x16_bf16 v[120:135], v[48:51], v[44:47], 0
    ds_read_b128 v[48:51], v147 offset:40960
    v_exp_f32 v110, v110
    v_exp_f32 v111, v111
    v_exp_f32 v112, v112
    v_exp_f32 v113, v113
    v_exp_f32 v114, v114
    v_smfmac_f32_32x32x32_bf16 v[72:87], v[56:59], v[104:111], v136
    ds_read_b128 v[68:71], v143 offset:6656
    v_exp_f32 v115, v115
    v_exp_f32 v116, v116
    v_exp_f32 v117, v117
    v_exp_f32 v118, v118
    v_exp_f32 v119, v119
    v_exp_f32 v120, v120
    v_exp_f32 v121, v121
    v_exp_f32 v122, v122
    v_smfmac_f32_32x32x32_bf16 v[72:87], v[60:63], v[112:119], v136
    v_exp_f32 v123, v123
    v_exp_f32 v124, v124
    v_exp_f32 v125, v125
    v_mfma_f32_32x32x16_bf16 v[104:119], v[52:55], v[40:43], 0
    ds_read_b128 v[64:67], v143 offset:6144
    v_exp_f32 v126, v126
    v_exp_f32 v127, v127
    v_exp_f32 v128, v128
    v_exp_f32 v129, v129
    v_exp_f32 v130, v130
    v_smfmac_f32_32x32x32_bf16 v[88:103], v[56:59], v[120:127], v136
    v_exp_f32 v131, v131
    v_exp_f32 v132, v132
    v_exp_f32 v133, v133
    v_exp_f32 v134, v134
    v_exp_f32 v135, v135
    v_exp_f32 v104, v104
    v_exp_f32 v105, v105
    v_exp_f32 v106, v106
    v_smfmac_f32_32x32x32_bf16 v[88:103], v[60:63], v[128:135], v136
    s_waitcnt lgkmcnt(0)
    v_exp_f32 v107, v107
    v_exp_f32 v108, v108
    v_exp_f32 v109, v109
    v_mfma_f32_32x32x16_bf16 v[120:135], v[52:55], v[44:47], 0
    ds_read_b128 v[52:55], v147 offset:43008
    v_exp_f32 v110, v110
    v_exp_f32 v111, v111
    v_exp_f32 v112, v112
    v_exp_f32 v113, v113
    v_exp_f32 v114, v114
    v_smfmac_f32_32x32x32_bf16 v[72:87], v[64:67], v[104:111], v136
    ds_read_b128 v[60:63], v144 offset:512
    v_exp_f32 v115, v115
    v_exp_f32 v116, v116
    v_exp_f32 v117, v117
    v_exp_f32 v118, v118
    v_exp_f32 v119, v119
    v_exp_f32 v120, v120
    v_exp_f32 v121, v121
    v_exp_f32 v122, v122
    v_smfmac_f32_32x32x32_bf16 v[72:87], v[68:71], v[112:119], v136
    v_exp_f32 v123, v123
    v_exp_f32 v124, v124
    v_exp_f32 v125, v125
    v_mfma_f32_32x32x16_bf16 v[104:119], v[48:51], v[40:43], 0
    ds_read_b128 v[56:59], v144 offset:0
    v_exp_f32 v126, v126
    v_exp_f32 v127, v127
    v_exp_f32 v128, v128
    v_exp_f32 v129, v129
    v_exp_f32 v130, v130
    v_smfmac_f32_32x32x32_bf16 v[88:103], v[64:67], v[120:127], v136
    v_exp_f32 v131, v131
    v_exp_f32 v132, v132
    v_exp_f32 v133, v133
    v_exp_f32 v134, v134
    v_exp_f32 v135, v135
    v_exp_f32 v104, v104
    v_exp_f32 v105, v105
    v_exp_f32 v106, v106
    v_smfmac_f32_32x32x32_bf16 v[88:103], v[68:71], v[128:135], v136
    s_waitcnt lgkmcnt(0)
    v_exp_f32 v107, v107
    v_exp_f32 v108, v108
    v_exp_f32 v109, v109
    v_mfma_f32_32x32x16_bf16 v[120:135], v[48:51], v[44:47], 0
    ds_read_b128 v[48:51], v147 offset:45056
    v_exp_f32 v110, v110
    v_exp_f32 v111, v111
    v_exp_f32 v112, v112
    v_exp_f32 v113, v113
    v_exp_f32 v114, v114
    v_smfmac_f32_32x32x32_bf16 v[72:87], v[56:59], v[104:111], v136
    ds_read_b128 v[68:71], v144 offset:2560
    v_exp_f32 v115, v115
    v_exp_f32 v116, v116
    v_exp_f32 v117, v117
    v_exp_f32 v118, v118
    v_exp_f32 v119, v119
    v_exp_f32 v120, v120
    v_exp_f32 v121, v121
    v_exp_f32 v122, v122
    v_smfmac_f32_32x32x32_bf16 v[72:87], v[60:63], v[112:119], v136
    v_exp_f32 v123, v123
    v_exp_f32 v124, v124
    v_exp_f32 v125, v125
    v_mfma_f32_32x32x16_bf16 v[104:119], v[52:55], v[40:43], 0
    ds_read_b128 v[64:67], v144 offset:2048
    v_exp_f32 v126, v126
    v_exp_f32 v127, v127
    v_exp_f32 v128, v128
    v_exp_f32 v129, v129
    v_exp_f32 v130, v130
    v_smfmac_f32_32x32x32_bf16 v[88:103], v[56:59], v[120:127], v136
    v_exp_f32 v131, v131
    v_exp_f32 v132, v132
    v_exp_f32 v133, v133
    v_exp_f32 v134, v134
    v_exp_f32 v135, v135
    v_exp_f32 v104, v104
    v_exp_f32 v105, v105
    v_exp_f32 v106, v106
    v_smfmac_f32_32x32x32_bf16 v[88:103], v[60:63], v[128:135], v136
    s_waitcnt lgkmcnt(0)
    v_exp_f32 v107, v107
    v_exp_f32 v108, v108
    v_exp_f32 v109, v109
    v_mfma_f32_32x32x16_bf16 v[120:135], v[52:55], v[44:47], 0
    ds_read_b128 v[52:55], v147 offset:47104
    v_exp_f32 v110, v110
    v_exp_f32 v111, v111
    v_exp_f32 v112, v112
    v_exp_f32 v113, v113
    v_exp_f32 v114, v114
    v_smfmac_f32_32x32x32_bf16 v[72:87], v[64:67], v[104:111], v136
    ds_read_b128 v[60:63], v144 offset:4608
    v_exp_f32 v115, v115
    v_exp_f32 v116, v116
    v_exp_f32 v117, v117
    v_exp_f32 v118, v118
    v_exp_f32 v119, v119
    v_exp_f32 v120, v120
    v_exp_f32 v121, v121
    v_exp_f32 v122, v122
    v_smfmac_f32_32x32x32_bf16 v[72:87], v[68:71], v[112:119], v136
    v_exp_f32 v123, v123
    v_exp_f32 v124, v124
    v_exp_f32 v125, v125
    v_mfma_f32_32x32x16_bf16 v[104:119], v[48:51], v[40:43], 0
    ds_read_b128 v[56:59], v144 offset:4096
    v_exp_f32 v126, v126
    v_exp_f32 v127, v127
    v_exp_f32 v128, v128
    v_exp_f32 v129, v129
    v_exp_f32 v130, v130
    v_smfmac_f32_32x32x32_bf16 v[88:103], v[64:67], v[120:127], v136
    v_exp_f32 v131, v131
    v_exp_f32 v132, v132
    v_exp_f32 v133, v133
    v_exp_f32 v134, v134
    v_exp_f32 v135, v135
    v_exp_f32 v104, v104
    v_exp_f32 v105, v105
    v_exp_f32 v106, v106
    v_smfmac_f32_32x32x32_bf16 v[88:103], v[68:71], v[128:135], v136
    s_waitcnt vmcnt(2) lgkmcnt(0)
    s_barrier
    v_exp_f32 v107, v107
    v_exp_f32 v108, v108
    v_exp_f32 v109, v109
    v_mfma_f32_32x32x16_bf16 v[120:135], v[48:51], v[44:47], 0
    ds_read_b128 v[48:51], v147 offset:49152
    v_exp_f32 v110, v110
    v_exp_f32 v111, v111
    v_exp_f32 v112, v112
    v_exp_f32 v113, v113
    v_exp_f32 v114, v114
    v_smfmac_f32_32x32x32_bf16 v[72:87], v[56:59], v[104:111], v136
    ds_read_b128 v[68:71], v144 offset:6656
    v_exp_f32 v115, v115
    v_exp_f32 v116, v116
    v_exp_f32 v117, v117
    v_exp_f32 v118, v118
    v_exp_f32 v119, v119
    v_exp_f32 v120, v120
    v_exp_f32 v121, v121
    v_exp_f32 v122, v122
    v_smfmac_f32_32x32x32_bf16 v[72:87], v[60:63], v[112:119], v136
    s_add_u32 m0, s34, 24576
    s_add_u32 s33, s33, 917504
    v_exp_f32 v123, v123
    v_exp_f32 v124, v124
    v_exp_f32 v125, v125
    v_mfma_f32_32x32x16_bf16 v[104:119], v[52:55], v[40:43], 0
    ds_read_b128 v[64:67], v144 offset:6144
    v_exp_f32 v126, v126
    v_exp_f32 v127, v127
    v_exp_f32 v128, v128
    v_exp_f32 v129, v129
    v_exp_f32 v130, v130
    v_smfmac_f32_32x32x32_bf16 v[88:103], v[56:59], v[120:127], v136
    buffer_load_dwordx4 v4, s[52:55], s33 offen offset:0 lds
    buffer_load_dwordx4 v5, s[52:55], s33 offen offset:1024 lds
    v_exp_f32 v131, v131
    v_exp_f32 v132, v132
    v_exp_f32 v133, v133
    v_exp_f32 v134, v134
    v_exp_f32 v135, v135
    v_exp_f32 v104, v104
    v_exp_f32 v105, v105
    v_exp_f32 v106, v106
    v_smfmac_f32_32x32x32_bf16 v[88:103], v[60:63], v[128:135], v136
    s_waitcnt lgkmcnt(0)
    v_exp_f32 v107, v107
    v_exp_f32 v108, v108
    v_exp_f32 v109, v109
    v_mfma_f32_32x32x16_bf16 v[120:135], v[52:55], v[44:47], 0
    ds_read_b128 v[52:55], v147 offset:51200
    v_exp_f32 v110, v110
    v_exp_f32 v111, v111
    v_exp_f32 v112, v112
    v_exp_f32 v113, v113
    v_exp_f32 v114, v114
    v_smfmac_f32_32x32x32_bf16 v[72:87], v[64:67], v[104:111], v136
    ds_read_b128 v[60:63], v145 offset:512
    v_exp_f32 v115, v115
    v_exp_f32 v116, v116
    v_exp_f32 v117, v117
    v_exp_f32 v118, v118
    v_exp_f32 v119, v119
    v_exp_f32 v120, v120
    v_exp_f32 v121, v121
    v_exp_f32 v122, v122
    v_smfmac_f32_32x32x32_bf16 v[72:87], v[68:71], v[112:119], v136
    buffer_load_dwordx4 v6, s[52:55], s33 offen offset:2048 lds
    buffer_load_dwordx4 v7, s[52:55], s33 offen offset:3072 lds
    s_add_u32 m0, s34, 28672
    s_add_u32 s33, s33, 131072
    v_exp_f32 v123, v123
    v_exp_f32 v124, v124
    v_exp_f32 v125, v125
    v_mfma_f32_32x32x16_bf16 v[104:119], v[48:51], v[40:43], 0
    ds_read_b128 v[56:59], v145 offset:0
    v_exp_f32 v126, v126
    v_exp_f32 v127, v127
    v_exp_f32 v128, v128
    v_exp_f32 v129, v129
    v_exp_f32 v130, v130
    v_smfmac_f32_32x32x32_bf16 v[88:103], v[64:67], v[120:127], v136
    buffer_load_dwordx4 v4, s[52:55], s33 offen offset:0 lds
    buffer_load_dwordx4 v5, s[52:55], s33 offen offset:1024 lds
    v_exp_f32 v131, v131
    v_exp_f32 v132, v132
    v_exp_f32 v133, v133
    v_exp_f32 v134, v134
    v_exp_f32 v135, v135
    v_exp_f32 v104, v104
    v_exp_f32 v105, v105
    v_exp_f32 v106, v106
    v_smfmac_f32_32x32x32_bf16 v[88:103], v[68:71], v[128:135], v136
    s_waitcnt lgkmcnt(0)
    v_exp_f32 v107, v107
    v_exp_f32 v108, v108
    v_exp_f32 v109, v109
    v_mfma_f32_32x32x16_bf16 v[120:135], v[48:51], v[44:47], 0
    ds_read_b128 v[48:51], v147 offset:53248
    v_exp_f32 v110, v110
    v_exp_f32 v111, v111
    v_exp_f32 v112, v112
    v_exp_f32 v113, v113
    v_exp_f32 v114, v114
    v_smfmac_f32_32x32x32_bf16 v[72:87], v[56:59], v[104:111], v136
    ds_read_b128 v[68:71], v145 offset:2560
    v_exp_f32 v115, v115
    v_exp_f32 v116, v116
    v_exp_f32 v117, v117
    v_exp_f32 v118, v118
    v_exp_f32 v119, v119
    v_exp_f32 v120, v120
    v_exp_f32 v121, v121
    v_exp_f32 v122, v122
    v_smfmac_f32_32x32x32_bf16 v[72:87], v[60:63], v[112:119], v136
    buffer_load_dwordx4 v6, s[52:55], s33 offen offset:2048 lds
    buffer_load_dwordx4 v7, s[52:55], s33 offen offset:3072 lds
    v_exp_f32 v123, v123
    v_exp_f32 v124, v124
    v_exp_f32 v125, v125
    v_mfma_f32_32x32x16_bf16 v[104:119], v[52:55], v[40:43], 0
    ds_read_b128 v[64:67], v145 offset:2048
    v_exp_f32 v126, v126
    v_exp_f32 v127, v127
    v_exp_f32 v128, v128
    v_exp_f32 v129, v129
    v_exp_f32 v130, v130
    v_smfmac_f32_32x32x32_bf16 v[88:103], v[56:59], v[120:127], v136
    v_exp_f32 v131, v131
    v_exp_f32 v132, v132
    v_exp_f32 v133, v133
    v_exp_f32 v134, v134
    v_exp_f32 v135, v135
    v_exp_f32 v104, v104
    v_exp_f32 v105, v105
    v_exp_f32 v106, v106
    v_smfmac_f32_32x32x32_bf16 v[88:103], v[60:63], v[128:135], v136
    s_waitcnt lgkmcnt(0)
    v_exp_f32 v107, v107
    v_exp_f32 v108, v108
    v_exp_f32 v109, v109
    v_mfma_f32_32x32x16_bf16 v[120:135], v[52:55], v[44:47], 0
    ds_read_b128 v[52:55], v147 offset:55296
    v_exp_f32 v110, v110
    v_exp_f32 v111, v111
    v_exp_f32 v112, v112
    v_exp_f32 v113, v113
    v_exp_f32 v114, v114
    v_smfmac_f32_32x32x32_bf16 v[72:87], v[64:67], v[104:111], v136
    ds_read_b128 v[60:63], v145 offset:4608
    v_exp_f32 v115, v115
    v_exp_f32 v116, v116
    v_exp_f32 v117, v117
    v_exp_f32 v118, v118
    v_exp_f32 v119, v119
    v_exp_f32 v120, v120
    v_exp_f32 v121, v121
    v_exp_f32 v122, v122
    v_smfmac_f32_32x32x32_bf16 v[72:87], v[68:71], v[112:119], v136
    v_exp_f32 v123, v123
    v_exp_f32 v124, v124
    v_exp_f32 v125, v125
    v_mfma_f32_32x32x16_bf16 v[104:119], v[48:51], v[40:43], 0
    ds_read_b128 v[56:59], v145 offset:4096
    v_exp_f32 v126, v126
    v_exp_f32 v127, v127
    v_exp_f32 v128, v128
    v_exp_f32 v129, v129
    v_exp_f32 v130, v130
    v_smfmac_f32_32x32x32_bf16 v[88:103], v[64:67], v[120:127], v136
    v_exp_f32 v131, v131
    v_exp_f32 v132, v132
    v_exp_f32 v133, v133
    v_exp_f32 v134, v134
    v_exp_f32 v135, v135
    v_exp_f32 v104, v104
    v_exp_f32 v105, v105
    v_exp_f32 v106, v106
    v_smfmac_f32_32x32x32_bf16 v[88:103], v[68:71], v[128:135], v136
    s_waitcnt lgkmcnt(0)
    v_exp_f32 v107, v107
    v_exp_f32 v108, v108
    v_exp_f32 v109, v109
    v_mfma_f32_32x32x16_bf16 v[120:135], v[48:51], v[44:47], 0
    s_nop 0
    v_exp_f32 v110, v110
    v_exp_f32 v111, v111
    v_exp_f32 v112, v112
    v_exp_f32 v113, v113
    v_exp_f32 v114, v114
    v_smfmac_f32_32x32x32_bf16 v[72:87], v[56:59], v[104:111], v136
    ds_read_b128 v[68:71], v145 offset:6656
    v_exp_f32 v115, v115
    v_exp_f32 v116, v116
    v_exp_f32 v117, v117
    v_exp_f32 v118, v118
    v_exp_f32 v119, v119
    v_exp_f32 v120, v120
    v_exp_f32 v121, v121
    v_exp_f32 v122, v122
    v_smfmac_f32_32x32x32_bf16 v[72:87], v[60:63], v[112:119], v136
    v_exp_f32 v123, v123
    v_exp_f32 v124, v124
    v_exp_f32 v125, v125
    v_mfma_f32_32x32x16_bf16 v[104:119], v[52:55], v[40:43], 0
    ds_read_b128 v[64:67], v145 offset:6144
    v_exp_f32 v126, v126
    v_exp_f32 v127, v127
    v_exp_f32 v128, v128
    v_exp_f32 v129, v129
    v_exp_f32 v130, v130
    v_smfmac_f32_32x32x32_bf16 v[88:103], v[56:59], v[120:127], v136
    v_exp_f32 v131, v131
    v_exp_f32 v132, v132
    v_exp_f32 v133, v133
    v_exp_f32 v134, v134
    v_exp_f32 v135, v135
    v_exp_f32 v104, v104
    v_exp_f32 v105, v105
    v_exp_f32 v106, v106
    v_smfmac_f32_32x32x32_bf16 v[88:103], v[60:63], v[128:135], v136
    s_waitcnt lgkmcnt(0)
    v_exp_f32 v107, v107
    v_exp_f32 v108, v108
    v_exp_f32 v109, v109
    v_mfma_f32_32x32x16_bf16 v[120:135], v[52:55], v[44:47], 0
    s_nop 0
    v_exp_f32 v110, v110
    v_exp_f32 v111, v111
    v_exp_f32 v112, v112
    v_exp_f32 v113, v113
    v_exp_f32 v114, v114
    v_smfmac_f32_32x32x32_bf16 v[72:87], v[64:67], v[104:111], v136
    v_exp_f32 v115, v115
    v_exp_f32 v116, v116
    v_exp_f32 v117, v117
    v_exp_f32 v118, v118
    v_exp_f32 v119, v119
    v_exp_f32 v120, v120
    v_exp_f32 v121, v121
    v_exp_f32 v122, v122
    v_smfmac_f32_32x32x32_bf16 v[72:87], v[68:71], v[112:119], v136
    v_exp_f32 v123, v123
    v_exp_f32 v124, v124
    v_exp_f32 v125, v125
    v_exp_f32 v126, v126
    v_exp_f32 v127, v127
    v_exp_f32 v128, v128
    v_exp_f32 v129, v129
    v_exp_f32 v130, v130
    v_smfmac_f32_32x32x32_bf16 v[88:103], v[64:67], v[120:127], v136
    v_exp_f32 v131, v131
    v_exp_f32 v132, v132
    v_exp_f32 v133, v133
    v_exp_f32 v134, v134
    v_exp_f32 v135, v135
    s_nop 1
    v_smfmac_f32_32x32x32_bf16 v[88:103], v[68:71], v[128:135], v136
    s_branch L_at_epi
L_ls_3_g:
    buffer_store_dwordx4 v[132:135], v2, s[12:15], s98 offen sc1
    buffer_store_dwordx4 v[132:135], v2, s[12:15], s99 offen sc1
    s_branch L_ls_3_d
L_ls_5_g:
    buffer_store_dword v11, v12, s[12:15], s73 offen sc1
    s_branch L_ls_5_d
L_ls_7_g:
    buffer_store_dwordx4 v[72:75], v2, s[12:15], s98 offen sc1
    buffer_store_dwordx4 v[76:79], v2, s[12:15], s99 offen sc1
    s_branch L_ls_7_d
L_qt_10:
    s_mov_b32 s24, 0
L_qt_10_l:
    buffer_load_dwordx4 v[40:43], v2, s[12:15], s26 offen offset:0 sc1
    buffer_load_dwordx4 v[44:47], v2, s[12:15], s26 offen offset:1024 sc1
    s_add_u32 s24, s24, 1
    s_waitcnt vmcnt(0)
    v_max3_u32 v14, v40, v41, v42
    v_max3_u32 v13, v44, v45, v46
    v_max3_u32 v14, v14, v43, v47
    v_max_u32 v14, v14, v13
    v_cmp_eq_u32 vcc, -1, v14
    s_cmp_ge_u32 s24, 65536
    s_cbranch_scc1 L_qt_10_d
    s_cbranch_vccnz L_qt_10_l
    s_branch L_qt_10_d
L_sn_11:
    s_mov_b32 s24, 0
L_sn_11_l:
    buffer_load_dword v14, v12, s[12:15], s90 offen sc1
    s_add_u32 s24, s24, 1
    s_waitcnt vmcnt(0)
    v_cmp_gt_u32 vcc, 32, v14
    s_cmp_ge_u32 s24, 65536
    s_cbranch_scc1 L_sn_11_d
    s_cbranch_vccnz L_sn_11_l
    s_branch L_sn_11_d
L_gq_12:
    s_mov_b32 s24, 0
L_pl_44:
    buffer_load_dword v14, v20, s[12:15], s76 offen sc1
    s_add_u32 s24, s24, 1
    s_waitcnt vmcnt(0)
    v_cmp_eq_u32 vcc, 0, v14
    s_cmp_ge_u32 s24, 65536
    s_cbranch_scc1 L_pl_44_x
    s_cbranch_vccz L_pl_44_x
    s_mov_b64 exec, vcc
    s_branch L_pl_44
L_pl_44_x:
    s_mov_b64 exec, -1
L_pl_44_go:
    s_branch L_gq_12_d
L_ls_13_g:
    buffer_store_dwordx4 v[150:153], v2, s[12:15], s75 offen sc1
    buffer_store_dwordx4 v[150:153], v2, s[12:15], s77 offen sc1
    s_branch L_ls_13_d
L_ls_14_g:
    buffer_store_dword v150, v138, s[12:15], s72 offen sc1
    s_branch L_ls_14_d
L_ls_16_g:
    buffer_store_dwordx4 v[48:51], v2, s[12:15], s75 offen sc1
    buffer_store_dwordx4 v[52:55], v2, s[12:15], s77 offen sc1
    s_branch L_ls_16_d
L_at_slow:
    s_cmp_lg_u32 s31, 0
    s_cbranch_scc1 L_at_nan
    s_waitcnt vmcnt(0)
    v_and_b32 v11, 15, v1
    v_lshlrev_b32 v11, 4, v11
    v_lshrrev_b32 v13, 5, v1
    v_lshl_add_u32 v13, v13, 8, v11
    s_mov_b32 s30, 0xffff
    s_mov_b32 s31, 0xffff
    v_mov_b32 v138, 0xff800000
    s_mov_b32 s29, s28
    s_mov_b32 s24, 0
L_at_max0:
    buffer_load_dwordx4 v[48:51], v2, s[12:15], s29 offen sc1
    s_waitcnt vmcnt(0)
    v_mfma_f32_32x32x16_bf16 v[104:119], v[48:51], v[40:43], 0
    s_nop 15
    v_max3_f32 v138, v104, v105, v138
    v_max3_f32 v138, v106, v107, v138
    v_max3_f32 v138, v108, v109, v138
    v_max3_f32 v138, v110, v111, v138
    v_max3_f32 v138, v112, v113, v138
    v_max3_f32 v138, v114, v115, v138
    v_max3_f32 v138, v116, v117, v138
    v_max3_f32 v138, v118, v119, v138
    s_add_u32 s29, s29, 2048
    s_add_u32 s24, s24, 1
    s_cmp_lt_u32 s24, 64
    s_cbranch_scc1 L_at_max0
    v_mov_b32 v139, v138
    s_nop 1
    v_permlane32_swap_b32 v138, v139
    s_nop 1
    v_max_f32 v138, v138, v139
    v_sub_f32 v120, 0, v138
    v_mov_b32 v72, 0
    v_sub_f32 v121, 0, v138
    v_mov_b32 v73, 0
    v_sub_f32 v122, 0, v138
    v_mov_b32 v74, 0
    v_sub_f32 v123, 0, v138
    v_mov_b32 v75, 0
    v_sub_f32 v124, 0, v138
    v_mov_b32 v76, 0
    v_sub_f32 v125, 0, v138
    v_mov_b32 v77, 0
    v_sub_f32 v126, 0, v138
    v_mov_b32 v78, 0
    v_sub_f32 v127, 0, v138
    v_mov_b32 v79, 0
    v_sub_f32 v128, 0, v138
    v_mov_b32 v80, 0
    v_sub_f32 v129, 0, v138
    v_mov_b32 v81, 0
    v_sub_f32 v130, 0, v138
    v_mov_b32 v82, 0
    v_sub_f32 v131, 0, v138
    v_mov_b32 v83, 0
    v_sub_f32 v132, 0, v138
    v_mov_b32 v84, 0
    v_sub_f32 v133, 0, v138
    v_mov_b32 v85, 0
    v_sub_f32 v134, 0, v138
    v_mov_b32 v86, 0
    v_sub_f32 v135, 0, v138
    v_mov_b32 v87, 0
    s_mov_b32 s29, s28
    s_mov_b32 s24, 0
L_at_sl0:
    buffer_load_dwordx4 v[48:51], v2, s[12:15], s29 offen sc1
    s_mov_b64 exec, s[30:31]
    buffer_load_dwordx4 v[56:59], v13, s[12:15], s29 offen offset:1024 sc1
    buffer_load_dwordx4 v[60:63], v13, s[12:15], s29 offen offset:1536 sc1
    s_mov_b64 exec, -1
    s_waitcnt vmcnt(0)
    v_mfma_f32_32x32x16_bf16 v[104:119], v[48:51], v[40:43], v[120:135]
    s_nop 15
    v_exp_f32 v104, v104
    v_exp_f32 v105, v105
    v_exp_f32 v106, v106
    v_exp_f32 v107, v107
    v_exp_f32 v108, v108
    v_exp_f32 v109, v109
    v_exp_f32 v110, v110
    v_exp_f32 v111, v111
    v_exp_f32 v112, v112
    v_exp_f32 v113, v113
    v_exp_f32 v114, v114
    v_exp_f32 v115, v115
    v_exp_f32 v116, v116
    v_exp_f32 v117, v117
    v_exp_f32 v118, v118
    v_exp_f32 v119, v119
    s_nop 3
    v_smfmac_f32_32x32x32_bf16 v[72:87], v[56:59], v[104:111], v136
    v_smfmac_f32_32x32x32_bf16 v[72:87], v[60:63], v[112:119], v136
    s_add_u32 s29, s29, 2048
    s_add_u32 s24, s24, 1
    s_cmp_lt_u32 s24, 64
    s_nop 15
    s_cbranch_scc1 L_at_sl0
    v_mov_b32 v138, 0xff800000
    s_mov_b32 s29, s28
    s_mov_b32 s24, 0
L_at_max1:
    buffer_load_dwordx4 v[48:51], v2, s[12:15], s29 offen sc1
    s_waitcnt vmcnt(0)
    v_mfma_f32_32x32x16_bf16 v[104:119], v[48:51], v[44:47], 0
    s_nop 15
    v_max3_f32 v138, v104, v105, v138
    v_max3_f32 v138, v106, v107, v138
    v_max3_f32 v138, v108, v109, v138
    v_max3_f32 v138, v110, v111, v138
    v_max3_f32 v138, v112, v113, v138
    v_max3_f32 v138, v114, v115, v138
    v_max3_f32 v138, v116, v117, v138
    v_max3_f32 v138, v118, v119, v138
    s_add_u32 s29, s29, 2048
    s_add_u32 s24, s24, 1
    s_cmp_lt_u32 s24, 64
    s_cbranch_scc1 L_at_max1
    v_mov_b32 v139, v138
    s_nop 1
    v_permlane32_swap_b32 v138, v139
    s_nop 1
    v_max_f32 v138, v138, v139
    v_sub_f32 v120, 0, v138
    v_mov_b32 v88, 0
    v_sub_f32 v121, 0, v138
    v_mov_b32 v89, 0
    v_sub_f32 v122, 0, v138
    v_mov_b32 v90, 0
    v_sub_f32 v123, 0, v138
    v_mov_b32 v91, 0
    v_sub_f32 v124, 0, v138
    v_mov_b32 v92, 0
    v_sub_f32 v125, 0, v138
    v_mov_b32 v93, 0
    v_sub_f32 v126, 0, v138
    v_mov_b32 v94, 0
    v_sub_f32 v127, 0, v138
    v_mov_b32 v95, 0
    v_sub_f32 v128, 0, v138
    v_mov_b32 v96, 0
    v_sub_f32 v129, 0, v138
    v_mov_b32 v97, 0
    v_sub_f32 v130, 0, v138
    v_mov_b32 v98, 0
    v_sub_f32 v131, 0, v138
    v_mov_b32 v99, 0
    v_sub_f32 v132, 0, v138
    v_mov_b32 v100, 0
    v_sub_f32 v133, 0, v138
    v_mov_b32 v101, 0
    v_sub_f32 v134, 0, v138
    v_mov_b32 v102, 0
    v_sub_f32 v135, 0, v138
    v_mov_b32 v103, 0
    s_mov_b32 s29, s28
    s_mov_b32 s24, 0
L_at_sl1:
    buffer_load_dwordx4 v[48:51], v2, s[12:15], s29 offen sc1
    s_mov_b64 exec, s[30:31]
    buffer_load_dwordx4 v[56:59], v13, s[12:15], s29 offen offset:1024 sc1
    buffer_load_dwordx4 v[60:63], v13, s[12:15], s29 offen offset:1536 sc1
    s_mov_b64 exec, -1
    s_waitcnt vmcnt(0)
    v_mfma_f32_32x32x16_bf16 v[104:119], v[48:51], v[44:47], v[120:135]
    s_nop 15
    v_exp_f32 v104, v104
    v_exp_f32 v105, v105
    v_exp_f32 v106, v106
    v_exp_f32 v107, v107
    v_exp_f32 v108, v108
    v_exp_f32 v109, v109
    v_exp_f32 v110, v110
    v_exp_f32 v111, v111
    v_exp_f32 v112, v112
    v_exp_f32 v113, v113
    v_exp_f32 v114, v114
    v_exp_f32 v115, v115
    v_exp_f32 v116, v116
    v_exp_f32 v117, v117
    v_exp_f32 v118, v118
    v_exp_f32 v119, v119
    s_nop 3
    v_smfmac_f32_32x32x32_bf16 v[88:103], v[56:59], v[104:111], v136
    v_smfmac_f32_32x32x32_bf16 v[88:103], v[60:63], v[112:119], v136
    s_add_u32 s29, s29, 2048
    s_add_u32 s24, s24, 1
    s_cmp_lt_u32 s24, 64
    s_nop 15
    s_cbranch_scc1 L_at_sl1
    s_branch L_at_fin
L_at_nan:
    v_min_u32 v48, -2, v48
    v_min_u32 v49, -2, v49
    v_min_u32 v50, -2, v50
    v_min_u32 v51, -2, v51
    v_min_u32 v52, -2, v52
    v_min_u32 v53, -2, v53
    v_min_u32 v54, -2, v54
    v_min_u32 v55, -2, v55
    s_branch L_at_st
L_ls_19_g:
    buffer_store_dwordx2 v[132:133], v131, s[12:15], s25 offen sc1
    s_branch L_ls_19_d
L_ex_18_poll:
    s_mov_b32 s24, 0
L_ex_18_p2:
    buffer_load_dwordx4 v[80:83], v131, s[12:15], s28 offen offset:0 sc1
    buffer_load_dwordx4 v[84:87], v131, s[12:15], s28 offen offset:512 sc1
    buffer_load_dwordx4 v[88:91], v131, s[12:15], s28 offen offset:1024 sc1
    buffer_load_dwordx4 v[92:95], v131, s[12:15], s28 offen offset:1536 sc1
    s_add_u32 s24, s24, 1
    s_waitcnt vmcnt(0)
    v_max3_u32 v12, v80, v81, v82
    v_max3_u32 v12, v83, v84, v12
    v_max3_u32 v12, v85, v86, v12
    v_max3_u32 v12, v87, v88, v12
    v_max3_u32 v12, v89, v90, v12
    v_max3_u32 v12, v91, v92, v12
    v_max3_u32 v12, v93, v94, v12
    v_max_u32 v12, v95, v12
    v_cmp_eq_u32 vcc, -1, v12
    s_cmp_ge_u32 s24, 65536
    s_cbranch_scc1 L_ex_18_x
    s_cbranch_vccnz L_ex_18_p2
L_ex_18_x:
    v_pk_add_f32 v[80:81], v[80:81], v[88:89]
    v_pk_add_f32 v[82:83], v[82:83], v[90:91]
    v_pk_add_f32 v[84:85], v[84:85], v[92:93]
    v_pk_add_f32 v[86:87], v[86:87], v[94:95]
    v_pk_add_f32 v[80:81], v[80:81], v[84:85]
    v_pk_add_f32 v[82:83], v[82:83], v[86:87]
    v_pk_add_f32 v[132:133], v[80:81], v[82:83]
    v_mov_b32 v11, v132
    v_mov_b32 v12, v133
    s_nop 0
    v_permlane32_swap_b32 v132, v11
    v_permlane32_swap_b32 v133, v12
    v_add_f32 v132, v132, v11
    v_add_f32 v133, v133, v12
    s_mov_b64 vcc, 0
    s_branch L_ex_18_got
L_l1_20:
    s_lshl_b32 s78, s24, 15
    s_lshl_b32 s25, s25, 5
    s_add_u32 s78, s78, s25
    s_add_u32 s79, s78, 64
    s_mov_b32 s64, s68
    s_mov_b32 s65, s69
    s_mov_b32 s66, s70
    s_mov_b32 s6, 0
    v_and_b32 v158, 31, v1
    v_lshlrev_b32 v158, 10, v158
    v_lshrrev_b32 v159, 5, v1
    v_lshl_add_u32 v158, v159, 4, v158
    s_branch L_l1_20_d
L_finish:
    s_endpgm
L_mlp_idle:
    s_add_u32 m0, s34, 12288
    s_add_u32 s33, s91, 1179648
    buffer_load_dwordx4 v140, s[52:55], s33 offen offset:0 lds
    buffer_load_dwordx4 v141, s[52:55], s33 offen offset:1024 lds
    buffer_load_dwordx4 v142, s[52:55], s33 offen offset:2048 lds
    buffer_load_dwordx4 v143, s[52:55], s33 offen offset:3072 lds
    v_min_u32 v11, 11, v1
    v_lshrrev_b32 v12, 2, v11
    v_and_b32 v11, 3, v11
    v_lshlrev_b32 v11, 10, v11
    v_lshl_add_u32 v11, v12, 14, v11
L_pr_45:
    buffer_load_dword v14, v11, s[12:15], s77 offen sc1
    s_addk_i32 s94, 1
    s_waitcnt vmcnt(0)
    v_cmp_eq_u32 vcc, -1, v14
    s_cmpk_ge_u32 s94, 0xffff
    s_cbranch_scc1 L_pr_45_x
    s_cbranch_vccz L_pr_45_x
    s_mov_b64 exec, vcc
    s_sleep 8
    s_branch L_pr_45
L_pr_45_x:
    s_mov_b64 exec, -1
    s_mov_b32 s75, 33554432
    s_add_u32 s32, s77, 0
    buffer_load_dwordx4 v[120:123], v19, s[12:15], s32 offen offset:0 sc1
    buffer_load_dwordx4 v[124:127], v19, s[12:15], s32 offen offset:1024 sc1
    buffer_load_dwordx4 v[128:131], v19, s[12:15], s32 offen offset:2048 sc1
    buffer_load_dwordx4 v[132:135], v19, s[12:15], s32 offen offset:3072 sc1
    s_add_u32 s32, s77, 16384
    buffer_load_dwordx4 v[136:139], v19, s[12:15], s32 offen offset:0 sc1
    buffer_load_dwordx4 v[4:7], v19, s[12:15], s32 offen offset:1024 sc1
    buffer_load_dwordx4 v[104:107], v19, s[12:15], s32 offen offset:2048 sc1
    buffer_load_dwordx4 v[108:111], v19, s[12:15], s32 offen offset:3072 sc1
    s_add_u32 s32, s77, 32768
    buffer_load_dwordx4 v[112:115], v19, s[12:15], s32 offen offset:0 sc1
    buffer_load_dwordx4 v[116:119], v19, s[12:15], s32 offen offset:1024 sc1
    ds_read_b64_tr_b16 v[140:141], v21 offset:0
    ds_read_b64_tr_b16 v[142:143], v21 offset:1024
    ds_read_b64_tr_b16 v[144:145], v22 offset:0
    ds_read_b64_tr_b16 v[146:147], v22 offset:1024
    ds_read_b64_tr_b16 v[148:149], v21 offset:2048
    ds_read_b64_tr_b16 v[150:151], v21 offset:3072
L_pad_A_4:
    s_cbranch_execz L_ret_A_4
    ds_read_b64_tr_b16 v[152:153], v22 offset:2048
    ds_read_b64_tr_b16 v[154:155], v22 offset:3072
    s_branch L_mlp_p2
L_ls_22_g:
    buffer_store_dwordx4 v[56:59], v158, s[64:67], s78 offen sc1
    s_branch L_ls_22_d
L_ls_23_g:
    buffer_store_dword v11, v12, s[12:15], s72 offen sc1
    s_branch L_ls_23_d
L_ls_25_g:
    buffer_store_dwordx4 v[40:43], v2, s[12:15], s98 offen sc1
    buffer_store_dwordx4 v[40:43], v2, s[12:15], s99 offen sc1
    s_branch L_ls_25_d
L_ls_28_g:
    buffer_store_dwordx4 v[88:91], v158, s[64:67], s79 offen sc1
    s_branch L_ls_28_d
L_ls_29_g:
    buffer_store_dwordx2 v[156:157], v2, s[12:15], s28 offen sc1
    s_branch L_ls_29_d
L_ls_30_g:
    buffer_store_dword v11, v12, s[12:15], s73 offen sc1
    s_branch L_ls_30_d
L_ls_33_g:
    buffer_store_dword v11, v12, s[12:15], s73 offen sc1
    s_branch L_ls_33_d
L_ls_35_g:
    buffer_store_dwordx4 v[72:75], v2, s[12:15], s98 offen sc1
    buffer_store_dwordx4 v[76:79], v2, s[12:15], s99 offen sc1
    s_branch L_ls_35_d
L_qt_38:
    s_mov_b32 s24, 0
L_qt_38_l:
    buffer_load_dwordx4 v[40:43], v2, s[12:15], s26 offen offset:0 sc1
    buffer_load_dwordx4 v[44:47], v2, s[12:15], s26 offen offset:1024 sc1
    s_add_u32 s24, s24, 1
    s_waitcnt vmcnt(0)
    v_max3_u32 v14, v40, v41, v42
    v_max3_u32 v13, v44, v45, v46
    v_max3_u32 v14, v14, v43, v47
    v_max_u32 v14, v14, v13
    v_cmp_eq_u32 vcc, -1, v14
    s_cmp_ge_u32 s24, 65536
    s_cbranch_scc1 L_qt_38_d
    s_cbranch_vccnz L_qt_38_l
    s_branch L_qt_38_d
L_sn_39:
    s_mov_b32 s24, 0
L_sn_39_l:
    buffer_load_dword v14, v12, s[12:15], s90 offen sc1
    s_add_u32 s24, s24, 1
    s_waitcnt vmcnt(0)
    v_cmp_gt_u32 vcc, 32, v14
    s_cmp_ge_u32 s24, 65536
    s_cbranch_scc1 L_sn_39_d
    s_cbranch_vccnz L_sn_39_l
    s_branch L_sn_39_d
L_gq_40:
    s_mov_b32 s24, 0
L_pl_46:
    buffer_load_dword v14, v20, s[12:15], s76 offen sc1
    s_add_u32 s24, s24, 1
    s_waitcnt vmcnt(0)
    v_cmp_eq_u32 vcc, 0, v14
    s_cmp_ge_u32 s24, 65536
    s_cbranch_scc1 L_pl_46_x
    s_cbranch_vccz L_pl_46_x
    s_mov_b64 exec, vcc
    s_branch L_pl_46
L_pl_46_x:
    s_mov_b64 exec, -1
L_pl_46_go:
    s_branch L_gq_40_d
L_ls_41_g:
    buffer_store_dwordx4 v[150:153], v2, s[12:15], s75 offen sc1
    buffer_store_dwordx4 v[150:153], v2, s[12:15], s77 offen sc1
    s_branch L_ls_41_d
L_ls_42_g:
    buffer_store_dword v150, v138, s[12:15], s72 offen sc1
    s_branch L_ls_42_d
L_reg_N:
L_ort0:
    s_add_u32 s93, s31, 0
    buffer_load_dwordx4 v[80:83], v2, s[12:15], s93 offen offset:0 sc1
    buffer_load_dwordx4 v[84:87], v2, s[12:15], s93 offen offset:1024 sc1
    buffer_load_dwordx4 v[88:91], v2, s[12:15], s93 offen offset:2048 sc1
    buffer_load_dwordx4 v[92:95], v2, s[12:15], s93 offen offset:3072 sc1
    s_addk_i32 s94, 1
    s_cmpk_lt_u32 s94, 0xffff
    s_waitcnt vmcnt(0)
    v_max3_u32 v14, v80, v81, v82
    v_max_u32 v14, v14, v83
    v_cmp_eq_u32 vcc, -1, v14
    s_cbranch_scc0 L_ook0
    s_cbranch_vccnz L_ort0
    s_branch L_ook0
L_ort1:
    s_add_u32 s93, s31, 0
    buffer_load_dwordx4 v[84:87], v2, s[12:15], s93 offen offset:1024 sc1
    buffer_load_dwordx4 v[88:91], v2, s[12:15], s93 offen offset:2048 sc1
    buffer_load_dwordx4 v[92:95], v2, s[12:15], s93 offen offset:3072 sc1
    s_addk_i32 s94, 1
    s_cmpk_lt_u32 s94, 0xffff
    s_waitcnt vmcnt(0)
    v_max3_u32 v14, v84, v85, v86
    v_max_u32 v14, v14, v87
    v_cmp_eq_u32 vcc, -1, v14
    s_cbranch_scc0 L_ook1
    s_cbranch_vccnz L_ort1
    s_branch L_ook1
L_ort2:
    s_add_u32 s93, s31, 0
    buffer_load_dwordx4 v[88:91], v2, s[12:15], s93 offen offset:2048 sc1
    buffer_load_dwordx4 v[92:95], v2, s[12:15], s93 offen offset:3072 sc1
    s_addk_i32 s94, 1
    s_cmpk_lt_u32 s94, 0xffff
    s_waitcnt vmcnt(0)
    v_max3_u32 v14, v88, v89, v90
    v_max_u32 v14, v14, v91
    v_cmp_eq_u32 vcc, -1, v14
    s_cbranch_scc0 L_ook2
    s_cbranch_vccnz L_ort2
    s_branch L_ook2
L_ort3:
    s_add_u32 s93, s31, 0
    buffer_load_dwordx4 v[92:95], v2, s[12:15], s93 offen offset:3072 sc1
    s_addk_i32 s94, 1
    s_cmpk_lt_u32 s94, 0xffff
    s_waitcnt vmcnt(0)
    v_max3_u32 v14, v92, v93, v94
    v_max_u32 v14, v14, v95
    v_cmp_eq_u32 vcc, -1, v14
    s_cbranch_scc0 L_ook3
    s_cbranch_vccnz L_ort3
    s_branch L_ook3
L_ort4:
    s_add_u32 s93, s31, 4096
    buffer_load_dwordx4 v[96:99], v2, s[12:15], s93 offen offset:0 sc1
    buffer_load_dwordx4 v[100:103], v2, s[12:15], s93 offen offset:1024 sc1
    buffer_load_dwordx4 v[104:107], v2, s[12:15], s93 offen offset:2048 sc1
    buffer_load_dwordx4 v[108:111], v2, s[12:15], s93 offen offset:3072 sc1
    s_addk_i32 s94, 1
    s_cmpk_lt_u32 s94, 0xffff
    s_waitcnt vmcnt(0)
    v_max3_u32 v14, v96, v97, v98
    v_max_u32 v14, v14, v99
    v_cmp_eq_u32 vcc, -1, v14
    s_cbranch_scc0 L_ook4
    s_cbranch_vccnz L_ort4
    s_branch L_ook4
L_ort5:
    s_add_u32 s93, s31, 4096
    buffer_load_dwordx4 v[100:103], v2, s[12:15], s93 offen offset:1024 sc1
    buffer_load_dwordx4 v[104:107], v2, s[12:15], s93 offen offset:2048 sc1
    buffer_load_dwordx4 v[108:111], v2, s[12:15], s93 offen offset:3072 sc1
    s_addk_i32 s94, 1
    s_cmpk_lt_u32 s94, 0xffff
    s_waitcnt vmcnt(0)
    v_max3_u32 v14, v100, v101, v102
    v_max_u32 v14, v14, v103
    v_cmp_eq_u32 vcc, -1, v14
    s_cbranch_scc0 L_ook5
    s_cbranch_vccnz L_ort5
    s_branch L_ook5
L_ort6:
    s_add_u32 s93, s31, 4096
    buffer_load_dwordx4 v[104:107], v2, s[12:15], s93 offen offset:2048 sc1
    buffer_load_dwordx4 v[108:111], v2, s[12:15], s93 offen offset:3072 sc1
    s_addk_i32 s94, 1
    s_cmpk_lt_u32 s94, 0xffff
    s_waitcnt vmcnt(0)
    v_max3_u32 v14, v104, v105, v106
    v_max_u32 v14, v14, v107
    v_cmp_eq_u32 vcc, -1, v14
    s_cbranch_scc0 L_ook6
    s_cbranch_vccnz L_ort6
    s_branch L_ook6
L_ort7:
    s_add_u32 s93, s31, 4096
    buffer_load_dwordx4 v[108:111], v2, s[12:15], s93 offen offset:3072 sc1
    s_addk_i32 s94, 1
    s_cmpk_lt_u32 s94, 0xffff
    s_waitcnt vmcnt(0)
    v_max3_u32 v14, v108, v109, v110
    v_max_u32 v14, v14, v111
    v_cmp_eq_u32 vcc, -1, v14
    s_cbranch_scc0 L_ook7
    s_cbranch_vccnz L_ort7
    s_branch L_ook7
L_ort8:
    s_add_u32 s93, s31, 8192
    buffer_load_dwordx4 v[112:115], v2, s[12:15], s93 offen offset:0 sc1
    buffer_load_dwordx4 v[116:119], v2, s[12:15], s93 offen offset:1024 sc1
    buffer_load_dwordx4 v[120:123], v2, s[12:15], s93 offen offset:2048 sc1
    buffer_load_dwordx4 v[124:127], v2, s[12:15], s93 offen offset:3072 sc1
    s_addk_i32 s94, 1
    s_cmpk_lt_u32 s94, 0xffff
    s_waitcnt vmcnt(0)
    v_max3_u32 v14, v112, v113, v114
    v_max_u32 v14, v14, v115
    v_cmp_eq_u32 vcc, -1, v14
    s_cbranch_scc0 L_ook8
    s_cbranch_vccnz L_ort8
    s_branch L_ook8
L_ort9:
    s_add_u32 s93, s31, 8192
    buffer_load_dwordx4 v[116:119], v2, s[12:15], s93 offen offset:1024 sc1
    buffer_load_dwordx4 v[120:123], v2, s[12:15], s93 offen offset:2048 sc1
    buffer_load_dwordx4 v[124:127], v2, s[12:15], s93 offen offset:3072 sc1
    s_addk_i32 s94, 1
    s_cmpk_lt_u32 s94, 0xffff
    s_waitcnt vmcnt(0)
    v_max3_u32 v14, v116, v117, v118
    v_max_u32 v14, v14, v119
    v_cmp_eq_u32 vcc, -1, v14
    s_cbranch_scc0 L_ook9
    s_cbranch_vccnz L_ort9
    s_branch L_ook9
L_ort10:
    s_add_u32 s93, s31, 8192
    buffer_load_dwordx4 v[120:123], v2, s[12:15], s93 offen offset:2048 sc1
    buffer_load_dwordx4 v[124:127], v2, s[12:15], s93 offen offset:3072 sc1
    s_addk_i32 s94, 1
    s_cmpk_lt_u32 s94, 0xffff
    s_waitcnt vmcnt(0)
    v_max3_u32 v14, v120, v121, v122
    v_max_u32 v14, v14, v123
    v_cmp_eq_u32 vcc, -1, v14
    s_cbranch_scc0 L_ook10
    s_cbranch_vccnz L_ort10
    s_branch L_ook10
L_ort11:
    s_add_u32 s93, s31, 8192
    buffer_load_dwordx4 v[124:127], v2, s[12:15], s93 offen offset:3072 sc1
    s_addk_i32 s94, 1
    s_cmpk_lt_u32 s94, 0xffff
    s_waitcnt vmcnt(0)
    v_max3_u32 v14, v124, v125, v126
    v_max_u32 v14, v14, v127
    v_cmp_eq_u32 vcc, -1, v14
    s_cbranch_scc0 L_ook11
    s_cbranch_vccnz L_ort11
    s_branch L_ook11
L_ort12:
    s_add_u32 s93, s31, 12288
    buffer_load_dwordx4 v[80:83], v2, s[12:15], s93 offen offset:0 sc1
    buffer_load_dwordx4 v[84:87], v2, s[12:15], s93 offen offset:1024 sc1
    buffer_load_dwordx4 v[88:91], v2, s[12:15], s93 offen offset:2048 sc1
    buffer_load_dwordx4 v[92:95], v2, s[12:15], s93 offen offset:3072 sc1
    s_addk_i32 s94, 1
    s_cmpk_lt_u32 s94, 0xffff
    s_waitcnt vmcnt(0)
    v_max3_u32 v14, v80, v81, v82
    v_max_u32 v14, v14, v83
    v_cmp_eq_u32 vcc, -1, v14
    s_cbranch_scc0 L_ook12
    s_cbranch_vccnz L_ort12
    s_branch L_ook12
L_ort13:
    s_add_u32 s93, s31, 12288
    buffer_load_dwordx4 v[84:87], v2, s[12:15], s93 offen offset:1024 sc1
    buffer_load_dwordx4 v[88:91], v2, s[12:15], s93 offen offset:2048 sc1
    buffer_load_dwordx4 v[92:95], v2, s[12:15], s93 offen offset:3072 sc1
    s_addk_i32 s94, 1
    s_cmpk_lt_u32 s94, 0xffff
    s_waitcnt vmcnt(0)
    v_max3_u32 v14, v84, v85, v86
    v_max_u32 v14, v14, v87
    v_cmp_eq_u32 vcc, -1, v14
    s_cbranch_scc0 L_ook13
    s_cbranch_vccnz L_ort13
    s_branch L_ook13
L_ort14:
    s_add_u32 s93, s31, 12288
    buffer_load_dwordx4 v[88:91], v2, s[12:15], s93 offen offset:2048 sc1
    buffer_load_dwordx4 v[92:95], v2, s[12:15], s93 offen offset:3072 sc1
    s_addk_i32 s94, 1
    s_cmpk_lt_u32 s94, 0xffff
    s_waitcnt vmcnt(0)
    v_max3_u32 v14, v88, v89, v90
    v_max_u32 v14, v14, v91
    v_cmp_eq_u32 vcc, -1, v14
    s_cbranch_scc0 L_ook14
    s_cbranch_vccnz L_ort14
    s_branch L_ook14
L_ort15:
    s_add_u32 s93, s31, 12288
    buffer_load_dwordx4 v[92:95], v2, s[12:15], s93 offen offset:3072 sc1
    s_addk_i32 s94, 1
    s_cmpk_lt_u32 s94, 0xffff
    s_waitcnt vmcnt(0)
    v_max3_u32 v14, v92, v93, v94
    v_max_u32 v14, v14, v95
    v_cmp_eq_u32 vcc, -1, v14
    s_cbranch_scc0 L_ook15
    s_cbranch_vccnz L_ort15
    s_branch L_ook15
L_ort16:
    s_add_u32 s93, s31, 16384
    buffer_load_dwordx4 v[96:99], v2, s[12:15], s93 offen offset:0 sc1
    buffer_load_dwordx4 v[100:103], v2, s[12:15], s93 offen offset:1024 sc1
    buffer_load_dwordx4 v[104:107], v2, s[12:15], s93 offen offset:2048 sc1
    buffer_load_dwordx4 v[108:111], v2, s[12:15], s93 offen offset:3072 sc1
    s_addk_i32 s94, 1
    s_cmpk_lt_u32 s94, 0xffff
    s_waitcnt vmcnt(0)
    v_max3_u32 v14, v96, v97, v98
    v_max_u32 v14, v14, v99
    v_cmp_eq_u32 vcc, -1, v14
    s_cbranch_scc0 L_ook16
    s_cbranch_vccnz L_ort16
    s_branch L_ook16
L_ort17:
    s_add_u32 s93, s31, 16384
    buffer_load_dwordx4 v[100:103], v2, s[12:15], s93 offen offset:1024 sc1
    buffer_load_dwordx4 v[104:107], v2, s[12:15], s93 offen offset:2048 sc1
    buffer_load_dwordx4 v[108:111], v2, s[12:15], s93 offen offset:3072 sc1
    s_addk_i32 s94, 1
    s_cmpk_lt_u32 s94, 0xffff
    s_waitcnt vmcnt(0)
    v_max3_u32 v14, v100, v101, v102
    v_max_u32 v14, v14, v103
    v_cmp_eq_u32 vcc, -1, v14
    s_cbranch_scc0 L_ook17
    s_cbranch_vccnz L_ort17
    s_branch L_ook17
L_ort18:
    s_add_u32 s93, s31, 16384
    buffer_load_dwordx4 v[104:107], v2, s[12:15], s93 offen offset:2048 sc1
    buffer_load_dwordx4 v[108:111], v2, s[12:15], s93 offen offset:3072 sc1
    s_addk_i32 s94, 1
    s_cmpk_lt_u32 s94, 0xffff
    s_waitcnt vmcnt(0)
    v_max3_u32 v14, v104, v105, v106
    v_max_u32 v14, v14, v107
    v_cmp_eq_u32 vcc, -1, v14
    s_cbranch_scc0 L_ook18
    s_cbranch_vccnz L_ort18
    s_branch L_ook18
L_ort19:
    s_add_u32 s93, s31, 16384
    buffer_load_dwordx4 v[108:111], v2, s[12:15], s93 offen offset:3072 sc1
    s_addk_i32 s94, 1
    s_cmpk_lt_u32 s94, 0xffff
    s_waitcnt vmcnt(0)
    v_max3_u32 v14, v108, v109, v110
    v_max_u32 v14, v14, v111
    v_cmp_eq_u32 vcc, -1, v14
    s_cbranch_scc0 L_ook19
    s_cbranch_vccnz L_ort19
    s_branch L_ook19
L_ort20:
    s_add_u32 s93, s31, 20480
    buffer_load_dwordx4 v[112:115], v2, s[12:15], s93 offen offset:0 sc1
    buffer_load_dwordx4 v[116:119], v2, s[12:15], s93 offen offset:1024 sc1
    buffer_load_dwordx4 v[120:123], v2, s[12:15], s93 offen offset:2048 sc1
    buffer_load_dwordx4 v[124:127], v2, s[12:15], s93 offen offset:3072 sc1
    s_addk_i32 s94, 1
    s_cmpk_lt_u32 s94, 0xffff
    s_waitcnt vmcnt(0)
    v_max3_u32 v14, v112, v113, v114
    v_max_u32 v14, v14, v115
    v_cmp_eq_u32 vcc, -1, v14
    s_cbranch_scc0 L_ook20
    s_cbranch_vccnz L_ort20
    s_branch L_ook20
L_ort21:
    s_add_u32 s93, s31, 20480
    buffer_load_dwordx4 v[116:119], v2, s[12:15], s93 offen offset:1024 sc1
    buffer_load_dwordx4 v[120:123], v2, s[12:15], s93 offen offset:2048 sc1
    buffer_load_dwordx4 v[124:127], v2, s[12:15], s93 offen offset:3072 sc1
    s_addk_i32 s94, 1
    s_cmpk_lt_u32 s94, 0xffff
    s_waitcnt vmcnt(0)
    v_max3_u32 v14, v116, v117, v118
    v_max_u32 v14, v14, v119
    v_cmp_eq_u32 vcc, -1, v14
    s_cbranch_scc0 L_ook21
    s_cbranch_vccnz L_ort21
    s_branch L_ook21
L_ort22:
    s_add_u32 s93, s31, 20480
    buffer_load_dwordx4 v[120:123], v2, s[12:15], s93 offen offset:2048 sc1
    buffer_load_dwordx4 v[124:127], v2, s[12:15], s93 offen offset:3072 sc1
    s_addk_i32 s94, 1
    s_cmpk_lt_u32 s94, 0xffff
    s_waitcnt vmcnt(0)
    v_max3_u32 v14, v120, v121, v122
    v_max_u32 v14, v14, v123
    v_cmp_eq_u32 vcc, -1, v14
    s_cbranch_scc0 L_ook22
    s_cbranch_vccnz L_ort22
    s_branch L_ook22
L_ort23:
    s_add_u32 s93, s31, 20480
    buffer_load_dwordx4 v[124:127], v2, s[12:15], s93 offen offset:3072 sc1
    s_addk_i32 s94, 1
    s_cmpk_lt_u32 s94, 0xffff
    s_waitcnt vmcnt(0)
    v_max3_u32 v14, v124, v125, v126
    v_max_u32 v14, v14, v127
    v_cmp_eq_u32 vcc, -1, v14
    s_cbranch_scc0 L_ook23
    s_cbranch_vccnz L_ort23
    s_branch L_ook23
L_ort24:
    s_add_u32 s93, s31, 24576
    buffer_load_dwordx4 v[80:83], v2, s[12:15], s93 offen offset:0 sc1
    buffer_load_dwordx4 v[84:87], v2, s[12:15], s93 offen offset:1024 sc1
    buffer_load_dwordx4 v[88:91], v2, s[12:15], s93 offen offset:2048 sc1
    buffer_load_dwordx4 v[92:95], v2, s[12:15], s93 offen offset:3072 sc1
    s_addk_i32 s94, 1
    s_cmpk_lt_u32 s94, 0xffff
    s_waitcnt vmcnt(0)
    v_max3_u32 v14, v80, v81, v82
    v_max_u32 v14, v14, v83
    v_cmp_eq_u32 vcc, -1, v14
    s_cbranch_scc0 L_ook24
    s_cbranch_vccnz L_ort24
    s_branch L_ook24
L_ort25:
    s_add_u32 s93, s31, 24576
    buffer_load_dwordx4 v[84:87], v2, s[12:15], s93 offen offset:1024 sc1
    buffer_load_dwordx4 v[88:91], v2, s[12:15], s93 offen offset:2048 sc1
    buffer_load_dwordx4 v[92:95], v2, s[12:15], s93 offen offset:3072 sc1
    s_addk_i32 s94, 1
    s_cmpk_lt_u32 s94, 0xffff
    s_waitcnt vmcnt(0)
    v_max3_u32 v14, v84, v85, v86
    v_max_u32 v14, v14, v87
    v_cmp_eq_u32 vcc, -1, v14
    s_cbranch_scc0 L_ook25
    s_cbranch_vccnz L_ort25
    s_branch L_ook25
L_ort26:
    s_add_u32 s93, s31, 24576
    buffer_load_dwordx4 v[88:91], v2, s[12:15], s93 offen offset:2048 sc1
    buffer_load_dwordx4 v[92:95], v2, s[12:15], s93 offen offset:3072 sc1
    s_addk_i32 s94, 1
    s_cmpk_lt_u32 s94, 0xffff
    s_waitcnt vmcnt(0)
    v_max3_u32 v14, v88, v89, v90
    v_max_u32 v14, v14, v91
    v_cmp_eq_u32 vcc, -1, v14
    s_cbranch_scc0 L_ook26
    s_cbranch_vccnz L_ort26
    s_branch L_ook26
L_ort27:
    s_add_u32 s93, s31, 24576
    buffer_load_dwordx4 v[92:95], v2, s[12:15], s93 offen offset:3072 sc1
    s_addk_i32 s94, 1
    s_cmpk_lt_u32 s94, 0xffff
    s_waitcnt vmcnt(0)
    v_max3_u32 v14, v92, v93, v94
    v_max_u32 v14, v14, v95
    v_cmp_eq_u32 vcc, -1, v14
    s_cbranch_scc0 L_ook27
    s_cbranch_vccnz L_ort27
    s_branch L_ook27
L_ort28:
    s_add_u32 s93, s31, 28672
    buffer_load_dwordx4 v[96:99], v2, s[12:15], s93 offen offset:0 sc1
    buffer_load_dwordx4 v[100:103], v2, s[12:15], s93 offen offset:1024 sc1
    buffer_load_dwordx4 v[104:107], v2, s[12:15], s93 offen offset:2048 sc1
    buffer_load_dwordx4 v[108:111], v2, s[12:15], s93 offen offset:3072 sc1
    s_addk_i32 s94, 1
    s_cmpk_lt_u32 s94, 0xffff
    s_waitcnt vmcnt(0)
    v_max3_u32 v14, v96, v97, v98
    v_max_u32 v14, v14, v99
    v_cmp_eq_u32 vcc, -1, v14
    s_cbranch_scc0 L_ook28
    s_cbranch_vccnz L_ort28
    s_branch L_ook28
L_ort29:
    s_add_u32 s93, s31, 28672
    buffer_load_dwordx4 v[100:103], v2, s[12:15], s93 offen offset:1024 sc1
    buffer_load_dwordx4 v[104:107], v2, s[12:15], s93 offen offset:2048 sc1
    buffer_load_dwordx4 v[108:111], v2, s[12:15], s93 offen offset:3072 sc1
    s_addk_i32 s94, 1
    s_cmpk_lt_u32 s94, 0xffff
    s_waitcnt vmcnt(0)
    v_max3_u32 v14, v100, v101, v102
    v_max_u32 v14, v14, v103
    v_cmp_eq_u32 vcc, -1, v14
    s_cbranch_scc0 L_ook29
    s_cbranch_vccnz L_ort29
    s_branch L_ook29
L_ort30:
    s_add_u32 s93, s31, 28672
    buffer_load_dwordx4 v[104:107], v2, s[12:15], s93 offen offset:2048 sc1
    buffer_load_dwordx4 v[108:111], v2, s[12:15], s93 offen offset:3072 sc1
    s_addk_i32 s94, 1
    s_cmpk_lt_u32 s94, 0xffff
    s_waitcnt vmcnt(0)
    v_max3_u32 v14, v104, v105, v106
    v_max_u32 v14, v14, v107
    v_cmp_eq_u32 vcc, -1, v14
    s_cbranch_scc0 L_ook30
    s_cbranch_vccnz L_ort30
    s_branch L_ook30
L_ort31:
    s_add_u32 s93, s31, 28672
    buffer_load_dwordx4 v[108:111], v2, s[12:15], s93 offen offset:3072 sc1
    s_addk_i32 s94, 1
    s_cmpk_lt_u32 s94, 0xffff
    s_waitcnt vmcnt(0)
    v_max3_u32 v14, v108, v109, v110
    v_max_u32 v14, v14, v111
    v_cmp_eq_u32 vcc, -1, v14
    s_cbranch_scc0 L_ook31
    s_cbranch_vccnz L_ort31
    s_branch L_ook31
L_rt0:
    s_add_u32 s93, s76, 0
    buffer_load_dwordx4 v[104:107], v2, s[12:15], s93 offen offset:0 sc1
    buffer_load_dwordx4 v[108:111], v2, s[12:15], s93 offen offset:1024 sc1
    buffer_load_dwordx4 v[112:115], v2, s[12:15], s93 offen offset:2048 sc1
    buffer_load_dwordx4 v[116:119], v2, s[12:15], s93 offen offset:3072 sc1
    s_addk_i32 s94, 1
    s_cmpk_lt_u32 s94, 0xffff
    s_waitcnt vmcnt(0)
    v_max3_u32 v14, v104, v105, v106
    v_max_u32 v14, v14, v107
    v_cmp_eq_u32 vcc, -1, v14
    s_cbranch_scc0 L_ok0
    s_cbranch_vccnz L_rt0
    s_branch L_ok0
L_rt1:
    s_add_u32 s93, s76, 0
    buffer_load_dwordx4 v[108:111], v2, s[12:15], s93 offen offset:1024 sc1
    buffer_load_dwordx4 v[112:115], v2, s[12:15], s93 offen offset:2048 sc1
    buffer_load_dwordx4 v[116:119], v2, s[12:15], s93 offen offset:3072 sc1
    s_addk_i32 s94, 1
    s_cmpk_lt_u32 s94, 0xffff
    s_waitcnt vmcnt(0)
    v_max3_u32 v14, v108, v109, v110
    v_max_u32 v14, v14, v111
    v_cmp_eq_u32 vcc, -1, v14
    s_cbranch_scc0 L_ok1
    s_cbranch_vccnz L_rt1
    s_branch L_ok1
L_rt2:
    s_add_u32 s93, s76, 0
    buffer_load_dwordx4 v[112:115], v2, s[12:15], s93 offen offset:2048 sc1
    buffer_load_dwordx4 v[116:119], v2, s[12:15], s93 offen offset:3072 sc1
    s_addk_i32 s94, 1
    s_cmpk_lt_u32 s94, 0xffff
    s_waitcnt vmcnt(0)
    v_max3_u32 v14, v112, v113, v114
    v_max_u32 v14, v14, v115
    v_cmp_eq_u32 vcc, -1, v14
    s_cbranch_scc0 L_ok2
    s_cbranch_vccnz L_rt2
    s_branch L_ok2
L_rt3:
    s_add_u32 s93, s76, 0
    buffer_load_dwordx4 v[116:119], v2, s[12:15], s93 offen offset:3072 sc1
    s_addk_i32 s94, 1
    s_cmpk_lt_u32 s94, 0xffff
    s_waitcnt vmcnt(0)
    v_max3_u32 v14, v116, v117, v118
    v_max_u32 v14, v14, v119
    v_cmp_eq_u32 vcc, -1, v14
    s_cbranch_scc0 L_ok3
    s_cbranch_vccnz L_rt3
    s_branch L_ok3
L_rt4:
    s_add_u32 s93, s76, 16384
    buffer_load_dwordx4 v[120:123], v2, s[12:15], s93 offen offset:0 sc1
    buffer_load_dwordx4 v[124:127], v2, s[12:15], s93 offen offset:1024 sc1
    buffer_load_dwordx4 v[128:131], v2, s[12:15], s93 offen offset:2048 sc1
    buffer_load_dwordx4 v[132:135], v2, s[12:15], s93 offen offset:3072 sc1
    s_addk_i32 s94, 1
    s_cmpk_lt_u32 s94, 0xffff
    s_waitcnt vmcnt(0)
    v_max3_u32 v14, v120, v121, v122
    v_max_u32 v14, v14, v123
    v_cmp_eq_u32 vcc, -1, v14
    s_cbranch_scc0 L_ok4
    s_cbranch_vccnz L_rt4
    s_branch L_ok4
L_rt5:
    s_add_u32 s93, s76, 16384
    buffer_load_dwordx4 v[124:127], v2, s[12:15], s93 offen offset:1024 sc1
    buffer_load_dwordx4 v[128:131], v2, s[12:15], s93 offen offset:2048 sc1
    buffer_load_dwordx4 v[132:135], v2, s[12:15], s93 offen offset:3072 sc1
    s_addk_i32 s94, 1
    s_cmpk_lt_u32 s94, 0xffff
    s_waitcnt vmcnt(0)
    v_max3_u32 v14, v124, v125, v126
    v_max_u32 v14, v14, v127
    v_cmp_eq_u32 vcc, -1, v14
    s_cbranch_scc0 L_ok5
    s_cbranch_vccnz L_rt5
    s_branch L_ok5
L_rt6:
    s_add_u32 s93, s76, 16384
    buffer_load_dwordx4 v[128:131], v2, s[12:15], s93 offen offset:2048 sc1
    buffer_load_dwordx4 v[132:135], v2, s[12:15], s93 offen offset:3072 sc1
    s_addk_i32 s94, 1
    s_cmpk_lt_u32 s94, 0xffff
    s_waitcnt vmcnt(0)
    v_max3_u32 v14, v128, v129, v130
    v_max_u32 v14, v14, v131
    v_cmp_eq_u32 vcc, -1, v14
    s_cbranch_scc0 L_ok6
    s_cbranch_vccnz L_rt6
    s_branch L_ok6
L_rt7:
    s_add_u32 s93, s76, 16384
    buffer_load_dwordx4 v[132:135], v2, s[12:15], s93 offen offset:3072 sc1
    s_addk_i32 s94, 1
    s_cmpk_lt_u32 s94, 0xffff
    s_waitcnt vmcnt(0)
    v_max3_u32 v14, v132, v133, v134
    v_max_u32 v14, v14, v135
    v_cmp_eq_u32 vcc, -1, v14
    s_cbranch_scc0 L_ok7
    s_cbranch_vccnz L_rt7
    s_branch L_ok7
L_rt8:
    s_add_u32 s93, s76, 32768
    buffer_load_dwordx4 v[136:139], v2, s[12:15], s93 offen offset:0 sc1
    buffer_load_dwordx4 v[4:7], v2, s[12:15], s93 offen offset:1024 sc1
    buffer_load_dwordx4 v[104:107], v2, s[12:15], s93 offen offset:2048 sc1
    buffer_load_dwordx4 v[108:111], v2, s[12:15], s93 offen offset:3072 sc1
    s_addk_i32 s94, 1
    s_cmpk_lt_u32 s94, 0xffff
    s_waitcnt vmcnt(0)
    v_max3_u32 v14, v136, v137, v138
    v_max_u32 v14, v14, v139
    v_cmp_eq_u32 vcc, -1, v14
    s_cbranch_scc0 L_ok8
    s_cbranch_vccnz L_rt8
    s_branch L_ok8
L_rt9:
    s_add_u32 s93, s76, 32768
    buffer_load_dwordx4 v[4:7], v2, s[12:15], s93 offen offset:1024 sc1
    buffer_load_dwordx4 v[104:107], v2, s[12:15], s93 offen offset:2048 sc1
    buffer_load_dwordx4 v[108:111], v2, s[12:15], s93 offen offset:3072 sc1
    s_addk_i32 s94, 1
    s_cmpk_lt_u32 s94, 0xffff
    s_waitcnt vmcnt(0)
    v_max3_u32 v14, v4, v5, v6
    v_max_u32 v14, v14, v7
    v_cmp_eq_u32 vcc, -1, v14
    s_cbranch_scc0 L_ok9
    s_cbranch_vccnz L_rt9
    s_branch L_ok9
L_rt10:
    s_add_u32 s93, s76, 32768
    buffer_load_dwordx4 v[104:107], v2, s[12:15], s93 offen offset:2048 sc1
    buffer_load_dwordx4 v[108:111], v2, s[12:15], s93 offen offset:3072 sc1
    s_addk_i32 s94, 1
    s_cmpk_lt_u32 s94, 0xffff
    s_waitcnt vmcnt(0)
    v_max3_u32 v14, v104, v105, v106
    v_max_u32 v14, v14, v107
    v_cmp_eq_u32 vcc, -1, v14
    s_cbranch_scc0 L_ok10
    s_cbranch_vccnz L_rt10
    s_branch L_ok10
L_rt11:
    s_add_u32 s93, s76, 32768
    buffer_load_dwordx4 v[108:111], v2, s[12:15], s93 offen offset:3072 sc1
    s_addk_i32 s94, 1
    s_cmpk_lt_u32 s94, 0xffff
    s_waitcnt vmcnt(0)
    v_max3_u32 v14, v108, v109, v110
    v_max_u32 v14, v14, v111
    v_cmp_eq_u32 vcc, -1, v14
    s_cbranch_scc0 L_ok11
    s_cbranch_vccnz L_rt11
    s_branch L_ok11
L_rt12:
    s_add_u32 s93, s76, 49152
    buffer_load_dwordx4 v[112:115], v2, s[12:15], s93 offen offset:0 sc1
    buffer_load_dwordx4 v[116:119], v2, s[12:15], s93 offen offset:1024 sc1
    buffer_load_dwordx4 v[120:123], v2, s[12:15], s93 offen offset:2048 sc1
    buffer_load_dwordx4 v[124:127], v2, s[12:15], s93 offen offset:3072 sc1
    s_addk_i32 s94, 1
    s_cmpk_lt_u32 s94, 0xffff
    s_waitcnt vmcnt(0)
    v_max3_u32 v14, v112, v113, v114
    v_max_u32 v14, v14, v115
    v_cmp_eq_u32 vcc, -1, v14
    s_cbranch_scc0 L_ok12
    s_cbranch_vccnz L_rt12
    s_branch L_ok12
L_rt13:
    s_add_u32 s93, s76, 49152
    buffer_load_dwordx4 v[116:119], v2, s[12:15], s93 offen offset:1024 sc1
    buffer_load_dwordx4 v[120:123], v2, s[12:15], s93 offen offset:2048 sc1
    buffer_load_dwordx4 v[124:127], v2, s[12:15], s93 offen offset:3072 sc1
    s_addk_i32 s94, 1
    s_cmpk_lt_u32 s94, 0xffff
    s_waitcnt vmcnt(0)
    v_max3_u32 v14, v116, v117, v118
    v_max_u32 v14, v14, v119
    v_cmp_eq_u32 vcc, -1, v14
    s_cbranch_scc0 L_ok13
    s_cbranch_vccnz L_rt13
    s_branch L_ok13
L_rt14:
    s_add_u32 s93, s76, 49152
    buffer_load_dwordx4 v[120:123], v2, s[12:15], s93 offen offset:2048 sc1
    buffer_load_dwordx4 v[124:127], v2, s[12:15], s93 offen offset:3072 sc1
    s_addk_i32 s94, 1
    s_cmpk_lt_u32 s94, 0xffff
    s_waitcnt vmcnt(0)
    v_max3_u32 v14, v120, v121, v122
    v_max_u32 v14, v14, v123
    v_cmp_eq_u32 vcc, -1, v14
    s_cbranch_scc0 L_ok14
    s_cbranch_vccnz L_rt14
    s_branch L_ok14
L_rt15:
    s_add_u32 s93, s76, 49152
    buffer_load_dwordx4 v[124:127], v2, s[12:15], s93 offen offset:3072 sc1
    s_addk_i32 s94, 1
    s_cmpk_lt_u32 s94, 0xffff
    s_waitcnt vmcnt(0)
    v_max3_u32 v14, v124, v125, v126
    v_max_u32 v14, v14, v127
    v_cmp_eq_u32 vcc, -1, v14
    s_cbranch_scc0 L_ok15
    s_cbranch_vccnz L_rt15
    s_branch L_ok15
L_rt16:
    s_add_u32 s93, s76, 65536
    buffer_load_dwordx4 v[128:131], v2, s[12:15], s93 offen offset:0 sc1
    buffer_load_dwordx4 v[132:135], v2, s[12:15], s93 offen offset:1024 sc1
    buffer_load_dwordx4 v[136:139], v2, s[12:15], s93 offen offset:2048 sc1
    buffer_load_dwordx4 v[4:7], v2, s[12:15], s93 offen offset:3072 sc1
    s_addk_i32 s94, 1
    s_cmpk_lt_u32 s94, 0xffff
    s_waitcnt vmcnt(0)
    v_max3_u32 v14, v128, v129, v130
    v_max_u32 v14, v14, v131
    v_cmp_eq_u32 vcc, -1, v14
    s_cbranch_scc0 L_ok16
    s_cbranch_vccnz L_rt16
    s_branch L_ok16
L_rt17:
    s_add_u32 s93, s76, 65536
    buffer_load_dwordx4 v[132:135], v2, s[12:15], s93 offen offset:1024 sc1
    buffer_load_dwordx4 v[136:139], v2, s[12:15], s93 offen offset:2048 sc1
    buffer_load_dwordx4 v[4:7], v2, s[12:15], s93 offen offset:3072 sc1
    s_addk_i32 s94, 1
    s_cmpk_lt_u32 s94, 0xffff
    s_waitcnt vmcnt(0)
    v_max3_u32 v14, v132, v133, v134
    v_max_u32 v14, v14, v135
    v_cmp_eq_u32 vcc, -1, v14
    s_cbranch_scc0 L_ok17
    s_cbranch_vccnz L_rt17
    s_branch L_ok17
L_rt18:
    s_add_u32 s93, s76, 65536
    buffer_load_dwordx4 v[136:139], v2, s[12:15], s93 offen offset:2048 sc1
    buffer_load_dwordx4 v[4:7], v2, s[12:15], s93 offen offset:3072 sc1
    s_addk_i32 s94, 1
    s_cmpk_lt_u32 s94, 0xffff
    s_waitcnt vmcnt(0)
    v_max3_u32 v14, v136, v137, v138
    v_max_u32 v14, v14, v139
    v_cmp_eq_u32 vcc, -1, v14
    s_cbranch_scc0 L_ok18
    s_cbranch_vccnz L_rt18
    s_branch L_ok18
L_rt19:
    s_add_u32 s93, s76, 65536
    buffer_load_dwordx4 v[4:7], v2, s[12:15], s93 offen offset:3072 sc1
    s_addk_i32 s94, 1
    s_cmpk_lt_u32 s94, 0xffff
    s_waitcnt vmcnt(0)
    v_max3_u32 v14, v4, v5, v6
    v_max_u32 v14, v14, v7
    v_cmp_eq_u32 vcc, -1, v14
    s_cbranch_scc0 L_ok19
    s_cbranch_vccnz L_rt19
    s_branch L_ok19
L_rt20:
    s_add_u32 s93, s76, 81920
    buffer_load_dwordx4 v[104:107], v2, s[12:15], s93 offen offset:0 sc1
    buffer_load_dwordx4 v[108:111], v2, s[12:15], s93 offen offset:1024 sc1
    buffer_load_dwordx4 v[112:115], v2, s[12:15], s93 offen offset:2048 sc1
    buffer_load_dwordx4 v[116:119], v2, s[12:15], s93 offen offset:3072 sc1
    s_addk_i32 s94, 1
    s_cmpk_lt_u32 s94, 0xffff
    s_waitcnt vmcnt(0)
    v_max3_u32 v14, v104, v105, v106
    v_max_u32 v14, v14, v107
    v_cmp_eq_u32 vcc, -1, v14
    s_cbranch_scc0 L_ok20
    s_cbranch_vccnz L_rt20
    s_branch L_ok20
L_rt21:
    s_add_u32 s93, s76, 81920
    buffer_load_dwordx4 v[108:111], v2, s[12:15], s93 offen offset:1024 sc1
    buffer_load_dwordx4 v[112:115], v2, s[12:15], s93 offen offset:2048 sc1
    buffer_load_dwordx4 v[116:119], v2, s[12:15], s93 offen offset:3072 sc1
    s_addk_i32 s94, 1
    s_cmpk_lt_u32 s94, 0xffff
    s_waitcnt vmcnt(0)
    v_max3_u32 v14, v108, v109, v110
    v_max_u32 v14, v14, v111
    v_cmp_eq_u32 vcc, -1, v14
    s_cbranch_scc0 L_ok21
    s_cbranch_vccnz L_rt21
    s_branch L_ok21
L_rt22:
    s_add_u32 s93, s76, 81920
    buffer_load_dwordx4 v[112:115], v2, s[12:15], s93 offen offset:2048 sc1
    buffer_load_dwordx4 v[116:119], v2, s[12:15], s93 offen offset:3072 sc1
    s_addk_i32 s94, 1
    s_cmpk_lt_u32 s94, 0xffff
    s_waitcnt vmcnt(0)
    v_max3_u32 v14, v112, v113, v114
    v_max_u32 v14, v14, v115
    v_cmp_eq_u32 vcc, -1, v14
    s_cbranch_scc0 L_ok22
    s_cbranch_vccnz L_rt22
    s_branch L_ok22
L_rt23:
    s_add_u32 s93, s76, 81920
    buffer_load_dwordx4 v[116:119], v2, s[12:15], s93 offen offset:3072 sc1
    s_addk_i32 s94, 1
    s_cmpk_lt_u32 s94, 0xffff
    s_waitcnt vmcnt(0)
    v_max3_u32 v14, v116, v117, v118
    v_max_u32 v14, v14, v119
    v_cmp_eq_u32 vcc, -1, v14
    s_cbranch_scc0 L_ok23
    s_cbranch_vccnz L_rt23
    s_branch L_ok23
L_rt24:
    s_add_u32 s93, s76, 98304
    buffer_load_dwordx4 v[120:123], v2, s[12:15], s93 offen offset:0 sc1
    buffer_load_dwordx4 v[124:127], v2, s[12:15], s93 offen offset:1024 sc1
    buffer_load_dwordx4 v[128:131], v2, s[12:15], s93 offen offset:2048 sc1
    buffer_load_dwordx4 v[132:135], v2, s[12:15], s93 offen offset:3072 sc1
    s_addk_i32 s94, 1
    s_cmpk_lt_u32 s94, 0xffff
    s_waitcnt vmcnt(0)
    v_max3_u32 v14, v120, v121, v122
    v_max_u32 v14, v14, v123
    v_cmp_eq_u32 vcc, -1, v14
    s_cbranch_scc0 L_ok24
    s_cbranch_vccnz L_rt24
    s_branch L_ok24
L_rt25:
    s_add_u32 s93, s76, 98304
    buffer_load_dwordx4 v[124:127], v2, s[12:15], s93 offen offset:1024 sc1
    buffer_load_dwordx4 v[128:131], v2, s[12:15], s93 offen offset:2048 sc1
    buffer_load_dwordx4 v[132:135], v2, s[12:15], s93 offen offset:3072 sc1
    s_addk_i32 s94, 1
    s_cmpk_lt_u32 s94, 0xffff
    s_waitcnt vmcnt(0)
    v_max3_u32 v14, v124, v125, v126
    v_max_u32 v14, v14, v127
    v_cmp_eq_u32 vcc, -1, v14
    s_cbranch_scc0 L_ok25
    s_cbranch_vccnz L_rt25
    s_branch L_ok25
L_rt26:
    s_add_u32 s93, s76, 98304
    buffer_load_dwordx4 v[128:131], v2, s[12:15], s93 offen offset:2048 sc1
    buffer_load_dwordx4 v[132:135], v2, s[12:15], s93 offen offset:3072 sc1
    s_addk_i32 s94, 1
    s_cmpk_lt_u32 s94, 0xffff
    s_waitcnt vmcnt(0)
    v_max3_u32 v14, v128, v129, v130
    v_max_u32 v14, v14, v131
    v_cmp_eq_u32 vcc, -1, v14
    s_cbranch_scc0 L_ok26
    s_cbranch_vccnz L_rt26
    s_branch L_ok26
L_rt27:
    s_add_u32 s93, s76, 98304
    buffer_load_dwordx4 v[132:135], v2, s[12:15], s93 offen offset:3072 sc1
    s_addk_i32 s94, 1
    s_cmpk_lt_u32 s94, 0xffff
    s_waitcnt vmcnt(0)
    v_max3_u32 v14, v132, v133, v134
    v_max_u32 v14, v14, v135
    v_cmp_eq_u32 vcc, -1, v14
    s_cbranch_scc0 L_ok27
    s_cbranch_vccnz L_rt27
    s_branch L_ok27
L_rt28:
    s_add_u32 s93, s76, 114688
    buffer_load_dwordx4 v[136:139], v2, s[12:15], s93 offen offset:0 sc1
    buffer_load_dwordx4 v[4:7], v2, s[12:15], s93 offen offset:1024 sc1
    buffer_load_dwordx4 v[104:107], v2, s[12:15], s93 offen offset:2048 sc1
    buffer_load_dwordx4 v[108:111], v2, s[12:15], s93 offen offset:3072 sc1
    s_addk_i32 s94, 1
    s_cmpk_lt_u32 s94, 0xffff
    s_waitcnt vmcnt(0)
    v_max3_u32 v14, v136, v137, v138
    v_max_u32 v14, v14, v139
    v_cmp_eq_u32 vcc, -1, v14
    s_cbranch_scc0 L_ok28
    s_cbranch_vccnz L_rt28
    s_branch L_ok28
L_rt29:
    s_add_u32 s93, s76, 114688
    buffer_load_dwordx4 v[4:7], v2, s[12:15], s93 offen offset:1024 sc1
    buffer_load_dwordx4 v[104:107], v2, s[12:15], s93 offen offset:2048 sc1
    buffer_load_dwordx4 v[108:111], v2, s[12:15], s93 offen offset:3072 sc1
    s_addk_i32 s94, 1
    s_cmpk_lt_u32 s94, 0xffff
    s_waitcnt vmcnt(0)
    v_max3_u32 v14, v4, v5, v6
    v_max_u32 v14, v14, v7
    v_cmp_eq_u32 vcc, -1, v14
    s_cbranch_scc0 L_ok29
    s_cbranch_vccnz L_rt29
    s_branch L_ok29
L_rt30:
    s_add_u32 s93, s76, 114688
    buffer_load_dwordx4 v[104:107], v2, s[12:15], s93 offen offset:2048 sc1
    buffer_load_dwordx4 v[108:111], v2, s[12:15], s93 offen offset:3072 sc1
    s_addk_i32 s94, 1
    s_cmpk_lt_u32 s94, 0xffff
    s_waitcnt vmcnt(0)
    v_max3_u32 v14, v104, v105, v106
    v_max_u32 v14, v14, v107
    v_cmp_eq_u32 vcc, -1, v14
    s_cbranch_scc0 L_ok30
    s_cbranch_vccnz L_rt30
    s_branch L_ok30
L_rt31:
    s_add_u32 s93, s76, 114688
    buffer_load_dwordx4 v[108:111], v2, s[12:15], s93 offen offset:3072 sc1
    s_addk_i32 s94, 1
    s_cmpk_lt_u32 s94, 0xffff
    s_waitcnt vmcnt(0)
    v_max3_u32 v14, v108, v109, v110
    v_max_u32 v14, v14, v111
    v_cmp_eq_u32 vcc, -1, v14
    s_cbranch_scc0 L_ok31
    s_cbranch_vccnz L_rt31
    s_branch L_ok31
L_rt32:
    s_add_u32 s93, s76, 131072
    buffer_load_dwordx4 v[112:115], v2, s[12:15], s93 offen offset:0 sc1
    buffer_load_dwordx4 v[116:119], v2, s[12:15], s93 offen offset:1024 sc1
    buffer_load_dwordx4 v[120:123], v2, s[12:15], s93 offen offset:2048 sc1
    buffer_load_dwordx4 v[124:127], v2, s[12:15], s93 offen offset:3072 sc1
    s_addk_i32 s94, 1
    s_cmpk_lt_u32 s94, 0xffff
    s_waitcnt vmcnt(0)
    v_max3_u32 v14, v112, v113, v114
    v_max_u32 v14, v14, v115
    v_cmp_eq_u32 vcc, -1, v14
    s_cbranch_scc0 L_ok32
    s_cbranch_vccnz L_rt32
    s_branch L_ok32
L_rt33:
    s_add_u32 s93, s76, 131072
    buffer_load_dwordx4 v[116:119], v2, s[12:15], s93 offen offset:1024 sc1
    buffer_load_dwordx4 v[120:123], v2, s[12:15], s93 offen offset:2048 sc1
    buffer_load_dwordx4 v[124:127], v2, s[12:15], s93 offen offset:3072 sc1
    s_addk_i32 s94, 1
    s_cmpk_lt_u32 s94, 0xffff
    s_waitcnt vmcnt(0)
    v_max3_u32 v14, v116, v117, v118
    v_max_u32 v14, v14, v119
    v_cmp_eq_u32 vcc, -1, v14
    s_cbranch_scc0 L_ok33
    s_cbranch_vccnz L_rt33
    s_branch L_ok33
L_rt34:
    s_add_u32 s93, s76, 131072
    buffer_load_dwordx4 v[120:123], v2, s[12:15], s93 offen offset:2048 sc1
    buffer_load_dwordx4 v[124:127], v2, s[12:15], s93 offen offset:3072 sc1
    s_addk_i32 s94, 1
    s_cmpk_lt_u32 s94, 0xffff
    s_waitcnt vmcnt(0)
    v_max3_u32 v14, v120, v121, v122
    v_max_u32 v14, v14, v123
    v_cmp_eq_u32 vcc, -1, v14
    s_cbranch_scc0 L_ok34
    s_cbranch_vccnz L_rt34
    s_branch L_ok34
L_rt35:
    s_add_u32 s93, s76, 131072
    buffer_load_dwordx4 v[124:127], v2, s[12:15], s93 offen offset:3072 sc1
    s_addk_i32 s94, 1
    s_cmpk_lt_u32 s94, 0xffff
    s_waitcnt vmcnt(0)
    v_max3_u32 v14, v124, v125, v126
    v_max_u32 v14, v14, v127
    v_cmp_eq_u32 vcc, -1, v14
    s_cbranch_scc0 L_ok35
    s_cbranch_vccnz L_rt35
    s_branch L_ok35
L_rt36:
    s_add_u32 s93, s76, 147456
    buffer_load_dwordx4 v[128:131], v2, s[12:15], s93 offen offset:0 sc1
    buffer_load_dwordx4 v[132:135], v2, s[12:15], s93 offen offset:1024 sc1
    buffer_load_dwordx4 v[136:139], v2, s[12:15], s93 offen offset:2048 sc1
    buffer_load_dwordx4 v[4:7], v2, s[12:15], s93 offen offset:3072 sc1
    s_addk_i32 s94, 1
    s_cmpk_lt_u32 s94, 0xffff
    s_waitcnt vmcnt(0)
    v_max3_u32 v14, v128, v129, v130
    v_max_u32 v14, v14, v131
    v_cmp_eq_u32 vcc, -1, v14
    s_cbranch_scc0 L_ok36
    s_cbranch_vccnz L_rt36
    s_branch L_ok36
L_rt37:
    s_add_u32 s93, s76, 147456
    buffer_load_dwordx4 v[132:135], v2, s[12:15], s93 offen offset:1024 sc1
    buffer_load_dwordx4 v[136:139], v2, s[12:15], s93 offen offset:2048 sc1
    buffer_load_dwordx4 v[4:7], v2, s[12:15], s93 offen offset:3072 sc1
    s_addk_i32 s94, 1
    s_cmpk_lt_u32 s94, 0xffff
    s_waitcnt vmcnt(0)
    v_max3_u32 v14, v132, v133, v134
    v_max_u32 v14, v14, v135
    v_cmp_eq_u32 vcc, -1, v14
    s_cbranch_scc0 L_ok37
    s_cbranch_vccnz L_rt37
    s_branch L_ok37
L_rt38:
    s_add_u32 s93, s76, 147456
    buffer_load_dwordx4 v[136:139], v2, s[12:15], s93 offen offset:2048 sc1
    buffer_load_dwordx4 v[4:7], v2, s[12:15], s93 offen offset:3072 sc1
    s_addk_i32 s94, 1
    s_cmpk_lt_u32 s94, 0xffff
    s_waitcnt vmcnt(0)
    v_max3_u32 v14, v136, v137, v138
    v_max_u32 v14, v14, v139
    v_cmp_eq_u32 vcc, -1, v14
    s_cbranch_scc0 L_ok38
    s_cbranch_vccnz L_rt38
    s_branch L_ok38
L_rt39:
    s_add_u32 s93, s76, 147456
    buffer_load_dwordx4 v[4:7], v2, s[12:15], s93 offen offset:3072 sc1
    s_addk_i32 s94, 1
    s_cmpk_lt_u32 s94, 0xffff
    s_waitcnt vmcnt(0)
    v_max3_u32 v14, v4, v5, v6
    v_max_u32 v14, v14, v7
    v_cmp_eq_u32 vcc, -1, v14
    s_cbranch_scc0 L_ok39
    s_cbranch_vccnz L_rt39
    s_branch L_ok39
L_rt40:
    s_add_u32 s93, s76, 163840
    buffer_load_dwordx4 v[104:107], v2, s[12:15], s93 offen offset:0 sc1
    buffer_load_dwordx4 v[108:111], v2, s[12:15], s93 offen offset:1024 sc1
    buffer_load_dwordx4 v[112:115], v2, s[12:15], s93 offen offset:2048 sc1
    buffer_load_dwordx4 v[116:119], v2, s[12:15], s93 offen offset:3072 sc1
    s_addk_i32 s94, 1
    s_cmpk_lt_u32 s94, 0xffff
    s_waitcnt vmcnt(0)
    v_max3_u32 v14, v104, v105, v106
    v_max_u32 v14, v14, v107
    v_cmp_eq_u32 vcc, -1, v14
    s_cbranch_scc0 L_ok40
    s_cbranch_vccnz L_rt40
    s_branch L_ok40
L_rt41:
    s_add_u32 s93, s76, 163840
    buffer_load_dwordx4 v[108:111], v2, s[12:15], s93 offen offset:1024 sc1
    buffer_load_dwordx4 v[112:115], v2, s[12:15], s93 offen offset:2048 sc1
    buffer_load_dwordx4 v[116:119], v2, s[12:15], s93 offen offset:3072 sc1
    s_addk_i32 s94, 1
    s_cmpk_lt_u32 s94, 0xffff
    s_waitcnt vmcnt(0)
    v_max3_u32 v14, v108, v109, v110
    v_max_u32 v14, v14, v111
    v_cmp_eq_u32 vcc, -1, v14
    s_cbranch_scc0 L_ok41
    s_cbranch_vccnz L_rt41
    s_branch L_ok41
L_rt42:
    s_add_u32 s93, s76, 163840
    buffer_load_dwordx4 v[112:115], v2, s[12:15], s93 offen offset:2048 sc1
    buffer_load_dwordx4 v[116:119], v2, s[12:15], s93 offen offset:3072 sc1
    s_addk_i32 s94, 1
    s_cmpk_lt_u32 s94, 0xffff
    s_waitcnt vmcnt(0)
    v_max3_u32 v14, v112, v113, v114
    v_max_u32 v14, v14, v115
    v_cmp_eq_u32 vcc, -1, v14
    s_cbranch_scc0 L_ok42
    s_cbranch_vccnz L_rt42
    s_branch L_ok42
L_rt43:
    s_add_u32 s93, s76, 163840
    buffer_load_dwordx4 v[116:119], v2, s[12:15], s93 offen offset:3072 sc1
    s_addk_i32 s94, 1
    s_cmpk_lt_u32 s94, 0xffff
    s_waitcnt vmcnt(0)
    v_max3_u32 v14, v116, v117, v118
    v_max_u32 v14, v14, v119
    v_cmp_eq_u32 vcc, -1, v14
    s_cbranch_scc0 L_ok43
    s_cbranch_vccnz L_rt43
    s_branch L_ok43
L_rt44:
    s_add_u32 s93, s76, 180224
    buffer_load_dwordx4 v[120:123], v2, s[12:15], s93 offen offset:0 sc1
    buffer_load_dwordx4 v[124:127], v2, s[12:15], s93 offen offset:1024 sc1
    buffer_load_dwordx4 v[128:131], v2, s[12:15], s93 offen offset:2048 sc1
    buffer_load_dwordx4 v[132:135], v2, s[12:15], s93 offen offset:3072 sc1
    s_addk_i32 s94, 1
    s_cmpk_lt_u32 s94, 0xffff
    s_waitcnt vmcnt(0)
    v_max3_u32 v14, v120, v121, v122
    v_max_u32 v14, v14, v123
    v_cmp_eq_u32 vcc, -1, v14
    s_cbranch_scc0 L_ok44
    s_cbranch_vccnz L_rt44
    s_branch L_ok44
L_rt45:
    s_add_u32 s93, s76, 180224
    buffer_load_dwordx4 v[124:127], v2, s[12:15], s93 offen offset:1024 sc1
    buffer_load_dwordx4 v[128:131], v2, s[12:15], s93 offen offset:2048 sc1
    buffer_load_dwordx4 v[132:135], v2, s[12:15], s93 offen offset:3072 sc1
    s_addk_i32 s94, 1
    s_cmpk_lt_u32 s94, 0xffff
    s_waitcnt vmcnt(0)
    v_max3_u32 v14, v124, v125, v126
    v_max_u32 v14, v14, v127
    v_cmp_eq_u32 vcc, -1, v14
    s_cbranch_scc0 L_ok45
    s_cbranch_vccnz L_rt45
    s_branch L_ok45
L_rt46:
    s_add_u32 s93, s76, 180224
    buffer_load_dwordx4 v[128:131], v2, s[12:15], s93 offen offset:2048 sc1
    buffer_load_dwordx4 v[132:135], v2, s[12:15], s93 offen offset:3072 sc1
    s_addk_i32 s94, 1
    s_cmpk_lt_u32 s94, 0xffff
    s_waitcnt vmcnt(0)
    v_max3_u32 v14, v128, v129, v130
    v_max_u32 v14, v14, v131
    v_cmp_eq_u32 vcc, -1, v14
    s_cbranch_scc0 L_ok46
    s_cbranch_vccnz L_rt46
    s_branch L_ok46
L_rt47:
    s_add_u32 s93, s76, 180224
    buffer_load_dwordx4 v[132:135], v2, s[12:15], s93 offen offset:3072 sc1
    s_addk_i32 s94, 1
    s_cmpk_lt_u32 s94, 0xffff
    s_waitcnt vmcnt(0)
    v_max3_u32 v14, v132, v133, v134
    v_max_u32 v14, v14, v135
    v_cmp_eq_u32 vcc, -1, v14
    s_cbranch_scc0 L_ok47
    s_cbranch_vccnz L_rt47
    s_branch L_ok47
L_rt48:
    s_add_u32 s93, s76, 196608
    buffer_load_dwordx4 v[136:139], v2, s[12:15], s93 offen offset:0 sc1
    buffer_load_dwordx4 v[4:7], v2, s[12:15], s93 offen offset:1024 sc1
    buffer_load_dwordx4 v[104:107], v2, s[12:15], s93 offen offset:2048 sc1
    buffer_load_dwordx4 v[108:111], v2, s[12:15], s93 offen offset:3072 sc1
    s_addk_i32 s94, 1
    s_cmpk_lt_u32 s94, 0xffff
    s_waitcnt vmcnt(0)
    v_max3_u32 v14, v136, v137, v138
    v_max_u32 v14, v14, v139
    v_cmp_eq_u32 vcc, -1, v14
    s_cbranch_scc0 L_ok48
    s_cbranch_vccnz L_rt48
    s_branch L_ok48
L_rt49:
    s_add_u32 s93, s76, 196608
    buffer_load_dwordx4 v[4:7], v2, s[12:15], s93 offen offset:1024 sc1
    buffer_load_dwordx4 v[104:107], v2, s[12:15], s93 offen offset:2048 sc1
    buffer_load_dwordx4 v[108:111], v2, s[12:15], s93 offen offset:3072 sc1
    s_addk_i32 s94, 1
    s_cmpk_lt_u32 s94, 0xffff
    s_waitcnt vmcnt(0)
    v_max3_u32 v14, v4, v5, v6
    v_max_u32 v14, v14, v7
    v_cmp_eq_u32 vcc, -1, v14
    s_cbranch_scc0 L_ok49
    s_cbranch_vccnz L_rt49
    s_branch L_ok49
L_rt50:
    s_add_u32 s93, s76, 196608
    buffer_load_dwordx4 v[104:107], v2, s[12:15], s93 offen offset:2048 sc1
    buffer_load_dwordx4 v[108:111], v2, s[12:15], s93 offen offset:3072 sc1
    s_addk_i32 s94, 1
    s_cmpk_lt_u32 s94, 0xffff
    s_waitcnt vmcnt(0)
    v_max3_u32 v14, v104, v105, v106
    v_max_u32 v14, v14, v107
    v_cmp_eq_u32 vcc, -1, v14
    s_cbranch_scc0 L_ok50
    s_cbranch_vccnz L_rt50
    s_branch L_ok50
L_rt51:
    s_add_u32 s93, s76, 196608
    buffer_load_dwordx4 v[108:111], v2, s[12:15], s93 offen offset:3072 sc1
    s_addk_i32 s94, 1
    s_cmpk_lt_u32 s94, 0xffff
    s_waitcnt vmcnt(0)
    v_max3_u32 v14, v108, v109, v110
    v_max_u32 v14, v14, v111
    v_cmp_eq_u32 vcc, -1, v14
    s_cbranch_scc0 L_ok51
    s_cbranch_vccnz L_rt51
    s_branch L_ok51
L_rt52:
    s_add_u32 s93, s76, 212992
    buffer_load_dwordx4 v[112:115], v2, s[12:15], s93 offen offset:0 sc1
    buffer_load_dwordx4 v[116:119], v2, s[12:15], s93 offen offset:1024 sc1
    buffer_load_dwordx4 v[120:123], v2, s[12:15], s93 offen offset:2048 sc1
    buffer_load_dwordx4 v[124:127], v2, s[12:15], s93 offen offset:3072 sc1
    s_addk_i32 s94, 1
    s_cmpk_lt_u32 s94, 0xffff
    s_waitcnt vmcnt(0)
    v_max3_u32 v14, v112, v113, v114
    v_max_u32 v14, v14, v115
    v_cmp_eq_u32 vcc, -1, v14
    s_cbranch_scc0 L_ok52
    s_cbranch_vccnz L_rt52
    s_branch L_ok52
L_rt53:
    s_add_u32 s93, s76, 212992
    buffer_load_dwordx4 v[116:119], v2, s[12:15], s93 offen offset:1024 sc1
    buffer_load_dwordx4 v[120:123], v2, s[12:15], s93 offen offset:2048 sc1
    buffer_load_dwordx4 v[124:127], v2, s[12:15], s93 offen offset:3072 sc1
    s_addk_i32 s94, 1
    s_cmpk_lt_u32 s94, 0xffff
    s_waitcnt vmcnt(0)
    v_max3_u32 v14, v116, v117, v118
    v_max_u32 v14, v14, v119
    v_cmp_eq_u32 vcc, -1, v14
    s_cbranch_scc0 L_ok53
    s_cbranch_vccnz L_rt53
    s_branch L_ok53
L_rt54:
    s_add_u32 s93, s76, 212992
    buffer_load_dwordx4 v[120:123], v2, s[12:15], s93 offen offset:2048 sc1
    buffer_load_dwordx4 v[124:127], v2, s[12:15], s93 offen offset:3072 sc1
    s_addk_i32 s94, 1
    s_cmpk_lt_u32 s94, 0xffff
    s_waitcnt vmcnt(0)
    v_max3_u32 v14, v120, v121, v122
    v_max_u32 v14, v14, v123
    v_cmp_eq_u32 vcc, -1, v14
    s_cbranch_scc0 L_ok54
    s_cbranch_vccnz L_rt54
    s_branch L_ok54
L_rt55:
    s_add_u32 s93, s76, 212992
    buffer_load_dwordx4 v[124:127], v2, s[12:15], s93 offen offset:3072 sc1
    s_addk_i32 s94, 1
    s_cmpk_lt_u32 s94, 0xffff
    s_waitcnt vmcnt(0)
    v_max3_u32 v14, v124, v125, v126
    v_max_u32 v14, v14, v127
    v_cmp_eq_u32 vcc, -1, v14
    s_cbranch_scc0 L_ok55
    s_cbranch_vccnz L_rt55
    s_branch L_ok55
L_rt56:
    s_add_u32 s93, s76, 229376
    buffer_load_dwordx4 v[128:131], v2, s[12:15], s93 offen offset:0 sc1
    buffer_load_dwordx4 v[132:135], v2, s[12:15], s93 offen offset:1024 sc1
    buffer_load_dwordx4 v[136:139], v2, s[12:15], s93 offen offset:2048 sc1
    buffer_load_dwordx4 v[4:7], v2, s[12:15], s93 offen offset:3072 sc1
    s_addk_i32 s94, 1
    s_cmpk_lt_u32 s94, 0xffff
    s_waitcnt vmcnt(0)
    v_max3_u32 v14, v128, v129, v130
    v_max_u32 v14, v14, v131
    v_cmp_eq_u32 vcc, -1, v14
    s_cbranch_scc0 L_ok56
    s_cbranch_vccnz L_rt56
    s_branch L_ok56
L_rt57:
    s_add_u32 s93, s76, 229376
    buffer_load_dwordx4 v[132:135], v2, s[12:15], s93 offen offset:1024 sc1
    buffer_load_dwordx4 v[136:139], v2, s[12:15], s93 offen offset:2048 sc1
    buffer_load_dwordx4 v[4:7], v2, s[12:15], s93 offen offset:3072 sc1
    s_addk_i32 s94, 1
    s_cmpk_lt_u32 s94, 0xffff
    s_waitcnt vmcnt(0)
    v_max3_u32 v14, v132, v133, v134
    v_max_u32 v14, v14, v135
    v_cmp_eq_u32 vcc, -1, v14
    s_cbranch_scc0 L_ok57
    s_cbranch_vccnz L_rt57
    s_branch L_ok57
L_rt58:
    s_add_u32 s93, s76, 229376
    buffer_load_dwordx4 v[136:139], v2, s[12:15], s93 offen offset:2048 sc1
    buffer_load_dwordx4 v[4:7], v2, s[12:15], s93 offen offset:3072 sc1
    s_addk_i32 s94, 1
    s_cmpk_lt_u32 s94, 0xffff
    s_waitcnt vmcnt(0)
    v_max3_u32 v14, v136, v137, v138
    v_max_u32 v14, v14, v139
    v_cmp_eq_u32 vcc, -1, v14
    s_cbranch_scc0 L_ok58
    s_cbranch_vccnz L_rt58
    s_branch L_ok58
L_rt59:
    s_add_u32 s93, s76, 229376
    buffer_load_dwordx4 v[4:7], v2, s[12:15], s93 offen offset:3072 sc1
    s_addk_i32 s94, 1
    s_cmpk_lt_u32 s94, 0xffff
    s_waitcnt vmcnt(0)
    v_max3_u32 v14, v4, v5, v6
    v_max_u32 v14, v14, v7
    v_cmp_eq_u32 vcc, -1, v14
    s_cbranch_scc0 L_ok59
    s_cbranch_vccnz L_rt59
    s_branch L_ok59
L_rt60:
    s_add_u32 s93, s76, 245760
    buffer_load_dwordx4 v[104:107], v2, s[12:15], s93 offen offset:0 sc1
    buffer_load_dwordx4 v[108:111], v2, s[12:15], s93 offen offset:1024 sc1
    buffer_load_dwordx4 v[112:115], v2, s[12:15], s93 offen offset:2048 sc1
    buffer_load_dwordx4 v[116:119], v2, s[12:15], s93 offen offset:3072 sc1
    s_addk_i32 s94, 1
    s_cmpk_lt_u32 s94, 0xffff
    s_waitcnt vmcnt(0)
    v_max3_u32 v14, v104, v105, v106
    v_max_u32 v14, v14, v107
    v_cmp_eq_u32 vcc, -1, v14
    s_cbranch_scc0 L_ok60
    s_cbranch_vccnz L_rt60
    s_branch L_ok60
L_rt61:
    s_add_u32 s93, s76, 245760
    buffer_load_dwordx4 v[108:111], v2, s[12:15], s93 offen offset:1024 sc1
    buffer_load_dwordx4 v[112:115], v2, s[12:15], s93 offen offset:2048 sc1
    buffer_load_dwordx4 v[116:119], v2, s[12:15], s93 offen offset:3072 sc1
    s_addk_i32 s94, 1
    s_cmpk_lt_u32 s94, 0xffff
    s_waitcnt vmcnt(0)
    v_max3_u32 v14, v108, v109, v110
    v_max_u32 v14, v14, v111
    v_cmp_eq_u32 vcc, -1, v14
    s_cbranch_scc0 L_ok61
    s_cbranch_vccnz L_rt61
    s_branch L_ok61
L_rt62:
    s_add_u32 s93, s76, 245760
    buffer_load_dwordx4 v[112:115], v2, s[12:15], s93 offen offset:2048 sc1
    buffer_load_dwordx4 v[116:119], v2, s[12:15], s93 offen offset:3072 sc1
    s_addk_i32 s94, 1
    s_cmpk_lt_u32 s94, 0xffff
    s_waitcnt vmcnt(0)
    v_max3_u32 v14, v112, v113, v114
    v_max_u32 v14, v14, v115
    v_cmp_eq_u32 vcc, -1, v14
    s_cbranch_scc0 L_ok62
    s_cbranch_vccnz L_rt62
    s_branch L_ok62
L_rt63:
    s_add_u32 s93, s76, 245760
    buffer_load_dwordx4 v[116:119], v2, s[12:15], s93 offen offset:3072 sc1
    s_addk_i32 s94, 1
    s_cmpk_lt_u32 s94, 0xffff
    s_waitcnt vmcnt(0)
    v_max3_u32 v14, v116, v117, v118
    v_max_u32 v14, v14, v119
    v_cmp_eq_u32 vcc, -1, v14
    s_cbranch_scc0 L_ok63
    s_cbranch_vccnz L_rt63
    s_branch L_ok63
L_rt64:
    s_add_u32 s93, s77, 0
    buffer_load_dwordx4 v[120:123], v19, s[12:15], s93 offen offset:0 sc1
    buffer_load_dwordx4 v[124:127], v19, s[12:15], s93 offen offset:1024 sc1
    buffer_load_dwordx4 v[128:131], v19, s[12:15], s93 offen offset:2048 sc1
    buffer_load_dwordx4 v[132:135], v19, s[12:15], s93 offen offset:3072 sc1
    s_addk_i32 s94, 1
    s_cmpk_lt_u32 s94, 0xffff
    s_waitcnt vmcnt(0)
    v_max3_u32 v14, v120, v121, v122
    v_max_u32 v14, v14, v123
    v_cmp_eq_u32 vcc, -1, v14
    s_cbranch_scc0 L_ok64
    s_cbranch_vccnz L_rt64
    s_branch L_ok64
L_rt65:
    s_add_u32 s93, s77, 0
    buffer_load_dwordx4 v[124:127], v19, s[12:15], s93 offen offset:1024 sc1
    buffer_load_dwordx4 v[128:131], v19, s[12:15], s93 offen offset:2048 sc1
    buffer_load_dwordx4 v[132:135], v19, s[12:15], s93 offen offset:3072 sc1
    s_addk_i32 s94, 1
    s_cmpk_lt_u32 s94, 0xffff
    s_waitcnt vmcnt(0)
    v_max3_u32 v14, v124, v125, v126
    v_max_u32 v14, v14, v127
    v_cmp_eq_u32 vcc, -1, v14
    s_cbranch_scc0 L_ok65
    s_cbranch_vccnz L_rt65
    s_branch L_ok65
L_rt66:
    s_add_u32 s93, s77, 0
    buffer_load_dwordx4 v[128:131], v19, s[12:15], s93 offen offset:2048 sc1
    buffer_load_dwordx4 v[132:135], v19, s[12:15], s93 offen offset:3072 sc1
    s_addk_i32 s94, 1
    s_cmpk_lt_u32 s94, 0xffff
    s_waitcnt vmcnt(0)
    v_max3_u32 v14, v128, v129, v130
    v_max_u32 v14, v14, v131
    v_cmp_eq_u32 vcc, -1, v14
    s_cbranch_scc0 L_ok66
    s_cbranch_vccnz L_rt66
    s_branch L_ok66
L_rt67:
    s_add_u32 s93, s77, 0
    buffer_load_dwordx4 v[132:135], v19, s[12:15], s93 offen offset:3072 sc1
    s_addk_i32 s94, 1
    s_cmpk_lt_u32 s94, 0xffff
    s_waitcnt vmcnt(0)
    v_max3_u32 v14, v132, v133, v134
    v_max_u32 v14, v14, v135
    v_cmp_eq_u32 vcc, -1, v14
    s_cbranch_scc0 L_ok67
    s_cbranch_vccnz L_rt67
    s_branch L_ok67
L_rt68:
    s_add_u32 s93, s77, 16384
    buffer_load_dwordx4 v[136:139], v19, s[12:15], s93 offen offset:0 sc1
    buffer_load_dwordx4 v[4:7], v19, s[12:15], s93 offen offset:1024 sc1
    buffer_load_dwordx4 v[104:107], v19, s[12:15], s93 offen offset:2048 sc1
    buffer_load_dwordx4 v[108:111], v19, s[12:15], s93 offen offset:3072 sc1
    s_addk_i32 s94, 1
    s_cmpk_lt_u32 s94, 0xffff
    s_waitcnt vmcnt(0)
    v_max3_u32 v14, v136, v137, v138
    v_max_u32 v14, v14, v139
    v_cmp_eq_u32 vcc, -1, v14
    s_cbranch_scc0 L_ok68
    s_cbranch_vccnz L_rt68
    s_branch L_ok68
L_rt69:
    s_add_u32 s93, s77, 16384
    buffer_load_dwordx4 v[4:7], v19, s[12:15], s93 offen offset:1024 sc1
    buffer_load_dwordx4 v[104:107], v19, s[12:15], s93 offen offset:2048 sc1
    buffer_load_dwordx4 v[108:111], v19, s[12:15], s93 offen offset:3072 sc1
    s_addk_i32 s94, 1
    s_cmpk_lt_u32 s94, 0xffff
    s_waitcnt vmcnt(0)
    v_max3_u32 v14, v4, v5, v6
    v_max_u32 v14, v14, v7
    v_cmp_eq_u32 vcc, -1, v14
    s_cbranch_scc0 L_ok69
    s_cbranch_vccnz L_rt69
    s_branch L_ok69
L_rt70:
    s_add_u32 s93, s77, 16384
    buffer_load_dwordx4 v[104:107], v19, s[12:15], s93 offen offset:2048 sc1
    buffer_load_dwordx4 v[108:111], v19, s[12:15], s93 offen offset:3072 sc1
    s_addk_i32 s94, 1
    s_cmpk_lt_u32 s94, 0xffff
    s_waitcnt vmcnt(0)
    v_max3_u32 v14, v104, v105, v106
    v_max_u32 v14, v14, v107
    v_cmp_eq_u32 vcc, -1, v14
    s_cbranch_scc0 L_ok70
    s_cbranch_vccnz L_rt70
    s_branch L_ok70
L_rt71:
    s_add_u32 s93, s77, 16384
    buffer_load_dwordx4 v[108:111], v19, s[12:15], s93 offen offset:3072 sc1
    s_addk_i32 s94, 1
    s_cmpk_lt_u32 s94, 0xffff
    s_waitcnt vmcnt(0)
    v_max3_u32 v14, v108, v109, v110
    v_max_u32 v14, v14, v111
    v_cmp_eq_u32 vcc, -1, v14
    s_cbranch_scc0 L_ok71
    s_cbranch_vccnz L_rt71
    s_branch L_ok71
L_rt72:
    s_add_u32 s93, s77, 32768
    buffer_load_dwordx4 v[112:115], v19, s[12:15], s93 offen offset:0 sc1
    buffer_load_dwordx4 v[116:119], v19, s[12:15], s93 offen offset:1024 sc1
    buffer_load_dwordx4 v[120:123], v19, s[12:15], s93 offen offset:2048 sc1
    buffer_load_dwordx4 v[124:127], v19, s[12:15], s93 offen offset:3072 sc1
    s_addk_i32 s94, 1
    s_cmpk_lt_u32 s94, 0xffff
    s_waitcnt vmcnt(0)
    v_max3_u32 v14, v112, v113, v114
    v_max_u32 v14, v14, v115
    v_cmp_eq_u32 vcc, -1, v14
    s_cbranch_scc0 L_ok72
    s_cbranch_vccnz L_rt72
    s_branch L_ok72
L_rt73:
    s_add_u32 s93, s77, 32768
    buffer_load_dwordx4 v[116:119], v19, s[12:15], s93 offen offset:1024 sc1
    buffer_load_dwordx4 v[120:123], v19, s[12:15], s93 offen offset:2048 sc1
    buffer_load_dwordx4 v[124:127], v19, s[12:15], s93 offen offset:3072 sc1
    s_addk_i32 s94, 1
    s_cmpk_lt_u32 s94, 0xffff
    s_waitcnt vmcnt(0)
    v_max3_u32 v14, v116, v117, v118
    v_max_u32 v14, v14, v119
    v_cmp_eq_u32 vcc, -1, v14
    s_cbranch_scc0 L_ok73
    s_cbranch_vccnz L_rt73
    s_branch L_ok73
L_rt74:
    s_add_u32 s93, s77, 32768
    buffer_load_dwordx4 v[120:123], v19, s[12:15], s93 offen offset:2048 sc1
    buffer_load_dwordx4 v[124:127], v19, s[12:15], s93 offen offset:3072 sc1
    s_addk_i32 s94, 1
    s_cmpk_lt_u32 s94, 0xffff
    s_waitcnt vmcnt(0)
    v_max3_u32 v14, v120, v121, v122
    v_max_u32 v14, v14, v123
    v_cmp_eq_u32 vcc, -1, v14
    s_cbranch_scc0 L_ok74
    s_cbranch_vccnz L_rt74
    s_branch L_ok74
L_rt75:
    s_add_u32 s93, s77, 32768
    buffer_load_dwordx4 v[124:127], v19, s[12:15], s93 offen offset:3072 sc1
    s_addk_i32 s94, 1
    s_cmpk_lt_u32 s94, 0xffff
    s_waitcnt vmcnt(0)
    v_max3_u32 v14, v124, v125, v126
    v_max_u32 v14, v14, v127
    v_cmp_eq_u32 vcc, -1, v14
    s_cbranch_scc0 L_ok75
    s_cbranch_vccnz L_rt75
    s_branch L_ok75
L_rt76:
    s_add_u32 s93, s77, 49152
    buffer_load_dwordx4 v[128:131], v19, s[12:15], s93 offen offset:0 sc1
    buffer_load_dwordx4 v[132:135], v19, s[12:15], s93 offen offset:1024 sc1
    buffer_load_dwordx4 v[136:139], v19, s[12:15], s93 offen offset:2048 sc1
    buffer_load_dwordx4 v[4:7], v19, s[12:15], s93 offen offset:3072 sc1
    s_addk_i32 s94, 1
    s_cmpk_lt_u32 s94, 0xffff
    s_waitcnt vmcnt(0)
    v_max3_u32 v14, v128, v129, v130
    v_max_u32 v14, v14, v131
    v_cmp_eq_u32 vcc, -1, v14
    s_cbranch_scc0 L_ok76
    s_cbranch_vccnz L_rt76
    s_branch L_ok76
L_rt77:
    s_add_u32 s93, s77, 49152
    buffer_load_dwordx4 v[132:135], v19, s[12:15], s93 offen offset:1024 sc1
    buffer_load_dwordx4 v[136:139], v19, s[12:15], s93 offen offset:2048 sc1
    buffer_load_dwordx4 v[4:7], v19, s[12:15], s93 offen offset:3072 sc1
    s_addk_i32 s94, 1
    s_cmpk_lt_u32 s94, 0xffff
    s_waitcnt vmcnt(0)
    v_max3_u32 v14, v132, v133, v134
    v_max_u32 v14, v14, v135
    v_cmp_eq_u32 vcc, -1, v14
    s_cbranch_scc0 L_ok77
    s_cbranch_vccnz L_rt77
    s_branch L_ok77
L_rt78:
    s_add_u32 s93, s77, 49152
    buffer_load_dwordx4 v[136:139], v19, s[12:15], s93 offen offset:2048 sc1
    buffer_load_dwordx4 v[4:7], v19, s[12:15], s93 offen offset:3072 sc1
    s_addk_i32 s94, 1
    s_cmpk_lt_u32 s94, 0xffff
    s_waitcnt vmcnt(0)
    v_max3_u32 v14, v136, v137, v138
    v_max_u32 v14, v14, v139
    v_cmp_eq_u32 vcc, -1, v14
    s_cbranch_scc0 L_ok78
    s_cbranch_vccnz L_rt78
    s_branch L_ok78
L_rt79:
    s_add_u32 s93, s77, 49152
    buffer_load_dwordx4 v[4:7], v19, s[12:15], s93 offen offset:3072 sc1
    s_addk_i32 s94, 1
    s_cmpk_lt_u32 s94, 0xffff
    s_waitcnt vmcnt(0)
    v_max3_u32 v14, v4, v5, v6
    v_max_u32 v14, v14, v7
    v_cmp_eq_u32 vcc, -1, v14
    s_cbranch_scc0 L_ok79
    s_cbranch_vccnz L_rt79
    s_branch L_ok79
L_rt80:
    s_add_u32 s93, s77, 65536
    buffer_load_dwordx4 v[104:107], v19, s[12:15], s93 offen offset:0 sc1
    buffer_load_dwordx4 v[108:111], v19, s[12:15], s93 offen offset:1024 sc1
    buffer_load_dwordx4 v[112:115], v19, s[12:15], s93 offen offset:2048 sc1
    buffer_load_dwordx4 v[116:119], v19, s[12:15], s93 offen offset:3072 sc1
    s_addk_i32 s94, 1
    s_cmpk_lt_u32 s94, 0xffff
    s_waitcnt vmcnt(0)
    v_max3_u32 v14, v104, v105, v106
    v_max_u32 v14, v14, v107
    v_cmp_eq_u32 vcc, -1, v14
    s_cbranch_scc0 L_ok80
    s_cbranch_vccnz L_rt80
    s_branch L_ok80
L_rt81:
    s_add_u32 s93, s77, 65536
    buffer_load_dwordx4 v[108:111], v19, s[12:15], s93 offen offset:1024 sc1
    buffer_load_dwordx4 v[112:115], v19, s[12:15], s93 offen offset:2048 sc1
    buffer_load_dwordx4 v[116:119], v19, s[12:15], s93 offen offset:3072 sc1
    s_addk_i32 s94, 1
    s_cmpk_lt_u32 s94, 0xffff
    s_waitcnt vmcnt(0)
    v_max3_u32 v14, v108, v109, v110
    v_max_u32 v14, v14, v111
    v_cmp_eq_u32 vcc, -1, v14
    s_cbranch_scc0 L_ok81
    s_cbranch_vccnz L_rt81
    s_branch L_ok81
L_rt82:
    s_add_u32 s93, s77, 65536
    buffer_load_dwordx4 v[112:115], v19, s[12:15], s93 offen offset:2048 sc1
    buffer_load_dwordx4 v[116:119], v19, s[12:15], s93 offen offset:3072 sc1
    s_addk_i32 s94, 1
    s_cmpk_lt_u32 s94, 0xffff
    s_waitcnt vmcnt(0)
    v_max3_u32 v14, v112, v113, v114
    v_max_u32 v14, v14, v115
    v_cmp_eq_u32 vcc, -1, v14
    s_cbranch_scc0 L_ok82
    s_cbranch_vccnz L_rt82
    s_branch L_ok82
L_rt83:
    s_add_u32 s93, s77, 65536
    buffer_load_dwordx4 v[116:119], v19, s[12:15], s93 offen offset:3072 sc1
    s_addk_i32 s94, 1
    s_cmpk_lt_u32 s94, 0xffff
    s_waitcnt vmcnt(0)
    v_max3_u32 v14, v116, v117, v118
    v_max_u32 v14, v14, v119
    v_cmp_eq_u32 vcc, -1, v14
    s_cbranch_scc0 L_ok83
    s_cbranch_vccnz L_rt83
    s_branch L_ok83
L_rt84:
    s_add_u32 s93, s77, 81920
    buffer_load_dwordx4 v[120:123], v19, s[12:15], s93 offen offset:0 sc1
    buffer_load_dwordx4 v[124:127], v19, s[12:15], s93 offen offset:1024 sc1
    buffer_load_dwordx4 v[128:131], v19, s[12:15], s93 offen offset:2048 sc1
    buffer_load_dwordx4 v[132:135], v19, s[12:15], s93 offen offset:3072 sc1
    s_addk_i32 s94, 1
    s_cmpk_lt_u32 s94, 0xffff
    s_waitcnt vmcnt(0)
    v_max3_u32 v14, v120, v121, v122
    v_max_u32 v14, v14, v123
    v_cmp_eq_u32 vcc, -1, v14
    s_cbranch_scc0 L_ok84
    s_cbranch_vccnz L_rt84
    s_branch L_ok84
L_rt85:
    s_add_u32 s93, s77, 81920
    buffer_load_dwordx4 v[124:127], v19, s[12:15], s93 offen offset:1024 sc1
    buffer_load_dwordx4 v[128:131], v19, s[12:15], s93 offen offset:2048 sc1
    buffer_load_dwordx4 v[132:135], v19, s[12:15], s93 offen offset:3072 sc1
    s_addk_i32 s94, 1
    s_cmpk_lt_u32 s94, 0xffff
    s_waitcnt vmcnt(0)
    v_max3_u32 v14, v124, v125, v126
    v_max_u32 v14, v14, v127
    v_cmp_eq_u32 vcc, -1, v14
    s_cbranch_scc0 L_ok85
    s_cbranch_vccnz L_rt85
    s_branch L_ok85
L_rt86:
    s_add_u32 s93, s77, 81920
    buffer_load_dwordx4 v[128:131], v19, s[12:15], s93 offen offset:2048 sc1
    buffer_load_dwordx4 v[132:135], v19, s[12:15], s93 offen offset:3072 sc1
    s_addk_i32 s94, 1
    s_cmpk_lt_u32 s94, 0xffff
    s_waitcnt vmcnt(0)
    v_max3_u32 v14, v128, v129, v130
    v_max_u32 v14, v14, v131
    v_cmp_eq_u32 vcc, -1, v14
    s_cbranch_scc0 L_ok86
    s_cbranch_vccnz L_rt86
    s_branch L_ok86
L_rt87:
    s_add_u32 s93, s77, 81920
    buffer_load_dwordx4 v[132:135], v19, s[12:15], s93 offen offset:3072 sc1
    s_addk_i32 s94, 1
    s_cmpk_lt_u32 s94, 0xffff
    s_waitcnt vmcnt(0)
    v_max3_u32 v14, v132, v133, v134
    v_max_u32 v14, v14, v135
    v_cmp_eq_u32 vcc, -1, v14
    s_cbranch_scc0 L_ok87
    s_cbranch_vccnz L_rt87
    s_branch L_ok87
L_rt88:
    s_add_u32 s93, s77, 98304
    buffer_load_dwordx4 v[136:139], v19, s[12:15], s93 offen offset:0 sc1
    buffer_load_dwordx4 v[4:7], v19, s[12:15], s93 offen offset:1024 sc1
    buffer_load_dwordx4 v[104:107], v19, s[12:15], s93 offen offset:2048 sc1
    buffer_load_dwordx4 v[108:111], v19, s[12:15], s93 offen offset:3072 sc1
    s_addk_i32 s94, 1
    s_cmpk_lt_u32 s94, 0xffff
    s_waitcnt vmcnt(0)
    v_max3_u32 v14, v136, v137, v138
    v_max_u32 v14, v14, v139
    v_cmp_eq_u32 vcc, -1, v14
    s_cbranch_scc0 L_ok88
    s_cbranch_vccnz L_rt88
    s_branch L_ok88
L_rt89:
    s_add_u32 s93, s77, 98304
    buffer_load_dwordx4 v[4:7], v19, s[12:15], s93 offen offset:1024 sc1
    buffer_load_dwordx4 v[104:107], v19, s[12:15], s93 offen offset:2048 sc1
    buffer_load_dwordx4 v[108:111], v19, s[12:15], s93 offen offset:3072 sc1
    s_addk_i32 s94, 1
    s_cmpk_lt_u32 s94, 0xffff
    s_waitcnt vmcnt(0)
    v_max3_u32 v14, v4, v5, v6
    v_max_u32 v14, v14, v7
    v_cmp_eq_u32 vcc, -1, v14
    s_cbranch_scc0 L_ok89
    s_cbranch_vccnz L_rt89
    s_branch L_ok89
L_rt90:
    s_add_u32 s93, s77, 98304
    buffer_load_dwordx4 v[104:107], v19, s[12:15], s93 offen offset:2048 sc1
    buffer_load_dwordx4 v[108:111], v19, s[12:15], s93 offen offset:3072 sc1
    s_addk_i32 s94, 1
    s_cmpk_lt_u32 s94, 0xffff
    s_waitcnt vmcnt(0)
    v_max3_u32 v14, v104, v105, v106
    v_max_u32 v14, v14, v107
    v_cmp_eq_u32 vcc, -1, v14
    s_cbranch_scc0 L_ok90
    s_cbranch_vccnz L_rt90
    s_branch L_ok90
L_rt91:
    s_add_u32 s93, s77, 98304
    buffer_load_dwordx4 v[108:111], v19, s[12:15], s93 offen offset:3072 sc1
    s_addk_i32 s94, 1
    s_cmpk_lt_u32 s94, 0xffff
    s_waitcnt vmcnt(0)
    v_max3_u32 v14, v108, v109, v110
    v_max_u32 v14, v14, v111
    v_cmp_eq_u32 vcc, -1, v14
    s_cbranch_scc0 L_ok91
    s_cbranch_vccnz L_rt91
    s_branch L_ok91
L_rt92:
    s_add_u32 s93, s77, 114688
    buffer_load_dwordx4 v[112:115], v19, s[12:15], s93 offen offset:0 sc1
    buffer_load_dwordx4 v[116:119], v19, s[12:15], s93 offen offset:1024 sc1
    buffer_load_dwordx4 v[120:123], v19, s[12:15], s93 offen offset:2048 sc1
    buffer_load_dwordx4 v[124:127], v19, s[12:15], s93 offen offset:3072 sc1
    s_addk_i32 s94, 1
    s_cmpk_lt_u32 s94, 0xffff
    s_waitcnt vmcnt(0)
    v_max3_u32 v14, v112, v113, v114
    v_max_u32 v14, v14, v115
    v_cmp_eq_u32 vcc, -1, v14
    s_cbranch_scc0 L_ok92
    s_cbranch_vccnz L_rt92
    s_branch L_ok92
L_rt93:
    s_add_u32 s93, s77, 114688
    buffer_load_dwordx4 v[116:119], v19, s[12:15], s93 offen offset:1024 sc1
    buffer_load_dwordx4 v[120:123], v19, s[12:15], s93 offen offset:2048 sc1
    buffer_load_dwordx4 v[124:127], v19, s[12:15], s93 offen offset:3072 sc1
    s_addk_i32 s94, 1
    s_cmpk_lt_u32 s94, 0xffff
    s_waitcnt vmcnt(0)
    v_max3_u32 v14, v116, v117, v118
    v_max_u32 v14, v14, v119
    v_cmp_eq_u32 vcc, -1, v14
    s_cbranch_scc0 L_ok93
    s_cbranch_vccnz L_rt93
    s_branch L_ok93
L_rt94:
    s_add_u32 s93, s77, 114688
    buffer_load_dwordx4 v[120:123], v19, s[12:15], s93 offen offset:2048 sc1
    buffer_load_dwordx4 v[124:127], v19, s[12:15], s93 offen offset:3072 sc1
    s_addk_i32 s94, 1
    s_cmpk_lt_u32 s94, 0xffff
    s_waitcnt vmcnt(0)
    v_max3_u32 v14, v120, v121, v122
    v_max_u32 v14, v14, v123
    v_cmp_eq_u32 vcc, -1, v14
    s_cbranch_scc0 L_ok94
    s_cbranch_vccnz L_rt94
    s_branch L_ok94
L_rt95:
    s_add_u32 s93, s77, 114688
    buffer_load_dwordx4 v[124:127], v19, s[12:15], s93 offen offset:3072 sc1
    s_addk_i32 s94, 1
    s_cmpk_lt_u32 s94, 0xffff
    s_waitcnt vmcnt(0)
    v_max3_u32 v14, v124, v125, v126
    v_max_u32 v14, v14, v127
    v_cmp_eq_u32 vcc, -1, v14
    s_cbranch_scc0 L_ok95
    s_cbranch_vccnz L_rt95
    s_branch L_ok95
L_rt96:
    s_add_u32 s93, s77, 131072
    buffer_load_dwordx4 v[128:131], v19, s[12:15], s93 offen offset:0 sc1
    buffer_load_dwordx4 v[132:135], v19, s[12:15], s93 offen offset:1024 sc1
    buffer_load_dwordx4 v[136:139], v19, s[12:15], s93 offen offset:2048 sc1
    buffer_load_dwordx4 v[4:7], v19, s[12:15], s93 offen offset:3072 sc1
    s_addk_i32 s94, 1
    s_cmpk_lt_u32 s94, 0xffff
    s_waitcnt vmcnt(0)
    v_max3_u32 v14, v128, v129, v130
    v_max_u32 v14, v14, v131
    v_cmp_eq_u32 vcc, -1, v14
    s_cbranch_scc0 L_ok96
    s_cbranch_vccnz L_rt96
    s_branch L_ok96
L_rt97:
    s_add_u32 s93, s77, 131072
    buffer_load_dwordx4 v[132:135], v19, s[12:15], s93 offen offset:1024 sc1
    buffer_load_dwordx4 v[136:139], v19, s[12:15], s93 offen offset:2048 sc1
    buffer_load_dwordx4 v[4:7], v19, s[12:15], s93 offen offset:3072 sc1
    s_addk_i32 s94, 1
    s_cmpk_lt_u32 s94, 0xffff
    s_waitcnt vmcnt(0)
    v_max3_u32 v14, v132, v133, v134
    v_max_u32 v14, v14, v135
    v_cmp_eq_u32 vcc, -1, v14
    s_cbranch_scc0 L_ok97
    s_cbranch_vccnz L_rt97
    s_branch L_ok97
L_rt98:
    s_add_u32 s93, s77, 131072
    buffer_load_dwordx4 v[136:139], v19, s[12:15], s93 offen offset:2048 sc1
    buffer_load_dwordx4 v[4:7], v19, s[12:15], s93 offen offset:3072 sc1
    s_addk_i32 s94, 1
    s_cmpk_lt_u32 s94, 0xffff
    s_waitcnt vmcnt(0)
    v_max3_u32 v14, v136, v137, v138
    v_max_u32 v14, v14, v139
    v_cmp_eq_u32 vcc, -1, v14
    s_cbranch_scc0 L_ok98
    s_cbranch_vccnz L_rt98
    s_branch L_ok98
L_rt99:
    s_add_u32 s93, s77, 131072
    buffer_load_dwordx4 v[4:7], v19, s[12:15], s93 offen offset:3072 sc1
    s_addk_i32 s94, 1
    s_cmpk_lt_u32 s94, 0xffff
    s_waitcnt vmcnt(0)
    v_max3_u32 v14, v4, v5, v6
    v_max_u32 v14, v14, v7
    v_cmp_eq_u32 vcc, -1, v14
    s_cbranch_scc0 L_ok99
    s_cbranch_vccnz L_rt99
    s_branch L_ok99
L_rt100:
    s_add_u32 s93, s77, 147456
    buffer_load_dwordx4 v[104:107], v19, s[12:15], s93 offen offset:0 sc1
    buffer_load_dwordx4 v[108:111], v19, s[12:15], s93 offen offset:1024 sc1
    buffer_load_dwordx4 v[112:115], v19, s[12:15], s93 offen offset:2048 sc1
    buffer_load_dwordx4 v[116:119], v19, s[12:15], s93 offen offset:3072 sc1
    s_addk_i32 s94, 1
    s_cmpk_lt_u32 s94, 0xffff
    s_waitcnt vmcnt(0)
    v_max3_u32 v14, v104, v105, v106
    v_max_u32 v14, v14, v107
    v_cmp_eq_u32 vcc, -1, v14
    s_cbranch_scc0 L_ok100
    s_cbranch_vccnz L_rt100
    s_branch L_ok100
L_rt101:
    s_add_u32 s93, s77, 147456
    buffer_load_dwordx4 v[108:111], v19, s[12:15], s93 offen offset:1024 sc1
    buffer_load_dwordx4 v[112:115], v19, s[12:15], s93 offen offset:2048 sc1
    buffer_load_dwordx4 v[116:119], v19, s[12:15], s93 offen offset:3072 sc1
    s_addk_i32 s94, 1
    s_cmpk_lt_u32 s94, 0xffff
    s_waitcnt vmcnt(0)
    v_max3_u32 v14, v108, v109, v110
    v_max_u32 v14, v14, v111
    v_cmp_eq_u32 vcc, -1, v14
    s_cbranch_scc0 L_ok101
    s_cbranch_vccnz L_rt101
    s_branch L_ok101
L_rt102:
    s_add_u32 s93, s77, 147456
    buffer_load_dwordx4 v[112:115], v19, s[12:15], s93 offen offset:2048 sc1
    buffer_load_dwordx4 v[116:119], v19, s[12:15], s93 offen offset:3072 sc1
    s_addk_i32 s94, 1
    s_cmpk_lt_u32 s94, 0xffff
    s_waitcnt vmcnt(0)
    v_max3_u32 v14, v112, v113, v114
    v_max_u32 v14, v14, v115
    v_cmp_eq_u32 vcc, -1, v14
    s_cbranch_scc0 L_ok102
    s_cbranch_vccnz L_rt102
    s_branch L_ok102
L_rt103:
    s_add_u32 s93, s77, 147456
    buffer_load_dwordx4 v[116:119], v19, s[12:15], s93 offen offset:3072 sc1
    s_addk_i32 s94, 1
    s_cmpk_lt_u32 s94, 0xffff
    s_waitcnt vmcnt(0)
    v_max3_u32 v14, v116, v117, v118
    v_max_u32 v14, v14, v119
    v_cmp_eq_u32 vcc, -1, v14
    s_cbranch_scc0 L_ok103
    s_cbranch_vccnz L_rt103
    s_branch L_ok103
L_rt104:
    s_add_u32 s93, s77, 163840
    buffer_load_dwordx4 v[120:123], v19, s[12:15], s93 offen offset:0 sc1
    buffer_load_dwordx4 v[124:127], v19, s[12:15], s93 offen offset:1024 sc1
    buffer_load_dwordx4 v[128:131], v19, s[12:15], s93 offen offset:2048 sc1
    buffer_load_dwordx4 v[132:135], v19, s[12:15], s93 offen offset:3072 sc1
    s_addk_i32 s94, 1
    s_cmpk_lt_u32 s94, 0xffff
    s_waitcnt vmcnt(0)
    v_max3_u32 v14, v120, v121, v122
    v_max_u32 v14, v14, v123
    v_cmp_eq_u32 vcc, -1, v14
    s_cbranch_scc0 L_ok104
    s_cbranch_vccnz L_rt104
    s_branch L_ok104
L_rt105:
    s_add_u32 s93, s77, 163840
    buffer_load_dwordx4 v[124:127], v19, s[12:15], s93 offen offset:1024 sc1
    buffer_load_dwordx4 v[128:131], v19, s[12:15], s93 offen offset:2048 sc1
    buffer_load_dwordx4 v[132:135], v19, s[12:15], s93 offen offset:3072 sc1
    s_addk_i32 s94, 1
    s_cmpk_lt_u32 s94, 0xffff
    s_waitcnt vmcnt(0)
    v_max3_u32 v14, v124, v125, v126
    v_max_u32 v14, v14, v127
    v_cmp_eq_u32 vcc, -1, v14
    s_cbranch_scc0 L_ok105
    s_cbranch_vccnz L_rt105
    s_branch L_ok105
L_rt106:
    s_add_u32 s93, s77, 163840
    buffer_load_dwordx4 v[128:131], v19, s[12:15], s93 offen offset:2048 sc1
    buffer_load_dwordx4 v[132:135], v19, s[12:15], s93 offen offset:3072 sc1
    s_addk_i32 s94, 1
    s_cmpk_lt_u32 s94, 0xffff
    s_waitcnt vmcnt(0)
    v_max3_u32 v14, v128, v129, v130
    v_max_u32 v14, v14, v131
    v_cmp_eq_u32 vcc, -1, v14
    s_cbranch_scc0 L_ok106
    s_cbranch_vccnz L_rt106
    s_branch L_ok106
L_rt107:
    s_add_u32 s93, s77, 163840
    buffer_load_dwordx4 v[132:135], v19, s[12:15], s93 offen offset:3072 sc1
    s_addk_i32 s94, 1
    s_cmpk_lt_u32 s94, 0xffff
    s_waitcnt vmcnt(0)
    v_max3_u32 v14, v132, v133, v134
    v_max_u32 v14, v14, v135
    v_cmp_eq_u32 vcc, -1, v14
    s_cbranch_scc0 L_ok107
    s_cbranch_vccnz L_rt107
    s_branch L_ok107
L_rt108:
    s_add_u32 s93, s77, 180224
    buffer_load_dwordx4 v[136:139], v19, s[12:15], s93 offen offset:0 sc1
    buffer_load_dwordx4 v[4:7], v19, s[12:15], s93 offen offset:1024 sc1
    buffer_load_dwordx4 v[104:107], v19, s[12:15], s93 offen offset:2048 sc1
    buffer_load_dwordx4 v[108:111], v19, s[12:15], s93 offen offset:3072 sc1
    s_addk_i32 s94, 1
    s_cmpk_lt_u32 s94, 0xffff
    s_waitcnt vmcnt(0)
    v_max3_u32 v14, v136, v137, v138
    v_max_u32 v14, v14, v139
    v_cmp_eq_u32 vcc, -1, v14
    s_cbranch_scc0 L_ok108
    s_cbranch_vccnz L_rt108
    s_branch L_ok108
L_rt109:
    s_add_u32 s93, s77, 180224
    buffer_load_dwordx4 v[4:7], v19, s[12:15], s93 offen offset:1024 sc1
    buffer_load_dwordx4 v[104:107], v19, s[12:15], s93 offen offset:2048 sc1
    buffer_load_dwordx4 v[108:111], v19, s[12:15], s93 offen offset:3072 sc1
    s_addk_i32 s94, 1
    s_cmpk_lt_u32 s94, 0xffff
    s_waitcnt vmcnt(0)
    v_max3_u32 v14, v4, v5, v6
    v_max_u32 v14, v14, v7
    v_cmp_eq_u32 vcc, -1, v14
    s_cbranch_scc0 L_ok109
    s_cbranch_vccnz L_rt109
    s_branch L_ok109
L_rt110:
    s_add_u32 s93, s77, 180224
    buffer_load_dwordx4 v[104:107], v19, s[12:15], s93 offen offset:2048 sc1
    buffer_load_dwordx4 v[108:111], v19, s[12:15], s93 offen offset:3072 sc1
    s_addk_i32 s94, 1
    s_cmpk_lt_u32 s94, 0xffff
    s_waitcnt vmcnt(0)
    v_max3_u32 v14, v104, v105, v106
    v_max_u32 v14, v14, v107
    v_cmp_eq_u32 vcc, -1, v14
    s_cbranch_scc0 L_ok110
    s_cbranch_vccnz L_rt110
    s_branch L_ok110
L_rt111:
    s_add_u32 s93, s77, 180224
    buffer_load_dwordx4 v[108:111], v19, s[12:15], s93 offen offset:3072 sc1
    s_addk_i32 s94, 1
    s_cmpk_lt_u32 s94, 0xffff
    s_waitcnt vmcnt(0)
    v_max3_u32 v14, v108, v109, v110
    v_max_u32 v14, v14, v111
    v_cmp_eq_u32 vcc, -1, v14
    s_cbranch_scc0 L_ok111
    s_cbranch_vccnz L_rt111
    s_branch L_ok111
L_rt112:
    s_add_u32 s93, s77, 196608
    buffer_load_dwordx4 v[112:115], v19, s[12:15], s93 offen offset:0 sc1
    buffer_load_dwordx4 v[116:119], v19, s[12:15], s93 offen offset:1024 sc1
    buffer_load_dwordx4 v[120:123], v19, s[12:15], s93 offen offset:2048 sc1
    buffer_load_dwordx4 v[124:127], v19, s[12:15], s93 offen offset:3072 sc1
    s_addk_i32 s94, 1
    s_cmpk_lt_u32 s94, 0xffff
    s_waitcnt vmcnt(0)
    v_max3_u32 v14, v112, v113, v114
    v_max_u32 v14, v14, v115
    v_cmp_eq_u32 vcc, -1, v14
    s_cbranch_scc0 L_ok112
    s_cbranch_vccnz L_rt112
    s_branch L_ok112
L_rt113:
    s_add_u32 s93, s77, 196608
    buffer_load_dwordx4 v[116:119], v19, s[12:15], s93 offen offset:1024 sc1
    buffer_load_dwordx4 v[120:123], v19, s[12:15], s93 offen offset:2048 sc1
    buffer_load_dwordx4 v[124:127], v19, s[12:15], s93 offen offset:3072 sc1
    s_addk_i32 s94, 1
    s_cmpk_lt_u32 s94, 0xffff
    s_waitcnt vmcnt(0)
    v_max3_u32 v14, v116, v117, v118
    v_max_u32 v14, v14, v119
    v_cmp_eq_u32 vcc, -1, v14
    s_cbranch_scc0 L_ok113
    s_cbranch_vccnz L_rt113
    s_branch L_ok113
L_rt114:
    s_add_u32 s93, s77, 196608
    buffer_load_dwordx4 v[120:123], v19, s[12:15], s93 offen offset:2048 sc1
    buffer_load_dwordx4 v[124:127], v19, s[12:15], s93 offen offset:3072 sc1
    s_addk_i32 s94, 1
    s_cmpk_lt_u32 s94, 0xffff
    s_waitcnt vmcnt(0)
    v_max3_u32 v14, v120, v121, v122
    v_max_u32 v14, v14, v123
    v_cmp_eq_u32 vcc, -1, v14
    s_cbranch_scc0 L_ok114
    s_cbranch_vccnz L_rt114
    s_branch L_ok114
L_rt115:
    s_add_u32 s93, s77, 196608
    buffer_load_dwordx4 v[124:127], v19, s[12:15], s93 offen offset:3072 sc1
    s_addk_i32 s94, 1
    s_cmpk_lt_u32 s94, 0xffff
    s_waitcnt vmcnt(0)
    v_max3_u32 v14, v124, v125, v126
    v_max_u32 v14, v14, v127
    v_cmp_eq_u32 vcc, -1, v14
    s_cbranch_scc0 L_ok115
    s_cbranch_vccnz L_rt115
    s_branch L_ok115
L_rt116:
    s_add_u32 s93, s77, 212992
    buffer_load_dwordx4 v[128:131], v19, s[12:15], s93 offen offset:0 sc1
    buffer_load_dwordx4 v[132:135], v19, s[12:15], s93 offen offset:1024 sc1
    buffer_load_dwordx4 v[136:139], v19, s[12:15], s93 offen offset:2048 sc1
    buffer_load_dwordx4 v[4:7], v19, s[12:15], s93 offen offset:3072 sc1
    s_addk_i32 s94, 1
    s_cmpk_lt_u32 s94, 0xffff
    s_waitcnt vmcnt(0)
    v_max3_u32 v14, v128, v129, v130
    v_max_u32 v14, v14, v131
    v_cmp_eq_u32 vcc, -1, v14
    s_cbranch_scc0 L_ok116
    s_cbranch_vccnz L_rt116
    s_branch L_ok116
L_rt117:
    s_add_u32 s93, s77, 212992
    buffer_load_dwordx4 v[132:135], v19, s[12:15], s93 offen offset:1024 sc1
    buffer_load_dwordx4 v[136:139], v19, s[12:15], s93 offen offset:2048 sc1
    buffer_load_dwordx4 v[4:7], v19, s[12:15], s93 offen offset:3072 sc1
    s_addk_i32 s94, 1
    s_cmpk_lt_u32 s94, 0xffff
    s_waitcnt vmcnt(0)
    v_max3_u32 v14, v132, v133, v134
    v_max_u32 v14, v14, v135
    v_cmp_eq_u32 vcc, -1, v14
    s_cbranch_scc0 L_ok117
    s_cbranch_vccnz L_rt117
    s_branch L_ok117
L_rt118:
    s_add_u32 s93, s77, 212992
    buffer_load_dwordx4 v[136:139], v19, s[12:15], s93 offen offset:2048 sc1
    buffer_load_dwordx4 v[4:7], v19, s[12:15], s93 offen offset:3072 sc1
    s_addk_i32 s94, 1
    s_cmpk_lt_u32 s94, 0xffff
    s_waitcnt vmcnt(0)
    v_max3_u32 v14, v136, v137, v138
    v_max_u32 v14, v14, v139
    v_cmp_eq_u32 vcc, -1, v14
    s_cbranch_scc0 L_ok118
    s_cbranch_vccnz L_rt118
    s_branch L_ok118
L_rt119:
    s_add_u32 s93, s77, 212992
    buffer_load_dwordx4 v[4:7], v19, s[12:15], s93 offen offset:3072 sc1
    s_addk_i32 s94, 1
    s_cmpk_lt_u32 s94, 0xffff
    s_waitcnt vmcnt(0)
    v_max3_u32 v14, v4, v5, v6
    v_max_u32 v14, v14, v7
    v_cmp_eq_u32 vcc, -1, v14
    s_cbranch_scc0 L_ok119
    s_cbranch_vccnz L_rt119
    s_branch L_ok119
L_kb_end:
    s_endpgm
.section .rodata,"a"
.p2align 6
.amdhsa_kernel interleave_layers__softmax_full_mha__mixer_token_mlp__prompt_kernel
  .amdhsa_next_free_vgpr 512
  .amdhsa_next_free_sgpr 102
  .amdhsa_accum_offset 256
  .amdhsa_group_segment_fixed_size 0
  .amdhsa_kernarg_size 88
  .amdhsa_user_sgpr_count 2
  .amdhsa_user_sgpr_kernarg_segment_ptr 1
  .amdhsa_system_sgpr_workgroup_id_x 1
  .amdhsa_float_denorm_mode_32 3
.end_amdhsa_kernel
```
